```python
import torch

def _softmax(x, axis=-1):
    return torch.softmax(x, dim=axis)

def _gelu(x):
    return torch.nn.functional.gelu(x, approximate='tanh')

def _silu(x):
    return torch.nn.functional.silu(x)

def _sigmoid(x):
    return torch.sigmoid(x)

def _layernorm(x, axis=-1, eps=1e-05):
    m = x.mean(dim=axis, keepdim=True)
    v = x.var(dim=axis, keepdim=True, unbiased=False)
    return (x - m) / torch.sqrt(v + eps)

def _scatter_add(tgt, idx, src, axis=0):
    return tgt.clone().index_add_(axis, idx, src)

def _segment_sum(src, seg, n):
    out = torch.zeros((n,) + src.shape[1:], dtype=src.dtype)
    return out.index_add_(0, seg, src)

def _pad(x, pw):
    flat = tuple((v for pair in reversed(pw) for v in pair))
    return torch.nn.functional.pad(x, flat)
kernel_name = 'interleave_layers__memory_aug_recurrent_mem_tr__mixer_token_mlp__prompt'

def setup_inputs():

    _w = lambda a: (lambda t: t.to(torch.bfloat16) if t.is_floating_point() else t)(torch.as_tensor(a))

    def _A_setup():
        B, S, Dm = (1, 2048, 640)
        H, Dh = (32, 128)
        M, seg = (8, 32)
        seg = min(seg, S)
        S = S // seg * seg
        return {'x': _w((lambda *s: torch.randn(*s, dtype=torch.bfloat16) * 0.05)(B, S, Dm)), 'mem0': _w((lambda *s: torch.randn(*s, dtype=torch.bfloat16) * 0.2)(B, M, Dm)), 'Wq': _w((lambda *s: torch.randn(*s, dtype=torch.bfloat16) * 0.8)(Dm, H, Dh) * Dm ** (-0.5)), 'Wk': _w((lambda *s: torch.randn(*s, dtype=torch.bfloat16) * 0.8)(Dm, H, Dh) * Dm ** (-0.5)), 'Wv': _w((lambda *s: torch.randn(*s, dtype=torch.bfloat16) * 0.2)(Dm, H, Dh) * Dm ** (-0.5)), 'Wo': _w((lambda *s: torch.randn(*s, dtype=torch.bfloat16) * 0.2)(H, Dh, Dm) * (H * Dh) ** (-0.5)), 'seg_len': seg}
    _A_in = _A_setup()

    def _B_setup():
        B, S, D, F = (1, 2048, 640, 1728)
        return {'x': _w((lambda *s: torch.randn(*s, dtype=torch.bfloat16) * 0.05)(B, S, D)), 'w1': _w((lambda *s: torch.randn(*s, dtype=torch.bfloat16) * 0.2)(S, F) * S ** (-0.5)), 'b1': _w((lambda *s: torch.randn(*s, dtype=torch.bfloat16) * 3.2)(F) * 0.02), 'w2': _w((lambda *s: torch.randn(*s, dtype=torch.bfloat16) * 0.1)(F, S) * F ** (-0.5)), 'b2': _w((lambda *s: torch.randn(*s, dtype=torch.bfloat16) * 0.2)(S) * 0.02)}
    _B_in = _B_setup()
    return {'A_x': _A_in['x'], 'A_mem0': _A_in['mem0'], 'A_Wq': _A_in['Wq'], 'A_Wk': _A_in['Wk'], 'A_Wv': _A_in['Wv'], 'A_Wo': _A_in['Wo'], 'A_seg_len': _A_in['seg_len'], 'B_x': _B_in['x'], 'B_w1': _B_in['w1'], 'B_b1': _B_in['b1'], 'B_w2': _B_in['w2'], 'B_b2': _B_in['b2']}

def reference(A_x, A_mem0, A_Wq, A_Wk, A_Wv, A_Wo, A_seg_len, B_x, B_w1, B_b1, B_w2, B_b2):

    def _A_ref(x, mem0, Wq, Wk, Wv, Wo, seg_len):
        B, S, Dm = x.shape
        H, Dh = (Wq.shape[1], Wq.shape[2])
        M = mem0.shape[1]
        scale = Dh ** (-0.5)
        n_seg = S // seg_len
        L = M + seg_len
        idx = torch.arange(L)
        mask = (idx[:, None] < M) | (idx[:, None] >= idx[None, :])
        mem = mem0
        outs = []
        for s in range(n_seg):
            xs = x[:, s * seg_len:(s + 1) * seg_len, :].clone()
            h = torch.concatenate([mem, xs], axis=1)
            q = torch.einsum('btd,dhe->bhte', h, Wq)
            k = torch.einsum('btd,dhe->bhte', h, Wk)
            v = torch.einsum('btd,dhe->bhte', h, Wv)
            scores = torch.einsum('bhqe,bhke->bhqk', q, k) * scale
            scores = torch.where(mask[None, None], scores, -1000000000.0)
            p = _softmax(scores, axis=-1)
            o = torch.einsum('bhqk,bhke->bhqe', p, v)
            o = torch.einsum('bhte,hed->btd', o, Wo)
            mem = o[:, :M, :].clone()
            outs.append(o[:, M:, :])
        return torch.concatenate(outs, axis=1)

    def _B_ref(x, w1, b1, w2, b2):
        B, S, D = x.shape
        h = _layernorm(x, axis=-1)
        u = torch.einsum('bsd,sf->bdf', h, w1) + b1
        u = _gelu(u)
        y = torch.einsum('bdf,fs->bds', u, w2) + b2
        return (lambda x, *d: x.permute(*d))(y, 0, 2, 1)
    x = A_x
    x = x + _A_ref(_layernorm(x, axis=-1), A_mem0, A_Wq, A_Wk, A_Wv, A_Wo, A_seg_len)
    x = x + _B_ref(_layernorm(x, axis=-1), B_w1, B_b1, B_w2, B_b2)
    x = x + _A_ref(_layernorm(x, axis=-1), A_mem0, A_Wq, A_Wk, A_Wv, A_Wo, A_seg_len)
    x = x + _B_ref(_layernorm(x, axis=-1), B_w1, B_b1, B_w2, B_b2)
    return x
```

```asm
; @launch kernel=interleave_layers__memory_aug_recurrent_mem_tr__mixer_token_mlp__prompt_kernel grid=(256,1,1) block=(256,1,1) lds=163840
.amdgcn_target "amdgcn-amd-amdhsa--gfx950"
.text
  .globl interleave_layers__memory_aug_recurrent_mem_tr__mixer_token_mlp__prompt_kernel
  .p2align 8
  .type interleave_layers__memory_aug_recurrent_mem_tr__mixer_token_mlp__prompt_kernel,@function
interleave_layers__memory_aug_recurrent_mem_tr__mixer_token_mlp__prompt_kernel:
  s_cmp_lt_u32 s2, 256
  s_cbranch_scc1 mk_go
  s_endpgm
mk_go:
  s_load_dwordx8 s[56:63], s[0:1], 16
  s_load_dwordx4 s[64:67], s[0:1], 0
  s_load_dwordx4 s[72:75], s[0:1], 104
  s_load_dwordx8 s[40:47], s[0:1], 64
  s_load_dwordx2 s[48:49], s[0:1], 96
  s_getpc_b64 s[96:97]
mk_pc:
  s_waitcnt lgkmcnt(0)
  s_mov_b32 s0, 0
  s_mov_b32 s4, s74
  s_and_b32 s5, s75, 0xffff
  s_mov_b32 s6, 268435456
  s_mov_b32 s7, 0x00020000
  s_mov_b32 s76, s72
  s_and_b32 s77, s73, 0xffff
  s_mov_b32 s78, 256
  s_mov_b32 s79, 0x00020000
  s_getreg_b32 s80, hwreg(HW_REG_XCC_ID)
  s_and_b32 s80, s80, 7
  v_lshrrev_b32 v1, 6, v0
  s_nop 0
  v_readfirstlane_b32 s92, v1
  s_nop 0
  s_cmp_lg_u32 s92, 0
  s_cbranch_scc1 Lts_1_bar
  s_lshl_b32 s94, s80, 2
  s_cmp_eq_u32 s80, 0
  s_cselect_b32 s94, 128, s94
  s_mov_b64 exec, 1
  v_mov_b32 v2, 1
  buffer_atomic_add v2, off, s[76:79], s94 sc0
  s_mov_b64 exec, -1
  v_lshlrev_b32 v1, 2, v0
  v_mov_b32 v3, 128
  v_cmp_eq_u32 vcc, 0, v0
  s_nop 1
  v_cndmask_b32 v1, v1, v3, vcc
  s_waitcnt vmcnt(0)
  v_readfirstlane_b32 s81, v2
  s_mov_b32 s94, 0
Lts_1_poll:
  buffer_load_dword v2, v1, s[76:79], 0 offen sc1
  s_waitcnt vmcnt(0)
  v_readlane_b32 s84, v2, 0
  v_readlane_b32 s85, v2, 1
  v_readlane_b32 s86, v2, 2
  v_readlane_b32 s87, v2, 3
  v_readlane_b32 s88, v2, 4
  v_readlane_b32 s89, v2, 5
  v_readlane_b32 s90, v2, 6
  v_readlane_b32 s91, v2, 7
  s_cmp_ge_u32 s84, 32
  s_cselect_b32 s92, s80, 1
  s_cmp_lt_u32 s81, 32
  s_cselect_b32 s92, s92, 1
  s_mov_b32 s82, 1
  s_mov_b32 s83, s81
  s_cmp_eq_u32 s92, 0
  s_cbranch_scc1 Lts_1_done
  s_add_u32 s92, s84, s85
  s_add_u32 s92, s92, s86
  s_add_u32 s92, s92, s87
  s_add_u32 s92, s92, s88
  s_add_u32 s92, s92, s89
  s_add_u32 s92, s92, s90
  s_add_u32 s92, s92, s91
  s_add_u32 s94, s94, 1
  s_cmp_gt_u32 s94, 0x100000
  s_cbranch_scc1 Lts_1_go
  s_cmp_ge_u32 s92, 256
  s_cbranch_scc1 Lts_1_go
  s_sleep 2
  s_branch Lts_1_poll
Lts_1_go:
  s_mov_b32 s92, 8
  s_cmp_ge_u32 s91, 32
  s_cselect_b32 s92, 7, s92
  s_cmp_ge_u32 s90, 32
  s_cselect_b32 s92, 6, s92
  s_cmp_ge_u32 s89, 32
  s_cselect_b32 s92, 5, s92
  s_cmp_ge_u32 s88, 32
  s_cselect_b32 s92, 4, s92
  s_cmp_ge_u32 s87, 32
  s_cselect_b32 s92, 3, s92
  s_cmp_ge_u32 s86, 32
  s_cselect_b32 s92, 2, s92
  s_cmp_ge_u32 s85, 32
  s_cselect_b32 s92, 1, s92
  s_cmp_ge_u32 s84, 32
  s_cselect_b32 s92, 0, s92
  s_mov_b32 s83, s81
  s_cmp_gt_u32 s80, 0
  s_cselect_b32 s94, s84, 0
  s_add_u32 s83, s83, s94
  s_cmp_gt_u32 s80, 1
  s_cselect_b32 s94, s85, 0
  s_add_u32 s83, s83, s94
  s_cmp_gt_u32 s80, 2
  s_cselect_b32 s94, s86, 0
  s_add_u32 s83, s83, s94
  s_cmp_gt_u32 s80, 3
  s_cselect_b32 s94, s87, 0
  s_add_u32 s83, s83, s94
  s_cmp_gt_u32 s80, 4
  s_cselect_b32 s94, s88, 0
  s_add_u32 s83, s83, s94
  s_cmp_gt_u32 s80, 5
  s_cselect_b32 s94, s89, 0
  s_add_u32 s83, s83, s94
  s_cmp_gt_u32 s80, 6
  s_cselect_b32 s94, s90, 0
  s_add_u32 s83, s83, s94
  s_cmp_eq_u32 s92, 8
  s_cbranch_scc1 Lts_1_slow
  s_mov_b32 s82, 0
  s_cmp_ge_u32 s80, s92
  s_cselect_b32 s94, 32, 0
  s_sub_u32 s83, s83, s94
  s_cmp_lg_u32 s80, s92
  s_cbranch_scc1 Lts_1_done
  s_cmp_ge_u32 s81, 32
  s_cbranch_scc1 Lts_1_done
  s_mov_b32 s82, 1
  s_mov_b32 s83, s81
  s_branch Lts_1_done
Lts_1_slow:
  s_mov_b32 s82, 2
  s_cmp_lt_u32 s83, 32
  s_cbranch_scc1 Lts_1_done
  s_mov_b32 s82, 0
  s_sub_u32 s83, s83, 32
Lts_1_done:
  v_mov_b32 v4, s82
  v_mov_b32 v5, s83
  v_mov_b32 v6, s81
  v_mov_b32 v7, 0
  ds_write_b128 v7, v[4:7]
  s_waitcnt lgkmcnt(0)
Lts_1_bar:
  s_barrier
  v_mov_b32 v3, 0
  ds_read_b128 v[4:7], v3
  s_waitcnt lgkmcnt(0)
  v_readfirstlane_b32 s82, v4
  v_readfirstlane_b32 s83, v5
  v_readfirstlane_b32 s81, v6
  s_barrier
  s_cmp_eq_u32 s82, 0
  s_cbranch_scc1 mk_worker
  s_mov_b32 s12, s83
  v_lshrrev_b32 v15, 6, v0
  v_and_b32 v14, 63, v0
  v_readfirstlane_b32 s13, v15
  v_lshrrev_b32 v12, 4, v14
  v_and_b32 v13, 15, v14
  v_lshlrev_b32 v1, 4, v14
  v_mov_b32 v15, 0x4444
  v_mov_b32 v16, 0xeeee
  v_cmp_gt_u32 vcc, 8, v13
  s_nop 1
  v_cndmask_b32 v0, v16, v15, vcc
  s_mov_b32 s36, 0x00ff00ff
  s_mov_b32 s37, 0x00ff00ff
  s_lshl_b32 s15, s13, 11
  v_add_u32 v2, s15, v1
  s_mul_i32 s15, s13, 36864
  s_add_u32 s15, s15, 16384
  v_add_u32 v5, s15, v1
  v_and_b32 v15, 1, v12
  v_lshlrev_b32 v15, 10, v15
  v_lshrrev_b32 v16, 1, v12
  v_lshl_add_u32 v15, v16, 9, v15
  s_lshl_b32 s15, s13, 11
  v_add_u32 v15, s15, v15
  v_lshl_add_u32 v4, v13, 4, v15
  v_bfe_u32 v16, v13, 2, 1
  v_lshl_add_u32 v15, v16, 8, v15
  v_lshrrev_b32 v16, 3, v13
  v_lshl_add_u32 v15, v16, 6, v15
  v_and_b32 v16, 3, v13
  v_lshl_add_u32 v3, v16, 4, v15
  v_lshrrev_b32 v15, 3, v14
  v_lshlrev_b32 v15, 12, v15
  v_and_b32 v16, 7, v14
  v_lshl_add_u32 v15, v16, 4, v15
  v_lshlrev_b32 v16, 12, v12
  v_lshl_add_u32 v16, v13, 3, v16
  v_lshl_add_u32 v6, v16, 16, v15
  v_lshlrev_b32 v15, 8, v12
  v_and_b32 v16, 7, v13
  v_lshl_add_u32 v15, v16, 4, v15
  s_lshl_b32 s15, s13, 11
  v_add_u32 v15, s15, v15
  s_lshl_b32 s53, s13, 10
  s_and_b32 s54, s13, 1
  s_lshl_b32 s54, s54, 7
  s_lshr_b32 s15, s13, 1
  s_lshl_b32 s15, s15, 9
  s_add_u32 s54, s54, s15
  s_mov_b32 s42, 0
  s_mov_b32 s43, 0x00ff00ff
  v_lshlrev_b32 v17, 4, v16
  v_and_b32 v16, 1, v12
  v_lshl_add_u32 v17, v16, 8, v17
  v_lshrrev_b32 v16, 3, v13
  v_lshl_add_u32 v17, v16, 3, v17
  v_add_u32 v17, 14336, v17
  v_lshl_add_u32 v7, v17, 16, v15
  s_lshl_b32 s15, s12, 1
  s_add_u32 s15, s15, s13
  s_mov_b32 s38, 1
  s_cmp_lt_u32 s13, 2
  s_cbranch_scc1 Lrb_2
  s_add_u32 s15, s12, 64
  s_cmp_lt_u32 s12, 16
  s_cselect_b32 s38, 1, 0
  s_cmp_eq_u32 s13, 2
  s_cselect_b32 s38, s38, 0
  s_cmp_eq_u32 s38, 1
  s_cselect_b32 s15, s15, 0
Lrb_2:
  s_lshl_b32 s26, s15, 12
  s_add_u32 s26, s26, 131072
  s_mul_i32 s16, s15, 3277
  s_lshr_b32 s16, s16, 16
  s_mul_i32 s50, s16, 20
  s_sub_u32 s15, s15, s50
  s_mul_i32 s16, s16, 160
  s_lshr_b32 s50, s15, 3
  s_lshl_b32 s50, s50, 6
  s_add_u32 s16, s16, s50
  s_lshr_b32 s51, s15, 1
  s_and_b32 s51, s51, 3
  s_and_b32 s50, s15, 3
  s_cmp_ge_u32 s15, 16
  s_cselect_b32 s48, 1, 0
  s_cselect_b32 s51, s50, s51
  s_and_b32 s50, s51, 2
  s_lshl_b32 s41, s50, 4
  s_and_b32 s15, s15, 1
  s_lshl_b32 s15, s15, 4
  s_add_u32 s41, s41, s15
  s_lshl_b32 s50, s50, 3
  s_cmp_eq_u32 s48, 1
  s_cselect_b32 s50, s50, s41
  s_add_u32 s16, s16, s50
  s_and_b32 s50, s51, 1
  s_lshl_b32 s50, s50, 6
  v_lshlrev_b32 v15, 1, v13
  v_add_u32 v15, s16, v15
  v_lshrrev_b32 v16, 3, v15
  v_lshlrev_b32 v16, 7, v16
  v_and_b32 v15, 7, v15
  v_lshl_add_u32 v16, v15, 1, v16
  v_lshl_add_u32 v16, v12, 5, v16
  v_add_u32 v16, s50, v16
  v_and_b32 v15, 0x28, v14
  v_cmp_eq_u32 vcc, 0, v15
  v_mov_b32 v15, 0x8000
  s_nop 0
  v_cndmask_b32 v16, v15, v16, vcc
  v_lshl_or_b32 v0, v16, 16, v0
  s_and_b32 s39, s13, 1
  s_lshl_b32 s39, s39, 10
  s_add_u32 s39, s39, 8192
  s_mov_b32 s40, 0x3e0293ee
  s_mov_b32 s45, 0x05040100
  s_mov_b32 s46, 0x07060302
  s_lshl_b32 s15, s12, 2
  s_add_u32 s15, s15, s13
  s_mul_i32 s15, s15, 20480
  s_add_u32 s15, s15, 458752
  s_add_u32 s30, s15, 0
  s_add_u32 s31, s15, 4096
  s_add_u32 s32, s15, 8192
  s_add_u32 s33, s15, 12288
  s_add_u32 s34, s15, 16384
  s_mul_i32 s23, s13, 81920
  s_lshl_b32 s15, s12, 7
  s_add_u32 s23, s23, s15
  s_add_u32 s23, s23, 131072
  s_add_u32 s24, s23, 32768
  s_add_u32 s25, s23, 65536
  s_mul_i32 s17, s13, 40960
  s_lshl_b32 s21, s12, 2
  s_add_u32 s21, s21, s13
  s_mul_i32 s21, s21, 36864
  s_add_u32 s21, s21, 4194304
  v_lshrrev_b32 v26, 3, v14
  v_lshlrev_b32 v26, 13, v26
  v_and_b32 v27, 7, v14
  v_lshl_add_u32 v26, v27, 4, v26
  s_lshr_b32 s15, s13, 1
  s_lshl_b32 s15, s15, 7
  v_add_u32 v17, s15, v26
  s_mul_i32 s15, s13, 320
  s_mov_b32 s16, 3277
  s_movk_i32 s50, 1280
  v_add_u32 v26, 0, v14
  v_mul_lo_u32 v27, v26, s16
  v_lshrrev_b32 v27, 16, v27
  v_mul_u32_u24 v18, 20, v27
  v_sub_u32 v26, v26, v18
  v_mul_lo_u32 v27, v27, s50
  v_lshl_add_u32 v27, v26, 4, v27
  v_add_u32 v18, s15, v27
  v_add_u32 v26, 64, v14
  v_mul_lo_u32 v27, v26, s16
  v_lshrrev_b32 v27, 16, v27
  v_mul_u32_u24 v19, 20, v27
  v_sub_u32 v26, v26, v19
  v_mul_lo_u32 v27, v27, s50
  v_lshl_add_u32 v27, v26, 4, v27
  v_add_u32 v19, s15, v27
  v_add_u32 v26, 128, v14
  v_mul_lo_u32 v27, v26, s16
  v_lshrrev_b32 v27, 16, v27
  v_mul_u32_u24 v20, 20, v27
  v_sub_u32 v26, v26, v20
  v_mul_lo_u32 v27, v27, s50
  v_lshl_add_u32 v27, v26, 4, v27
  v_add_u32 v20, s15, v27
  v_add_u32 v26, 192, v14
  v_mul_lo_u32 v27, v26, s16
  v_lshrrev_b32 v27, 16, v27
  v_mul_u32_u24 v21, 20, v27
  v_sub_u32 v26, v26, v21
  v_mul_lo_u32 v27, v27, s50
  v_lshl_add_u32 v27, v26, 4, v27
  v_add_u32 v21, s15, v27
  v_add_u32 v26, 256, v14
  v_mul_lo_u32 v27, v26, s16
  v_lshrrev_b32 v27, 16, v27
  v_mul_u32_u24 v22, 20, v27
  v_sub_u32 v26, v26, v22
  v_mul_lo_u32 v27, v27, s50
  v_lshl_add_u32 v27, v26, 4, v27
  v_add_u32 v22, s15, v27
  v_lshrrev_b32 v26, 1, v12
  v_lshlrev_b32 v26, 4, v26
  v_and_b32 v27, 1, v12
  v_lshl_add_u32 v28, v27, 2, v26
  s_mov_b32 s8, s56
  s_and_b32 s9, s57, 0xffff
  s_mov_b32 s10, 5242880
  s_mov_b32 s11, 0x00020000
  s_lshl_b32 s19, s13, 1
  s_lshl_b32 s19, s19, 19
  s_lshl_b32 s20, s12, 8
  s_add_u32 s19, s19, s20
  s_add_u32 s20, s19, 0
  s_add_u32 m0, s17, 0
  s_nop 0
  buffer_load_dwordx4 v17, s[8:11], s20 offen lds
  s_add_u32 s20, s19, 65536
  s_add_u32 m0, s17, 1024
  s_nop 0
  buffer_load_dwordx4 v17, s[8:11], s20 offen lds
  s_add_u32 s20, s19, 131072
  s_add_u32 m0, s17, 2048
  s_nop 0
  buffer_load_dwordx4 v17, s[8:11], s20 offen lds
  s_add_u32 s20, s19, 196608
  s_add_u32 m0, s17, 3072
  s_nop 0
  buffer_load_dwordx4 v17, s[8:11], s20 offen lds
  s_add_u32 s20, s19, 262144
  s_add_u32 m0, s17, 4096
  s_nop 0
  buffer_load_dwordx4 v17, s[8:11], s20 offen lds
  s_add_u32 s20, s19, 327680
  s_add_u32 m0, s17, 5120
  s_nop 0
  buffer_load_dwordx4 v17, s[8:11], s20 offen lds
  s_add_u32 s20, s19, 393216
  s_add_u32 m0, s17, 6144
  s_nop 0
  buffer_load_dwordx4 v17, s[8:11], s20 offen lds
  s_add_u32 s20, s19, 458752
  s_add_u32 m0, s17, 7168
  s_nop 0
  buffer_load_dwordx4 v17, s[8:11], s20 offen lds
  s_lshl_b32 s19, s13, 1
  s_add_u32 s19, s19, 1
  s_lshl_b32 s19, s19, 19
  s_lshl_b32 s20, s12, 8
  s_add_u32 s19, s19, s20
  s_add_u32 s20, s19, 0
  s_add_u32 m0, s17, 8192
  s_nop 0
  buffer_load_dwordx4 v17, s[8:11], s20 offen lds
  s_add_u32 s20, s19, 65536
  s_add_u32 m0, s17, 9216
  s_nop 0
  buffer_load_dwordx4 v17, s[8:11], s20 offen lds
  s_add_u32 s20, s19, 131072
  s_add_u32 m0, s17, 10240
  s_nop 0
  buffer_load_dwordx4 v17, s[8:11], s20 offen lds
  s_add_u32 s20, s19, 196608
  s_add_u32 m0, s17, 11264
  s_nop 0
  buffer_load_dwordx4 v17, s[8:11], s20 offen lds
  s_add_u32 s20, s19, 262144
  s_add_u32 m0, s17, 12288
  s_nop 0
  buffer_load_dwordx4 v17, s[8:11], s20 offen lds
  s_add_u32 s20, s19, 327680
  s_add_u32 m0, s17, 13312
  s_nop 0
  buffer_load_dwordx4 v17, s[8:11], s20 offen lds
  s_add_u32 s20, s19, 393216
  s_add_u32 m0, s17, 14336
  s_nop 0
  buffer_load_dwordx4 v17, s[8:11], s20 offen lds
  s_add_u32 s20, s19, 458752
  s_add_u32 m0, s17, 15360
  s_nop 0
  buffer_load_dwordx4 v17, s[8:11], s20 offen lds
  s_and_b32 s19, s13, 1
  s_add_u32 s19, s19, 8
  s_lshl_b32 s19, s19, 19
  s_lshl_b32 s20, s12, 8
  s_add_u32 s19, s19, s20
  s_add_u32 s20, s19, 0
  s_add_u32 m0, s17, 16384
  s_nop 0
  buffer_load_dwordx4 v17, s[8:11], s20 offen lds
  s_add_u32 s20, s19, 65536
  s_add_u32 m0, s17, 17408
  s_nop 0
  buffer_load_dwordx4 v17, s[8:11], s20 offen lds
  s_add_u32 s20, s19, 131072
  s_add_u32 m0, s17, 18432
  s_nop 0
  buffer_load_dwordx4 v17, s[8:11], s20 offen lds
  s_add_u32 s20, s19, 196608
  s_add_u32 m0, s17, 19456
  s_nop 0
  buffer_load_dwordx4 v17, s[8:11], s20 offen lds
  s_add_u32 s20, s19, 262144
  s_add_u32 m0, s17, 20480
  s_nop 0
  buffer_load_dwordx4 v17, s[8:11], s20 offen lds
  s_add_u32 s20, s19, 327680
  s_add_u32 m0, s17, 21504
  s_nop 0
  buffer_load_dwordx4 v17, s[8:11], s20 offen lds
  s_add_u32 s20, s19, 393216
  s_add_u32 m0, s17, 22528
  s_nop 0
  buffer_load_dwordx4 v17, s[8:11], s20 offen lds
  s_add_u32 s20, s19, 458752
  s_add_u32 m0, s17, 23552
  s_nop 0
  buffer_load_dwordx4 v17, s[8:11], s20 offen lds
  s_xor_b32 s19, s13, 2
  s_lshl_b32 s19, s19, 1
  s_lshl_b32 s19, s19, 19
  s_lshl_b32 s20, s12, 8
  s_add_u32 s19, s19, s20
  s_add_u32 s20, s19, 0
  s_add_u32 m0, s17, 24576
  s_nop 0
  buffer_load_dwordx4 v17, s[8:11], s20 offen lds
  s_add_u32 s20, s19, 65536
  s_add_u32 m0, s17, 25600
  s_nop 0
  buffer_load_dwordx4 v17, s[8:11], s20 offen lds
  s_add_u32 s20, s19, 131072
  s_add_u32 m0, s17, 26624
  s_nop 0
  buffer_load_dwordx4 v17, s[8:11], s20 offen lds
  s_add_u32 s20, s19, 196608
  s_add_u32 m0, s17, 27648
  s_nop 0
  buffer_load_dwordx4 v17, s[8:11], s20 offen lds
  s_add_u32 s20, s19, 262144
  s_add_u32 m0, s17, 28672
  s_nop 0
  buffer_load_dwordx4 v17, s[8:11], s20 offen lds
  s_add_u32 s20, s19, 327680
  s_add_u32 m0, s17, 29696
  s_nop 0
  buffer_load_dwordx4 v17, s[8:11], s20 offen lds
  s_add_u32 s20, s19, 393216
  s_add_u32 m0, s17, 30720
  s_nop 0
  buffer_load_dwordx4 v17, s[8:11], s20 offen lds
  s_add_u32 s20, s19, 458752
  s_add_u32 m0, s17, 31744
  s_nop 0
  buffer_load_dwordx4 v17, s[8:11], s20 offen lds
  s_xor_b32 s19, s13, 2
  s_lshl_b32 s19, s19, 1
  s_add_u32 s19, s19, 1
  s_lshl_b32 s19, s19, 19
  s_lshl_b32 s20, s12, 8
  s_add_u32 s19, s19, s20
  s_add_u32 s20, s19, 0
  s_add_u32 m0, s17, 32768
  s_nop 0
  buffer_load_dwordx4 v17, s[8:11], s20 offen lds
  s_add_u32 s20, s19, 65536
  s_add_u32 m0, s17, 33792
  s_nop 0
  buffer_load_dwordx4 v17, s[8:11], s20 offen lds
  s_add_u32 s20, s19, 131072
  s_add_u32 m0, s17, 34816
  s_nop 0
  buffer_load_dwordx4 v17, s[8:11], s20 offen lds
  s_add_u32 s20, s19, 196608
  s_add_u32 m0, s17, 35840
  s_nop 0
  buffer_load_dwordx4 v17, s[8:11], s20 offen lds
  s_add_u32 s20, s19, 262144
  s_add_u32 m0, s17, 36864
  s_nop 0
  buffer_load_dwordx4 v17, s[8:11], s20 offen lds
  s_add_u32 s20, s19, 327680
  s_add_u32 m0, s17, 37888
  s_nop 0
  buffer_load_dwordx4 v17, s[8:11], s20 offen lds
  s_add_u32 s20, s19, 393216
  s_add_u32 m0, s17, 38912
  s_nop 0
  buffer_load_dwordx4 v17, s[8:11], s20 offen lds
  s_add_u32 s20, s19, 458752
  s_add_u32 m0, s17, 39936
  s_nop 0
  buffer_load_dwordx4 v17, s[8:11], s20 offen lds
  v_lshlrev_b32 v26, 7, v28
  v_lshl_add_u32 v26, v13, 2, v26
  s_and_b32 s15, s13, 1
  s_lshl_b32 s15, s15, 6
  v_add_u32 v26, s15, v26
  v_add_u32 v25, s17, v26
  s_xor_b32 s15, s13, 1
  s_mul_i32 s15, s15, 40960
  v_add_u32 v29, s15, v26
  s_waitcnt vmcnt(24)
  s_barrier
  v_add_u32 v23, 0, v25
  v_add_u32 v24, 1024, v25
  v_add_u32 v30, 4096, v25
  v_add_u32 v31, 5120, v25
  ds_read2_b32 v[32:33], v23 offset0:0 offset1:32
  ds_read2_b32 v[34:35], v24 offset0:0 offset1:32
  ds_read2_b32 v[36:37], v23 offset0:64 offset1:96
  ds_read2_b32 v[38:39], v24 offset0:64 offset1:96
  ds_read2_b32 v[40:41], v30 offset0:0 offset1:32
  ds_read2_b32 v[42:43], v31 offset0:0 offset1:32
  ds_read2_b32 v[44:45], v30 offset0:64 offset1:96
  ds_read2_b32 v[46:47], v31 offset0:64 offset1:96
  s_waitcnt lgkmcnt(0)
  v_perm_b32 v64, v33, v32, s45
  v_perm_b32 v65, v35, v34, s45
  v_perm_b32 v66, v37, v36, s45
  v_perm_b32 v67, v39, v38, s45
  v_perm_b32 v68, v41, v40, s45
  v_perm_b32 v69, v43, v42, s45
  v_perm_b32 v70, v45, v44, s45
  v_perm_b32 v71, v47, v46, s45
  s_add_u32 s20, s30, 0
  buffer_store_dwordx4 v[64:67], v1, s[4:7], s20 offen
  buffer_store_dwordx4 v[68:71], v1, s[4:7], s20 offen offset:1024
  v_perm_b32 v72, v33, v32, s46
  v_perm_b32 v73, v35, v34, s46
  v_perm_b32 v74, v37, v36, s46
  v_perm_b32 v75, v39, v38, s46
  v_perm_b32 v76, v41, v40, s46
  v_perm_b32 v77, v43, v42, s46
  v_perm_b32 v78, v45, v44, s46
  v_perm_b32 v79, v47, v46, s46
  s_add_u32 s20, s30, 4096
  buffer_store_dwordx4 v[72:75], v1, s[4:7], s20 offen
  buffer_store_dwordx4 v[76:79], v1, s[4:7], s20 offen offset:1024
  v_add_u32 v23, 0, v29
  v_add_u32 v24, 1024, v29
  v_add_u32 v30, 4096, v29
  v_add_u32 v31, 5120, v29
  ds_read2_b32 v[32:33], v23 offset0:0 offset1:32
  ds_read2_b32 v[34:35], v24 offset0:0 offset1:32
  ds_read2_b32 v[36:37], v23 offset0:64 offset1:96
  ds_read2_b32 v[38:39], v24 offset0:64 offset1:96
  ds_read2_b32 v[40:41], v30 offset0:0 offset1:32
  ds_read2_b32 v[42:43], v31 offset0:0 offset1:32
  ds_read2_b32 v[44:45], v30 offset0:64 offset1:96
  ds_read2_b32 v[46:47], v31 offset0:64 offset1:96
  s_waitcnt lgkmcnt(0)
  v_perm_b32 v64, v33, v32, s45
  v_perm_b32 v65, v35, v34, s45
  v_perm_b32 v66, v37, v36, s45
  v_perm_b32 v67, v39, v38, s45
  v_perm_b32 v68, v41, v40, s45
  v_perm_b32 v69, v43, v42, s45
  v_perm_b32 v70, v45, v44, s45
  v_perm_b32 v71, v47, v46, s45
  v_accvgpr_write_b32 a72, v64
  v_accvgpr_write_b32 a73, v65
  v_accvgpr_write_b32 a74, v66
  v_accvgpr_write_b32 a75, v67
  v_accvgpr_write_b32 a76, v68
  v_accvgpr_write_b32 a77, v69
  v_accvgpr_write_b32 a78, v70
  v_accvgpr_write_b32 a79, v71
  v_perm_b32 v72, v33, v32, s46
  v_perm_b32 v73, v35, v34, s46
  v_perm_b32 v74, v37, v36, s46
  v_perm_b32 v75, v39, v38, s46
  v_perm_b32 v76, v41, v40, s46
  v_perm_b32 v77, v43, v42, s46
  v_perm_b32 v78, v45, v44, s46
  v_perm_b32 v79, v47, v46, s46
  v_accvgpr_write_b32 a80, v72
  v_accvgpr_write_b32 a81, v73
  v_accvgpr_write_b32 a82, v74
  v_accvgpr_write_b32 a83, v75
  v_accvgpr_write_b32 a84, v76
  v_accvgpr_write_b32 a85, v77
  v_accvgpr_write_b32 a86, v78
  v_accvgpr_write_b32 a87, v79
  v_add_u32 v23, 8192, v25
  v_add_u32 v24, 9216, v25
  v_add_u32 v30, 12288, v25
  v_add_u32 v31, 13312, v25
  ds_read2_b32 v[32:33], v23 offset0:0 offset1:32
  ds_read2_b32 v[34:35], v24 offset0:0 offset1:32
  ds_read2_b32 v[36:37], v23 offset0:64 offset1:96
  ds_read2_b32 v[38:39], v24 offset0:64 offset1:96
  ds_read2_b32 v[40:41], v30 offset0:0 offset1:32
  ds_read2_b32 v[42:43], v31 offset0:0 offset1:32
  ds_read2_b32 v[44:45], v30 offset0:64 offset1:96
  ds_read2_b32 v[46:47], v31 offset0:64 offset1:96
  s_waitcnt lgkmcnt(0)
  v_perm_b32 v64, v33, v32, s45
  v_perm_b32 v65, v35, v34, s45
  v_perm_b32 v66, v37, v36, s45
  v_perm_b32 v67, v39, v38, s45
  v_perm_b32 v68, v41, v40, s45
  v_perm_b32 v69, v43, v42, s45
  v_perm_b32 v70, v45, v44, s45
  v_perm_b32 v71, v47, v46, s45
  v_accvgpr_write_b32 a0, v64
  v_accvgpr_write_b32 a1, v65
  v_accvgpr_write_b32 a2, v66
  v_accvgpr_write_b32 a3, v67
  v_accvgpr_write_b32 a4, v68
  v_accvgpr_write_b32 a5, v69
  v_accvgpr_write_b32 a6, v70
  v_accvgpr_write_b32 a7, v71
  v_perm_b32 v72, v33, v32, s46
  v_perm_b32 v73, v35, v34, s46
  v_perm_b32 v74, v37, v36, s46
  v_perm_b32 v75, v39, v38, s46
  v_perm_b32 v76, v41, v40, s46
  v_perm_b32 v77, v43, v42, s46
  v_perm_b32 v78, v45, v44, s46
  v_perm_b32 v79, v47, v46, s46
  v_accvgpr_write_b32 a16, v72
  v_accvgpr_write_b32 a17, v73
  v_accvgpr_write_b32 a18, v74
  v_accvgpr_write_b32 a19, v75
  v_accvgpr_write_b32 a20, v76
  v_accvgpr_write_b32 a21, v77
  v_accvgpr_write_b32 a22, v78
  v_accvgpr_write_b32 a23, v79
  v_add_u32 v23, 8192, v29
  v_add_u32 v24, 9216, v29
  v_add_u32 v30, 12288, v29
  v_add_u32 v31, 13312, v29
  ds_read2_b32 v[32:33], v23 offset0:0 offset1:32
  ds_read2_b32 v[34:35], v24 offset0:0 offset1:32
  ds_read2_b32 v[36:37], v23 offset0:64 offset1:96
  ds_read2_b32 v[38:39], v24 offset0:64 offset1:96
  ds_read2_b32 v[40:41], v30 offset0:0 offset1:32
  ds_read2_b32 v[42:43], v31 offset0:0 offset1:32
  ds_read2_b32 v[44:45], v30 offset0:64 offset1:96
  ds_read2_b32 v[46:47], v31 offset0:64 offset1:96
  s_waitcnt lgkmcnt(0)
  v_perm_b32 v64, v33, v32, s45
  v_perm_b32 v65, v35, v34, s45
  v_perm_b32 v66, v37, v36, s45
  v_perm_b32 v67, v39, v38, s45
  v_perm_b32 v68, v41, v40, s45
  v_perm_b32 v69, v43, v42, s45
  v_perm_b32 v70, v45, v44, s45
  v_perm_b32 v71, v47, v46, s45
  v_accvgpr_write_b32 a96, v64
  v_accvgpr_write_b32 a97, v65
  v_accvgpr_write_b32 a98, v66
  v_accvgpr_write_b32 a99, v67
  v_accvgpr_write_b32 a100, v68
  v_accvgpr_write_b32 a101, v69
  v_accvgpr_write_b32 a102, v70
  v_accvgpr_write_b32 a103, v71
  v_perm_b32 v72, v33, v32, s46
  v_perm_b32 v73, v35, v34, s46
  v_perm_b32 v74, v37, v36, s46
  v_perm_b32 v75, v39, v38, s46
  v_perm_b32 v76, v41, v40, s46
  v_perm_b32 v77, v43, v42, s46
  v_perm_b32 v78, v45, v44, s46
  v_perm_b32 v79, v47, v46, s46
  v_accvgpr_write_b32 a104, v72
  v_accvgpr_write_b32 a105, v73
  v_accvgpr_write_b32 a106, v74
  v_accvgpr_write_b32 a107, v75
  v_accvgpr_write_b32 a108, v76
  v_accvgpr_write_b32 a109, v77
  v_accvgpr_write_b32 a110, v78
  v_accvgpr_write_b32 a111, v79
  s_waitcnt vmcnt(20)
  s_barrier
  s_mov_b32 s8, s58
  s_and_b32 s9, s59, 0xffff
  s_mov_b32 s10, 5242880
  s_mov_b32 s11, 0x00020000
  s_lshl_b32 s19, s13, 1
  s_lshl_b32 s19, s19, 19
  s_lshl_b32 s20, s12, 8
  s_add_u32 s19, s19, s20
  s_add_u32 s20, s19, 0
  s_add_u32 m0, s17, 0
  s_nop 0
  buffer_load_dwordx4 v17, s[8:11], s20 offen lds
  s_add_u32 s20, s19, 65536
  s_add_u32 m0, s17, 1024
  s_nop 0
  buffer_load_dwordx4 v17, s[8:11], s20 offen lds
  s_add_u32 s20, s19, 131072
  s_add_u32 m0, s17, 2048
  s_nop 0
  buffer_load_dwordx4 v17, s[8:11], s20 offen lds
  s_add_u32 s20, s19, 196608
  s_add_u32 m0, s17, 3072
  s_nop 0
  buffer_load_dwordx4 v17, s[8:11], s20 offen lds
  s_add_u32 s20, s19, 262144
  s_add_u32 m0, s17, 4096
  s_nop 0
  buffer_load_dwordx4 v17, s[8:11], s20 offen lds
  s_add_u32 s20, s19, 327680
  s_add_u32 m0, s17, 5120
  s_nop 0
  buffer_load_dwordx4 v17, s[8:11], s20 offen lds
  s_add_u32 s20, s19, 393216
  s_add_u32 m0, s17, 6144
  s_nop 0
  buffer_load_dwordx4 v17, s[8:11], s20 offen lds
  s_add_u32 s20, s19, 458752
  s_add_u32 m0, s17, 7168
  s_nop 0
  buffer_load_dwordx4 v17, s[8:11], s20 offen lds
  s_lshl_b32 s19, s13, 1
  s_add_u32 s19, s19, 1
  s_lshl_b32 s19, s19, 19
  s_lshl_b32 s20, s12, 8
  s_add_u32 s19, s19, s20
  s_add_u32 s20, s19, 0
  s_add_u32 m0, s17, 8192
  s_nop 0
  buffer_load_dwordx4 v17, s[8:11], s20 offen lds
  s_add_u32 s20, s19, 65536
  s_add_u32 m0, s17, 9216
  s_nop 0
  buffer_load_dwordx4 v17, s[8:11], s20 offen lds
  s_add_u32 s20, s19, 131072
  s_add_u32 m0, s17, 10240
  s_nop 0
  buffer_load_dwordx4 v17, s[8:11], s20 offen lds
  s_add_u32 s20, s19, 196608
  s_add_u32 m0, s17, 11264
  s_nop 0
  buffer_load_dwordx4 v17, s[8:11], s20 offen lds
  s_add_u32 s20, s19, 262144
  s_add_u32 m0, s17, 12288
  s_nop 0
  buffer_load_dwordx4 v17, s[8:11], s20 offen lds
  s_add_u32 s20, s19, 327680
  s_add_u32 m0, s17, 13312
  s_nop 0
  buffer_load_dwordx4 v17, s[8:11], s20 offen lds
  s_add_u32 s20, s19, 393216
  s_add_u32 m0, s17, 14336
  s_nop 0
  buffer_load_dwordx4 v17, s[8:11], s20 offen lds
  s_add_u32 s20, s19, 458752
  s_add_u32 m0, s17, 15360
  s_nop 0
  buffer_load_dwordx4 v17, s[8:11], s20 offen lds
  v_add_u32 v23, 16384, v25
  v_add_u32 v24, 17408, v25
  v_add_u32 v30, 20480, v25
  v_add_u32 v31, 21504, v25
  ds_read2_b32 v[32:33], v23 offset0:0 offset1:32
  ds_read2_b32 v[34:35], v24 offset0:0 offset1:32
  ds_read2_b32 v[36:37], v23 offset0:64 offset1:96
  ds_read2_b32 v[38:39], v24 offset0:64 offset1:96
  ds_read2_b32 v[40:41], v30 offset0:0 offset1:32
  ds_read2_b32 v[42:43], v31 offset0:0 offset1:32
  ds_read2_b32 v[44:45], v30 offset0:64 offset1:96
  ds_read2_b32 v[46:47], v31 offset0:64 offset1:96
  s_waitcnt lgkmcnt(0)
  v_perm_b32 v64, v33, v32, s45
  v_perm_b32 v65, v35, v34, s45
  v_perm_b32 v66, v37, v36, s45
  v_perm_b32 v67, v39, v38, s45
  v_perm_b32 v68, v41, v40, s45
  v_perm_b32 v69, v43, v42, s45
  v_perm_b32 v70, v45, v44, s45
  v_perm_b32 v71, v47, v46, s45
  v_accvgpr_write_b32 a24, v64
  v_accvgpr_write_b32 a25, v65
  v_accvgpr_write_b32 a26, v66
  v_accvgpr_write_b32 a27, v67
  v_accvgpr_write_b32 a28, v68
  v_accvgpr_write_b32 a29, v69
  v_accvgpr_write_b32 a30, v70
  v_accvgpr_write_b32 a31, v71
  v_perm_b32 v72, v33, v32, s46
  v_perm_b32 v73, v35, v34, s46
  v_perm_b32 v74, v37, v36, s46
  v_perm_b32 v75, v39, v38, s46
  v_perm_b32 v76, v41, v40, s46
  v_perm_b32 v77, v43, v42, s46
  v_perm_b32 v78, v45, v44, s46
  v_perm_b32 v79, v47, v46, s46
  v_accvgpr_write_b32 a32, v72
  v_accvgpr_write_b32 a33, v73
  v_accvgpr_write_b32 a34, v74
  v_accvgpr_write_b32 a35, v75
  v_accvgpr_write_b32 a36, v76
  v_accvgpr_write_b32 a37, v77
  v_accvgpr_write_b32 a38, v78
  v_accvgpr_write_b32 a39, v79
  v_add_u32 v23, 16384, v29
  v_add_u32 v24, 17408, v29
  v_add_u32 v30, 20480, v29
  v_add_u32 v31, 21504, v29
  ds_read2_b32 v[32:33], v23 offset0:0 offset1:32
  ds_read2_b32 v[34:35], v24 offset0:0 offset1:32
  ds_read2_b32 v[36:37], v23 offset0:64 offset1:96
  ds_read2_b32 v[38:39], v24 offset0:64 offset1:96
  ds_read2_b32 v[40:41], v30 offset0:0 offset1:32
  ds_read2_b32 v[42:43], v31 offset0:0 offset1:32
  ds_read2_b32 v[44:45], v30 offset0:64 offset1:96
  ds_read2_b32 v[46:47], v31 offset0:64 offset1:96
  s_waitcnt lgkmcnt(0)
  v_perm_b32 v64, v33, v32, s45
  v_perm_b32 v65, v35, v34, s45
  v_perm_b32 v66, v37, v36, s45
  v_perm_b32 v67, v39, v38, s45
  v_perm_b32 v68, v41, v40, s45
  v_perm_b32 v69, v43, v42, s45
  v_perm_b32 v70, v45, v44, s45
  v_perm_b32 v71, v47, v46, s45
  v_accvgpr_write_b32 a48, v64
  v_accvgpr_write_b32 a49, v65
  v_accvgpr_write_b32 a50, v66
  v_accvgpr_write_b32 a51, v67
  v_accvgpr_write_b32 a52, v68
  v_accvgpr_write_b32 a53, v69
  v_accvgpr_write_b32 a54, v70
  v_accvgpr_write_b32 a55, v71
  v_perm_b32 v72, v33, v32, s46
  v_perm_b32 v73, v35, v34, s46
  v_perm_b32 v74, v37, v36, s46
  v_perm_b32 v75, v39, v38, s46
  v_perm_b32 v76, v41, v40, s46
  v_perm_b32 v77, v43, v42, s46
  v_perm_b32 v78, v45, v44, s46
  v_perm_b32 v79, v47, v46, s46
  v_accvgpr_write_b32 a56, v72
  v_accvgpr_write_b32 a57, v73
  v_accvgpr_write_b32 a58, v74
  v_accvgpr_write_b32 a59, v75
  v_accvgpr_write_b32 a60, v76
  v_accvgpr_write_b32 a61, v77
  v_accvgpr_write_b32 a62, v78
  v_accvgpr_write_b32 a63, v79
  s_waitcnt vmcnt(20)
  s_barrier
  s_mov_b32 s8, s58
  s_and_b32 s9, s59, 0xffff
  s_mov_b32 s10, 5242880
  s_mov_b32 s11, 0x00020000
  s_and_b32 s19, s13, 1
  s_add_u32 s19, s19, 8
  s_lshl_b32 s19, s19, 19
  s_lshl_b32 s20, s12, 8
  s_add_u32 s19, s19, s20
  s_add_u32 s20, s19, 0
  s_add_u32 m0, s17, 16384
  s_nop 0
  buffer_load_dwordx4 v17, s[8:11], s20 offen lds
  s_add_u32 s20, s19, 65536
  s_add_u32 m0, s17, 17408
  s_nop 0
  buffer_load_dwordx4 v17, s[8:11], s20 offen lds
  s_add_u32 s20, s19, 131072
  s_add_u32 m0, s17, 18432
  s_nop 0
  buffer_load_dwordx4 v17, s[8:11], s20 offen lds
  s_add_u32 s20, s19, 196608
  s_add_u32 m0, s17, 19456
  s_nop 0
  buffer_load_dwordx4 v17, s[8:11], s20 offen lds
  s_add_u32 s20, s19, 262144
  s_add_u32 m0, s17, 20480
  s_nop 0
  buffer_load_dwordx4 v17, s[8:11], s20 offen lds
  s_add_u32 s20, s19, 327680
  s_add_u32 m0, s17, 21504
  s_nop 0
  buffer_load_dwordx4 v17, s[8:11], s20 offen lds
  s_add_u32 s20, s19, 393216
  s_add_u32 m0, s17, 22528
  s_nop 0
  buffer_load_dwordx4 v17, s[8:11], s20 offen lds
  s_add_u32 s20, s19, 458752
  s_add_u32 m0, s17, 23552
  s_nop 0
  buffer_load_dwordx4 v17, s[8:11], s20 offen lds
  v_add_u32 v23, 24576, v25
  v_add_u32 v24, 25600, v25
  v_add_u32 v30, 28672, v25
  v_add_u32 v31, 29696, v25
  ds_read2_b32 v[32:33], v23 offset0:0 offset1:32
  ds_read2_b32 v[34:35], v24 offset0:0 offset1:32
  ds_read2_b32 v[36:37], v23 offset0:64 offset1:96
  ds_read2_b32 v[38:39], v24 offset0:64 offset1:96
  ds_read2_b32 v[40:41], v30 offset0:0 offset1:32
  ds_read2_b32 v[42:43], v31 offset0:0 offset1:32
  ds_read2_b32 v[44:45], v30 offset0:64 offset1:96
  ds_read2_b32 v[46:47], v31 offset0:64 offset1:96
  s_waitcnt lgkmcnt(0)
  v_perm_b32 v64, v33, v32, s45
  v_perm_b32 v65, v35, v34, s45
  v_perm_b32 v66, v37, v36, s45
  v_perm_b32 v67, v39, v38, s45
  v_perm_b32 v68, v41, v40, s45
  v_perm_b32 v69, v43, v42, s45
  v_perm_b32 v70, v45, v44, s45
  v_perm_b32 v71, v47, v46, s45
  v_accvgpr_write_b32 a120, v64
  v_accvgpr_write_b32 a121, v65
  v_accvgpr_write_b32 a122, v66
  v_accvgpr_write_b32 a123, v67
  v_accvgpr_write_b32 a124, v68
  v_accvgpr_write_b32 a125, v69
  v_accvgpr_write_b32 a126, v70
  v_accvgpr_write_b32 a127, v71
  v_perm_b32 v72, v33, v32, s46
  v_perm_b32 v73, v35, v34, s46
  v_perm_b32 v74, v37, v36, s46
  v_perm_b32 v75, v39, v38, s46
  v_perm_b32 v76, v41, v40, s46
  v_perm_b32 v77, v43, v42, s46
  v_perm_b32 v78, v45, v44, s46
  v_perm_b32 v79, v47, v46, s46
  v_accvgpr_write_b32 a128, v72
  v_accvgpr_write_b32 a129, v73
  v_accvgpr_write_b32 a130, v74
  v_accvgpr_write_b32 a131, v75
  v_accvgpr_write_b32 a132, v76
  v_accvgpr_write_b32 a133, v77
  v_accvgpr_write_b32 a134, v78
  v_accvgpr_write_b32 a135, v79
  v_add_u32 v23, 24576, v29
  v_add_u32 v24, 25600, v29
  v_add_u32 v30, 28672, v29
  v_add_u32 v31, 29696, v29
  ds_read2_b32 v[32:33], v23 offset0:0 offset1:32
  ds_read2_b32 v[34:35], v24 offset0:0 offset1:32
  ds_read2_b32 v[36:37], v23 offset0:64 offset1:96
  ds_read2_b32 v[38:39], v24 offset0:64 offset1:96
  ds_read2_b32 v[40:41], v30 offset0:0 offset1:32
  ds_read2_b32 v[42:43], v31 offset0:0 offset1:32
  ds_read2_b32 v[44:45], v30 offset0:64 offset1:96
  ds_read2_b32 v[46:47], v31 offset0:64 offset1:96
  s_waitcnt lgkmcnt(0)
  v_perm_b32 v64, v33, v32, s45
  v_perm_b32 v65, v35, v34, s45
  v_perm_b32 v66, v37, v36, s45
  v_perm_b32 v67, v39, v38, s45
  v_perm_b32 v68, v41, v40, s45
  v_perm_b32 v69, v43, v42, s45
  v_perm_b32 v70, v45, v44, s45
  v_perm_b32 v71, v47, v46, s45
  v_accvgpr_write_b32 a168, v64
  v_accvgpr_write_b32 a169, v65
  v_accvgpr_write_b32 a170, v66
  v_accvgpr_write_b32 a171, v67
  v_accvgpr_write_b32 a172, v68
  v_accvgpr_write_b32 a173, v69
  v_accvgpr_write_b32 a174, v70
  v_accvgpr_write_b32 a175, v71
  v_perm_b32 v72, v33, v32, s46
  v_perm_b32 v73, v35, v34, s46
  v_perm_b32 v74, v37, v36, s46
  v_perm_b32 v75, v39, v38, s46
  v_perm_b32 v76, v41, v40, s46
  v_perm_b32 v77, v43, v42, s46
  v_perm_b32 v78, v45, v44, s46
  v_perm_b32 v79, v47, v46, s46
  v_accvgpr_write_b32 a176, v72
  v_accvgpr_write_b32 a177, v73
  v_accvgpr_write_b32 a178, v74
  v_accvgpr_write_b32 a179, v75
  v_accvgpr_write_b32 a180, v76
  v_accvgpr_write_b32 a181, v77
  v_accvgpr_write_b32 a182, v78
  v_accvgpr_write_b32 a183, v79
  v_add_u32 v23, 32768, v25
  v_add_u32 v24, 33792, v25
  v_add_u32 v30, 36864, v25
  v_add_u32 v31, 37888, v25
  ds_read2_b32 v[32:33], v23 offset0:0 offset1:32
  ds_read2_b32 v[34:35], v24 offset0:0 offset1:32
  ds_read2_b32 v[36:37], v23 offset0:64 offset1:96
  ds_read2_b32 v[38:39], v24 offset0:64 offset1:96
  ds_read2_b32 v[40:41], v30 offset0:0 offset1:32
  ds_read2_b32 v[42:43], v31 offset0:0 offset1:32
  ds_read2_b32 v[44:45], v30 offset0:64 offset1:96
  ds_read2_b32 v[46:47], v31 offset0:64 offset1:96
  s_waitcnt lgkmcnt(0)
  v_perm_b32 v64, v33, v32, s45
  v_perm_b32 v65, v35, v34, s45
  v_perm_b32 v66, v37, v36, s45
  v_perm_b32 v67, v39, v38, s45
  v_perm_b32 v68, v41, v40, s45
  v_perm_b32 v69, v43, v42, s45
  v_perm_b32 v70, v45, v44, s45
  v_perm_b32 v71, v47, v46, s45
  v_accvgpr_write_b32 a144, v64
  v_accvgpr_write_b32 a145, v65
  v_accvgpr_write_b32 a146, v66
  v_accvgpr_write_b32 a147, v67
  v_accvgpr_write_b32 a148, v68
  v_accvgpr_write_b32 a149, v69
  v_accvgpr_write_b32 a150, v70
  v_accvgpr_write_b32 a151, v71
  v_perm_b32 v72, v33, v32, s46
  v_perm_b32 v73, v35, v34, s46
  v_perm_b32 v74, v37, v36, s46
  v_perm_b32 v75, v39, v38, s46
  v_perm_b32 v76, v41, v40, s46
  v_perm_b32 v77, v43, v42, s46
  v_perm_b32 v78, v45, v44, s46
  v_perm_b32 v79, v47, v46, s46
  v_accvgpr_write_b32 a152, v72
  v_accvgpr_write_b32 a153, v73
  v_accvgpr_write_b32 a154, v74
  v_accvgpr_write_b32 a155, v75
  v_accvgpr_write_b32 a156, v76
  v_accvgpr_write_b32 a157, v77
  v_accvgpr_write_b32 a158, v78
  v_accvgpr_write_b32 a159, v79
  v_add_u32 v23, 32768, v29
  v_add_u32 v24, 33792, v29
  v_add_u32 v30, 36864, v29
  v_add_u32 v31, 37888, v29
  ds_read2_b32 v[32:33], v23 offset0:0 offset1:32
  ds_read2_b32 v[34:35], v24 offset0:0 offset1:32
  ds_read2_b32 v[36:37], v23 offset0:64 offset1:96
  ds_read2_b32 v[38:39], v24 offset0:64 offset1:96
  ds_read2_b32 v[40:41], v30 offset0:0 offset1:32
  ds_read2_b32 v[42:43], v31 offset0:0 offset1:32
  ds_read2_b32 v[44:45], v30 offset0:64 offset1:96
  ds_read2_b32 v[46:47], v31 offset0:64 offset1:96
  s_waitcnt lgkmcnt(0)
  v_perm_b32 v64, v33, v32, s45
  v_perm_b32 v65, v35, v34, s45
  v_perm_b32 v66, v37, v36, s45
  v_perm_b32 v67, v39, v38, s45
  v_perm_b32 v68, v41, v40, s45
  v_perm_b32 v69, v43, v42, s45
  v_perm_b32 v70, v45, v44, s45
  v_perm_b32 v71, v47, v46, s45
  v_accvgpr_write_b32 a192, v64
  v_accvgpr_write_b32 a193, v65
  v_accvgpr_write_b32 a194, v66
  v_accvgpr_write_b32 a195, v67
  v_accvgpr_write_b32 a196, v68
  v_accvgpr_write_b32 a197, v69
  v_accvgpr_write_b32 a198, v70
  v_accvgpr_write_b32 a199, v71
  v_perm_b32 v72, v33, v32, s46
  v_perm_b32 v73, v35, v34, s46
  v_perm_b32 v74, v37, v36, s46
  v_perm_b32 v75, v39, v38, s46
  v_perm_b32 v76, v41, v40, s46
  v_perm_b32 v77, v43, v42, s46
  v_perm_b32 v78, v45, v44, s46
  v_perm_b32 v79, v47, v46, s46
  v_accvgpr_write_b32 a200, v72
  v_accvgpr_write_b32 a201, v73
  v_accvgpr_write_b32 a202, v74
  v_accvgpr_write_b32 a203, v75
  v_accvgpr_write_b32 a204, v76
  v_accvgpr_write_b32 a205, v77
  v_accvgpr_write_b32 a206, v78
  v_accvgpr_write_b32 a207, v79
  s_waitcnt vmcnt(8)
  s_barrier
  s_mov_b32 s8, s58
  s_and_b32 s9, s59, 0xffff
  s_mov_b32 s10, 5242880
  s_mov_b32 s11, 0x00020000
  s_xor_b32 s19, s13, 2
  s_lshl_b32 s19, s19, 1
  s_lshl_b32 s19, s19, 19
  s_lshl_b32 s20, s12, 8
  s_add_u32 s19, s19, s20
  s_add_u32 s20, s19, 0
  s_add_u32 m0, s17, 24576
  s_nop 0
  buffer_load_dwordx4 v17, s[8:11], s20 offen lds
  s_add_u32 s20, s19, 65536
  s_add_u32 m0, s17, 25600
  s_nop 0
  buffer_load_dwordx4 v17, s[8:11], s20 offen lds
  s_add_u32 s20, s19, 131072
  s_add_u32 m0, s17, 26624
  s_nop 0
  buffer_load_dwordx4 v17, s[8:11], s20 offen lds
  s_add_u32 s20, s19, 196608
  s_add_u32 m0, s17, 27648
  s_nop 0
  buffer_load_dwordx4 v17, s[8:11], s20 offen lds
  s_add_u32 s20, s19, 262144
  s_add_u32 m0, s17, 28672
  s_nop 0
  buffer_load_dwordx4 v17, s[8:11], s20 offen lds
  s_add_u32 s20, s19, 327680
  s_add_u32 m0, s17, 29696
  s_nop 0
  buffer_load_dwordx4 v17, s[8:11], s20 offen lds
  s_add_u32 s20, s19, 393216
  s_add_u32 m0, s17, 30720
  s_nop 0
  buffer_load_dwordx4 v17, s[8:11], s20 offen lds
  s_add_u32 s20, s19, 458752
  s_add_u32 m0, s17, 31744
  s_nop 0
  buffer_load_dwordx4 v17, s[8:11], s20 offen lds
  s_xor_b32 s19, s13, 2
  s_lshl_b32 s19, s19, 1
  s_add_u32 s19, s19, 1
  s_lshl_b32 s19, s19, 19
  s_lshl_b32 s20, s12, 8
  s_add_u32 s19, s19, s20
  s_add_u32 s20, s19, 0
  s_add_u32 m0, s17, 32768
  s_nop 0
  buffer_load_dwordx4 v17, s[8:11], s20 offen lds
  s_add_u32 s20, s19, 65536
  s_add_u32 m0, s17, 33792
  s_nop 0
  buffer_load_dwordx4 v17, s[8:11], s20 offen lds
  s_add_u32 s20, s19, 131072
  s_add_u32 m0, s17, 34816
  s_nop 0
  buffer_load_dwordx4 v17, s[8:11], s20 offen lds
  s_add_u32 s20, s19, 196608
  s_add_u32 m0, s17, 35840
  s_nop 0
  buffer_load_dwordx4 v17, s[8:11], s20 offen lds
  s_add_u32 s20, s19, 262144
  s_add_u32 m0, s17, 36864
  s_nop 0
  buffer_load_dwordx4 v17, s[8:11], s20 offen lds
  s_add_u32 s20, s19, 327680
  s_add_u32 m0, s17, 37888
  s_nop 0
  buffer_load_dwordx4 v17, s[8:11], s20 offen lds
  s_add_u32 s20, s19, 393216
  s_add_u32 m0, s17, 38912
  s_nop 0
  buffer_load_dwordx4 v17, s[8:11], s20 offen lds
  s_add_u32 s20, s19, 458752
  s_add_u32 m0, s17, 39936
  s_nop 0
  buffer_load_dwordx4 v17, s[8:11], s20 offen lds
  v_add_u32 v23, 0, v25
  v_add_u32 v24, 1024, v25
  v_add_u32 v30, 4096, v25
  v_add_u32 v31, 5120, v25
  ds_read2_b32 v[32:33], v23 offset0:0 offset1:32
  ds_read2_b32 v[34:35], v24 offset0:0 offset1:32
  ds_read2_b32 v[36:37], v23 offset0:64 offset1:96
  ds_read2_b32 v[38:39], v24 offset0:64 offset1:96
  ds_read2_b32 v[40:41], v30 offset0:0 offset1:32
  ds_read2_b32 v[42:43], v31 offset0:0 offset1:32
  ds_read2_b32 v[44:45], v30 offset0:64 offset1:96
  ds_read2_b32 v[46:47], v31 offset0:64 offset1:96
  s_waitcnt lgkmcnt(0)
  v_perm_b32 v64, v33, v32, s45
  v_perm_b32 v65, v35, v34, s45
  v_perm_b32 v66, v37, v36, s45
  v_perm_b32 v67, v39, v38, s45
  v_perm_b32 v68, v41, v40, s45
  v_perm_b32 v69, v43, v42, s45
  v_perm_b32 v70, v45, v44, s45
  v_perm_b32 v71, v47, v46, s45
  s_add_u32 s20, s30, 2048
  buffer_store_dwordx4 v[64:67], v1, s[4:7], s20 offen
  buffer_store_dwordx4 v[68:71], v1, s[4:7], s20 offen offset:1024
  v_perm_b32 v72, v33, v32, s46
  v_perm_b32 v73, v35, v34, s46
  v_perm_b32 v74, v37, v36, s46
  v_perm_b32 v75, v39, v38, s46
  v_perm_b32 v76, v41, v40, s46
  v_perm_b32 v77, v43, v42, s46
  v_perm_b32 v78, v45, v44, s46
  v_perm_b32 v79, v47, v46, s46
  s_add_u32 s20, s30, 6144
  buffer_store_dwordx4 v[72:75], v1, s[4:7], s20 offen
  buffer_store_dwordx4 v[76:79], v1, s[4:7], s20 offen offset:1024
  v_add_u32 v23, 0, v29
  v_add_u32 v24, 1024, v29
  v_add_u32 v30, 4096, v29
  v_add_u32 v31, 5120, v29
  ds_read2_b32 v[32:33], v23 offset0:0 offset1:32
  ds_read2_b32 v[34:35], v24 offset0:0 offset1:32
  ds_read2_b32 v[36:37], v23 offset0:64 offset1:96
  ds_read2_b32 v[38:39], v24 offset0:64 offset1:96
  ds_read2_b32 v[40:41], v30 offset0:0 offset1:32
  ds_read2_b32 v[42:43], v31 offset0:0 offset1:32
  ds_read2_b32 v[44:45], v30 offset0:64 offset1:96
  ds_read2_b32 v[46:47], v31 offset0:64 offset1:96
  s_waitcnt lgkmcnt(0)
  v_perm_b32 v64, v33, v32, s45
  v_perm_b32 v65, v35, v34, s45
  v_perm_b32 v66, v37, v36, s45
  v_perm_b32 v67, v39, v38, s45
  v_perm_b32 v68, v41, v40, s45
  v_perm_b32 v69, v43, v42, s45
  v_perm_b32 v70, v45, v44, s45
  v_perm_b32 v71, v47, v46, s45
  s_add_u32 s20, s21, 6144
  buffer_store_dwordx4 v[64:67], v1, s[4:7], s20 offen
  buffer_store_dwordx4 v[68:71], v1, s[4:7], s20 offen offset:1024
  v_perm_b32 v72, v33, v32, s46
  v_perm_b32 v73, v35, v34, s46
  v_perm_b32 v74, v37, v36, s46
  v_perm_b32 v75, v39, v38, s46
  v_perm_b32 v76, v41, v40, s46
  v_perm_b32 v77, v43, v42, s46
  v_perm_b32 v78, v45, v44, s46
  v_perm_b32 v79, v47, v46, s46
  v_accvgpr_write_b32 a88, v72
  v_accvgpr_write_b32 a89, v73
  v_accvgpr_write_b32 a90, v74
  v_accvgpr_write_b32 a91, v75
  v_accvgpr_write_b32 a92, v76
  v_accvgpr_write_b32 a93, v77
  v_accvgpr_write_b32 a94, v78
  v_accvgpr_write_b32 a95, v79
  v_add_u32 v23, 8192, v25
  v_add_u32 v24, 9216, v25
  v_add_u32 v30, 12288, v25
  v_add_u32 v31, 13312, v25
  ds_read2_b32 v[32:33], v23 offset0:0 offset1:32
  ds_read2_b32 v[34:35], v24 offset0:0 offset1:32
  ds_read2_b32 v[36:37], v23 offset0:64 offset1:96
  ds_read2_b32 v[38:39], v24 offset0:64 offset1:96
  ds_read2_b32 v[40:41], v30 offset0:0 offset1:32
  ds_read2_b32 v[42:43], v31 offset0:0 offset1:32
  ds_read2_b32 v[44:45], v30 offset0:64 offset1:96
  ds_read2_b32 v[46:47], v31 offset0:64 offset1:96
  s_waitcnt lgkmcnt(0)
  v_perm_b32 v64, v33, v32, s45
  v_perm_b32 v65, v35, v34, s45
  v_perm_b32 v66, v37, v36, s45
  v_perm_b32 v67, v39, v38, s45
  v_perm_b32 v68, v41, v40, s45
  v_perm_b32 v69, v43, v42, s45
  v_perm_b32 v70, v45, v44, s45
  v_perm_b32 v71, v47, v46, s45
  v_accvgpr_write_b32 a8, v64
  v_accvgpr_write_b32 a9, v65
  v_accvgpr_write_b32 a10, v66
  v_accvgpr_write_b32 a11, v67
  v_accvgpr_write_b32 a12, v68
  v_accvgpr_write_b32 a13, v69
  v_accvgpr_write_b32 a14, v70
  v_accvgpr_write_b32 a15, v71
  v_perm_b32 v72, v33, v32, s46
  v_perm_b32 v73, v35, v34, s46
  v_perm_b32 v74, v37, v36, s46
  v_perm_b32 v75, v39, v38, s46
  v_perm_b32 v76, v41, v40, s46
  v_perm_b32 v77, v43, v42, s46
  v_perm_b32 v78, v45, v44, s46
  v_perm_b32 v79, v47, v46, s46
  s_add_u32 s20, s21, 0
  buffer_store_dwordx4 v[72:75], v1, s[4:7], s20 offen
  buffer_store_dwordx4 v[76:79], v1, s[4:7], s20 offen offset:1024
  v_add_u32 v23, 8192, v29
  v_add_u32 v24, 9216, v29
  v_add_u32 v30, 12288, v29
  v_add_u32 v31, 13312, v29
  ds_read2_b32 v[32:33], v23 offset0:0 offset1:32
  ds_read2_b32 v[34:35], v24 offset0:0 offset1:32
  ds_read2_b32 v[36:37], v23 offset0:64 offset1:96
  ds_read2_b32 v[38:39], v24 offset0:64 offset1:96
  ds_read2_b32 v[40:41], v30 offset0:0 offset1:32
  ds_read2_b32 v[42:43], v31 offset0:0 offset1:32
  ds_read2_b32 v[44:45], v30 offset0:64 offset1:96
  ds_read2_b32 v[46:47], v31 offset0:64 offset1:96
  s_waitcnt lgkmcnt(0)
  v_perm_b32 v64, v33, v32, s45
  v_perm_b32 v65, v35, v34, s45
  v_perm_b32 v66, v37, v36, s45
  v_perm_b32 v67, v39, v38, s45
  v_perm_b32 v68, v41, v40, s45
  v_perm_b32 v69, v43, v42, s45
  v_perm_b32 v70, v45, v44, s45
  v_perm_b32 v71, v47, v46, s45
  s_add_u32 s20, s21, 8192
  buffer_store_dwordx4 v[64:67], v1, s[4:7], s20 offen
  buffer_store_dwordx4 v[68:71], v1, s[4:7], s20 offen offset:1024
  v_perm_b32 v72, v33, v32, s46
  v_perm_b32 v73, v35, v34, s46
  v_perm_b32 v74, v37, v36, s46
  v_perm_b32 v75, v39, v38, s46
  v_perm_b32 v76, v41, v40, s46
  v_perm_b32 v77, v43, v42, s46
  v_perm_b32 v78, v45, v44, s46
  v_perm_b32 v79, v47, v46, s46
  v_accvgpr_write_b32 a112, v72
  v_accvgpr_write_b32 a113, v73
  v_accvgpr_write_b32 a114, v74
  v_accvgpr_write_b32 a115, v75
  v_accvgpr_write_b32 a116, v76
  v_accvgpr_write_b32 a117, v77
  v_accvgpr_write_b32 a118, v78
  v_accvgpr_write_b32 a119, v79
  s_waitcnt vmcnt(26)
  s_barrier
  s_mov_b32 s8, s60
  s_and_b32 s9, s61, 0xffff
  s_mov_b32 s10, 5242880
  s_mov_b32 s11, 0x00020000
  s_lshl_b32 s19, s13, 1
  s_lshl_b32 s19, s19, 19
  s_lshl_b32 s20, s12, 8
  s_add_u32 s19, s19, s20
  s_add_u32 s20, s19, 0
  s_add_u32 m0, s17, 0
  s_nop 0
  buffer_load_dwordx4 v17, s[8:11], s20 offen lds
  s_add_u32 s20, s19, 65536
  s_add_u32 m0, s17, 1024
  s_nop 0
  buffer_load_dwordx4 v17, s[8:11], s20 offen lds
  s_add_u32 s20, s19, 131072
  s_add_u32 m0, s17, 2048
  s_nop 0
  buffer_load_dwordx4 v17, s[8:11], s20 offen lds
  s_add_u32 s20, s19, 196608
  s_add_u32 m0, s17, 3072
  s_nop 0
  buffer_load_dwordx4 v17, s[8:11], s20 offen lds
  s_add_u32 s20, s19, 262144
  s_add_u32 m0, s17, 4096
  s_nop 0
  buffer_load_dwordx4 v17, s[8:11], s20 offen lds
  s_add_u32 s20, s19, 327680
  s_add_u32 m0, s17, 5120
  s_nop 0
  buffer_load_dwordx4 v17, s[8:11], s20 offen lds
  s_add_u32 s20, s19, 393216
  s_add_u32 m0, s17, 6144
  s_nop 0
  buffer_load_dwordx4 v17, s[8:11], s20 offen lds
  s_add_u32 s20, s19, 458752
  s_add_u32 m0, s17, 7168
  s_nop 0
  buffer_load_dwordx4 v17, s[8:11], s20 offen lds
  s_lshl_b32 s19, s13, 1
  s_add_u32 s19, s19, 1
  s_lshl_b32 s19, s19, 19
  s_lshl_b32 s20, s12, 8
  s_add_u32 s19, s19, s20
  s_add_u32 s20, s19, 0
  s_add_u32 m0, s17, 8192
  s_nop 0
  buffer_load_dwordx4 v17, s[8:11], s20 offen lds
  s_add_u32 s20, s19, 65536
  s_add_u32 m0, s17, 9216
  s_nop 0
  buffer_load_dwordx4 v17, s[8:11], s20 offen lds
  s_add_u32 s20, s19, 131072
  s_add_u32 m0, s17, 10240
  s_nop 0
  buffer_load_dwordx4 v17, s[8:11], s20 offen lds
  s_add_u32 s20, s19, 196608
  s_add_u32 m0, s17, 11264
  s_nop 0
  buffer_load_dwordx4 v17, s[8:11], s20 offen lds
  s_add_u32 s20, s19, 262144
  s_add_u32 m0, s17, 12288
  s_nop 0
  buffer_load_dwordx4 v17, s[8:11], s20 offen lds
  s_add_u32 s20, s19, 327680
  s_add_u32 m0, s17, 13312
  s_nop 0
  buffer_load_dwordx4 v17, s[8:11], s20 offen lds
  s_add_u32 s20, s19, 393216
  s_add_u32 m0, s17, 14336
  s_nop 0
  buffer_load_dwordx4 v17, s[8:11], s20 offen lds
  s_add_u32 s20, s19, 458752
  s_add_u32 m0, s17, 15360
  s_nop 0
  buffer_load_dwordx4 v17, s[8:11], s20 offen lds
  v_add_u32 v23, 16384, v25
  v_add_u32 v24, 17408, v25
  v_add_u32 v30, 20480, v25
  v_add_u32 v31, 21504, v25
  ds_read2_b32 v[32:33], v23 offset0:0 offset1:32
  ds_read2_b32 v[34:35], v24 offset0:0 offset1:32
  ds_read2_b32 v[36:37], v23 offset0:64 offset1:96
  ds_read2_b32 v[38:39], v24 offset0:64 offset1:96
  ds_read2_b32 v[40:41], v30 offset0:0 offset1:32
  ds_read2_b32 v[42:43], v31 offset0:0 offset1:32
  ds_read2_b32 v[44:45], v30 offset0:64 offset1:96
  ds_read2_b32 v[46:47], v31 offset0:64 offset1:96
  s_waitcnt lgkmcnt(0)
  v_perm_b32 v64, v33, v32, s45
  v_perm_b32 v65, v35, v34, s45
  v_perm_b32 v66, v37, v36, s45
  v_perm_b32 v67, v39, v38, s45
  v_perm_b32 v68, v41, v40, s45
  v_perm_b32 v69, v43, v42, s45
  v_perm_b32 v70, v45, v44, s45
  v_perm_b32 v71, v47, v46, s45
  s_add_u32 s20, s21, 2048
  buffer_store_dwordx4 v[64:67], v1, s[4:7], s20 offen
  buffer_store_dwordx4 v[68:71], v1, s[4:7], s20 offen offset:1024
  v_perm_b32 v72, v33, v32, s46
  v_perm_b32 v73, v35, v34, s46
  v_perm_b32 v74, v37, v36, s46
  v_perm_b32 v75, v39, v38, s46
  v_perm_b32 v76, v41, v40, s46
  v_perm_b32 v77, v43, v42, s46
  v_perm_b32 v78, v45, v44, s46
  v_perm_b32 v79, v47, v46, s46
  v_accvgpr_write_b32 a40, v72
  v_accvgpr_write_b32 a41, v73
  v_accvgpr_write_b32 a42, v74
  v_accvgpr_write_b32 a43, v75
  v_accvgpr_write_b32 a44, v76
  v_accvgpr_write_b32 a45, v77
  v_accvgpr_write_b32 a46, v78
  v_accvgpr_write_b32 a47, v79
  v_add_u32 v23, 16384, v29
  v_add_u32 v24, 17408, v29
  v_add_u32 v30, 20480, v29
  v_add_u32 v31, 21504, v29
  ds_read2_b32 v[32:33], v23 offset0:0 offset1:32
  ds_read2_b32 v[34:35], v24 offset0:0 offset1:32
  ds_read2_b32 v[36:37], v23 offset0:64 offset1:96
  ds_read2_b32 v[38:39], v24 offset0:64 offset1:96
  ds_read2_b32 v[40:41], v30 offset0:0 offset1:32
  ds_read2_b32 v[42:43], v31 offset0:0 offset1:32
  ds_read2_b32 v[44:45], v30 offset0:64 offset1:96
  ds_read2_b32 v[46:47], v31 offset0:64 offset1:96
  s_waitcnt lgkmcnt(0)
  v_perm_b32 v64, v33, v32, s45
  v_perm_b32 v65, v35, v34, s45
  v_perm_b32 v66, v37, v36, s45
  v_perm_b32 v67, v39, v38, s45
  v_perm_b32 v68, v41, v40, s45
  v_perm_b32 v69, v43, v42, s45
  v_perm_b32 v70, v45, v44, s45
  v_perm_b32 v71, v47, v46, s45
  s_add_u32 s20, s21, 4096
  buffer_store_dwordx4 v[64:67], v1, s[4:7], s20 offen
  buffer_store_dwordx4 v[68:71], v1, s[4:7], s20 offen offset:1024
  v_perm_b32 v72, v33, v32, s46
  v_perm_b32 v73, v35, v34, s46
  v_perm_b32 v74, v37, v36, s46
  v_perm_b32 v75, v39, v38, s46
  v_perm_b32 v76, v41, v40, s46
  v_perm_b32 v77, v43, v42, s46
  v_perm_b32 v78, v45, v44, s46
  v_perm_b32 v79, v47, v46, s46
  v_accvgpr_write_b32 a64, v72
  v_accvgpr_write_b32 a65, v73
  v_accvgpr_write_b32 a66, v74
  v_accvgpr_write_b32 a67, v75
  v_accvgpr_write_b32 a68, v76
  v_accvgpr_write_b32 a69, v77
  v_accvgpr_write_b32 a70, v78
  v_accvgpr_write_b32 a71, v79
  s_waitcnt vmcnt(30)
  s_barrier
  s_mov_b32 s8, s60
  s_and_b32 s9, s61, 0xffff
  s_mov_b32 s10, 5242880
  s_mov_b32 s11, 0x00020000
  s_and_b32 s19, s13, 1
  s_add_u32 s19, s19, 8
  s_lshl_b32 s19, s19, 19
  s_lshl_b32 s20, s12, 8
  s_add_u32 s19, s19, s20
  s_add_u32 s20, s19, 0
  s_add_u32 m0, s17, 16384
  s_nop 0
  buffer_load_dwordx4 v17, s[8:11], s20 offen lds
  s_add_u32 s20, s19, 65536
  s_add_u32 m0, s17, 17408
  s_nop 0
  buffer_load_dwordx4 v17, s[8:11], s20 offen lds
  s_add_u32 s20, s19, 131072
  s_add_u32 m0, s17, 18432
  s_nop 0
  buffer_load_dwordx4 v17, s[8:11], s20 offen lds
  s_add_u32 s20, s19, 196608
  s_add_u32 m0, s17, 19456
  s_nop 0
  buffer_load_dwordx4 v17, s[8:11], s20 offen lds
  s_add_u32 s20, s19, 262144
  s_add_u32 m0, s17, 20480
  s_nop 0
  buffer_load_dwordx4 v17, s[8:11], s20 offen lds
  s_add_u32 s20, s19, 327680
  s_add_u32 m0, s17, 21504
  s_nop 0
  buffer_load_dwordx4 v17, s[8:11], s20 offen lds
  s_add_u32 s20, s19, 393216
  s_add_u32 m0, s17, 22528
  s_nop 0
  buffer_load_dwordx4 v17, s[8:11], s20 offen lds
  s_add_u32 s20, s19, 458752
  s_add_u32 m0, s17, 23552
  s_nop 0
  buffer_load_dwordx4 v17, s[8:11], s20 offen lds
  v_add_u32 v23, 24576, v25
  v_add_u32 v24, 25600, v25
  v_add_u32 v30, 28672, v25
  v_add_u32 v31, 29696, v25
  ds_read2_b32 v[32:33], v23 offset0:0 offset1:32
  ds_read2_b32 v[34:35], v24 offset0:0 offset1:32
  ds_read2_b32 v[36:37], v23 offset0:64 offset1:96
  ds_read2_b32 v[38:39], v24 offset0:64 offset1:96
  ds_read2_b32 v[40:41], v30 offset0:0 offset1:32
  ds_read2_b32 v[42:43], v31 offset0:0 offset1:32
  ds_read2_b32 v[44:45], v30 offset0:64 offset1:96
  ds_read2_b32 v[46:47], v31 offset0:64 offset1:96
  s_waitcnt lgkmcnt(0)
  v_perm_b32 v64, v33, v32, s45
  v_perm_b32 v65, v35, v34, s45
  v_perm_b32 v66, v37, v36, s45
  v_perm_b32 v67, v39, v38, s45
  v_perm_b32 v68, v41, v40, s45
  v_perm_b32 v69, v43, v42, s45
  v_perm_b32 v70, v45, v44, s45
  v_perm_b32 v71, v47, v46, s45
  s_add_u32 s20, s21, 10240
  buffer_store_dwordx4 v[64:67], v1, s[4:7], s20 offen
  buffer_store_dwordx4 v[68:71], v1, s[4:7], s20 offen offset:1024
  v_perm_b32 v72, v33, v32, s46
  v_perm_b32 v73, v35, v34, s46
  v_perm_b32 v74, v37, v36, s46
  v_perm_b32 v75, v39, v38, s46
  v_perm_b32 v76, v41, v40, s46
  v_perm_b32 v77, v43, v42, s46
  v_perm_b32 v78, v45, v44, s46
  v_perm_b32 v79, v47, v46, s46
  v_accvgpr_write_b32 a136, v72
  v_accvgpr_write_b32 a137, v73
  v_accvgpr_write_b32 a138, v74
  v_accvgpr_write_b32 a139, v75
  v_accvgpr_write_b32 a140, v76
  v_accvgpr_write_b32 a141, v77
  v_accvgpr_write_b32 a142, v78
  v_accvgpr_write_b32 a143, v79
  v_add_u32 v23, 24576, v29
  v_add_u32 v24, 25600, v29
  v_add_u32 v30, 28672, v29
  v_add_u32 v31, 29696, v29
  ds_read2_b32 v[32:33], v23 offset0:0 offset1:32
  ds_read2_b32 v[34:35], v24 offset0:0 offset1:32
  ds_read2_b32 v[36:37], v23 offset0:64 offset1:96
  ds_read2_b32 v[38:39], v24 offset0:64 offset1:96
  ds_read2_b32 v[40:41], v30 offset0:0 offset1:32
  ds_read2_b32 v[42:43], v31 offset0:0 offset1:32
  ds_read2_b32 v[44:45], v30 offset0:64 offset1:96
  ds_read2_b32 v[46:47], v31 offset0:64 offset1:96
  s_waitcnt lgkmcnt(0)
  v_perm_b32 v64, v33, v32, s45
  v_perm_b32 v65, v35, v34, s45
  v_perm_b32 v66, v37, v36, s45
  v_perm_b32 v67, v39, v38, s45
  v_perm_b32 v68, v41, v40, s45
  v_perm_b32 v69, v43, v42, s45
  v_perm_b32 v70, v45, v44, s45
  v_perm_b32 v71, v47, v46, s45
  s_add_u32 s20, s21, 14336
  buffer_store_dwordx4 v[64:67], v1, s[4:7], s20 offen
  buffer_store_dwordx4 v[68:71], v1, s[4:7], s20 offen offset:1024
  v_perm_b32 v72, v33, v32, s46
  v_perm_b32 v73, v35, v34, s46
  v_perm_b32 v74, v37, v36, s46
  v_perm_b32 v75, v39, v38, s46
  v_perm_b32 v76, v41, v40, s46
  v_perm_b32 v77, v43, v42, s46
  v_perm_b32 v78, v45, v44, s46
  v_perm_b32 v79, v47, v46, s46
  v_accvgpr_write_b32 a184, v72
  v_accvgpr_write_b32 a185, v73
  v_accvgpr_write_b32 a186, v74
  v_accvgpr_write_b32 a187, v75
  v_accvgpr_write_b32 a188, v76
  v_accvgpr_write_b32 a189, v77
  v_accvgpr_write_b32 a190, v78
  v_accvgpr_write_b32 a191, v79
  v_add_u32 v23, 32768, v25
  v_add_u32 v24, 33792, v25
  v_add_u32 v30, 36864, v25
  v_add_u32 v31, 37888, v25
  ds_read2_b32 v[32:33], v23 offset0:0 offset1:32
  ds_read2_b32 v[34:35], v24 offset0:0 offset1:32
  ds_read2_b32 v[36:37], v23 offset0:64 offset1:96
  ds_read2_b32 v[38:39], v24 offset0:64 offset1:96
  ds_read2_b32 v[40:41], v30 offset0:0 offset1:32
  ds_read2_b32 v[42:43], v31 offset0:0 offset1:32
  ds_read2_b32 v[44:45], v30 offset0:64 offset1:96
  ds_read2_b32 v[46:47], v31 offset0:64 offset1:96
  s_waitcnt lgkmcnt(0)
  v_perm_b32 v64, v33, v32, s45
  v_perm_b32 v65, v35, v34, s45
  v_perm_b32 v66, v37, v36, s45
  v_perm_b32 v67, v39, v38, s45
  v_perm_b32 v68, v41, v40, s45
  v_perm_b32 v69, v43, v42, s45
  v_perm_b32 v70, v45, v44, s45
  v_perm_b32 v71, v47, v46, s45
  s_add_u32 s20, s21, 12288
  buffer_store_dwordx4 v[64:67], v1, s[4:7], s20 offen
  buffer_store_dwordx4 v[68:71], v1, s[4:7], s20 offen offset:1024
  v_perm_b32 v72, v33, v32, s46
  v_perm_b32 v73, v35, v34, s46
  v_perm_b32 v74, v37, v36, s46
  v_perm_b32 v75, v39, v38, s46
  v_perm_b32 v76, v41, v40, s46
  v_perm_b32 v77, v43, v42, s46
  v_perm_b32 v78, v45, v44, s46
  v_perm_b32 v79, v47, v46, s46
  v_accvgpr_write_b32 a160, v72
  v_accvgpr_write_b32 a161, v73
  v_accvgpr_write_b32 a162, v74
  v_accvgpr_write_b32 a163, v75
  v_accvgpr_write_b32 a164, v76
  v_accvgpr_write_b32 a165, v77
  v_accvgpr_write_b32 a166, v78
  v_accvgpr_write_b32 a167, v79
  v_add_u32 v23, 32768, v29
  v_add_u32 v24, 33792, v29
  v_add_u32 v30, 36864, v29
  v_add_u32 v31, 37888, v29
  ds_read2_b32 v[32:33], v23 offset0:0 offset1:32
  ds_read2_b32 v[34:35], v24 offset0:0 offset1:32
  ds_read2_b32 v[36:37], v23 offset0:64 offset1:96
  ds_read2_b32 v[38:39], v24 offset0:64 offset1:96
  ds_read2_b32 v[40:41], v30 offset0:0 offset1:32
  ds_read2_b32 v[42:43], v31 offset0:0 offset1:32
  ds_read2_b32 v[44:45], v30 offset0:64 offset1:96
  ds_read2_b32 v[46:47], v31 offset0:64 offset1:96
  s_waitcnt lgkmcnt(0)
  v_perm_b32 v64, v33, v32, s45
  v_perm_b32 v65, v35, v34, s45
  v_perm_b32 v66, v37, v36, s45
  v_perm_b32 v67, v39, v38, s45
  v_perm_b32 v68, v41, v40, s45
  v_perm_b32 v69, v43, v42, s45
  v_perm_b32 v70, v45, v44, s45
  v_perm_b32 v71, v47, v46, s45
  s_add_u32 s20, s21, 16384
  buffer_store_dwordx4 v[64:67], v1, s[4:7], s20 offen
  buffer_store_dwordx4 v[68:71], v1, s[4:7], s20 offen offset:1024
  v_perm_b32 v72, v33, v32, s46
  v_perm_b32 v73, v35, v34, s46
  v_perm_b32 v74, v37, v36, s46
  v_perm_b32 v75, v39, v38, s46
  v_perm_b32 v76, v41, v40, s46
  v_perm_b32 v77, v43, v42, s46
  v_perm_b32 v78, v45, v44, s46
  v_perm_b32 v79, v47, v46, s46
  v_accvgpr_write_b32 a208, v72
  v_accvgpr_write_b32 a209, v73
  v_accvgpr_write_b32 a210, v74
  v_accvgpr_write_b32 a211, v75
  v_accvgpr_write_b32 a212, v76
  v_accvgpr_write_b32 a213, v77
  v_accvgpr_write_b32 a214, v78
  v_accvgpr_write_b32 a215, v79
  s_waitcnt vmcnt(20)
  s_barrier
  s_mov_b32 s8, s60
  s_and_b32 s9, s61, 0xffff
  s_mov_b32 s10, 5242880
  s_mov_b32 s11, 0x00020000
  s_xor_b32 s19, s13, 2
  s_lshl_b32 s19, s19, 1
  s_lshl_b32 s19, s19, 19
  s_lshl_b32 s20, s12, 8
  s_add_u32 s19, s19, s20
  s_add_u32 s20, s19, 0
  s_add_u32 m0, s17, 24576
  s_nop 0
  buffer_load_dwordx4 v17, s[8:11], s20 offen lds
  s_add_u32 s20, s19, 65536
  s_add_u32 m0, s17, 25600
  s_nop 0
  buffer_load_dwordx4 v17, s[8:11], s20 offen lds
  s_add_u32 s20, s19, 131072
  s_add_u32 m0, s17, 26624
  s_nop 0
  buffer_load_dwordx4 v17, s[8:11], s20 offen lds
  s_add_u32 s20, s19, 196608
  s_add_u32 m0, s17, 27648
  s_nop 0
  buffer_load_dwordx4 v17, s[8:11], s20 offen lds
  s_add_u32 s20, s19, 262144
  s_add_u32 m0, s17, 28672
  s_nop 0
  buffer_load_dwordx4 v17, s[8:11], s20 offen lds
  s_add_u32 s20, s19, 327680
  s_add_u32 m0, s17, 29696
  s_nop 0
  buffer_load_dwordx4 v17, s[8:11], s20 offen lds
  s_add_u32 s20, s19, 393216
  s_add_u32 m0, s17, 30720
  s_nop 0
  buffer_load_dwordx4 v17, s[8:11], s20 offen lds
  s_add_u32 s20, s19, 458752
  s_add_u32 m0, s17, 31744
  s_nop 0
  buffer_load_dwordx4 v17, s[8:11], s20 offen lds
  s_xor_b32 s19, s13, 2
  s_lshl_b32 s19, s19, 1
  s_add_u32 s19, s19, 1
  s_lshl_b32 s19, s19, 19
  s_lshl_b32 s20, s12, 8
  s_add_u32 s19, s19, s20
  s_add_u32 s20, s19, 0
  s_add_u32 m0, s17, 32768
  s_nop 0
  buffer_load_dwordx4 v17, s[8:11], s20 offen lds
  s_add_u32 s20, s19, 65536
  s_add_u32 m0, s17, 33792
  s_nop 0
  buffer_load_dwordx4 v17, s[8:11], s20 offen lds
  s_add_u32 s20, s19, 131072
  s_add_u32 m0, s17, 34816
  s_nop 0
  buffer_load_dwordx4 v17, s[8:11], s20 offen lds
  s_add_u32 s20, s19, 196608
  s_add_u32 m0, s17, 35840
  s_nop 0
  buffer_load_dwordx4 v17, s[8:11], s20 offen lds
  s_add_u32 s20, s19, 262144
  s_add_u32 m0, s17, 36864
  s_nop 0
  buffer_load_dwordx4 v17, s[8:11], s20 offen lds
  s_add_u32 s20, s19, 327680
  s_add_u32 m0, s17, 37888
  s_nop 0
  buffer_load_dwordx4 v17, s[8:11], s20 offen lds
  s_add_u32 s20, s19, 393216
  s_add_u32 m0, s17, 38912
  s_nop 0
  buffer_load_dwordx4 v17, s[8:11], s20 offen lds
  s_add_u32 s20, s19, 458752
  s_add_u32 m0, s17, 39936
  s_nop 0
  buffer_load_dwordx4 v17, s[8:11], s20 offen lds
  v_add_u32 v23, 0, v25
  v_add_u32 v24, 1024, v25
  v_add_u32 v30, 4096, v25
  v_add_u32 v31, 5120, v25
  ds_read2_b32 v[32:33], v23 offset0:0 offset1:32
  ds_read2_b32 v[34:35], v24 offset0:0 offset1:32
  ds_read2_b32 v[36:37], v23 offset0:64 offset1:96
  ds_read2_b32 v[38:39], v24 offset0:64 offset1:96
  ds_read2_b32 v[40:41], v30 offset0:0 offset1:32
  ds_read2_b32 v[42:43], v31 offset0:0 offset1:32
  ds_read2_b32 v[44:45], v30 offset0:64 offset1:96
  ds_read2_b32 v[46:47], v31 offset0:64 offset1:96
  s_waitcnt lgkmcnt(0)
  v_perm_b32 v64, v33, v32, s45
  v_perm_b32 v65, v35, v34, s45
  v_perm_b32 v66, v37, v36, s45
  v_perm_b32 v67, v39, v38, s45
  v_perm_b32 v68, v41, v40, s45
  v_perm_b32 v69, v43, v42, s45
  v_perm_b32 v70, v45, v44, s45
  v_perm_b32 v71, v47, v46, s45
  v_accvgpr_write_b32 a216, v64
  v_accvgpr_write_b32 a217, v65
  v_accvgpr_write_b32 a218, v66
  v_accvgpr_write_b32 a219, v67
  v_accvgpr_write_b32 a220, v68
  v_accvgpr_write_b32 a221, v69
  v_accvgpr_write_b32 a222, v70
  v_accvgpr_write_b32 a223, v71
  v_perm_b32 v72, v33, v32, s46
  v_perm_b32 v73, v35, v34, s46
  v_perm_b32 v74, v37, v36, s46
  v_perm_b32 v75, v39, v38, s46
  v_perm_b32 v76, v41, v40, s46
  v_perm_b32 v77, v43, v42, s46
  v_perm_b32 v78, v45, v44, s46
  v_perm_b32 v79, v47, v46, s46
  v_accvgpr_write_b32 a224, v72
  v_accvgpr_write_b32 a225, v73
  v_accvgpr_write_b32 a226, v74
  v_accvgpr_write_b32 a227, v75
  v_accvgpr_write_b32 a228, v76
  v_accvgpr_write_b32 a229, v77
  v_accvgpr_write_b32 a230, v78
  v_accvgpr_write_b32 a231, v79
  v_add_u32 v23, 0, v29
  v_add_u32 v24, 1024, v29
  v_add_u32 v30, 4096, v29
  v_add_u32 v31, 5120, v29
  ds_read2_b32 v[32:33], v23 offset0:0 offset1:32
  ds_read2_b32 v[34:35], v24 offset0:0 offset1:32
  ds_read2_b32 v[36:37], v23 offset0:64 offset1:96
  ds_read2_b32 v[38:39], v24 offset0:64 offset1:96
  ds_read2_b32 v[40:41], v30 offset0:0 offset1:32
  ds_read2_b32 v[42:43], v31 offset0:0 offset1:32
  ds_read2_b32 v[44:45], v30 offset0:64 offset1:96
  ds_read2_b32 v[46:47], v31 offset0:64 offset1:96
  s_waitcnt lgkmcnt(0)
  v_perm_b32 v96, v33, v32, s45
  v_perm_b32 v97, v35, v34, s45
  v_perm_b32 v98, v37, v36, s45
  v_perm_b32 v99, v39, v38, s45
  v_perm_b32 v100, v41, v40, s45
  v_perm_b32 v101, v43, v42, s45
  v_perm_b32 v102, v45, v44, s45
  v_perm_b32 v103, v47, v46, s45
  v_perm_b32 v72, v33, v32, s46
  v_perm_b32 v73, v35, v34, s46
  v_perm_b32 v74, v37, v36, s46
  v_perm_b32 v75, v39, v38, s46
  v_perm_b32 v76, v41, v40, s46
  v_perm_b32 v77, v43, v42, s46
  v_perm_b32 v78, v45, v44, s46
  v_perm_b32 v79, v47, v46, s46
  s_add_u32 s20, s21, 24576
  buffer_store_dwordx4 v[72:75], v1, s[4:7], s20 offen
  buffer_store_dwordx4 v[76:79], v1, s[4:7], s20 offen offset:1024
  v_add_u32 v23, 8192, v25
  v_add_u32 v24, 9216, v25
  v_add_u32 v30, 12288, v25
  v_add_u32 v31, 13312, v25
  ds_read2_b32 v[32:33], v23 offset0:0 offset1:32
  ds_read2_b32 v[34:35], v24 offset0:0 offset1:32
  ds_read2_b32 v[36:37], v23 offset0:64 offset1:96
  ds_read2_b32 v[38:39], v24 offset0:64 offset1:96
  ds_read2_b32 v[40:41], v30 offset0:0 offset1:32
  ds_read2_b32 v[42:43], v31 offset0:0 offset1:32
  ds_read2_b32 v[44:45], v30 offset0:64 offset1:96
  ds_read2_b32 v[46:47], v31 offset0:64 offset1:96
  s_waitcnt lgkmcnt(0)
  v_perm_b32 v64, v33, v32, s45
  v_perm_b32 v65, v35, v34, s45
  v_perm_b32 v66, v37, v36, s45
  v_perm_b32 v67, v39, v38, s45
  v_perm_b32 v68, v41, v40, s45
  v_perm_b32 v69, v43, v42, s45
  v_perm_b32 v70, v45, v44, s45
  v_perm_b32 v71, v47, v46, s45
  v_accvgpr_write_b32 a232, v64
  v_accvgpr_write_b32 a233, v65
  v_accvgpr_write_b32 a234, v66
  v_accvgpr_write_b32 a235, v67
  v_accvgpr_write_b32 a236, v68
  v_accvgpr_write_b32 a237, v69
  v_accvgpr_write_b32 a238, v70
  v_accvgpr_write_b32 a239, v71
  v_perm_b32 v72, v33, v32, s46
  v_perm_b32 v73, v35, v34, s46
  v_perm_b32 v74, v37, v36, s46
  v_perm_b32 v75, v39, v38, s46
  v_perm_b32 v76, v41, v40, s46
  v_perm_b32 v77, v43, v42, s46
  v_perm_b32 v78, v45, v44, s46
  v_perm_b32 v79, v47, v46, s46
  s_add_u32 s20, s21, 18432
  buffer_store_dwordx4 v[72:75], v1, s[4:7], s20 offen
  buffer_store_dwordx4 v[76:79], v1, s[4:7], s20 offen offset:1024
  v_add_u32 v23, 8192, v29
  v_add_u32 v24, 9216, v29
  v_add_u32 v30, 12288, v29
  v_add_u32 v31, 13312, v29
  ds_read2_b32 v[32:33], v23 offset0:0 offset1:32
  ds_read2_b32 v[34:35], v24 offset0:0 offset1:32
  ds_read2_b32 v[36:37], v23 offset0:64 offset1:96
  ds_read2_b32 v[38:39], v24 offset0:64 offset1:96
  ds_read2_b32 v[40:41], v30 offset0:0 offset1:32
  ds_read2_b32 v[42:43], v31 offset0:0 offset1:32
  ds_read2_b32 v[44:45], v30 offset0:64 offset1:96
  ds_read2_b32 v[46:47], v31 offset0:64 offset1:96
  s_waitcnt lgkmcnt(0)
  v_perm_b32 v104, v33, v32, s45
  v_perm_b32 v105, v35, v34, s45
  v_perm_b32 v106, v37, v36, s45
  v_perm_b32 v107, v39, v38, s45
  v_perm_b32 v108, v41, v40, s45
  v_perm_b32 v109, v43, v42, s45
  v_perm_b32 v110, v45, v44, s45
  v_perm_b32 v111, v47, v46, s45
  v_perm_b32 v72, v33, v32, s46
  v_perm_b32 v73, v35, v34, s46
  v_perm_b32 v74, v37, v36, s46
  v_perm_b32 v75, v39, v38, s46
  v_perm_b32 v76, v41, v40, s46
  v_perm_b32 v77, v43, v42, s46
  v_perm_b32 v78, v45, v44, s46
  v_perm_b32 v79, v47, v46, s46
  s_add_u32 s20, s21, 26624
  buffer_store_dwordx4 v[72:75], v1, s[4:7], s20 offen
  buffer_store_dwordx4 v[76:79], v1, s[4:7], s20 offen offset:1024
  s_waitcnt vmcnt(30)
  s_barrier
  s_mov_b32 s8, s62
  s_and_b32 s9, s63, 0xffff
  s_mov_b32 s10, 5242880
  s_mov_b32 s11, 0x00020000
  s_mul_i32 s19, s12, 163840
  s_add_u32 s20, s19, 0
  s_add_u32 m0, s17, 0
  s_nop 0
  buffer_load_dwordx4 v18, s[8:11], s20 offen lds
  s_add_u32 s20, s19, 0
  s_add_u32 m0, s17, 1024
  s_nop 0
  buffer_load_dwordx4 v19, s[8:11], s20 offen lds
  s_add_u32 s20, s19, 0
  s_add_u32 m0, s17, 2048
  s_nop 0
  buffer_load_dwordx4 v20, s[8:11], s20 offen lds
  s_add_u32 s20, s19, 0
  s_add_u32 m0, s17, 3072
  s_nop 0
  buffer_load_dwordx4 v21, s[8:11], s20 offen lds
  s_add_u32 s20, s19, 0
  s_add_u32 m0, s17, 4096
  s_nop 0
  buffer_load_dwordx4 v22, s[8:11], s20 offen lds
  s_add_u32 s20, s19, 20480
  s_add_u32 m0, s17, 5120
  s_nop 0
  buffer_load_dwordx4 v18, s[8:11], s20 offen lds
  s_add_u32 s20, s19, 20480
  s_add_u32 m0, s17, 6144
  s_nop 0
  buffer_load_dwordx4 v19, s[8:11], s20 offen lds
  s_add_u32 s20, s19, 20480
  s_add_u32 m0, s17, 7168
  s_nop 0
  buffer_load_dwordx4 v20, s[8:11], s20 offen lds
  s_mul_i32 s19, s12, 163840
  s_add_u32 s20, s19, 20480
  s_add_u32 m0, s17, 8192
  s_nop 0
  buffer_load_dwordx4 v21, s[8:11], s20 offen lds
  s_add_u32 s20, s19, 20480
  s_add_u32 m0, s17, 9216
  s_nop 0
  buffer_load_dwordx4 v22, s[8:11], s20 offen lds
  s_add_u32 s20, s19, 40960
  s_add_u32 m0, s17, 10240
  s_nop 0
  buffer_load_dwordx4 v18, s[8:11], s20 offen lds
  s_add_u32 s20, s19, 40960
  s_add_u32 m0, s17, 11264
  s_nop 0
  buffer_load_dwordx4 v19, s[8:11], s20 offen lds
  s_add_u32 s20, s19, 40960
  s_add_u32 m0, s17, 12288
  s_nop 0
  buffer_load_dwordx4 v20, s[8:11], s20 offen lds
  s_add_u32 s20, s19, 40960
  s_add_u32 m0, s17, 13312
  s_nop 0
  buffer_load_dwordx4 v21, s[8:11], s20 offen lds
  s_add_u32 s20, s19, 40960
  s_add_u32 m0, s17, 14336
  s_nop 0
  buffer_load_dwordx4 v22, s[8:11], s20 offen lds
  s_add_u32 s20, s19, 61440
  s_add_u32 m0, s17, 15360
  s_nop 0
  buffer_load_dwordx4 v18, s[8:11], s20 offen lds
  v_add_u32 v23, 16384, v25
  v_add_u32 v24, 17408, v25
  v_add_u32 v30, 20480, v25
  v_add_u32 v31, 21504, v25
  ds_read2_b32 v[32:33], v23 offset0:0 offset1:32
  ds_read2_b32 v[34:35], v24 offset0:0 offset1:32
  ds_read2_b32 v[36:37], v23 offset0:64 offset1:96
  ds_read2_b32 v[38:39], v24 offset0:64 offset1:96
  ds_read2_b32 v[40:41], v30 offset0:0 offset1:32
  ds_read2_b32 v[42:43], v31 offset0:0 offset1:32
  ds_read2_b32 v[44:45], v30 offset0:64 offset1:96
  ds_read2_b32 v[46:47], v31 offset0:64 offset1:96
  s_waitcnt lgkmcnt(0)
  v_perm_b32 v64, v33, v32, s45
  v_perm_b32 v65, v35, v34, s45
  v_perm_b32 v66, v37, v36, s45
  v_perm_b32 v67, v39, v38, s45
  v_perm_b32 v68, v41, v40, s45
  v_perm_b32 v69, v43, v42, s45
  v_perm_b32 v70, v45, v44, s45
  v_perm_b32 v71, v47, v46, s45
  v_accvgpr_write_b32 a240, v64
  v_accvgpr_write_b32 a241, v65
  v_accvgpr_write_b32 a242, v66
  v_accvgpr_write_b32 a243, v67
  v_accvgpr_write_b32 a244, v68
  v_accvgpr_write_b32 a245, v69
  v_accvgpr_write_b32 a246, v70
  v_accvgpr_write_b32 a247, v71
  v_perm_b32 v72, v33, v32, s46
  v_perm_b32 v73, v35, v34, s46
  v_perm_b32 v74, v37, v36, s46
  v_perm_b32 v75, v39, v38, s46
  v_perm_b32 v76, v41, v40, s46
  v_perm_b32 v77, v43, v42, s46
  v_perm_b32 v78, v45, v44, s46
  v_perm_b32 v79, v47, v46, s46
  s_add_u32 s20, s21, 20480
  buffer_store_dwordx4 v[72:75], v1, s[4:7], s20 offen
  buffer_store_dwordx4 v[76:79], v1, s[4:7], s20 offen offset:1024
  v_add_u32 v23, 16384, v29
  v_add_u32 v24, 17408, v29
  v_add_u32 v30, 20480, v29
  v_add_u32 v31, 21504, v29
  ds_read2_b32 v[32:33], v23 offset0:0 offset1:32
  ds_read2_b32 v[34:35], v24 offset0:0 offset1:32
  ds_read2_b32 v[36:37], v23 offset0:64 offset1:96
  ds_read2_b32 v[38:39], v24 offset0:64 offset1:96
  ds_read2_b32 v[40:41], v30 offset0:0 offset1:32
  ds_read2_b32 v[42:43], v31 offset0:0 offset1:32
  ds_read2_b32 v[44:45], v30 offset0:64 offset1:96
  ds_read2_b32 v[46:47], v31 offset0:64 offset1:96
  s_waitcnt lgkmcnt(0)
  v_perm_b32 v64, v33, v32, s45
  v_perm_b32 v65, v35, v34, s45
  v_perm_b32 v66, v37, v36, s45
  v_perm_b32 v67, v39, v38, s45
  v_perm_b32 v68, v41, v40, s45
  v_perm_b32 v69, v43, v42, s45
  v_perm_b32 v70, v45, v44, s45
  v_perm_b32 v71, v47, v46, s45
  v_accvgpr_write_b32 a248, v64
  v_accvgpr_write_b32 a249, v65
  v_accvgpr_write_b32 a250, v66
  v_accvgpr_write_b32 a251, v67
  v_accvgpr_write_b32 a252, v68
  v_accvgpr_write_b32 a253, v69
  v_accvgpr_write_b32 a254, v70
  v_accvgpr_write_b32 a255, v71
  v_perm_b32 v72, v33, v32, s46
  v_perm_b32 v73, v35, v34, s46
  v_perm_b32 v74, v37, v36, s46
  v_perm_b32 v75, v39, v38, s46
  v_perm_b32 v76, v41, v40, s46
  v_perm_b32 v77, v43, v42, s46
  v_perm_b32 v78, v45, v44, s46
  v_perm_b32 v79, v47, v46, s46
  s_add_u32 s20, s21, 22528
  buffer_store_dwordx4 v[72:75], v1, s[4:7], s20 offen
  buffer_store_dwordx4 v[76:79], v1, s[4:7], s20 offen offset:1024
  s_waitcnt vmcnt(26)
  s_barrier
  s_mov_b32 s8, s62
  s_and_b32 s9, s63, 0xffff
  s_mov_b32 s10, 5242880
  s_mov_b32 s11, 0x00020000
  s_mul_i32 s19, s12, 163840
  s_add_u32 s20, s19, 61440
  s_add_u32 m0, s17, 16384
  s_nop 0
  buffer_load_dwordx4 v19, s[8:11], s20 offen lds
  s_add_u32 s20, s19, 61440
  s_add_u32 m0, s17, 17408
  s_nop 0
  buffer_load_dwordx4 v20, s[8:11], s20 offen lds
  s_add_u32 s20, s19, 61440
  s_add_u32 m0, s17, 18432
  s_nop 0
  buffer_load_dwordx4 v21, s[8:11], s20 offen lds
  s_add_u32 s20, s19, 61440
  s_add_u32 m0, s17, 19456
  s_nop 0
  buffer_load_dwordx4 v22, s[8:11], s20 offen lds
  s_add_u32 s20, s19, 81920
  s_add_u32 m0, s17, 20480
  s_nop 0
  buffer_load_dwordx4 v18, s[8:11], s20 offen lds
  s_add_u32 s20, s19, 81920
  s_add_u32 m0, s17, 21504
  s_nop 0
  buffer_load_dwordx4 v19, s[8:11], s20 offen lds
  s_add_u32 s20, s19, 81920
  s_add_u32 m0, s17, 22528
  s_nop 0
  buffer_load_dwordx4 v20, s[8:11], s20 offen lds
  s_add_u32 s20, s19, 81920
  s_add_u32 m0, s17, 23552
  s_nop 0
  buffer_load_dwordx4 v21, s[8:11], s20 offen lds
  v_add_u32 v23, 24576, v25
  v_add_u32 v24, 25600, v25
  v_add_u32 v30, 28672, v25
  v_add_u32 v31, 29696, v25
  ds_read2_b32 v[32:33], v23 offset0:0 offset1:32
  ds_read2_b32 v[34:35], v24 offset0:0 offset1:32
  ds_read2_b32 v[36:37], v23 offset0:64 offset1:96
  ds_read2_b32 v[38:39], v24 offset0:64 offset1:96
  ds_read2_b32 v[40:41], v30 offset0:0 offset1:32
  ds_read2_b32 v[42:43], v31 offset0:0 offset1:32
  ds_read2_b32 v[44:45], v30 offset0:64 offset1:96
  ds_read2_b32 v[46:47], v31 offset0:64 offset1:96
  s_waitcnt lgkmcnt(0)
  v_perm_b32 v112, v33, v32, s45
  v_perm_b32 v113, v35, v34, s45
  v_perm_b32 v114, v37, v36, s45
  v_perm_b32 v115, v39, v38, s45
  v_perm_b32 v116, v41, v40, s45
  v_perm_b32 v117, v43, v42, s45
  v_perm_b32 v118, v45, v44, s45
  v_perm_b32 v119, v47, v46, s45
  v_perm_b32 v72, v33, v32, s46
  v_perm_b32 v73, v35, v34, s46
  v_perm_b32 v74, v37, v36, s46
  v_perm_b32 v75, v39, v38, s46
  v_perm_b32 v76, v41, v40, s46
  v_perm_b32 v77, v43, v42, s46
  v_perm_b32 v78, v45, v44, s46
  v_perm_b32 v79, v47, v46, s46
  s_add_u32 s20, s21, 28672
  buffer_store_dwordx4 v[72:75], v1, s[4:7], s20 offen
  buffer_store_dwordx4 v[76:79], v1, s[4:7], s20 offen offset:1024
  v_add_u32 v23, 24576, v29
  v_add_u32 v24, 25600, v29
  v_add_u32 v30, 28672, v29
  v_add_u32 v31, 29696, v29
  ds_read2_b32 v[32:33], v23 offset0:0 offset1:32
  ds_read2_b32 v[34:35], v24 offset0:0 offset1:32
  ds_read2_b32 v[36:37], v23 offset0:64 offset1:96
  ds_read2_b32 v[38:39], v24 offset0:64 offset1:96
  ds_read2_b32 v[40:41], v30 offset0:0 offset1:32
  ds_read2_b32 v[42:43], v31 offset0:0 offset1:32
  ds_read2_b32 v[44:45], v30 offset0:64 offset1:96
  ds_read2_b32 v[46:47], v31 offset0:64 offset1:96
  s_waitcnt lgkmcnt(0)
  v_perm_b32 v64, v33, v32, s45
  v_perm_b32 v65, v35, v34, s45
  v_perm_b32 v66, v37, v36, s45
  v_perm_b32 v67, v39, v38, s45
  v_perm_b32 v68, v41, v40, s45
  v_perm_b32 v69, v43, v42, s45
  v_perm_b32 v70, v45, v44, s45
  v_perm_b32 v71, v47, v46, s45
  s_add_u32 s20, s21, 32768
  buffer_store_dwordx4 v[64:67], v1, s[4:7], s20 offen
  buffer_store_dwordx4 v[68:71], v1, s[4:7], s20 offen offset:1024
  v_perm_b32 v72, v33, v32, s46
  v_perm_b32 v73, v35, v34, s46
  v_perm_b32 v74, v37, v36, s46
  v_perm_b32 v75, v39, v38, s46
  v_perm_b32 v76, v41, v40, s46
  v_perm_b32 v77, v43, v42, s46
  v_perm_b32 v78, v45, v44, s46
  v_perm_b32 v79, v47, v46, s46
  s_add_u32 s20, s21, 34816
  buffer_store_dwordx4 v[72:75], v1, s[4:7], s20 offen
  buffer_store_dwordx4 v[76:79], v1, s[4:7], s20 offen offset:1024
  v_add_u32 v23, 32768, v25
  v_add_u32 v24, 33792, v25
  v_add_u32 v30, 36864, v25
  v_add_u32 v31, 37888, v25
  ds_read2_b32 v[32:33], v23 offset0:0 offset1:32
  ds_read2_b32 v[34:35], v24 offset0:0 offset1:32
  ds_read2_b32 v[36:37], v23 offset0:64 offset1:96
  ds_read2_b32 v[38:39], v24 offset0:64 offset1:96
  ds_read2_b32 v[40:41], v30 offset0:0 offset1:32
  ds_read2_b32 v[42:43], v31 offset0:0 offset1:32
  ds_read2_b32 v[44:45], v30 offset0:64 offset1:96
  ds_read2_b32 v[46:47], v31 offset0:64 offset1:96
  s_waitcnt lgkmcnt(0)
  v_perm_b32 v120, v33, v32, s45
  v_perm_b32 v121, v35, v34, s45
  v_perm_b32 v122, v37, v36, s45
  v_perm_b32 v123, v39, v38, s45
  v_perm_b32 v124, v41, v40, s45
  v_perm_b32 v125, v43, v42, s45
  v_perm_b32 v126, v45, v44, s45
  v_perm_b32 v127, v47, v46, s45
  v_perm_b32 v72, v33, v32, s46
  v_perm_b32 v73, v35, v34, s46
  v_perm_b32 v74, v37, v36, s46
  v_perm_b32 v75, v39, v38, s46
  v_perm_b32 v76, v41, v40, s46
  v_perm_b32 v77, v43, v42, s46
  v_perm_b32 v78, v45, v44, s46
  v_perm_b32 v79, v47, v46, s46
  s_add_u32 s20, s21, 30720
  buffer_store_dwordx4 v[72:75], v1, s[4:7], s20 offen
  buffer_store_dwordx4 v[76:79], v1, s[4:7], s20 offen offset:1024
  v_add_u32 v23, 32768, v29
  v_add_u32 v24, 33792, v29
  v_add_u32 v30, 36864, v29
  v_add_u32 v31, 37888, v29
  ds_read2_b32 v[32:33], v23 offset0:0 offset1:32
  ds_read2_b32 v[34:35], v24 offset0:0 offset1:32
  ds_read2_b32 v[36:37], v23 offset0:64 offset1:96
  ds_read2_b32 v[38:39], v24 offset0:64 offset1:96
  ds_read2_b32 v[40:41], v30 offset0:0 offset1:32
  ds_read2_b32 v[42:43], v31 offset0:0 offset1:32
  ds_read2_b32 v[44:45], v30 offset0:64 offset1:96
  ds_read2_b32 v[46:47], v31 offset0:64 offset1:96
  s_waitcnt lgkmcnt(0)
  v_perm_b32 v64, v33, v32, s45
  v_perm_b32 v65, v35, v34, s45
  v_perm_b32 v66, v37, v36, s45
  v_perm_b32 v67, v39, v38, s45
  v_perm_b32 v68, v41, v40, s45
  v_perm_b32 v69, v43, v42, s45
  v_perm_b32 v70, v45, v44, s45
  v_perm_b32 v71, v47, v46, s45
  s_add_u32 s20, s30, 8192
  buffer_store_dwordx4 v[64:67], v1, s[4:7], s20 offen
  buffer_store_dwordx4 v[68:71], v1, s[4:7], s20 offen offset:1024
  v_perm_b32 v72, v33, v32, s46
  v_perm_b32 v73, v35, v34, s46
  v_perm_b32 v74, v37, v36, s46
  v_perm_b32 v75, v39, v38, s46
  v_perm_b32 v76, v41, v40, s46
  v_perm_b32 v77, v43, v42, s46
  v_perm_b32 v78, v45, v44, s46
  v_perm_b32 v79, v47, v46, s46
  s_add_u32 s20, s30, 10240
  buffer_store_dwordx4 v[72:75], v1, s[4:7], s20 offen
  buffer_store_dwordx4 v[76:79], v1, s[4:7], s20 offen offset:1024
  s_barrier
  s_mov_b32 s8, s62
  s_and_b32 s9, s63, 0xffff
  s_mov_b32 s10, 5242880
  s_mov_b32 s11, 0x00020000
  s_mul_i32 s19, s12, 163840
  s_add_u32 s20, s19, 81920
  s_add_u32 m0, s17, 24576
  s_nop 0
  buffer_load_dwordx4 v22, s[8:11], s20 offen lds
  s_add_u32 s20, s19, 102400
  s_add_u32 m0, s17, 25600
  s_nop 0
  buffer_load_dwordx4 v18, s[8:11], s20 offen lds
  s_add_u32 s20, s19, 102400
  s_add_u32 m0, s17, 26624
  s_nop 0
  buffer_load_dwordx4 v19, s[8:11], s20 offen lds
  s_add_u32 s20, s19, 102400
  s_add_u32 m0, s17, 27648
  s_nop 0
  buffer_load_dwordx4 v20, s[8:11], s20 offen lds
  s_add_u32 s20, s19, 102400
  s_add_u32 m0, s17, 28672
  s_nop 0
  buffer_load_dwordx4 v21, s[8:11], s20 offen lds
  s_add_u32 s20, s19, 102400
  s_add_u32 m0, s17, 29696
  s_nop 0
  buffer_load_dwordx4 v22, s[8:11], s20 offen lds
  s_add_u32 s20, s19, 122880
  s_add_u32 m0, s17, 30720
  s_nop 0
  buffer_load_dwordx4 v18, s[8:11], s20 offen lds
  s_add_u32 s20, s19, 122880
  s_add_u32 m0, s17, 31744
  s_nop 0
  buffer_load_dwordx4 v19, s[8:11], s20 offen lds
  s_mul_i32 s19, s12, 163840
  s_add_u32 s20, s19, 122880
  s_add_u32 m0, s17, 32768
  s_nop 0
  buffer_load_dwordx4 v20, s[8:11], s20 offen lds
  s_add_u32 s20, s19, 122880
  s_add_u32 m0, s17, 33792
  s_nop 0
  buffer_load_dwordx4 v21, s[8:11], s20 offen lds
  s_add_u32 s20, s19, 122880
  s_add_u32 m0, s17, 34816
  s_nop 0
  buffer_load_dwordx4 v22, s[8:11], s20 offen lds
  s_add_u32 s20, s19, 143360
  s_add_u32 m0, s17, 35840
  s_nop 0
  buffer_load_dwordx4 v18, s[8:11], s20 offen lds
  s_add_u32 s20, s19, 143360
  s_add_u32 m0, s17, 36864
  s_nop 0
  buffer_load_dwordx4 v19, s[8:11], s20 offen lds
  s_add_u32 s20, s19, 143360
  s_add_u32 m0, s17, 37888
  s_nop 0
  buffer_load_dwordx4 v20, s[8:11], s20 offen lds
  s_add_u32 s20, s19, 143360
  s_add_u32 m0, s17, 38912
  s_nop 0
  buffer_load_dwordx4 v21, s[8:11], s20 offen lds
  s_add_u32 s20, s19, 143360
  s_add_u32 m0, s17, 39936
  s_nop 0
  buffer_load_dwordx4 v22, s[8:11], s20 offen lds
  s_movk_i32 s50, 1280
  v_mul_lo_u32 v26, v12, s50
  v_add_u32 v26, s17, v26
  v_lshl_add_u32 v25, v13, 2, v26
  v_lshrrev_b32 v27, 1, v13
  v_lshl_add_u32 v27, v27, 2, v26
  v_add_u32 v27, 256, v27
  v_and_b32 v26, 1, v13
  v_mov_b32 v29, s45
  v_mov_b32 v30, s46
  v_cmp_eq_u32 vcc, 1, v26
  s_nop 1
  v_cndmask_b32 v29, v29, v30, vcc
  s_waitcnt vmcnt(0)
  s_xor_b32 s19, s13, 0
  s_mul_i32 s19, s19, 10240
  s_add_u32 s20, s19, 0
  v_add_u32 v23, s20, v25
  ds_read2_b32 v[32:33], v23 offset0:0 offset1:80
  s_add_u32 s20, s19, 64
  v_add_u32 v23, s20, v25
  ds_read2_b32 v[34:35], v23 offset0:0 offset1:80
  s_add_u32 s20, s19, 640
  v_add_u32 v23, s20, v25
  ds_read2_b32 v[36:37], v23 offset0:0 offset1:80
  s_add_u32 s20, s19, 704
  v_add_u32 v23, s20, v25
  ds_read2_b32 v[38:39], v23 offset0:0 offset1:80
  s_add_u32 s20, s19, 5120
  v_add_u32 v23, s20, v25
  ds_read2_b32 v[40:41], v23 offset0:0 offset1:80
  s_add_u32 s20, s19, 5184
  v_add_u32 v23, s20, v25
  ds_read2_b32 v[42:43], v23 offset0:0 offset1:80
  s_add_u32 s20, s19, 5760
  v_add_u32 v23, s20, v25
  ds_read2_b32 v[44:45], v23 offset0:0 offset1:80
  s_add_u32 s20, s19, 5824
  v_add_u32 v23, s20, v25
  ds_read2_b32 v[46:47], v23 offset0:0 offset1:80
  s_waitcnt lgkmcnt(0)
  v_perm_b32 v64, v33, v32, s45
  v_perm_b32 v65, v35, v34, s45
  v_perm_b32 v66, v37, v36, s45
  v_perm_b32 v67, v39, v38, s45
  v_perm_b32 v68, v41, v40, s45
  v_perm_b32 v69, v43, v42, s45
  v_perm_b32 v70, v45, v44, s45
  v_perm_b32 v71, v47, v46, s45
  s_add_u32 s20, s30, 12288
  buffer_store_dwordx4 v[64:67], v1, s[4:7], s20 offen
  buffer_store_dwordx4 v[68:71], v1, s[4:7], s20 offen offset:1024
  v_perm_b32 v72, v33, v32, s46
  v_perm_b32 v73, v35, v34, s46
  v_perm_b32 v74, v37, v36, s46
  v_perm_b32 v75, v39, v38, s46
  v_perm_b32 v76, v41, v40, s46
  v_perm_b32 v77, v43, v42, s46
  v_perm_b32 v78, v45, v44, s46
  v_perm_b32 v79, v47, v46, s46
  s_add_u32 s20, s30, 14336
  buffer_store_dwordx4 v[72:75], v1, s[4:7], s20 offen
  buffer_store_dwordx4 v[76:79], v1, s[4:7], s20 offen offset:1024
  s_add_u32 s20, s19, 128
  v_add_u32 v23, s20, v25
  ds_read2_b32 v[32:33], v23 offset0:0 offset1:80
  s_add_u32 s20, s19, 192
  v_add_u32 v23, s20, v25
  ds_read2_b32 v[34:35], v23 offset0:0 offset1:80
  s_add_u32 s20, s19, 768
  v_add_u32 v23, s20, v25
  ds_read2_b32 v[36:37], v23 offset0:0 offset1:80
  s_add_u32 s20, s19, 832
  v_add_u32 v23, s20, v25
  ds_read2_b32 v[38:39], v23 offset0:0 offset1:80
  s_add_u32 s20, s19, 5248
  v_add_u32 v23, s20, v25
  ds_read2_b32 v[40:41], v23 offset0:0 offset1:80
  s_add_u32 s20, s19, 5312
  v_add_u32 v23, s20, v25
  ds_read2_b32 v[42:43], v23 offset0:0 offset1:80
  s_add_u32 s20, s19, 5888
  v_add_u32 v23, s20, v25
  ds_read2_b32 v[44:45], v23 offset0:0 offset1:80
  s_add_u32 s20, s19, 5952
  v_add_u32 v23, s20, v25
  ds_read2_b32 v[46:47], v23 offset0:0 offset1:80
  s_waitcnt lgkmcnt(0)
  v_perm_b32 v64, v33, v32, s45
  v_perm_b32 v65, v35, v34, s45
  v_perm_b32 v66, v37, v36, s45
  v_perm_b32 v67, v39, v38, s45
  v_perm_b32 v68, v41, v40, s45
  v_perm_b32 v69, v43, v42, s45
  v_perm_b32 v70, v45, v44, s45
  v_perm_b32 v71, v47, v46, s45
  s_add_u32 s20, s30, 16384
  buffer_store_dwordx4 v[64:67], v1, s[4:7], s20 offen
  buffer_store_dwordx4 v[68:71], v1, s[4:7], s20 offen offset:1024
  v_perm_b32 v72, v33, v32, s46
  v_perm_b32 v73, v35, v34, s46
  v_perm_b32 v74, v37, v36, s46
  v_perm_b32 v75, v39, v38, s46
  v_perm_b32 v76, v41, v40, s46
  v_perm_b32 v77, v43, v42, s46
  v_perm_b32 v78, v45, v44, s46
  v_perm_b32 v79, v47, v46, s46
  s_add_u32 s20, s30, 18432
  buffer_store_dwordx4 v[72:75], v1, s[4:7], s20 offen
  buffer_store_dwordx4 v[76:79], v1, s[4:7], s20 offen offset:1024
  s_add_u32 s20, s19, 0
  v_add_u32 v23, s20, v27
  ds_read2_b32 v[32:33], v23 offset0:0 offset1:80
  s_add_u32 s20, s19, 32
  v_add_u32 v23, s20, v27
  ds_read2_b32 v[34:35], v23 offset0:0 offset1:80
  s_add_u32 s20, s19, 640
  v_add_u32 v23, s20, v27
  ds_read2_b32 v[36:37], v23 offset0:0 offset1:80
  s_add_u32 s20, s19, 672
  v_add_u32 v23, s20, v27
  ds_read2_b32 v[38:39], v23 offset0:0 offset1:80
  s_add_u32 s20, s19, 5120
  v_add_u32 v23, s20, v27
  ds_read2_b32 v[40:41], v23 offset0:0 offset1:80
  s_add_u32 s20, s19, 5152
  v_add_u32 v23, s20, v27
  ds_read2_b32 v[42:43], v23 offset0:0 offset1:80
  s_add_u32 s20, s19, 5760
  v_add_u32 v23, s20, v27
  ds_read2_b32 v[44:45], v23 offset0:0 offset1:80
  s_add_u32 s20, s19, 5792
  v_add_u32 v23, s20, v27
  ds_read2_b32 v[46:47], v23 offset0:0 offset1:80
  s_waitcnt lgkmcnt(0)
  v_perm_b32 v128, v33, v32, v29
  v_perm_b32 v129, v35, v34, v29
  v_perm_b32 v130, v37, v36, v29
  v_perm_b32 v131, v39, v38, v29
  v_perm_b32 v132, v41, v40, v29
  v_perm_b32 v133, v43, v42, v29
  v_perm_b32 v134, v45, v44, v29
  v_perm_b32 v135, v47, v46, v29
  s_xor_b32 s19, s13, 1
  s_mul_i32 s19, s19, 10240
  s_add_u32 s20, s19, 0
  v_add_u32 v23, s20, v25
  ds_read2_b32 v[32:33], v23 offset0:0 offset1:80
  s_add_u32 s20, s19, 64
  v_add_u32 v23, s20, v25
  ds_read2_b32 v[34:35], v23 offset0:0 offset1:80
  s_add_u32 s20, s19, 640
  v_add_u32 v23, s20, v25
  ds_read2_b32 v[36:37], v23 offset0:0 offset1:80
  s_add_u32 s20, s19, 704
  v_add_u32 v23, s20, v25
  ds_read2_b32 v[38:39], v23 offset0:0 offset1:80
  s_add_u32 s20, s19, 5120
  v_add_u32 v23, s20, v25
  ds_read2_b32 v[40:41], v23 offset0:0 offset1:80
  s_add_u32 s20, s19, 5184
  v_add_u32 v23, s20, v25
  ds_read2_b32 v[42:43], v23 offset0:0 offset1:80
  s_add_u32 s20, s19, 5760
  v_add_u32 v23, s20, v25
  ds_read2_b32 v[44:45], v23 offset0:0 offset1:80
  s_add_u32 s20, s19, 5824
  v_add_u32 v23, s20, v25
  ds_read2_b32 v[46:47], v23 offset0:0 offset1:80
  s_waitcnt lgkmcnt(0)
  v_perm_b32 v136, v33, v32, s45
  v_perm_b32 v137, v35, v34, s45
  v_perm_b32 v138, v37, v36, s45
  v_perm_b32 v139, v39, v38, s45
  v_perm_b32 v140, v41, v40, s45
  v_perm_b32 v141, v43, v42, s45
  v_perm_b32 v142, v45, v44, s45
  v_perm_b32 v143, v47, v46, s45
  v_perm_b32 v144, v33, v32, s46
  v_perm_b32 v145, v35, v34, s46
  v_perm_b32 v146, v37, v36, s46
  v_perm_b32 v147, v39, v38, s46
  v_perm_b32 v148, v41, v40, s46
  v_perm_b32 v149, v43, v42, s46
  v_perm_b32 v150, v45, v44, s46
  v_perm_b32 v151, v47, v46, s46
  s_add_u32 s20, s19, 128
  v_add_u32 v23, s20, v25
  ds_read2_b32 v[32:33], v23 offset0:0 offset1:80
  s_add_u32 s20, s19, 192
  v_add_u32 v23, s20, v25
  ds_read2_b32 v[34:35], v23 offset0:0 offset1:80
  s_add_u32 s20, s19, 768
  v_add_u32 v23, s20, v25
  ds_read2_b32 v[36:37], v23 offset0:0 offset1:80
  s_add_u32 s20, s19, 832
  v_add_u32 v23, s20, v25
  ds_read2_b32 v[38:39], v23 offset0:0 offset1:80
  s_add_u32 s20, s19, 5248
  v_add_u32 v23, s20, v25
  ds_read2_b32 v[40:41], v23 offset0:0 offset1:80
  s_add_u32 s20, s19, 5312
  v_add_u32 v23, s20, v25
  ds_read2_b32 v[42:43], v23 offset0:0 offset1:80
  s_add_u32 s20, s19, 5888
  v_add_u32 v23, s20, v25
  ds_read2_b32 v[44:45], v23 offset0:0 offset1:80
  s_add_u32 s20, s19, 5952
  v_add_u32 v23, s20, v25
  ds_read2_b32 v[46:47], v23 offset0:0 offset1:80
  s_waitcnt lgkmcnt(0)
  v_perm_b32 v152, v33, v32, s45
  v_perm_b32 v153, v35, v34, s45
  v_perm_b32 v154, v37, v36, s45
  v_perm_b32 v155, v39, v38, s45
  v_perm_b32 v156, v41, v40, s45
  v_perm_b32 v157, v43, v42, s45
  v_perm_b32 v158, v45, v44, s45
  v_perm_b32 v159, v47, v46, s45
  v_perm_b32 v160, v33, v32, s46
  v_perm_b32 v161, v35, v34, s46
  v_perm_b32 v162, v37, v36, s46
  v_perm_b32 v163, v39, v38, s46
  v_perm_b32 v164, v41, v40, s46
  v_perm_b32 v165, v43, v42, s46
  v_perm_b32 v166, v45, v44, s46
  v_perm_b32 v167, v47, v46, s46
  s_add_u32 s20, s19, 0
  v_add_u32 v23, s20, v27
  ds_read2_b32 v[32:33], v23 offset0:0 offset1:80
  s_add_u32 s20, s19, 32
  v_add_u32 v23, s20, v27
  ds_read2_b32 v[34:35], v23 offset0:0 offset1:80
  s_add_u32 s20, s19, 640
  v_add_u32 v23, s20, v27
  ds_read2_b32 v[36:37], v23 offset0:0 offset1:80
  s_add_u32 s20, s19, 672
  v_add_u32 v23, s20, v27
  ds_read2_b32 v[38:39], v23 offset0:0 offset1:80
  s_add_u32 s20, s19, 5120
  v_add_u32 v23, s20, v27
  ds_read2_b32 v[40:41], v23 offset0:0 offset1:80
  s_add_u32 s20, s19, 5152
  v_add_u32 v23, s20, v27
  ds_read2_b32 v[42:43], v23 offset0:0 offset1:80
  s_add_u32 s20, s19, 5760
  v_add_u32 v23, s20, v27
  ds_read2_b32 v[44:45], v23 offset0:0 offset1:80
  s_add_u32 s20, s19, 5792
  v_add_u32 v23, s20, v27
  ds_read2_b32 v[46:47], v23 offset0:0 offset1:80
  s_waitcnt lgkmcnt(0)
  v_perm_b32 v168, v33, v32, v29
  v_perm_b32 v169, v35, v34, v29
  v_perm_b32 v170, v37, v36, v29
  v_perm_b32 v171, v39, v38, v29
  v_perm_b32 v172, v41, v40, v29
  v_perm_b32 v173, v43, v42, v29
  v_perm_b32 v174, v45, v44, v29
  v_perm_b32 v175, v47, v46, v29
  s_xor_b32 s19, s13, 2
  s_mul_i32 s19, s19, 10240
  s_add_u32 s20, s19, 0
  v_add_u32 v23, s20, v25
  ds_read2_b32 v[32:33], v23 offset0:0 offset1:80
  s_add_u32 s20, s19, 64
  v_add_u32 v23, s20, v25
  ds_read2_b32 v[34:35], v23 offset0:0 offset1:80
  s_add_u32 s20, s19, 640
  v_add_u32 v23, s20, v25
  ds_read2_b32 v[36:37], v23 offset0:0 offset1:80
  s_add_u32 s20, s19, 704
  v_add_u32 v23, s20, v25
  ds_read2_b32 v[38:39], v23 offset0:0 offset1:80
  s_add_u32 s20, s19, 5120
  v_add_u32 v23, s20, v25
  ds_read2_b32 v[40:41], v23 offset0:0 offset1:80
  s_add_u32 s20, s19, 5184
  v_add_u32 v23, s20, v25
  ds_read2_b32 v[42:43], v23 offset0:0 offset1:80
  s_add_u32 s20, s19, 5760
  v_add_u32 v23, s20, v25
  ds_read2_b32 v[44:45], v23 offset0:0 offset1:80
  s_add_u32 s20, s19, 5824
  v_add_u32 v23, s20, v25
  ds_read2_b32 v[46:47], v23 offset0:0 offset1:80
  s_waitcnt lgkmcnt(0)
  v_perm_b32 v176, v33, v32, s45
  v_perm_b32 v177, v35, v34, s45
  v_perm_b32 v178, v37, v36, s45
  v_perm_b32 v179, v39, v38, s45
  v_perm_b32 v180, v41, v40, s45
  v_perm_b32 v181, v43, v42, s45
  v_perm_b32 v182, v45, v44, s45
  v_perm_b32 v183, v47, v46, s45
  v_perm_b32 v184, v33, v32, s46
  v_perm_b32 v185, v35, v34, s46
  v_perm_b32 v186, v37, v36, s46
  v_perm_b32 v187, v39, v38, s46
  v_perm_b32 v188, v41, v40, s46
  v_perm_b32 v189, v43, v42, s46
  v_perm_b32 v190, v45, v44, s46
  v_perm_b32 v191, v47, v46, s46
  s_add_u32 s20, s19, 128
  v_add_u32 v23, s20, v25
  ds_read2_b32 v[32:33], v23 offset0:0 offset1:80
  s_add_u32 s20, s19, 192
  v_add_u32 v23, s20, v25
  ds_read2_b32 v[34:35], v23 offset0:0 offset1:80
  s_add_u32 s20, s19, 768
  v_add_u32 v23, s20, v25
  ds_read2_b32 v[36:37], v23 offset0:0 offset1:80
  s_add_u32 s20, s19, 832
  v_add_u32 v23, s20, v25
  ds_read2_b32 v[38:39], v23 offset0:0 offset1:80
  s_add_u32 s20, s19, 5248
  v_add_u32 v23, s20, v25
  ds_read2_b32 v[40:41], v23 offset0:0 offset1:80
  s_add_u32 s20, s19, 5312
  v_add_u32 v23, s20, v25
  ds_read2_b32 v[42:43], v23 offset0:0 offset1:80
  s_add_u32 s20, s19, 5888
  v_add_u32 v23, s20, v25
  ds_read2_b32 v[44:45], v23 offset0:0 offset1:80
  s_add_u32 s20, s19, 5952
  v_add_u32 v23, s20, v25
  ds_read2_b32 v[46:47], v23 offset0:0 offset1:80
  s_waitcnt lgkmcnt(0)
  v_perm_b32 v192, v33, v32, s45
  v_perm_b32 v193, v35, v34, s45
  v_perm_b32 v194, v37, v36, s45
  v_perm_b32 v195, v39, v38, s45
  v_perm_b32 v196, v41, v40, s45
  v_perm_b32 v197, v43, v42, s45
  v_perm_b32 v198, v45, v44, s45
  v_perm_b32 v199, v47, v46, s45
  v_perm_b32 v200, v33, v32, s46
  v_perm_b32 v201, v35, v34, s46
  v_perm_b32 v202, v37, v36, s46
  v_perm_b32 v203, v39, v38, s46
  v_perm_b32 v204, v41, v40, s46
  v_perm_b32 v205, v43, v42, s46
  v_perm_b32 v206, v45, v44, s46
  v_perm_b32 v207, v47, v46, s46
  s_add_u32 s20, s19, 0
  v_add_u32 v23, s20, v27
  ds_read2_b32 v[32:33], v23 offset0:0 offset1:80
  s_add_u32 s20, s19, 32
  v_add_u32 v23, s20, v27
  ds_read2_b32 v[34:35], v23 offset0:0 offset1:80
  s_add_u32 s20, s19, 640
  v_add_u32 v23, s20, v27
  ds_read2_b32 v[36:37], v23 offset0:0 offset1:80
  s_add_u32 s20, s19, 672
  v_add_u32 v23, s20, v27
  ds_read2_b32 v[38:39], v23 offset0:0 offset1:80
  s_add_u32 s20, s19, 5120
  v_add_u32 v23, s20, v27
  ds_read2_b32 v[40:41], v23 offset0:0 offset1:80
  s_add_u32 s20, s19, 5152
  v_add_u32 v23, s20, v27
  ds_read2_b32 v[42:43], v23 offset0:0 offset1:80
  s_add_u32 s20, s19, 5760
  v_add_u32 v23, s20, v27
  ds_read2_b32 v[44:45], v23 offset0:0 offset1:80
  s_add_u32 s20, s19, 5792
  v_add_u32 v23, s20, v27
  ds_read2_b32 v[46:47], v23 offset0:0 offset1:80
  s_waitcnt lgkmcnt(0)
  v_perm_b32 v208, v33, v32, v29
  v_perm_b32 v209, v35, v34, v29
  v_perm_b32 v210, v37, v36, v29
  v_perm_b32 v211, v39, v38, v29
  v_perm_b32 v212, v41, v40, v29
  v_perm_b32 v213, v43, v42, v29
  v_perm_b32 v214, v45, v44, v29
  v_perm_b32 v215, v47, v46, v29
  s_xor_b32 s19, s13, 3
  s_mul_i32 s19, s19, 10240
  s_add_u32 s20, s19, 0
  v_add_u32 v23, s20, v25
  ds_read2_b32 v[32:33], v23 offset0:0 offset1:80
  s_add_u32 s20, s19, 64
  v_add_u32 v23, s20, v25
  ds_read2_b32 v[34:35], v23 offset0:0 offset1:80
  s_add_u32 s20, s19, 640
  v_add_u32 v23, s20, v25
  ds_read2_b32 v[36:37], v23 offset0:0 offset1:80
  s_add_u32 s20, s19, 704
  v_add_u32 v23, s20, v25
  ds_read2_b32 v[38:39], v23 offset0:0 offset1:80
  s_add_u32 s20, s19, 5120
  v_add_u32 v23, s20, v25
  ds_read2_b32 v[40:41], v23 offset0:0 offset1:80
  s_add_u32 s20, s19, 5184
  v_add_u32 v23, s20, v25
  ds_read2_b32 v[42:43], v23 offset0:0 offset1:80
  s_add_u32 s20, s19, 5760
  v_add_u32 v23, s20, v25
  ds_read2_b32 v[44:45], v23 offset0:0 offset1:80
  s_add_u32 s20, s19, 5824
  v_add_u32 v23, s20, v25
  ds_read2_b32 v[46:47], v23 offset0:0 offset1:80
  s_waitcnt lgkmcnt(0)
  v_perm_b32 v216, v33, v32, s45
  v_perm_b32 v217, v35, v34, s45
  v_perm_b32 v218, v37, v36, s45
  v_perm_b32 v219, v39, v38, s45
  v_perm_b32 v220, v41, v40, s45
  v_perm_b32 v221, v43, v42, s45
  v_perm_b32 v222, v45, v44, s45
  v_perm_b32 v223, v47, v46, s45
  v_perm_b32 v224, v33, v32, s46
  v_perm_b32 v225, v35, v34, s46
  v_perm_b32 v226, v37, v36, s46
  v_perm_b32 v227, v39, v38, s46
  v_perm_b32 v228, v41, v40, s46
  v_perm_b32 v229, v43, v42, s46
  v_perm_b32 v230, v45, v44, s46
  v_perm_b32 v231, v47, v46, s46
  s_add_u32 s20, s19, 128
  v_add_u32 v23, s20, v25
  ds_read2_b32 v[32:33], v23 offset0:0 offset1:80
  s_add_u32 s20, s19, 192
  v_add_u32 v23, s20, v25
  ds_read2_b32 v[34:35], v23 offset0:0 offset1:80
  s_add_u32 s20, s19, 768
  v_add_u32 v23, s20, v25
  ds_read2_b32 v[36:37], v23 offset0:0 offset1:80
  s_add_u32 s20, s19, 832
  v_add_u32 v23, s20, v25
  ds_read2_b32 v[38:39], v23 offset0:0 offset1:80
  s_add_u32 s20, s19, 5248
  v_add_u32 v23, s20, v25
  ds_read2_b32 v[40:41], v23 offset0:0 offset1:80
  s_add_u32 s20, s19, 5312
  v_add_u32 v23, s20, v25
  ds_read2_b32 v[42:43], v23 offset0:0 offset1:80
  s_add_u32 s20, s19, 5888
  v_add_u32 v23, s20, v25
  ds_read2_b32 v[44:45], v23 offset0:0 offset1:80
  s_add_u32 s20, s19, 5952
  v_add_u32 v23, s20, v25
  ds_read2_b32 v[46:47], v23 offset0:0 offset1:80
  s_waitcnt lgkmcnt(0)
  v_perm_b32 v232, v33, v32, s45
  v_perm_b32 v233, v35, v34, s45
  v_perm_b32 v234, v37, v36, s45
  v_perm_b32 v235, v39, v38, s45
  v_perm_b32 v236, v41, v40, s45
  v_perm_b32 v237, v43, v42, s45
  v_perm_b32 v238, v45, v44, s45
  v_perm_b32 v239, v47, v46, s45
  v_perm_b32 v240, v33, v32, s46
  v_perm_b32 v241, v35, v34, s46
  v_perm_b32 v242, v37, v36, s46
  v_perm_b32 v243, v39, v38, s46
  v_perm_b32 v244, v41, v40, s46
  v_perm_b32 v245, v43, v42, s46
  v_perm_b32 v246, v45, v44, s46
  v_perm_b32 v247, v47, v46, s46
  s_add_u32 s20, s19, 0
  v_add_u32 v23, s20, v27
  ds_read2_b32 v[32:33], v23 offset0:0 offset1:80
  s_add_u32 s20, s19, 32
  v_add_u32 v23, s20, v27
  ds_read2_b32 v[34:35], v23 offset0:0 offset1:80
  s_add_u32 s20, s19, 640
  v_add_u32 v23, s20, v27
  ds_read2_b32 v[36:37], v23 offset0:0 offset1:80
  s_add_u32 s20, s19, 672
  v_add_u32 v23, s20, v27
  ds_read2_b32 v[38:39], v23 offset0:0 offset1:80
  s_add_u32 s20, s19, 5120
  v_add_u32 v23, s20, v27
  ds_read2_b32 v[40:41], v23 offset0:0 offset1:80
  s_add_u32 s20, s19, 5152
  v_add_u32 v23, s20, v27
  ds_read2_b32 v[42:43], v23 offset0:0 offset1:80
  s_add_u32 s20, s19, 5760
  v_add_u32 v23, s20, v27
  ds_read2_b32 v[44:45], v23 offset0:0 offset1:80
  s_add_u32 s20, s19, 5792
  v_add_u32 v23, s20, v27
  ds_read2_b32 v[46:47], v23 offset0:0 offset1:80
  s_waitcnt lgkmcnt(0)
  v_perm_b32 v248, v33, v32, v29
  v_perm_b32 v249, v35, v34, v29
  v_perm_b32 v250, v37, v36, v29
  v_perm_b32 v251, v39, v38, v29
  v_perm_b32 v252, v41, v40, v29
  v_perm_b32 v253, v43, v42, v29
  v_perm_b32 v254, v45, v44, v29
  v_perm_b32 v255, v47, v46, v29
  s_waitcnt vmcnt(0)
  s_barrier
  s_mul_i32 s17, s13, 36864
  s_add_u32 s17, s17, 16384
  s_add_u32 s20, s21, 0
  s_add_u32 m0, s17, 0
  s_nop 0
  buffer_load_dwordx4 v1, s[4:7], s20 offen lds
  s_add_u32 s20, s21, 1024
  s_add_u32 m0, s17, 1024
  s_nop 0
  buffer_load_dwordx4 v1, s[4:7], s20 offen lds
  s_add_u32 s20, s21, 2048
  s_add_u32 m0, s17, 2048
  s_nop 0
  buffer_load_dwordx4 v1, s[4:7], s20 offen lds
  s_add_u32 s20, s21, 3072
  s_add_u32 m0, s17, 3072
  s_nop 0
  buffer_load_dwordx4 v1, s[4:7], s20 offen lds
  s_add_u32 s20, s21, 4096
  s_add_u32 m0, s17, 4096
  s_nop 0
  buffer_load_dwordx4 v1, s[4:7], s20 offen lds
  s_add_u32 s20, s21, 5120
  s_add_u32 m0, s17, 5120
  s_nop 0
  buffer_load_dwordx4 v1, s[4:7], s20 offen lds
  s_add_u32 s20, s21, 6144
  s_add_u32 m0, s17, 6144
  s_nop 0
  buffer_load_dwordx4 v1, s[4:7], s20 offen lds
  s_add_u32 s20, s21, 7168
  s_add_u32 m0, s17, 7168
  s_nop 0
  buffer_load_dwordx4 v1, s[4:7], s20 offen lds
  s_add_u32 s20, s21, 8192
  s_add_u32 m0, s17, 8192
  s_nop 0
  buffer_load_dwordx4 v1, s[4:7], s20 offen lds
  s_add_u32 s20, s21, 9216
  s_add_u32 m0, s17, 9216
  s_nop 0
  buffer_load_dwordx4 v1, s[4:7], s20 offen lds
  s_add_u32 s20, s21, 10240
  s_add_u32 m0, s17, 10240
  s_nop 0
  buffer_load_dwordx4 v1, s[4:7], s20 offen lds
  s_add_u32 s20, s21, 11264
  s_add_u32 m0, s17, 11264
  s_nop 0
  buffer_load_dwordx4 v1, s[4:7], s20 offen lds
  s_add_u32 s20, s21, 12288
  s_add_u32 m0, s17, 12288
  s_nop 0
  buffer_load_dwordx4 v1, s[4:7], s20 offen lds
  s_add_u32 s20, s21, 13312
  s_add_u32 m0, s17, 13312
  s_nop 0
  buffer_load_dwordx4 v1, s[4:7], s20 offen lds
  s_add_u32 s20, s21, 14336
  s_add_u32 m0, s17, 14336
  s_nop 0
  buffer_load_dwordx4 v1, s[4:7], s20 offen lds
  s_add_u32 s20, s21, 15360
  s_add_u32 m0, s17, 15360
  s_nop 0
  buffer_load_dwordx4 v1, s[4:7], s20 offen lds
  s_add_u32 s20, s21, 16384
  s_add_u32 m0, s17, 16384
  s_nop 0
  buffer_load_dwordx4 v1, s[4:7], s20 offen lds
  s_add_u32 s20, s21, 17408
  s_add_u32 m0, s17, 17408
  s_nop 0
  buffer_load_dwordx4 v1, s[4:7], s20 offen lds
  s_add_u32 s20, s21, 18432
  s_add_u32 m0, s17, 18432
  s_nop 0
  buffer_load_dwordx4 v1, s[4:7], s20 offen lds
  s_add_u32 s20, s21, 19456
  s_add_u32 m0, s17, 19456
  s_nop 0
  buffer_load_dwordx4 v1, s[4:7], s20 offen lds
  s_add_u32 s20, s21, 20480
  s_add_u32 m0, s17, 20480
  s_nop 0
  buffer_load_dwordx4 v1, s[4:7], s20 offen lds
  s_add_u32 s20, s21, 21504
  s_add_u32 m0, s17, 21504
  s_nop 0
  buffer_load_dwordx4 v1, s[4:7], s20 offen lds
  s_add_u32 s20, s21, 22528
  s_add_u32 m0, s17, 22528
  s_nop 0
  buffer_load_dwordx4 v1, s[4:7], s20 offen lds
  s_add_u32 s20, s21, 23552
  s_add_u32 m0, s17, 23552
  s_nop 0
  buffer_load_dwordx4 v1, s[4:7], s20 offen lds
  s_add_u32 s20, s21, 24576
  s_add_u32 m0, s17, 24576
  s_nop 0
  buffer_load_dwordx4 v1, s[4:7], s20 offen lds
  s_add_u32 s20, s21, 25600
  s_add_u32 m0, s17, 25600
  s_nop 0
  buffer_load_dwordx4 v1, s[4:7], s20 offen lds
  s_add_u32 s20, s21, 26624
  s_add_u32 m0, s17, 26624
  s_nop 0
  buffer_load_dwordx4 v1, s[4:7], s20 offen lds
  s_add_u32 s20, s21, 27648
  s_add_u32 m0, s17, 27648
  s_nop 0
  buffer_load_dwordx4 v1, s[4:7], s20 offen lds
  s_add_u32 s20, s21, 28672
  s_add_u32 m0, s17, 28672
  s_nop 0
  buffer_load_dwordx4 v1, s[4:7], s20 offen lds
  s_add_u32 s20, s21, 29696
  s_add_u32 m0, s17, 29696
  s_nop 0
  buffer_load_dwordx4 v1, s[4:7], s20 offen lds
  s_add_u32 s20, s21, 30720
  s_add_u32 m0, s17, 30720
  s_nop 0
  buffer_load_dwordx4 v1, s[4:7], s20 offen lds
  s_add_u32 s20, s21, 31744
  s_add_u32 m0, s17, 31744
  s_nop 0
  buffer_load_dwordx4 v1, s[4:7], s20 offen lds
  s_add_u32 s20, s21, 32768
  s_add_u32 m0, s17, 32768
  s_nop 0
  buffer_load_dwordx4 v1, s[4:7], s20 offen lds
  s_add_u32 s20, s21, 33792
  s_add_u32 m0, s17, 33792
  s_nop 0
  buffer_load_dwordx4 v1, s[4:7], s20 offen lds
  s_add_u32 s20, s21, 34816
  s_add_u32 m0, s17, 34816
  s_nop 0
  buffer_load_dwordx4 v1, s[4:7], s20 offen lds
  s_add_u32 s20, s21, 35840
  s_add_u32 m0, s17, 35840
  s_nop 0
  buffer_load_dwordx4 v1, s[4:7], s20 offen lds
  v_and_b32 v26, 1, v12
  v_lshlrev_b32 v26, 2, v26
  v_sub_u32 v26, v13, v26
  v_mov_b32 v23, 0x3f80
  v_mov_b32 v24, 0x3f800000
  v_mov_b32 v32, 0
  v_cmp_eq_u32 vcc, 0, v26
  s_nop 1
  v_cndmask_b32 v32, v32, v23, vcc
  v_cmp_eq_u32 vcc, 1, v26
  s_nop 1
  v_cndmask_b32 v32, v32, v24, vcc
  v_mov_b32 v33, 0
  v_cmp_eq_u32 vcc, 2, v26
  s_nop 1
  v_cndmask_b32 v33, v33, v23, vcc
  v_cmp_eq_u32 vcc, 3, v26
  s_nop 1
  v_cndmask_b32 v33, v33, v24, vcc
  v_mov_b32 v34, 0
  v_cmp_eq_u32 vcc, 8, v26
  s_nop 1
  v_cndmask_b32 v34, v34, v23, vcc
  v_cmp_eq_u32 vcc, 9, v26
  s_nop 1
  v_cndmask_b32 v34, v34, v24, vcc
  v_mov_b32 v35, 0
  v_cmp_eq_u32 vcc, 10, v26
  s_nop 1
  v_cndmask_b32 v35, v35, v23, vcc
  v_cmp_eq_u32 vcc, 11, v26
  s_nop 1
  v_cndmask_b32 v35, v35, v24, vcc
  v_and_b32 v27, 0x1f0, v1
  ds_write_b128 v27, v[32:35] offset:15360
  v_mov_b32 v26, v13
  v_mov_b32 v36, 0
  v_cmp_eq_u32 vcc, 0, v26
  s_nop 1
  v_cndmask_b32 v36, v36, v23, vcc
  v_cmp_eq_u32 vcc, 1, v26
  s_nop 1
  v_cndmask_b32 v36, v36, v24, vcc
  v_mov_b32 v37, 0
  v_cmp_eq_u32 vcc, 2, v26
  s_nop 1
  v_cndmask_b32 v37, v37, v23, vcc
  v_cmp_eq_u32 vcc, 3, v26
  s_nop 1
  v_cndmask_b32 v37, v37, v24, vcc
  v_mov_b32 v38, 0
  v_cmp_eq_u32 vcc, 4, v26
  s_nop 1
  v_cndmask_b32 v38, v38, v23, vcc
  v_cmp_eq_u32 vcc, 5, v26
  s_nop 1
  v_cndmask_b32 v38, v38, v24, vcc
  v_mov_b32 v39, 0
  v_cmp_eq_u32 vcc, 6, v26
  s_nop 1
  v_cndmask_b32 v39, v39, v23, vcc
  v_cmp_eq_u32 vcc, 7, v26
  s_nop 1
  v_cndmask_b32 v39, v39, v24, vcc
  v_and_b32 v27, 0xf0, v1
  ds_write_b128 v27, v[36:39] offset:15872
  v_and_b32 v26, 8, v13
  v_bfe_u32 v27, v13, 1, 2
  v_add_u32 v26, v26, v27
  v_and_b32 v27, 1, v13
  v_lshl_add_u32 v26, v27, 2, v26
  v_mov_b32 v36, 0
  v_cmp_eq_u32 vcc, 0, v26
  s_nop 1
  v_cndmask_b32 v36, v36, v23, vcc
  v_cmp_eq_u32 vcc, 1, v26
  s_nop 1
  v_cndmask_b32 v36, v36, v24, vcc
  v_mov_b32 v37, 0
  v_cmp_eq_u32 vcc, 2, v26
  s_nop 1
  v_cndmask_b32 v37, v37, v23, vcc
  v_cmp_eq_u32 vcc, 3, v26
  s_nop 1
  v_cndmask_b32 v37, v37, v24, vcc
  v_mov_b32 v38, 0
  v_cmp_eq_u32 vcc, 4, v26
  s_nop 1
  v_cndmask_b32 v38, v38, v23, vcc
  v_cmp_eq_u32 vcc, 5, v26
  s_nop 1
  v_cndmask_b32 v38, v38, v24, vcc
  v_mov_b32 v39, 0
  v_cmp_eq_u32 vcc, 6, v26
  s_nop 1
  v_cndmask_b32 v39, v39, v23, vcc
  v_cmp_eq_u32 vcc, 7, v26
  s_nop 1
  v_cndmask_b32 v39, v39, v24, vcc
  v_and_b32 v27, 0xf0, v1
  ds_write_b128 v27, v[36:39] offset:16128
  s_waitcnt vmcnt(0)
  s_waitcnt lgkmcnt(0)
  s_barrier
  buffer_load_dwordx4 v[64:67], v1, s[4:7], s30 offen sc1
  buffer_load_dwordx4 v[68:71], v1, s[4:7], s30 offen offset:1024 sc1
  buffer_load_dwordx4 v[72:75], v1, s[4:7], s30 offen offset:2048 sc1
  buffer_load_dwordx4 v[76:79], v1, s[4:7], s30 offen offset:3072 sc1
  buffer_load_dwordx4 v[80:83], v1, s[4:7], s31 offen sc1
  buffer_load_dwordx4 v[84:87], v1, s[4:7], s31 offen offset:1024 sc1
  buffer_load_dwordx4 v[88:91], v1, s[4:7], s31 offen offset:2048 sc1
  buffer_load_dwordx4 v[92:95], v1, s[4:7], s31 offen offset:3072 sc1
  s_lshl_b32 s60, s13, 1
  s_lshl_b32 s60, s60, 10
  s_lshl_b32 s61, s13, 1
  s_add_u32 s61, s61, 1
  s_lshl_b32 s61, s61, 10
  s_and_b32 s62, s13, 1
  s_add_u32 s62, s62, 8
  s_lshl_b32 s62, s62, 10
  s_lshl_b32 s29, s13, 3
  s_add_u32 s29, s29, s12
  s_and_b32 s63, s29, 31
  v_mov_b64 v[24:25], 0
  v_mov_b64 v[26:27], 0
  v_mov_b64 v[28:29], 0
  v_mov_b64 v[30:31], 0
  v_mov_b64 v[32:33], 0
  v_mov_b64 v[34:35], 0
  v_mov_b64 v[36:37], 0
  v_mov_b64 v[38:39], 0
  v_mov_b64 v[40:41], 0
  v_mov_b64 v[42:43], 0
  v_mov_b64 v[44:45], 0
  v_mov_b64 v[46:47], 0
  s_mov_b32 s27, 81920
  s_mov_b32 s28, 112640
  s_cmp_eq_u32 s12, 31
  s_cselect_b32 s41, 62, 1000
  s_mov_b32 s21, 16777216
  s_lshl_b32 s22, s12, 7
  s_add_u32 s22, s22, 3670016
  v_mbcnt_lo_u32_b32 v12, -1, 0
  v_mbcnt_hi_u32_b32 v12, -1, v12
  v_lshlrev_b32 v12, 2, v12
Liw_3:
  buffer_load_dword v13, v12, s[76:79], 0 offen offset:160 sc1
  s_waitcnt vmcnt(0)
  v_readlane_b32 s15, v13, 0
  v_readlane_b32 s16, v13, 1
  s_nop 0
  s_add_u32 s15, s15, s16
  v_readlane_b32 s16, v13, 2
  s_nop 0
  s_add_u32 s15, s15, s16
  v_readlane_b32 s16, v13, 3
  s_nop 0
  s_add_u32 s15, s15, s16
  v_readlane_b32 s16, v13, 4
  s_nop 0
  s_add_u32 s15, s15, s16
  v_readlane_b32 s16, v13, 5
  s_nop 0
  s_add_u32 s15, s15, s16
  v_readlane_b32 s16, v13, 6
  s_nop 0
  s_add_u32 s15, s15, s16
  v_readlane_b32 s16, v13, 7
  s_nop 0
  s_add_u32 s15, s15, s16
  s_add_u32 s0, s0, 1
  s_cmp_ge_u32 s15, 160
  s_cbranch_scc1 Liw_3_ok
  s_sleep 4
  s_cmp_lt_u32 s0, 1572864
  s_cbranch_scc1 Liw_3
Liw_3_ok:
  s_barrier
  s_mov_b32 s47, 63
  s_mov_b32 s59, s82
mk_layer:
  s_lshl_b32 s15, s12, 13
  s_add_u32 s15, s15, s21
  s_add_u32 s19, s15, 3145728
  s_add_u32 s20, s15, 19922944
  s_add_u32 s55, s21, 53467136
  s_lshl_b32 s15, s13, 11
  s_add_u32 s17, s15, 65536
  s_add_u32 s18, s39, 65536
  s_mov_b32 s14, 0
  s_mov_b32 s49, 0
  s_add_u32 s15, s14, 0
  s_lshr_b32 s15, s15, 2
  s_min_u32 s15, s15, 15
  s_cmp_lt_u32 s15, s49
  s_cbranch_scc1 Lkvr0_4_ok
Lkvr0_4_sp:
  v_lshrrev_b32 v11, 2, v1
  buffer_load_dword v11, v11, s[4:7], s22 offen sc1
  s_waitcnt vmcnt(0)
  v_cmp_le_u32 vcc, 4, v11
  s_add_u32 s0, s0, 1
  s_and_b32 s49, vcc_lo, 0xffff
  s_ff0_i32_b32 s49, s49
  s_cmp_lt_u32 s15, s49
  s_cbranch_scc1 Lkvr0_4_ok
  s_cmp_lt_u32 s0, 1572864
  s_cbranch_scc1 Lkvr0_4_sp
Lkvr0_4_ok:
  s_mov_b32 s14, -1
  s_cmp_eq_u32 s59, 2
  s_cbranch_scc1 mk_slow
mkcf_top:
  v_add_u32 v9, s39, v1
mkcf_mpoll:
  buffer_load_dwordx4 v[12:15], v1, s[4:7], s17 offen sc1
  buffer_load_dwordx4 v[16:19], v1, s[4:7], s17 offen offset:1024 sc1
  buffer_load_dwordx4 v[20:23], v1, s[4:7], s18 offen sc1
  s_add_u32 s0, s0, 1
  s_cmp_lt_u32 s0, 1572864
  s_cselect_b64 s[50:51], -1, 0
  s_waitcnt vmcnt(2)
  v_max3_u32 v10, v12, v13, v14
  ds_write_b128 v2, v[12:15]
  v_max_u32 v10, v10, v15
  v_cmp_eq_u32 vcc, -1, v10
  s_nop 0
  s_and_b64 vcc, vcc, s[50:51]
  s_cbranch_vccnz mkcf_mpoll
  v_smfmac_f32_16x16x64_bf16 v[24:27], v[12:15], v[64:71], v0
  s_waitcnt vmcnt(1)
  v_max3_u32 v10, v16, v17, v18
  v_max_u32 v10, v10, v19
  v_cmp_eq_u32 vcc, -1, v10
  s_cbranch_vccnz mkcf_mrt1
mkcf_mok1:
  ds_write_b128 v2, v[16:19] offset:1024
  v_smfmac_f32_16x16x64_bf16 v[28:31], v[12:15], v[72:79], v0
  v_smfmac_f32_16x16x64_bf16 v[32:35], v[12:15], v[80:87], v0
  ds_read_b128 v[80:83], v5 offset:0
  ds_read_b128 v[84:87], v5 offset:1024
  s_waitcnt vmcnt(0)
  v_max3_u32 v10, v20, v21, v22
  v_max_u32 v10, v10, v23
  v_cmp_eq_u32 vcc, -1, v10
  s_cbranch_vccnz mkcf_mrt2
mkcf_mok2:
  ds_write_b128 v9, v[20:23]
  v_smfmac_f32_16x16x64_bf16 v[36:39], v[12:15], v[88:95], v0
  buffer_load_dwordx4 v[48:51], v3, s[4:7], s19 offen sc1 nt
  ds_read_b128 v[88:91], v5 offset:18432
  ds_read_b128 v[92:95], v5 offset:19456
  v_smfmac_f32_16x16x64_bf16 v[40:43], v[12:15], a[216:223], v0
  buffer_load_dwordx4 v[52:55], v3, s[4:7], s19 offen offset:128 sc1 nt
  v_smfmac_f32_16x16x64_bf16 v[44:47], v[12:15], a[224:231], v0
  buffer_load_dwordx4 v[56:59], v4, s[4:7], s20 offen sc1 nt
  v_smfmac_f32_16x16x64_bf16 v[24:27], v[16:19], a[0:7], v0
  buffer_load_dwordx4 v[60:63], v4, s[4:7], s20 offen offset:256 sc1 nt
  v_smfmac_f32_16x16x64_bf16 v[28:31], v[16:19], a[8:15], v0
  v_smfmac_f32_16x16x64_bf16 v[32:35], v[16:19], a[16:23], v0
  s_waitcnt lgkmcnt(3)
  v_smfmac_f32_16x16x64_bf16 v[36:39], v[16:19], v[80:87], v0
  ds_read_b128 v[80:83], v5 offset:2048
  ds_read_b128 v[84:87], v5 offset:3072
  v_smfmac_f32_16x16x64_bf16 v[40:43], v[16:19], a[232:239], v0
  s_waitcnt lgkmcnt(2)
  v_xor_b32 v9, 0x400, v9
  v_smfmac_f32_16x16x64_bf16 v[44:47], v[16:19], v[88:95], v0
  ds_read_b128 v[88:91], v5 offset:20480
  ds_read_b128 v[92:95], v5 offset:21504
  s_cmp_lt_u32 s63, 3
  s_cbranch_scc1 mkcf_cp
mkcf_mokcp:
  v_smfmac_f32_16x16x64_bf16 v[24:27], v[20:23], a[24:31], v0
  s_waitcnt lgkmcnt(2)
  s_add_u32 s19, s19, 262144
  v_smfmac_f32_16x16x64_bf16 v[28:31], v[20:23], v[80:87], v0
  ds_read_b128 v[80:83], v5 offset:4096
  ds_read_b128 v[84:87], v5 offset:5120
  s_barrier
  ds_read_b128 v[12:15], v9
  v_xor_b32 v9, 2048, v2
  ds_read_b128 v[16:19], v9 offset:0
  v_smfmac_f32_16x16x64_bf16 v[32:35], v[20:23], a[32:39], v0
  s_add_u32 s20, s20, 262144
  s_add_u32 s55, s55, 10240
  v_smfmac_f32_16x16x64_bf16 v[36:39], v[20:23], a[40:47], v0
  s_add_u32 s14, s14, 1
  s_and_b32 s52, s14, 1
  v_smfmac_f32_16x16x64_bf16 v[40:43], v[20:23], a[240:247], v0
  s_waitcnt lgkmcnt(4)
  s_mov_b32 s44, s28
  v_smfmac_f32_16x16x64_bf16 v[44:47], v[20:23], v[88:95], v0
  ds_read_b128 v[88:91], v5 offset:22528
  ds_read_b128 v[92:95], v5 offset:23552
  ds_read_b128 v[20:23], v9 offset:1024
  s_waitcnt lgkmcnt(4)
  v_smfmac_f32_16x16x64_bf16 v[24:27], v[12:15], a[48:55], v0
  buffer_load_dwordx4 v[64:67], v1, s[4:7], s32 offen sc1
  s_mov_b32 s28, s27
  v_smfmac_f32_16x16x64_bf16 v[28:31], v[12:15], v[80:87], v0
  ds_read_b128 v[80:83], v5 offset:6144
  ds_read_b128 v[84:87], v5 offset:7168
  v_smfmac_f32_16x16x64_bf16 v[32:35], v[12:15], a[56:63], v0
  s_add_u32 s27, s27, 10240
  v_xor_b32 v9, 4096, v2
  v_smfmac_f32_16x16x64_bf16 v[36:39], v[12:15], a[64:71], v0
  s_cmp_ge_u32 s27, 122880
  s_cselect_b32 s27, 81920, s27
  v_smfmac_f32_16x16x64_bf16 v[40:43], v[12:15], a[248:255], v0
  s_waitcnt lgkmcnt(3)
  s_lshl_b32 s15, s13, 11
  v_smfmac_f32_16x16x64_bf16 v[44:47], v[12:15], v[88:95], v0
  ds_read_b128 v[88:91], v5 offset:24576
  ds_read_b128 v[92:95], v5 offset:25600
  ds_read_b128 v[12:15], v9 offset:0
  v_smfmac_f32_16x16x64_bf16 v[24:27], v[16:19], a[72:79], v0
  buffer_load_dwordx4 v[68:71], v1, s[4:7], s32 offen offset:1024 sc1
  s_waitcnt lgkmcnt(3)
  v_smfmac_f32_16x16x64_bf16 v[28:31], v[16:19], v[80:87], v0
  ds_read_b128 v[80:83], v5 offset:8192
  ds_read_b128 v[84:87], v5 offset:9216
  v_smfmac_f32_16x16x64_bf16 v[32:35], v[16:19], a[80:87], v0
  s_add_u32 s17, s27, s15
  v_smfmac_f32_16x16x64_bf16 v[36:39], v[16:19], a[88:95], v0
  s_add_u32 s18, s27, s39
  s_add_u32 s18, s18, 0
  v_smfmac_f32_16x16x64_bf16 v[40:43], v[16:19], v[96:103], v0
  s_waitcnt lgkmcnt(3)
  s_add_u32 s63, s14, s29
  v_smfmac_f32_16x16x64_bf16 v[44:47], v[16:19], v[88:95], v0
  ds_read_b128 v[88:91], v5 offset:26624
  ds_read_b128 v[92:95], v5 offset:27648
  ds_read_b128 v[16:19], v9 offset:1024
  v_smfmac_f32_16x16x64_bf16 v[24:27], v[20:23], a[96:103], v0
  buffer_load_dwordx4 v[72:75], v1, s[4:7], s32 offen offset:2048 sc1
  s_waitcnt lgkmcnt(3)
  v_smfmac_f32_16x16x64_bf16 v[28:31], v[20:23], v[80:87], v0
  ds_read_b128 v[80:83], v5 offset:10240
  ds_read_b128 v[84:87], v5 offset:11264
  v_smfmac_f32_16x16x64_bf16 v[32:35], v[20:23], a[104:111], v0
  s_and_b32 s63, s63, 31
  v_xor_b32 v9, 6144, v2
  v_smfmac_f32_16x16x64_bf16 v[36:39], v[20:23], a[112:119], v0
  v_smfmac_f32_16x16x64_bf16 v[40:43], v[20:23], v[104:111], v0
  s_waitcnt lgkmcnt(3)
  v_smfmac_f32_16x16x64_bf16 v[44:47], v[20:23], v[88:95], v0
  ds_read_b128 v[88:91], v5 offset:28672
  ds_read_b128 v[92:95], v5 offset:29696
  ds_read_b128 v[20:23], v9 offset:0
  v_smfmac_f32_16x16x64_bf16 v[24:27], v[12:15], a[120:127], v0
  buffer_load_dwordx4 v[76:79], v1, s[4:7], s32 offen offset:3072 sc1
  s_waitcnt lgkmcnt(3)
  v_smfmac_f32_16x16x64_bf16 v[28:31], v[12:15], v[80:87], v0
  ds_read_b128 v[80:83], v5 offset:12288
  ds_read_b128 v[84:87], v5 offset:13312
  v_smfmac_f32_16x16x64_bf16 v[32:35], v[12:15], a[128:135], v0
  v_smfmac_f32_16x16x64_bf16 v[36:39], v[12:15], a[136:143], v0
  v_smfmac_f32_16x16x64_bf16 v[40:43], v[12:15], v[112:119], v0
  s_waitcnt lgkmcnt(3)
  v_smfmac_f32_16x16x64_bf16 v[44:47], v[12:15], v[88:95], v0
  ds_read_b128 v[88:91], v5 offset:30720
  ds_read_b128 v[92:95], v5 offset:31744
  ds_read_b128 v[12:15], v9 offset:1024
  v_smfmac_f32_16x16x64_bf16 v[24:27], v[16:19], a[144:151], v0
  s_waitcnt lgkmcnt(3)
  v_smfmac_f32_16x16x64_bf16 v[28:31], v[16:19], v[80:87], v0
  ds_read_b128 v[80:83], v5 offset:14336
  ds_read_b128 v[84:87], v5 offset:15360
  v_smfmac_f32_16x16x64_bf16 v[32:35], v[16:19], a[152:159], v0
  v_smfmac_f32_16x16x64_bf16 v[36:39], v[16:19], a[160:167], v0
  v_smfmac_f32_16x16x64_bf16 v[40:43], v[16:19], v[120:127], v0
  s_waitcnt lgkmcnt(3)
  v_smfmac_f32_16x16x64_bf16 v[44:47], v[16:19], v[88:95], v0
  ds_read_b128 v[88:91], v5 offset:16384
  ds_read_b128 v[92:95], v5 offset:17408
  v_smfmac_f32_16x16x64_bf16 v[24:27], v[20:23], a[168:175], v0
  s_waitcnt lgkmcnt(2)
  v_smfmac_f32_16x16x64_bf16 v[28:31], v[20:23], v[80:87], v0
  ds_read_b128 v[80:83], v5 offset:32768
  ds_read_b128 v[84:87], v5 offset:33792
  v_smfmac_f32_16x16x64_bf16 v[32:35], v[20:23], a[176:183], v0
  v_and_b32 v10, 0x1f0, v1
  v_smfmac_f32_16x16x64_bf16 v[36:39], v[20:23], a[184:191], v0
  ds_read_b128 v[8:11], v10 offset:15360
  v_smfmac_f32_16x16x64_bf16 v[24:27], v[12:15], a[192:199], v0
  s_waitcnt lgkmcnt(3)
  v_smfmac_f32_16x16x64_bf16 v[28:31], v[12:15], v[88:95], v0
  ds_read_b128 v[88:91], v5 offset:34816
  ds_read_b128 v[92:95], v5 offset:35840
  v_smfmac_f32_16x16x64_bf16 v[32:35], v[12:15], a[200:207], v0
  v_smfmac_f32_16x16x64_bf16 v[36:39], v[12:15], a[208:215], v0
  v_cvt_pk_bf16_f32 v24, v24, v25
  v_cvt_pk_bf16_f32 v25, v26, v27
  v_cvt_pk_bf16_f32 v26, v28, v29
  v_cvt_pk_bf16_f32 v27, v30, v31
  v_cvt_pk_bf16_f32 v32, v32, v33
  s_waitcnt lgkmcnt(2)
  v_mfma_f32_16x16x32_bf16 v[28:31], v[24:27], v[8:11], 0
  v_cvt_pk_bf16_f32 v33, v34, v35
  v_cvt_pk_bf16_f32 v34, v36, v37
  v_cvt_pk_bf16_f32 v35, v38, v39
  s_nop 1
  v_mfma_f32_16x16x32_bf16 v[36:39], v[32:35], v[8:11], 0
  v_smfmac_f32_16x16x64_bf16 v[40:43], v[20:23], v[80:87], v0
  buffer_load_dwordx4 v[80:83], v1, s[4:7], s33 offen sc1
  s_nop 2
  v_cvt_pk_bf16_f32 v24, v28, v36
  v_cvt_pk_bf16_f32 v25, v29, v37
  v_cvt_pk_bf16_f32 v26, v30, v38
  v_cvt_pk_bf16_f32 v27, v31, v39
  v_lshrrev_b32 v10, 16, v7
  s_waitcnt vmcnt(7)
  v_mfma_f32_16x16x32_bf16 v[28:31], v[48:51], v[24:27], 0
  v_add_u32 v11, s53, v1
  v_mfma_f32_16x16x32_bf16 v[36:39], v[52:55], v[24:27], 0
  v_add_u32 v8, s54, v1
  v_mfma_f32_16x16x32_bf16 v[32:35], v[24:27], v[24:27], 0
  buffer_load_dwordx4 v[84:87], v1, s[4:7], s33 offen offset:1024 sc1
  s_nop 2
  v_mov_b32_dpp v28, v36 row_ror:8 row_mask:0xf bank_mask:0xc
  v_mov_b32_dpp v29, v37 row_ror:8 row_mask:0xf bank_mask:0xc
  v_mov_b32_dpp v30, v38 row_ror:8 row_mask:0xf bank_mask:0xc
  v_mov_b32_dpp v31, v39 row_ror:8 row_mask:0xf bank_mask:0xc
  ds_write_b128 v11, v[28:31] offset:10240
  s_mov_b64 exec, s[42:43]
  ds_write_b128 v8, v[32:35] offset:13824
  s_mov_b64 exec, -1
  s_waitcnt lgkmcnt(2)
  v_smfmac_f32_16x16x64_bf16 v[44:47], v[20:23], v[88:95], v0
  buffer_load_dwordx4 v[88:91], v1, s[4:7], s33 offen offset:2048 sc1
  s_add_u32 s15, s14, 1
  s_lshr_b32 s15, s15, 2
  s_min_u32 s15, s15, 15
  s_cmp_lt_u32 s15, s49
  s_cbranch_scc1 mkcf_kvr_ok
mkcf_kvr_sp:
  v_lshrrev_b32 v11, 2, v1
  buffer_load_dword v11, v11, s[4:7], s22 offen sc1
  s_waitcnt vmcnt(0)
  v_cmp_le_u32 vcc, 4, v11
  s_add_u32 s0, s0, 1
  s_and_b32 s49, vcc_lo, 0xffff
  s_ff0_i32_b32 s49, s49
  s_cmp_lt_u32 s15, s49
  s_cbranch_scc1 mkcf_kvr_ok
  s_cmp_lt_u32 s0, 1572864
  s_cbranch_scc1 mkcf_kvr_sp
mkcf_kvr_ok:
  buffer_load_dwordx4 v[92:95], v1, s[4:7], s33 offen offset:3072 sc1
  s_waitcnt lgkmcnt(0)
  s_barrier
  ds_read_b128 v[28:31], v1 offset:10240
  ds_read_b128 v[36:39], v1 offset:11264
  ds_read_b128 v[32:35], v1 offset:12288
  ds_read_b128 v[24:27], v1 offset:13312
  ds_read2_b64 v[48:51], v10 offset0:0 offset1:16
  ds_read2_b64 v[52:55], v10 offset0:64 offset1:80
  s_waitcnt vmcnt(6)
  v_smfmac_f32_16x16x64_bf16 v[40:43], v[12:15], v[64:71], v0
  s_waitcnt vmcnt(4)
  v_smfmac_f32_16x16x64_bf16 v[44:47], v[12:15], v[72:79], v0
  buffer_load_dwordx4 v[64:67], v1, s[4:7], s34 offen sc1
  s_waitcnt lgkmcnt(4)
  v_pk_add_f32 v[28:29], v[28:29], v[36:37]
  v_pk_add_f32 v[30:31], v[30:31], v[38:39]
  s_waitcnt lgkmcnt(2)
  v_pk_add_f32 v[32:33], v[32:33], v[24:25]
  v_pk_add_f32 v[34:35], v[34:35], v[26:27]
  buffer_load_dwordx4 v[68:71], v1, s[4:7], s34 offen offset:1024 sc1
  s_waitcnt lgkmcnt(0)
  v_pk_add_f32 v[48:49], v[48:49], v[50:51]
  v_pk_add_f32 v[52:53], v[52:53], v[54:55]
  v_pk_add_f32 v[28:29], v[28:29], v[32:33]
  v_pk_add_f32 v[30:31], v[30:31], v[34:35]
  v_pk_add_f32 v[32:33], v[48:49], v[52:53]
  v_max3_f32 v36, v28, v29, v30
  v_max3_f32 v37, v31, v32, v33
  v_max_f32 v36, v36, v37
  buffer_load_dwordx4 v[72:75], v1, s[4:7], s34 offen offset:2048 sc1
  v_cvt_pk_bf16_f32 v40, v40, v41
  v_max_f32_dpp v36, v36, v36 row_ror:8 row_mask:0xf bank_mask:0xf
  v_mov_b32 v37, v36
  v_cvt_pk_bf16_f32 v41, v42, v43
  buffer_load_dwordx4 v[76:79], v1, s[4:7], s34 offen offset:3072 sc1
  v_permlane16_swap_b32 v36, v37
  v_max_f32 v36, v36, v37
  v_mov_b32 v37, v36
  v_cvt_pk_bf16_f32 v42, v44, v45
  v_cvt_pk_bf16_f32 v43, v46, v47
  v_permlane32_swap_b32 v36, v37
  v_max_f32 v36, v36, v37
  v_mul_f32 v36, s40, v36
  v_fma_f32 v28, v28, s40, -v36
  v_fma_f32 v29, v29, s40, -v36
  v_fma_f32 v30, v30, s40, -v36
  v_fma_f32 v31, v31, s40, -v36
  v_fma_f32 v32, v32, s40, -v36
  v_fma_f32 v33, v33, s40, -v36
  s_sub_u32 s16, s63, 8
  s_cmp_lt_u32 s16, 3
  s_cbranch_scc1 mkcf_pub
mkcf_mokpub:
  v_exp_f32 v28, v28
  v_exp_f32 v29, v29
  v_exp_f32 v30, v30
  v_exp_f32 v31, v31
  v_exp_f32 v32, v32
  v_exp_f32 v33, v33
  v_cvt_pk_bf16_f32 v20, v28, v29
  v_cvt_pk_bf16_f32 v21, v30, v31
  v_cvt_pk_bf16_f32 v22, v28, v29
  v_cvt_pk_bf16_f32 v23, v30, v31
  v_cvt_pk_bf16_f32 v34, v32, v33
  v_mov_b32_dpp v22, v20 row_ror:8 row_mask:0xf bank_mask:0x3
  v_mov_b32_dpp v23, v21 row_ror:8 row_mask:0xf bank_mask:0x3
  v_mov_b32_dpp v20, v20 row_ror:8 row_mask:0xf bank_mask:0xc
  v_mov_b32_dpp v21, v21 row_ror:8 row_mask:0xf bank_mask:0xc
  v_cvt_pk_bf16_f32 v35, v32, v33
  v_pk_add_f32 v[28:29], v[28:29], v[30:31]
  v_mfma_f32_16x16x32_bf16 v[8:11], v[56:59], v[20:23], 0
  v_mov_b32_dpp v35, v34 row_ror:8 row_mask:0xf bank_mask:0x3
  v_mov_b32_dpp v34, v34 row_ror:8 row_mask:0xf bank_mask:0xc
  v_mfma_f32_16x16x32_bf16 v[12:15], v[60:63], v[20:23], 0
  v_add_f32 v39, v32, v33
  v_add_f32 v38, v28, v29
  v_mfma_f32_16x16x16_bf16 v[8:11], v[40:41], v[34:35], v[8:11]
  v_fma_f32 v38, v39, 0.5, v38
  v_mfma_f32_16x16x16_bf16 v[12:15], v[42:43], v[34:35], v[12:15]
  v_mov_b64 v[24:25], 0
  v_add_f32_dpp v38, v38, v38 row_ror:8 row_mask:0xf bank_mask:0xf
  v_mov_b32 v39, v38
  v_mov_b64 v[26:27], 0
  v_mov_b64 v[28:29], 0
  v_permlane16_swap_b32 v38, v39
  v_add_f32 v38, v38, v39
  v_mov_b32 v39, v38
  v_mov_b64 v[30:31], 0
  v_mov_b64 v[32:33], 0
  v_permlane32_swap_b32 v38, v39
  v_add_f32 v38, v38, v39
  v_rcp_f32 v38, v38
  s_nop 0
  v_pk_mul_f32 v[8:9], v[8:9], v[38:39] op_sel_hi:[1,0]
  v_pk_mul_f32 v[10:11], v[10:11], v[38:39] op_sel_hi:[1,0]
  v_pk_mul_f32 v[12:13], v[12:13], v[38:39] op_sel_hi:[1,0]
  v_pk_mul_f32 v[14:15], v[14:15], v[38:39] op_sel_hi:[1,0]
  v_cvt_pk_bf16_f32 v40, v8, v12
  v_cvt_pk_bf16_f32 v41, v9, v13
  v_cvt_pk_bf16_f32 v42, v10, v14
  v_cvt_pk_bf16_f32 v43, v11, v15
  s_mov_b64 exec, s[36:37]
  ds_write_b128 v2, v[40:43]
  s_mov_b64 exec, -1
  v_and_b32 v10, 0xffff, v7
  s_waitcnt vmcnt(6)
  v_smfmac_f32_16x16x64_bf16 v[24:27], v[40:43], v[80:87], v0
  v_mov_b64 v[34:35], 0
  v_mov_b64 v[36:37], 0
  v_xor_b32 v11, 2048, v10
  s_waitcnt vmcnt(4)
  v_smfmac_f32_16x16x64_bf16 v[28:31], v[40:43], v[88:95], v0
  v_mov_b64 v[38:39], 0
  v_mov_b64 v[44:45], 0
  v_xor_b32 v9, 4096, v10
  s_waitcnt vmcnt(2)
  v_smfmac_f32_16x16x64_bf16 v[32:35], v[40:43], v[64:71], v0
  v_mov_b64 v[46:47], 0
  v_xor_b32 v10, 6144, v10
  s_waitcnt lgkmcnt(0)
  s_barrier
  ds_read_b128 v[16:19], v11
  ds_read_b128 v[20:23], v9
  ds_read_b128 v[12:15], v10
  s_waitcnt vmcnt(0)
  v_smfmac_f32_16x16x64_bf16 v[36:39], v[40:43], v[72:79], v0
  buffer_load_dwordx4 v[80:83], v1, s[4:7], s31 offen sc1
  v_and_b32 v11, 0xffff, v6
  v_smfmac_f32_16x16x64_bf16 v[44:47], v[40:43], v[128:135], v0
  v_lshrrev_b32 v9, 16, v6
  s_waitcnt lgkmcnt(2)
  v_smfmac_f32_16x16x64_bf16 v[24:27], v[16:19], v[136:143], v0
  s_waitcnt lgkmcnt(1)
  v_smfmac_f32_16x16x64_bf16 v[24:27], v[20:23], v[176:183], v0
  buffer_load_dwordx4 v[84:87], v1, s[4:7], s31 offen offset:1024 sc1
  v_and_b32 v10, 0xf0, v1
  s_waitcnt lgkmcnt(0)
  v_smfmac_f32_16x16x64_bf16 v[24:27], v[12:15], v[216:223], v0
  v_ashrrev_i32 v8, 16, v0
  v_smfmac_f32_16x16x64_bf16 v[28:31], v[16:19], v[144:151], v0
  v_smfmac_f32_16x16x64_bf16 v[28:31], v[20:23], v[184:191], v0
  buffer_load_dwordx4 v[88:91], v1, s[4:7], s31 offen offset:2048 sc1
  v_lshl_add_u32 v10, s48, 8, v10
  v_smfmac_f32_16x16x64_bf16 v[28:31], v[12:15], v[224:231], v0
  v_smfmac_f32_16x16x64_bf16 v[32:35], v[16:19], v[152:159], v0
  v_smfmac_f32_16x16x64_bf16 v[32:35], v[20:23], v[192:199], v0
  v_cvt_pk_bf16_f32 v24, v24, v28
  v_cvt_pk_bf16_f32 v26, v26, v30
  v_cvt_pk_bf16_f32 v25, v25, v29
  v_cvt_pk_bf16_f32 v27, v27, v31
  v_and_or_b32 v24, v24, -2, s52
  v_and_or_b32 v26, v26, -2, s52
  buffer_store_dwordx4 v[24:27], v11, s[4:7], s23 offen
  v_smfmac_f32_16x16x64_bf16 v[32:35], v[12:15], v[232:239], v0
  buffer_load_dwordx4 v[92:95], v1, s[4:7], s31 offen offset:3072 sc1
  v_smfmac_f32_16x16x64_bf16 v[36:39], v[16:19], v[160:167], v0
  v_smfmac_f32_16x16x64_bf16 v[36:39], v[20:23], v[200:207], v0
  v_smfmac_f32_16x16x64_bf16 v[36:39], v[12:15], v[240:247], v0
  v_smfmac_f32_16x16x64_bf16 v[44:47], v[16:19], v[168:175], v0
  v_smfmac_f32_16x16x64_bf16 v[44:47], v[20:23], v[208:215], v0
  v_cvt_pk_bf16_f32 v32, v32, v36
  v_cvt_pk_bf16_f32 v34, v34, v38
  v_cvt_pk_bf16_f32 v33, v33, v37
  v_cvt_pk_bf16_f32 v35, v35, v39
  v_and_or_b32 v32, v32, -2, s52
  v_and_or_b32 v34, v34, -2, s52
  buffer_store_dwordx4 v[32:35], v11, s[4:7], s24 offen
  v_smfmac_f32_16x16x64_bf16 v[44:47], v[12:15], v[248:255], v0
  ds_read_b128 v[20:23], v10 offset:15872
  s_nop 6
  v_cvt_pk_bf16_f32 v44, v44, v45
  v_cvt_pk_bf16_f32 v45, v46, v47
  v_and_or_b32 v44, v44, -2, s52
  buffer_store_dwordx2 v[44:45], v9, s[4:7], s25 offen
  s_cmp_eq_u32 s38, 0
  s_cbranch_scc1 mkcf_noredx
  s_waitcnt vmcnt(1)
  buffer_load_dwordx4 v[24:27], v1, s[4:7], s26 offen sc1
  buffer_load_dwordx4 v[28:31], v1, s[4:7], s26 offen offset:1024 sc1
  buffer_load_dwordx4 v[32:35], v1, s[4:7], s26 offen offset:2048 sc1
  buffer_load_dwordx4 v[36:39], v1, s[4:7], s26 offen offset:3072 sc1
  s_cmp_eq_u32 s52, 0
  s_cbranch_scc1 mkcf_rpoll0f
mkcf_rpoll1f:
  s_waitcnt vmcnt(3) lgkmcnt(0)
  v_mfma_f32_16x16x32_bf16 v[16:19], v[20:23], v[24:27], 0
  v_bitop3_b32 v10, v24, v26, v24 bitop3:0x80
  s_waitcnt vmcnt(2)
  v_mfma_f32_16x16x32_bf16 v[16:19], v[20:23], v[28:31], v[16:19]
  v_bitop3_b32 v10, v28, v30, v10 bitop3:0x80
  s_waitcnt vmcnt(1)
  v_mfma_f32_16x16x32_bf16 v[16:19], v[20:23], v[32:35], v[16:19]
  v_bitop3_b32 v10, v32, v34, v10 bitop3:0x80
  s_waitcnt vmcnt(0)
  v_mfma_f32_16x16x32_bf16 v[16:19], v[20:23], v[36:39], v[16:19]
  v_bitop3_b32 v10, v36, v38, v10 bitop3:0x80
  v_and_b32 v10, 1, v10
  v_cmp_ne_u32 vcc, 1, v10
  s_cbranch_vccz mkcf_rgo
mkcf_rpoll1:
  buffer_load_dwordx4 v[24:27], v1, s[4:7], s26 offen sc1
  buffer_load_dwordx4 v[28:31], v1, s[4:7], s26 offen offset:1024 sc1
  buffer_load_dwordx4 v[32:35], v1, s[4:7], s26 offen offset:2048 sc1
  buffer_load_dwordx4 v[36:39], v1, s[4:7], s26 offen offset:3072 sc1
  s_add_u32 s0, s0, 1
  s_waitcnt vmcnt(3) lgkmcnt(0)
  v_mfma_f32_16x16x32_bf16 v[16:19], v[20:23], v[24:27], 0
  v_bitop3_b32 v10, v24, v26, v24 bitop3:0x80
  s_waitcnt vmcnt(2)
  v_mfma_f32_16x16x32_bf16 v[16:19], v[20:23], v[28:31], v[16:19]
  v_bitop3_b32 v10, v28, v30, v10 bitop3:0x80
  s_waitcnt vmcnt(1)
  v_mfma_f32_16x16x32_bf16 v[16:19], v[20:23], v[32:35], v[16:19]
  v_bitop3_b32 v10, v32, v34, v10 bitop3:0x80
  s_waitcnt vmcnt(0)
  v_mfma_f32_16x16x32_bf16 v[16:19], v[20:23], v[36:39], v[16:19]
  v_bitop3_b32 v10, v36, v38, v10 bitop3:0x80
  v_and_b32 v10, 1, v10
  v_cmp_ne_u32 vcc, 1, v10
  s_cbranch_vccz mkcf_rgo
  s_cmp_lt_u32 s0, 1572864
  s_cbranch_scc1 mkcf_rpoll1
  s_branch mkcf_rgo
mkcf_rpoll0f:
  s_waitcnt vmcnt(3) lgkmcnt(0)
  v_mfma_f32_16x16x32_bf16 v[16:19], v[20:23], v[24:27], 0
  v_or3_b32 v10, v24, v26, v24
  s_waitcnt vmcnt(2)
  v_mfma_f32_16x16x32_bf16 v[16:19], v[20:23], v[28:31], v[16:19]
  v_or3_b32 v10, v28, v30, v10
  s_waitcnt vmcnt(1)
  v_mfma_f32_16x16x32_bf16 v[16:19], v[20:23], v[32:35], v[16:19]
  v_or3_b32 v10, v32, v34, v10
  s_waitcnt vmcnt(0)
  v_mfma_f32_16x16x32_bf16 v[16:19], v[20:23], v[36:39], v[16:19]
  v_or3_b32 v10, v36, v38, v10
  v_and_b32 v10, 1, v10
  v_cmp_ne_u32 vcc, 0, v10
  s_cbranch_vccz mkcf_rgo
mkcf_rpoll0:
  buffer_load_dwordx4 v[24:27], v1, s[4:7], s26 offen sc1
  buffer_load_dwordx4 v[28:31], v1, s[4:7], s26 offen offset:1024 sc1
  buffer_load_dwordx4 v[32:35], v1, s[4:7], s26 offen offset:2048 sc1
  buffer_load_dwordx4 v[36:39], v1, s[4:7], s26 offen offset:3072 sc1
  s_add_u32 s0, s0, 1
  s_waitcnt vmcnt(3) lgkmcnt(0)
  v_mfma_f32_16x16x32_bf16 v[16:19], v[20:23], v[24:27], 0
  v_or3_b32 v10, v24, v26, v24
  s_waitcnt vmcnt(2)
  v_mfma_f32_16x16x32_bf16 v[16:19], v[20:23], v[28:31], v[16:19]
  v_or3_b32 v10, v28, v30, v10
  s_waitcnt vmcnt(1)
  v_mfma_f32_16x16x32_bf16 v[16:19], v[20:23], v[32:35], v[16:19]
  v_or3_b32 v10, v32, v34, v10
  s_waitcnt vmcnt(0)
  v_mfma_f32_16x16x32_bf16 v[16:19], v[20:23], v[36:39], v[16:19]
  v_or3_b32 v10, v36, v38, v10
  v_and_b32 v10, 1, v10
  v_cmp_ne_u32 vcc, 0, v10
  s_cbranch_vccz mkcf_rgo
  s_cmp_lt_u32 s0, 1572864
  s_cbranch_scc1 mkcf_rpoll0
mkcf_rgo:
  s_nop 4
  v_add_f32_dpp v16, v16, v16 row_ror:8 row_mask:0xf bank_mask:0xf
  v_add_f32_dpp v17, v17, v17 row_ror:8 row_mask:0xf bank_mask:0xf
  v_add_f32_dpp v18, v18, v18 row_ror:8 row_mask:0xf bank_mask:0xf
  v_add_f32_dpp v19, v19, v19 row_ror:8 row_mask:0xf bank_mask:0xf
  v_cvt_pk_bf16_f32 v16, v16, v17
  v_cvt_pk_bf16_f32 v17, v18, v19
  buffer_store_dword v16, v8, s[4:7], s27 offen
  buffer_store_dword v17, v8, s[4:7], s27 offen offset:16
mkcf_nored:
  buffer_load_dwordx4 v[64:67], v1, s[4:7], s30 offen sc1
  buffer_load_dwordx4 v[68:71], v1, s[4:7], s30 offen offset:1024 sc1
  buffer_load_dwordx4 v[72:75], v1, s[4:7], s30 offen offset:2048 sc1
  buffer_load_dwordx4 v[76:79], v1, s[4:7], s30 offen offset:3072 sc1
  v_mov_b64 v[24:25], 0
  v_mov_b64 v[26:27], 0
  v_mov_b64 v[28:29], 0
  v_mov_b64 v[30:31], 0
  v_mov_b64 v[32:33], 0
  v_mov_b64 v[34:35], 0
  v_mov_b64 v[36:37], 0
  v_mov_b64 v[38:39], 0
  v_mov_b64 v[40:41], 0
  v_mov_b64 v[42:43], 0
  v_mov_b64 v[44:45], 0
  v_mov_b64 v[46:47], 0
  s_waitcnt vmcnt(0)
  s_barrier
  s_cmp_lt_u32 s14, s47
  s_cbranch_scc1 mkcf_top
  s_branch mkcf_exit
mkcf_cp:
  s_cmp_eq_u32 s63, 0
  s_cbranch_scc0 mkcf_cp1
  s_add_u32 s15, s60, s55
  s_add_u32 s15, s15, 10240
  buffer_store_dwordx4 v[12:15], v1, s[4:7], s15 offen sc1
  s_branch mkcf_mokcp
mkcf_cp1:
  s_cmp_eq_u32 s63, 1
  s_cbranch_scc0 mkcf_cp2
  s_add_u32 s15, s61, s55
  s_add_u32 s15, s15, 10240
  buffer_store_dwordx4 v[16:19], v1, s[4:7], s15 offen sc1
  s_branch mkcf_mokcp
mkcf_cp2:
  s_add_u32 s15, s62, s55
  s_add_u32 s15, s15, 10240
  buffer_store_dwordx4 v[20:23], v1, s[4:7], s15 offen sc1
  s_branch mkcf_mokcp
mkcf_noredx:
  s_waitcnt vmcnt(0)
  s_branch mkcf_nored
mkcf_mrt1:
  buffer_load_dwordx4 v[16:19], v1, s[4:7], s17 offen offset:1024 sc1
  s_add_u32 s0, s0, 1
  s_cmp_lt_u32 s0, 1572864
  s_waitcnt vmcnt(0)
  s_cbranch_scc0 mkcf_mok1
  v_max3_u32 v10, v16, v17, v18
  v_max_u32 v10, v10, v19
  v_cmp_eq_u32 vcc, -1, v10
  s_cbranch_vccnz mkcf_mrt1
  s_branch mkcf_mok1
mkcf_mrt2:
  buffer_load_dwordx4 v[20:23], v1, s[4:7], s18 offen sc1
  s_add_u32 s0, s0, 1
  s_cmp_lt_u32 s0, 1572864
  s_waitcnt vmcnt(0)
  s_cbranch_scc0 mkcf_mok2
  v_max3_u32 v10, v20, v21, v22
  v_max_u32 v10, v10, v23
  v_cmp_eq_u32 vcc, -1, v10
  s_cbranch_vccnz mkcf_mrt2
  s_branch mkcf_mok2
mkcf_pub:
  v_mov_b64 v[44:45], -1
  v_mov_b64 v[46:47], -1
  s_cmp_eq_u32 s16, 1
  s_cselect_b32 s15, s61, s60
  s_cmp_eq_u32 s16, 2
  s_cselect_b32 s15, s62, s15
  s_add_u32 s15, s15, s44
  buffer_store_dwordx4 v[44:47], v1, s[4:7], s15 offen
  s_branch mkcf_mokpub
mkcf_exit:
  s_branch mk_fin
mk_slow:
mkcs_top:
  v_add_u32 v9, s39, v1
mkcs_mpoll:
  buffer_load_dwordx4 v[12:15], v1, s[4:7], s17 offen sc1
  buffer_load_dwordx4 v[16:19], v1, s[4:7], s17 offen offset:1024 sc1
  buffer_load_dwordx4 v[20:23], v1, s[4:7], s18 offen sc1
  s_add_u32 s0, s0, 1
  s_cmp_lt_u32 s0, 1572864
  s_cselect_b64 s[50:51], -1, 0
  s_waitcnt vmcnt(2)
  v_max3_u32 v10, v12, v13, v14
  ds_write_b128 v2, v[12:15]
  v_max_u32 v10, v10, v15
  v_cmp_eq_u32 vcc, -1, v10
  s_nop 0
  s_and_b64 vcc, vcc, s[50:51]
  s_cbranch_vccnz mkcs_mpoll
  v_smfmac_f32_16x16x64_bf16 v[24:27], v[12:15], v[64:71], v0
  s_waitcnt vmcnt(1)
  v_max3_u32 v10, v16, v17, v18
  v_max_u32 v10, v10, v19
  v_cmp_eq_u32 vcc, -1, v10
  s_cbranch_vccnz mkcs_mrt1
mkcs_mok1:
  ds_write_b128 v2, v[16:19] offset:1024
  v_smfmac_f32_16x16x64_bf16 v[28:31], v[12:15], v[72:79], v0
  v_smfmac_f32_16x16x64_bf16 v[32:35], v[12:15], v[80:87], v0
  ds_read_b128 v[80:83], v5 offset:0
  ds_read_b128 v[84:87], v5 offset:1024
  s_waitcnt vmcnt(0)
  v_max3_u32 v10, v20, v21, v22
  v_max_u32 v10, v10, v23
  v_cmp_eq_u32 vcc, -1, v10
  s_cbranch_vccnz mkcs_mrt2
mkcs_mok2:
  ds_write_b128 v9, v[20:23]
  v_smfmac_f32_16x16x64_bf16 v[36:39], v[12:15], v[88:95], v0
  buffer_load_dwordx4 v[48:51], v3, s[4:7], s19 offen sc1 nt
  ds_read_b128 v[88:91], v5 offset:18432
  ds_read_b128 v[92:95], v5 offset:19456
  v_smfmac_f32_16x16x64_bf16 v[40:43], v[12:15], a[216:223], v0
  buffer_load_dwordx4 v[52:55], v3, s[4:7], s19 offen offset:128 sc1 nt
  v_smfmac_f32_16x16x64_bf16 v[44:47], v[12:15], a[224:231], v0
  buffer_load_dwordx4 v[56:59], v4, s[4:7], s20 offen sc1 nt
  v_smfmac_f32_16x16x64_bf16 v[24:27], v[16:19], a[0:7], v0
  buffer_load_dwordx4 v[60:63], v4, s[4:7], s20 offen offset:256 sc1 nt
  v_smfmac_f32_16x16x64_bf16 v[28:31], v[16:19], a[8:15], v0
  v_smfmac_f32_16x16x64_bf16 v[32:35], v[16:19], a[16:23], v0
  s_waitcnt lgkmcnt(3)
  v_smfmac_f32_16x16x64_bf16 v[36:39], v[16:19], v[80:87], v0
  ds_read_b128 v[80:83], v5 offset:2048
  ds_read_b128 v[84:87], v5 offset:3072
  v_smfmac_f32_16x16x64_bf16 v[40:43], v[16:19], a[232:239], v0
  s_waitcnt lgkmcnt(2)
  v_xor_b32 v9, 0x400, v9
  v_smfmac_f32_16x16x64_bf16 v[44:47], v[16:19], v[88:95], v0
  ds_read_b128 v[88:91], v5 offset:20480
  ds_read_b128 v[92:95], v5 offset:21504
  s_cmp_lt_u32 s63, 3
  s_cbranch_scc1 mkcs_cp
mkcs_mokcp:
  v_smfmac_f32_16x16x64_bf16 v[24:27], v[20:23], a[24:31], v0
  s_waitcnt lgkmcnt(2)
  s_add_u32 s19, s19, 262144
  v_smfmac_f32_16x16x64_bf16 v[28:31], v[20:23], v[80:87], v0
  ds_read_b128 v[80:83], v5 offset:4096
  ds_read_b128 v[84:87], v5 offset:5120
  s_barrier
  ds_read_b128 v[12:15], v9
  v_xor_b32 v9, 2048, v2
  ds_read_b128 v[16:19], v9 offset:0
  v_smfmac_f32_16x16x64_bf16 v[32:35], v[20:23], a[32:39], v0
  s_add_u32 s20, s20, 262144
  s_add_u32 s55, s55, 10240
  v_smfmac_f32_16x16x64_bf16 v[36:39], v[20:23], a[40:47], v0
  s_add_u32 s14, s14, 1
  s_and_b32 s52, s14, 1
  v_smfmac_f32_16x16x64_bf16 v[40:43], v[20:23], a[240:247], v0
  s_waitcnt lgkmcnt(4)
  s_mov_b32 s44, s28
  v_smfmac_f32_16x16x64_bf16 v[44:47], v[20:23], v[88:95], v0
  ds_read_b128 v[88:91], v5 offset:22528
  ds_read_b128 v[92:95], v5 offset:23552
  ds_read_b128 v[20:23], v9 offset:1024
  s_waitcnt lgkmcnt(4)
  v_smfmac_f32_16x16x64_bf16 v[24:27], v[12:15], a[48:55], v0
  buffer_load_dwordx4 v[64:67], v1, s[4:7], s32 offen sc1
  s_mov_b32 s28, s27
  v_smfmac_f32_16x16x64_bf16 v[28:31], v[12:15], v[80:87], v0
  ds_read_b128 v[80:83], v5 offset:6144
  ds_read_b128 v[84:87], v5 offset:7168
  v_smfmac_f32_16x16x64_bf16 v[32:35], v[12:15], a[56:63], v0
  s_add_u32 s27, s27, 10240
  v_xor_b32 v9, 4096, v2
  v_smfmac_f32_16x16x64_bf16 v[36:39], v[12:15], a[64:71], v0
  s_cmp_ge_u32 s27, 122880
  s_cselect_b32 s27, 81920, s27
  v_smfmac_f32_16x16x64_bf16 v[40:43], v[12:15], a[248:255], v0
  s_waitcnt lgkmcnt(3)
  s_lshl_b32 s15, s13, 11
  v_smfmac_f32_16x16x64_bf16 v[44:47], v[12:15], v[88:95], v0
  ds_read_b128 v[88:91], v5 offset:24576
  ds_read_b128 v[92:95], v5 offset:25600
  ds_read_b128 v[12:15], v9 offset:0
  v_smfmac_f32_16x16x64_bf16 v[24:27], v[16:19], a[72:79], v0
  buffer_load_dwordx4 v[68:71], v1, s[4:7], s32 offen offset:1024 sc1
  s_waitcnt lgkmcnt(3)
  v_smfmac_f32_16x16x64_bf16 v[28:31], v[16:19], v[80:87], v0
  ds_read_b128 v[80:83], v5 offset:8192
  ds_read_b128 v[84:87], v5 offset:9216
  v_smfmac_f32_16x16x64_bf16 v[32:35], v[16:19], a[80:87], v0
  s_add_u32 s17, s27, s15
  v_smfmac_f32_16x16x64_bf16 v[36:39], v[16:19], a[88:95], v0
  s_add_u32 s18, s27, s39
  s_add_u32 s18, s18, 0
  v_smfmac_f32_16x16x64_bf16 v[40:43], v[16:19], v[96:103], v0
  s_waitcnt lgkmcnt(3)
  s_add_u32 s63, s14, s29
  v_smfmac_f32_16x16x64_bf16 v[44:47], v[16:19], v[88:95], v0
  ds_read_b128 v[88:91], v5 offset:26624
  ds_read_b128 v[92:95], v5 offset:27648
  ds_read_b128 v[16:19], v9 offset:1024
  v_smfmac_f32_16x16x64_bf16 v[24:27], v[20:23], a[96:103], v0
  buffer_load_dwordx4 v[72:75], v1, s[4:7], s32 offen offset:2048 sc1
  s_waitcnt lgkmcnt(3)
  v_smfmac_f32_16x16x64_bf16 v[28:31], v[20:23], v[80:87], v0
  ds_read_b128 v[80:83], v5 offset:10240
  ds_read_b128 v[84:87], v5 offset:11264
  v_smfmac_f32_16x16x64_bf16 v[32:35], v[20:23], a[104:111], v0
  s_and_b32 s63, s63, 31
  v_xor_b32 v9, 6144, v2
  v_smfmac_f32_16x16x64_bf16 v[36:39], v[20:23], a[112:119], v0
  v_smfmac_f32_16x16x64_bf16 v[40:43], v[20:23], v[104:111], v0
  s_waitcnt lgkmcnt(3)
  v_smfmac_f32_16x16x64_bf16 v[44:47], v[20:23], v[88:95], v0
  ds_read_b128 v[88:91], v5 offset:28672
  ds_read_b128 v[92:95], v5 offset:29696
  ds_read_b128 v[20:23], v9 offset:0
  v_smfmac_f32_16x16x64_bf16 v[24:27], v[12:15], a[120:127], v0
  buffer_load_dwordx4 v[76:79], v1, s[4:7], s32 offen offset:3072 sc1
  s_waitcnt lgkmcnt(3)
  v_smfmac_f32_16x16x64_bf16 v[28:31], v[12:15], v[80:87], v0
  ds_read_b128 v[80:83], v5 offset:12288
  ds_read_b128 v[84:87], v5 offset:13312
  v_smfmac_f32_16x16x64_bf16 v[32:35], v[12:15], a[128:135], v0
  v_smfmac_f32_16x16x64_bf16 v[36:39], v[12:15], a[136:143], v0
  v_smfmac_f32_16x16x64_bf16 v[40:43], v[12:15], v[112:119], v0
  s_waitcnt lgkmcnt(3)
  v_smfmac_f32_16x16x64_bf16 v[44:47], v[12:15], v[88:95], v0
  ds_read_b128 v[88:91], v5 offset:30720
  ds_read_b128 v[92:95], v5 offset:31744
  ds_read_b128 v[12:15], v9 offset:1024
  v_smfmac_f32_16x16x64_bf16 v[24:27], v[16:19], a[144:151], v0
  s_waitcnt lgkmcnt(3)
  v_smfmac_f32_16x16x64_bf16 v[28:31], v[16:19], v[80:87], v0
  ds_read_b128 v[80:83], v5 offset:14336
  ds_read_b128 v[84:87], v5 offset:15360
  v_smfmac_f32_16x16x64_bf16 v[32:35], v[16:19], a[152:159], v0
  v_smfmac_f32_16x16x64_bf16 v[36:39], v[16:19], a[160:167], v0
  v_smfmac_f32_16x16x64_bf16 v[40:43], v[16:19], v[120:127], v0
  s_waitcnt lgkmcnt(3)
  v_smfmac_f32_16x16x64_bf16 v[44:47], v[16:19], v[88:95], v0
  ds_read_b128 v[88:91], v5 offset:16384
  ds_read_b128 v[92:95], v5 offset:17408
  v_smfmac_f32_16x16x64_bf16 v[24:27], v[20:23], a[168:175], v0
  s_waitcnt lgkmcnt(2)
  v_smfmac_f32_16x16x64_bf16 v[28:31], v[20:23], v[80:87], v0
  ds_read_b128 v[80:83], v5 offset:32768
  ds_read_b128 v[84:87], v5 offset:33792
  v_smfmac_f32_16x16x64_bf16 v[32:35], v[20:23], a[176:183], v0
  v_and_b32 v10, 0x1f0, v1
  v_smfmac_f32_16x16x64_bf16 v[36:39], v[20:23], a[184:191], v0
  ds_read_b128 v[8:11], v10 offset:15360
  v_smfmac_f32_16x16x64_bf16 v[24:27], v[12:15], a[192:199], v0
  s_waitcnt lgkmcnt(3)
  v_smfmac_f32_16x16x64_bf16 v[28:31], v[12:15], v[88:95], v0
  ds_read_b128 v[88:91], v5 offset:34816
  ds_read_b128 v[92:95], v5 offset:35840
  v_smfmac_f32_16x16x64_bf16 v[32:35], v[12:15], a[200:207], v0
  v_smfmac_f32_16x16x64_bf16 v[36:39], v[12:15], a[208:215], v0
  v_cvt_pk_bf16_f32 v24, v24, v25
  v_cvt_pk_bf16_f32 v25, v26, v27
  v_cvt_pk_bf16_f32 v26, v28, v29
  v_cvt_pk_bf16_f32 v27, v30, v31
  v_cvt_pk_bf16_f32 v32, v32, v33
  s_waitcnt lgkmcnt(2)
  v_mfma_f32_16x16x32_bf16 v[28:31], v[24:27], v[8:11], 0
  v_cvt_pk_bf16_f32 v33, v34, v35
  v_cvt_pk_bf16_f32 v34, v36, v37
  v_cvt_pk_bf16_f32 v35, v38, v39
  s_nop 1
  v_mfma_f32_16x16x32_bf16 v[36:39], v[32:35], v[8:11], 0
  v_smfmac_f32_16x16x64_bf16 v[40:43], v[20:23], v[80:87], v0
  buffer_load_dwordx4 v[80:83], v1, s[4:7], s33 offen sc1
  s_nop 2
  v_cvt_pk_bf16_f32 v24, v28, v36
  v_cvt_pk_bf16_f32 v25, v29, v37
  v_cvt_pk_bf16_f32 v26, v30, v38
  v_cvt_pk_bf16_f32 v27, v31, v39
  v_lshrrev_b32 v10, 16, v7
  s_waitcnt vmcnt(7)
  v_mfma_f32_16x16x32_bf16 v[28:31], v[48:51], v[24:27], 0
  v_add_u32 v11, s53, v1
  v_mfma_f32_16x16x32_bf16 v[36:39], v[52:55], v[24:27], 0
  v_add_u32 v8, s54, v1
  v_mfma_f32_16x16x32_bf16 v[32:35], v[24:27], v[24:27], 0
  buffer_load_dwordx4 v[84:87], v1, s[4:7], s33 offen offset:1024 sc1
  s_nop 2
  v_mov_b32_dpp v28, v36 row_ror:8 row_mask:0xf bank_mask:0xc
  v_mov_b32_dpp v29, v37 row_ror:8 row_mask:0xf bank_mask:0xc
  v_mov_b32_dpp v30, v38 row_ror:8 row_mask:0xf bank_mask:0xc
  v_mov_b32_dpp v31, v39 row_ror:8 row_mask:0xf bank_mask:0xc
  ds_write_b128 v11, v[28:31] offset:10240
  s_mov_b64 exec, s[42:43]
  ds_write_b128 v8, v[32:35] offset:13824
  s_mov_b64 exec, -1
  s_waitcnt lgkmcnt(2)
  v_smfmac_f32_16x16x64_bf16 v[44:47], v[20:23], v[88:95], v0
  buffer_load_dwordx4 v[88:91], v1, s[4:7], s33 offen offset:2048 sc1
  s_add_u32 s15, s14, 1
  s_lshr_b32 s15, s15, 2
  s_min_u32 s15, s15, 15
  s_cmp_lt_u32 s15, s49
  s_cbranch_scc1 mkcs_kvr_ok
mkcs_kvr_sp:
  v_lshrrev_b32 v11, 2, v1
  buffer_load_dword v11, v11, s[4:7], s22 offen sc1
  s_waitcnt vmcnt(0)
  v_cmp_le_u32 vcc, 4, v11
  s_add_u32 s0, s0, 1
  s_and_b32 s49, vcc_lo, 0xffff
  s_ff0_i32_b32 s49, s49
  s_cmp_lt_u32 s15, s49
  s_cbranch_scc1 mkcs_kvr_ok
  s_cmp_lt_u32 s0, 1572864
  s_cbranch_scc1 mkcs_kvr_sp
mkcs_kvr_ok:
  buffer_load_dwordx4 v[92:95], v1, s[4:7], s33 offen offset:3072 sc1
  s_waitcnt lgkmcnt(0)
  s_barrier
  ds_read_b128 v[28:31], v1 offset:10240
  ds_read_b128 v[36:39], v1 offset:11264
  ds_read_b128 v[32:35], v1 offset:12288
  ds_read_b128 v[24:27], v1 offset:13312
  ds_read2_b64 v[48:51], v10 offset0:0 offset1:16
  ds_read2_b64 v[52:55], v10 offset0:64 offset1:80
  s_waitcnt vmcnt(6)
  v_smfmac_f32_16x16x64_bf16 v[40:43], v[12:15], v[64:71], v0
  s_waitcnt vmcnt(4)
  v_smfmac_f32_16x16x64_bf16 v[44:47], v[12:15], v[72:79], v0
  buffer_load_dwordx4 v[64:67], v1, s[4:7], s34 offen sc1
  s_waitcnt lgkmcnt(4)
  v_pk_add_f32 v[28:29], v[28:29], v[36:37]
  v_pk_add_f32 v[30:31], v[30:31], v[38:39]
  s_waitcnt lgkmcnt(2)
  v_pk_add_f32 v[32:33], v[32:33], v[24:25]
  v_pk_add_f32 v[34:35], v[34:35], v[26:27]
  buffer_load_dwordx4 v[68:71], v1, s[4:7], s34 offen offset:1024 sc1
  s_waitcnt lgkmcnt(0)
  v_pk_add_f32 v[48:49], v[48:49], v[50:51]
  v_pk_add_f32 v[52:53], v[52:53], v[54:55]
  v_pk_add_f32 v[28:29], v[28:29], v[32:33]
  v_pk_add_f32 v[30:31], v[30:31], v[34:35]
  v_pk_add_f32 v[32:33], v[48:49], v[52:53]
  v_max3_f32 v36, v28, v29, v30
  v_max3_f32 v37, v31, v32, v33
  v_max_f32 v36, v36, v37
  buffer_load_dwordx4 v[72:75], v1, s[4:7], s34 offen offset:2048 sc1
  v_cvt_pk_bf16_f32 v40, v40, v41
  v_max_f32_dpp v36, v36, v36 row_ror:8 row_mask:0xf bank_mask:0xf
  v_mov_b32 v37, v36
  v_cvt_pk_bf16_f32 v41, v42, v43
  buffer_load_dwordx4 v[76:79], v1, s[4:7], s34 offen offset:3072 sc1
  v_permlane16_swap_b32 v36, v37
  v_max_f32 v36, v36, v37
  v_mov_b32 v37, v36
  v_cvt_pk_bf16_f32 v42, v44, v45
  v_cvt_pk_bf16_f32 v43, v46, v47
  v_permlane32_swap_b32 v36, v37
  v_max_f32 v36, v36, v37
  v_mul_f32 v36, s40, v36
  v_fma_f32 v28, v28, s40, -v36
  v_fma_f32 v29, v29, s40, -v36
  v_fma_f32 v30, v30, s40, -v36
  v_fma_f32 v31, v31, s40, -v36
  v_fma_f32 v32, v32, s40, -v36
  v_fma_f32 v33, v33, s40, -v36
  s_sub_u32 s16, s63, 8
  s_cmp_lt_u32 s16, 3
  s_cbranch_scc1 mkcs_pub
mkcs_mokpub:
  v_exp_f32 v28, v28
  v_exp_f32 v29, v29
  v_exp_f32 v30, v30
  v_exp_f32 v31, v31
  v_exp_f32 v32, v32
  v_exp_f32 v33, v33
  v_cvt_pk_bf16_f32 v20, v28, v29
  v_cvt_pk_bf16_f32 v21, v30, v31
  v_cvt_pk_bf16_f32 v22, v28, v29
  v_cvt_pk_bf16_f32 v23, v30, v31
  v_cvt_pk_bf16_f32 v34, v32, v33
  v_mov_b32_dpp v22, v20 row_ror:8 row_mask:0xf bank_mask:0x3
  v_mov_b32_dpp v23, v21 row_ror:8 row_mask:0xf bank_mask:0x3
  v_mov_b32_dpp v20, v20 row_ror:8 row_mask:0xf bank_mask:0xc
  v_mov_b32_dpp v21, v21 row_ror:8 row_mask:0xf bank_mask:0xc
  v_cvt_pk_bf16_f32 v35, v32, v33
  v_pk_add_f32 v[28:29], v[28:29], v[30:31]
  v_mfma_f32_16x16x32_bf16 v[8:11], v[56:59], v[20:23], 0
  v_mov_b32_dpp v35, v34 row_ror:8 row_mask:0xf bank_mask:0x3
  v_mov_b32_dpp v34, v34 row_ror:8 row_mask:0xf bank_mask:0xc
  v_mfma_f32_16x16x32_bf16 v[12:15], v[60:63], v[20:23], 0
  v_add_f32 v39, v32, v33
  v_add_f32 v38, v28, v29
  v_mfma_f32_16x16x16_bf16 v[8:11], v[40:41], v[34:35], v[8:11]
  v_fma_f32 v38, v39, 0.5, v38
  v_mfma_f32_16x16x16_bf16 v[12:15], v[42:43], v[34:35], v[12:15]
  v_mov_b64 v[24:25], 0
  v_add_f32_dpp v38, v38, v38 row_ror:8 row_mask:0xf bank_mask:0xf
  v_mov_b32 v39, v38
  v_mov_b64 v[26:27], 0
  v_mov_b64 v[28:29], 0
  v_permlane16_swap_b32 v38, v39
  v_add_f32 v38, v38, v39
  v_mov_b32 v39, v38
  v_mov_b64 v[30:31], 0
  v_mov_b64 v[32:33], 0
  v_permlane32_swap_b32 v38, v39
  v_add_f32 v38, v38, v39
  v_rcp_f32 v38, v38
  s_nop 0
  v_pk_mul_f32 v[8:9], v[8:9], v[38:39] op_sel_hi:[1,0]
  v_pk_mul_f32 v[10:11], v[10:11], v[38:39] op_sel_hi:[1,0]
  v_pk_mul_f32 v[12:13], v[12:13], v[38:39] op_sel_hi:[1,0]
  v_pk_mul_f32 v[14:15], v[14:15], v[38:39] op_sel_hi:[1,0]
  v_cvt_pk_bf16_f32 v40, v8, v12
  v_cvt_pk_bf16_f32 v41, v9, v13
  v_cvt_pk_bf16_f32 v42, v10, v14
  v_cvt_pk_bf16_f32 v43, v11, v15
  s_mov_b64 exec, s[36:37]
  ds_write_b128 v2, v[40:43]
  s_mov_b64 exec, -1
  v_and_b32 v10, 0xffff, v7
  s_waitcnt vmcnt(6)
  v_smfmac_f32_16x16x64_bf16 v[24:27], v[40:43], v[80:87], v0
  v_mov_b64 v[34:35], 0
  v_mov_b64 v[36:37], 0
  v_xor_b32 v11, 2048, v10
  s_waitcnt vmcnt(4)
  v_smfmac_f32_16x16x64_bf16 v[28:31], v[40:43], v[88:95], v0
  v_mov_b64 v[38:39], 0
  v_mov_b64 v[44:45], 0
  v_xor_b32 v9, 4096, v10
  s_waitcnt vmcnt(2)
  v_smfmac_f32_16x16x64_bf16 v[32:35], v[40:43], v[64:71], v0
  v_mov_b64 v[46:47], 0
  v_xor_b32 v10, 6144, v10
  s_waitcnt lgkmcnt(0)
  s_barrier
  ds_read_b128 v[16:19], v11
  ds_read_b128 v[20:23], v9
  ds_read_b128 v[12:15], v10
  s_waitcnt vmcnt(0)
  v_smfmac_f32_16x16x64_bf16 v[36:39], v[40:43], v[72:79], v0
  buffer_load_dwordx4 v[80:83], v1, s[4:7], s31 offen sc1
  v_and_b32 v11, 0xffff, v6
  v_smfmac_f32_16x16x64_bf16 v[44:47], v[40:43], v[128:135], v0
  v_lshrrev_b32 v9, 16, v6
  s_waitcnt lgkmcnt(2)
  v_smfmac_f32_16x16x64_bf16 v[24:27], v[16:19], v[136:143], v0
  s_waitcnt lgkmcnt(1)
  v_smfmac_f32_16x16x64_bf16 v[24:27], v[20:23], v[176:183], v0
  buffer_load_dwordx4 v[84:87], v1, s[4:7], s31 offen offset:1024 sc1
  v_and_b32 v10, 0xf0, v1
  s_waitcnt lgkmcnt(0)
  v_smfmac_f32_16x16x64_bf16 v[24:27], v[12:15], v[216:223], v0
  v_ashrrev_i32 v8, 16, v0
  v_smfmac_f32_16x16x64_bf16 v[28:31], v[16:19], v[144:151], v0
  v_smfmac_f32_16x16x64_bf16 v[28:31], v[20:23], v[184:191], v0
  buffer_load_dwordx4 v[88:91], v1, s[4:7], s31 offen offset:2048 sc1
  v_lshl_add_u32 v10, s48, 8, v10
  v_smfmac_f32_16x16x64_bf16 v[28:31], v[12:15], v[224:231], v0
  v_smfmac_f32_16x16x64_bf16 v[32:35], v[16:19], v[152:159], v0
  v_smfmac_f32_16x16x64_bf16 v[32:35], v[20:23], v[192:199], v0
  v_cvt_pk_bf16_f32 v24, v24, v28
  v_cvt_pk_bf16_f32 v26, v26, v30
  v_cvt_pk_bf16_f32 v25, v25, v29
  v_cvt_pk_bf16_f32 v27, v27, v31
  v_and_or_b32 v24, v24, -2, s52
  v_and_or_b32 v26, v26, -2, s52
  buffer_store_dwordx4 v[24:27], v11, s[4:7], s23 offen sc1
  v_smfmac_f32_16x16x64_bf16 v[32:35], v[12:15], v[232:239], v0
  buffer_load_dwordx4 v[92:95], v1, s[4:7], s31 offen offset:3072 sc1
  v_smfmac_f32_16x16x64_bf16 v[36:39], v[16:19], v[160:167], v0
  v_smfmac_f32_16x16x64_bf16 v[36:39], v[20:23], v[200:207], v0
  v_smfmac_f32_16x16x64_bf16 v[36:39], v[12:15], v[240:247], v0
  v_smfmac_f32_16x16x64_bf16 v[44:47], v[16:19], v[168:175], v0
  v_smfmac_f32_16x16x64_bf16 v[44:47], v[20:23], v[208:215], v0
  v_cvt_pk_bf16_f32 v32, v32, v36
  v_cvt_pk_bf16_f32 v34, v34, v38
  v_cvt_pk_bf16_f32 v33, v33, v37
  v_cvt_pk_bf16_f32 v35, v35, v39
  v_and_or_b32 v32, v32, -2, s52
  v_and_or_b32 v34, v34, -2, s52
  buffer_store_dwordx4 v[32:35], v11, s[4:7], s24 offen sc1
  v_smfmac_f32_16x16x64_bf16 v[44:47], v[12:15], v[248:255], v0
  ds_read_b128 v[20:23], v10 offset:15872
  s_nop 6
  v_cvt_pk_bf16_f32 v44, v44, v45
  v_cvt_pk_bf16_f32 v45, v46, v47
  v_and_or_b32 v44, v44, -2, s52
  buffer_store_dwordx2 v[44:45], v9, s[4:7], s25 offen sc1
  s_cmp_eq_u32 s38, 0
  s_cbranch_scc1 mkcs_noredx
  s_waitcnt vmcnt(1)
  buffer_load_dwordx4 v[24:27], v1, s[4:7], s26 offen sc1
  buffer_load_dwordx4 v[28:31], v1, s[4:7], s26 offen offset:1024 sc1
  buffer_load_dwordx4 v[32:35], v1, s[4:7], s26 offen offset:2048 sc1
  buffer_load_dwordx4 v[36:39], v1, s[4:7], s26 offen offset:3072 sc1
  s_cmp_eq_u32 s52, 0
  s_cbranch_scc1 mkcs_rpoll0f
mkcs_rpoll1f:
  s_waitcnt vmcnt(3) lgkmcnt(0)
  v_mfma_f32_16x16x32_bf16 v[16:19], v[20:23], v[24:27], 0
  v_bitop3_b32 v10, v24, v26, v24 bitop3:0x80
  s_waitcnt vmcnt(2)
  v_mfma_f32_16x16x32_bf16 v[16:19], v[20:23], v[28:31], v[16:19]
  v_bitop3_b32 v10, v28, v30, v10 bitop3:0x80
  s_waitcnt vmcnt(1)
  v_mfma_f32_16x16x32_bf16 v[16:19], v[20:23], v[32:35], v[16:19]
  v_bitop3_b32 v10, v32, v34, v10 bitop3:0x80
  s_waitcnt vmcnt(0)
  v_mfma_f32_16x16x32_bf16 v[16:19], v[20:23], v[36:39], v[16:19]
  v_bitop3_b32 v10, v36, v38, v10 bitop3:0x80
  v_and_b32 v10, 1, v10
  v_cmp_ne_u32 vcc, 1, v10
  s_cbranch_vccz mkcs_rgo
mkcs_rpoll1:
  buffer_load_dwordx4 v[24:27], v1, s[4:7], s26 offen sc1
  buffer_load_dwordx4 v[28:31], v1, s[4:7], s26 offen offset:1024 sc1
  buffer_load_dwordx4 v[32:35], v1, s[4:7], s26 offen offset:2048 sc1
  buffer_load_dwordx4 v[36:39], v1, s[4:7], s26 offen offset:3072 sc1
  s_add_u32 s0, s0, 1
  s_waitcnt vmcnt(3) lgkmcnt(0)
  v_mfma_f32_16x16x32_bf16 v[16:19], v[20:23], v[24:27], 0
  v_bitop3_b32 v10, v24, v26, v24 bitop3:0x80
  s_waitcnt vmcnt(2)
  v_mfma_f32_16x16x32_bf16 v[16:19], v[20:23], v[28:31], v[16:19]
  v_bitop3_b32 v10, v28, v30, v10 bitop3:0x80
  s_waitcnt vmcnt(1)
  v_mfma_f32_16x16x32_bf16 v[16:19], v[20:23], v[32:35], v[16:19]
  v_bitop3_b32 v10, v32, v34, v10 bitop3:0x80
  s_waitcnt vmcnt(0)
  v_mfma_f32_16x16x32_bf16 v[16:19], v[20:23], v[36:39], v[16:19]
  v_bitop3_b32 v10, v36, v38, v10 bitop3:0x80
  v_and_b32 v10, 1, v10
  v_cmp_ne_u32 vcc, 1, v10
  s_cbranch_vccz mkcs_rgo
  s_cmp_lt_u32 s0, 1572864
  s_cbranch_scc1 mkcs_rpoll1
  s_branch mkcs_rgo
mkcs_rpoll0f:
  s_waitcnt vmcnt(3) lgkmcnt(0)
  v_mfma_f32_16x16x32_bf16 v[16:19], v[20:23], v[24:27], 0
  v_or3_b32 v10, v24, v26, v24
  s_waitcnt vmcnt(2)
  v_mfma_f32_16x16x32_bf16 v[16:19], v[20:23], v[28:31], v[16:19]
  v_or3_b32 v10, v28, v30, v10
  s_waitcnt vmcnt(1)
  v_mfma_f32_16x16x32_bf16 v[16:19], v[20:23], v[32:35], v[16:19]
  v_or3_b32 v10, v32, v34, v10
  s_waitcnt vmcnt(0)
  v_mfma_f32_16x16x32_bf16 v[16:19], v[20:23], v[36:39], v[16:19]
  v_or3_b32 v10, v36, v38, v10
  v_and_b32 v10, 1, v10
  v_cmp_ne_u32 vcc, 0, v10
  s_cbranch_vccz mkcs_rgo
mkcs_rpoll0:
  buffer_load_dwordx4 v[24:27], v1, s[4:7], s26 offen sc1
  buffer_load_dwordx4 v[28:31], v1, s[4:7], s26 offen offset:1024 sc1
  buffer_load_dwordx4 v[32:35], v1, s[4:7], s26 offen offset:2048 sc1
  buffer_load_dwordx4 v[36:39], v1, s[4:7], s26 offen offset:3072 sc1
  s_add_u32 s0, s0, 1
  s_waitcnt vmcnt(3) lgkmcnt(0)
  v_mfma_f32_16x16x32_bf16 v[16:19], v[20:23], v[24:27], 0
  v_or3_b32 v10, v24, v26, v24
  s_waitcnt vmcnt(2)
  v_mfma_f32_16x16x32_bf16 v[16:19], v[20:23], v[28:31], v[16:19]
  v_or3_b32 v10, v28, v30, v10
  s_waitcnt vmcnt(1)
  v_mfma_f32_16x16x32_bf16 v[16:19], v[20:23], v[32:35], v[16:19]
  v_or3_b32 v10, v32, v34, v10
  s_waitcnt vmcnt(0)
  v_mfma_f32_16x16x32_bf16 v[16:19], v[20:23], v[36:39], v[16:19]
  v_or3_b32 v10, v36, v38, v10
  v_and_b32 v10, 1, v10
  v_cmp_ne_u32 vcc, 0, v10
  s_cbranch_vccz mkcs_rgo
  s_cmp_lt_u32 s0, 1572864
  s_cbranch_scc1 mkcs_rpoll0
mkcs_rgo:
  s_nop 4
  v_add_f32_dpp v16, v16, v16 row_ror:8 row_mask:0xf bank_mask:0xf
  v_add_f32_dpp v17, v17, v17 row_ror:8 row_mask:0xf bank_mask:0xf
  v_add_f32_dpp v18, v18, v18 row_ror:8 row_mask:0xf bank_mask:0xf
  v_add_f32_dpp v19, v19, v19 row_ror:8 row_mask:0xf bank_mask:0xf
  v_cvt_pk_bf16_f32 v16, v16, v17
  v_cvt_pk_bf16_f32 v17, v18, v19
  buffer_store_dword v16, v8, s[4:7], s27 offen sc1
  buffer_store_dword v17, v8, s[4:7], s27 offen offset:16 sc1
mkcs_nored:
  buffer_load_dwordx4 v[64:67], v1, s[4:7], s30 offen sc1
  buffer_load_dwordx4 v[68:71], v1, s[4:7], s30 offen offset:1024 sc1
  buffer_load_dwordx4 v[72:75], v1, s[4:7], s30 offen offset:2048 sc1
  buffer_load_dwordx4 v[76:79], v1, s[4:7], s30 offen offset:3072 sc1
  v_mov_b64 v[24:25], 0
  v_mov_b64 v[26:27], 0
  v_mov_b64 v[28:29], 0
  v_mov_b64 v[30:31], 0
  v_mov_b64 v[32:33], 0
  v_mov_b64 v[34:35], 0
  v_mov_b64 v[36:37], 0
  v_mov_b64 v[38:39], 0
  v_mov_b64 v[40:41], 0
  v_mov_b64 v[42:43], 0
  v_mov_b64 v[44:45], 0
  v_mov_b64 v[46:47], 0
  s_waitcnt vmcnt(0)
  s_barrier
  s_cmp_lt_u32 s14, s47
  s_cbranch_scc1 mkcs_top
  s_branch mkcs_exit
mkcs_cp:
  s_cmp_eq_u32 s63, 0
  s_cbranch_scc0 mkcs_cp1
  s_add_u32 s15, s60, s55
  s_add_u32 s15, s15, 10240
  buffer_store_dwordx4 v[12:15], v1, s[4:7], s15 offen sc1
  s_branch mkcs_mokcp
mkcs_cp1:
  s_cmp_eq_u32 s63, 1
  s_cbranch_scc0 mkcs_cp2
  s_add_u32 s15, s61, s55
  s_add_u32 s15, s15, 10240
  buffer_store_dwordx4 v[16:19], v1, s[4:7], s15 offen sc1
  s_branch mkcs_mokcp
mkcs_cp2:
  s_add_u32 s15, s62, s55
  s_add_u32 s15, s15, 10240
  buffer_store_dwordx4 v[20:23], v1, s[4:7], s15 offen sc1
  s_branch mkcs_mokcp
mkcs_noredx:
  s_waitcnt vmcnt(0)
  s_branch mkcs_nored
mkcs_mrt1:
  buffer_load_dwordx4 v[16:19], v1, s[4:7], s17 offen offset:1024 sc1
  s_add_u32 s0, s0, 1
  s_cmp_lt_u32 s0, 1572864
  s_waitcnt vmcnt(0)
  s_cbranch_scc0 mkcs_mok1
  v_max3_u32 v10, v16, v17, v18
  v_max_u32 v10, v10, v19
  v_cmp_eq_u32 vcc, -1, v10
  s_cbranch_vccnz mkcs_mrt1
  s_branch mkcs_mok1
mkcs_mrt2:
  buffer_load_dwordx4 v[20:23], v1, s[4:7], s18 offen sc1
  s_add_u32 s0, s0, 1
  s_cmp_lt_u32 s0, 1572864
  s_waitcnt vmcnt(0)
  s_cbranch_scc0 mkcs_mok2
  v_max3_u32 v10, v20, v21, v22
  v_max_u32 v10, v10, v23
  v_cmp_eq_u32 vcc, -1, v10
  s_cbranch_vccnz mkcs_mrt2
  s_branch mkcs_mok2
mkcs_pub:
  v_mov_b64 v[44:45], -1
  v_mov_b64 v[46:47], -1
  s_cmp_eq_u32 s16, 1
  s_cselect_b32 s15, s61, s60
  s_cmp_eq_u32 s16, 2
  s_cselect_b32 s15, s62, s15
  s_add_u32 s15, s15, s44
  buffer_store_dwordx4 v[44:47], v1, s[4:7], s15 offen sc1
  s_branch mkcs_mokpub
mkcs_exit:
mk_fin:
  s_cmp_eq_u32 s21, 16777216
  s_mov_b32 s21, 117440512
  s_cbranch_scc0 mk_tend
  s_add_u32 s22, s22, 131072
  s_branch mk_layer
mk_tend:
  s_endpgm
mk_worker:
  s_mov_b32 s16, s83
  v_and_b32 v1, 63, v0
  v_lshrrev_b32 v3, 6, v0
  v_lshlrev_b32 v2, 4, v1
  v_readfirstlane_b32 s17, v3
  s_lshr_b32 s18, s16, 5
  s_and_b32 s19, s16, 31
  s_cmp_lt_u32 s18, 4
  s_cselect_b32 s20, 5, 4
  s_lshl_b32 s29, s17, 10
  s_lshl_b32 s24, s20, 1
  s_cmp_lt_u32 s19, s24
  s_cbranch_scc0 mk_gw
  s_and_b32 s3, s19, 1
  s_lshr_b32 s19, s19, 1
  s_mul_i32 s12, s19, 7
  s_add_u32 s12, s12, s18
  v_lshrrev_b32 v15, 6, v0
  v_and_b32 v14, 63, v0
  v_readfirstlane_b32 s13, v15
  v_lshrrev_b32 v12, 4, v14
  v_and_b32 v13, 15, v14
  v_lshlrev_b32 v1, 4, v14
  v_mov_b32 v15, 0x4444
  v_mov_b32 v16, 0xeeee
  v_cmp_gt_u32 vcc, 8, v13
  s_nop 1
  v_cndmask_b32 v0, v16, v15, vcc
  s_mov_b32 s36, 0x00ff00ff
  s_mov_b32 s37, 0x00ff00ff
  s_lshl_b32 s15, s13, 11
  v_add_u32 v2, s15, v1
  s_mul_i32 s15, s13, 36864
  s_add_u32 s15, s15, 16384
  v_add_u32 v5, s15, v1
  v_and_b32 v15, 1, v12
  v_lshlrev_b32 v15, 10, v15
  v_lshrrev_b32 v16, 1, v12
  v_lshl_add_u32 v15, v16, 9, v15
  s_lshl_b32 s15, s13, 11
  v_add_u32 v15, s15, v15
  v_lshl_add_u32 v4, v13, 4, v15
  v_bfe_u32 v16, v13, 2, 1
  v_lshl_add_u32 v15, v16, 8, v15
  v_lshrrev_b32 v16, 3, v13
  v_lshl_add_u32 v15, v16, 6, v15
  v_and_b32 v16, 3, v13
  v_lshl_add_u32 v3, v16, 4, v15
  v_lshrrev_b32 v15, 3, v14
  v_lshlrev_b32 v15, 12, v15
  v_and_b32 v16, 7, v14
  v_lshl_add_u32 v15, v16, 4, v15
  v_lshlrev_b32 v16, 12, v12
  v_lshl_add_u32 v16, v13, 3, v16
  v_lshl_add_u32 v6, v16, 16, v15
  v_lshlrev_b32 v15, 8, v12
  v_and_b32 v16, 7, v13
  v_lshl_add_u32 v15, v16, 4, v15
  s_lshl_b32 s15, s13, 11
  v_add_u32 v15, s15, v15
  s_lshl_b32 s53, s13, 10
  s_and_b32 s54, s13, 1
  s_lshl_b32 s54, s54, 7
  s_lshr_b32 s15, s13, 1
  s_lshl_b32 s15, s15, 9
  s_add_u32 s54, s54, s15
  s_mov_b32 s42, 0
  s_mov_b32 s43, 0x00ff00ff
  v_lshlrev_b32 v17, 4, v16
  v_and_b32 v16, 1, v12
  v_lshl_add_u32 v17, v16, 8, v17
  v_lshrrev_b32 v16, 3, v13
  v_lshl_add_u32 v17, v16, 3, v17
  v_add_u32 v17, 14336, v17
  v_lshl_add_u32 v7, v17, 16, v15
  s_lshl_b32 s15, s12, 1
  s_add_u32 s15, s15, s13
  s_mov_b32 s38, 1
  s_cmp_lt_u32 s13, 2
  s_cbranch_scc1 Lrb_5
  s_add_u32 s15, s12, 64
  s_cmp_lt_u32 s12, 16
  s_cselect_b32 s38, 1, 0
  s_cmp_eq_u32 s13, 2
  s_cselect_b32 s38, s38, 0
  s_cmp_eq_u32 s38, 1
  s_cselect_b32 s15, s15, 0
Lrb_5:
  s_lshl_b32 s26, s15, 12
  s_add_u32 s26, s26, 131072
  s_mul_i32 s16, s15, 3277
  s_lshr_b32 s16, s16, 16
  s_mul_i32 s50, s16, 20
  s_sub_u32 s15, s15, s50
  s_mul_i32 s16, s16, 160
  s_lshr_b32 s50, s15, 3
  s_lshl_b32 s50, s50, 6
  s_add_u32 s16, s16, s50
  s_lshr_b32 s51, s15, 1
  s_and_b32 s51, s51, 3
  s_and_b32 s50, s15, 3
  s_cmp_ge_u32 s15, 16
  s_cselect_b32 s48, 1, 0
  s_cselect_b32 s51, s50, s51
  s_and_b32 s50, s51, 2
  s_lshl_b32 s41, s50, 4
  s_and_b32 s15, s15, 1
  s_lshl_b32 s15, s15, 4
  s_add_u32 s41, s41, s15
  s_lshl_b32 s50, s50, 3
  s_cmp_eq_u32 s48, 1
  s_cselect_b32 s50, s50, s41
  s_add_u32 s16, s16, s50
  s_and_b32 s50, s51, 1
  s_lshl_b32 s50, s50, 6
  v_lshlrev_b32 v15, 1, v13
  v_add_u32 v15, s16, v15
  v_lshrrev_b32 v16, 3, v15
  v_lshlrev_b32 v16, 7, v16
  v_and_b32 v15, 7, v15
  v_lshl_add_u32 v16, v15, 1, v16
  v_lshl_add_u32 v16, v12, 5, v16
  v_add_u32 v16, s50, v16
  v_and_b32 v15, 0x28, v14
  v_cmp_eq_u32 vcc, 0, v15
  v_mov_b32 v15, 0x8000
  s_nop 0
  v_cndmask_b32 v16, v15, v16, vcc
  v_lshl_or_b32 v0, v16, 16, v0
  s_and_b32 s39, s13, 1
  s_lshl_b32 s39, s39, 10
  s_add_u32 s39, s39, 8192
  s_mov_b32 s40, 0x3e0293ee
  s_mov_b32 s45, 0x05040100
  s_mov_b32 s46, 0x07060302
  s_lshl_b32 s15, s12, 2
  s_add_u32 s15, s15, s13
  s_mul_i32 s15, s15, 20480
  s_add_u32 s15, s15, 458752
  s_add_u32 s30, s15, 0
  s_add_u32 s31, s15, 4096
  s_add_u32 s32, s15, 8192
  s_add_u32 s33, s15, 12288
  s_add_u32 s34, s15, 16384
  s_mul_i32 s23, s13, 81920
  s_lshl_b32 s15, s12, 7
  s_add_u32 s23, s23, s15
  s_add_u32 s23, s23, 131072
  s_add_u32 s24, s23, 32768
  s_add_u32 s25, s23, 65536
  s_mul_i32 s17, s13, 40960
  s_lshl_b32 s21, s12, 2
  s_add_u32 s21, s21, s13
  s_mul_i32 s21, s21, 36864
  s_add_u32 s21, s21, 4194304
  v_lshrrev_b32 v26, 3, v14
  v_lshlrev_b32 v26, 13, v26
  v_and_b32 v27, 7, v14
  v_lshl_add_u32 v26, v27, 4, v26
  s_lshr_b32 s15, s13, 1
  s_lshl_b32 s15, s15, 7
  v_add_u32 v17, s15, v26
  s_mul_i32 s15, s13, 320
  s_mov_b32 s16, 3277
  s_movk_i32 s50, 1280
  v_add_u32 v26, 0, v14
  v_mul_lo_u32 v27, v26, s16
  v_lshrrev_b32 v27, 16, v27
  v_mul_u32_u24 v18, 20, v27
  v_sub_u32 v26, v26, v18
  v_mul_lo_u32 v27, v27, s50
  v_lshl_add_u32 v27, v26, 4, v27
  v_add_u32 v18, s15, v27
  v_add_u32 v26, 64, v14
  v_mul_lo_u32 v27, v26, s16
  v_lshrrev_b32 v27, 16, v27
  v_mul_u32_u24 v19, 20, v27
  v_sub_u32 v26, v26, v19
  v_mul_lo_u32 v27, v27, s50
  v_lshl_add_u32 v27, v26, 4, v27
  v_add_u32 v19, s15, v27
  v_add_u32 v26, 128, v14
  v_mul_lo_u32 v27, v26, s16
  v_lshrrev_b32 v27, 16, v27
  v_mul_u32_u24 v20, 20, v27
  v_sub_u32 v26, v26, v20
  v_mul_lo_u32 v27, v27, s50
  v_lshl_add_u32 v27, v26, 4, v27
  v_add_u32 v20, s15, v27
  v_add_u32 v26, 192, v14
  v_mul_lo_u32 v27, v26, s16
  v_lshrrev_b32 v27, 16, v27
  v_mul_u32_u24 v21, 20, v27
  v_sub_u32 v26, v26, v21
  v_mul_lo_u32 v27, v27, s50
  v_lshl_add_u32 v27, v26, 4, v27
  v_add_u32 v21, s15, v27
  v_add_u32 v26, 256, v14
  v_mul_lo_u32 v27, v26, s16
  v_lshrrev_b32 v27, 16, v27
  v_mul_u32_u24 v22, 20, v27
  v_sub_u32 v26, v26, v22
  v_mul_lo_u32 v27, v27, s50
  v_lshl_add_u32 v27, v26, 4, v27
  v_add_u32 v22, s15, v27
  v_lshrrev_b32 v26, 1, v12
  v_lshlrev_b32 v26, 4, v26
  v_and_b32 v27, 1, v12
  v_lshl_add_u32 v28, v27, 2, v26
  s_mov_b32 s8, s58
  s_and_b32 s9, s59, 0xffff
  s_mov_b32 s10, 5242880
  s_mov_b32 s11, 0x00020000
  s_lshl_b32 s19, s13, 1
  s_lshl_b32 s19, s19, 19
  s_lshl_b32 s20, s12, 8
  s_add_u32 s19, s19, s20
  s_add_u32 s20, s19, 0
  s_add_u32 m0, s17, 0
  s_nop 0
  buffer_load_dwordx4 v17, s[8:11], s20 offen lds
  s_add_u32 s20, s19, 65536
  s_add_u32 m0, s17, 1024
  s_nop 0
  buffer_load_dwordx4 v17, s[8:11], s20 offen lds
  s_add_u32 s20, s19, 131072
  s_add_u32 m0, s17, 2048
  s_nop 0
  buffer_load_dwordx4 v17, s[8:11], s20 offen lds
  s_add_u32 s20, s19, 196608
  s_add_u32 m0, s17, 3072
  s_nop 0
  buffer_load_dwordx4 v17, s[8:11], s20 offen lds
  s_add_u32 s20, s19, 262144
  s_add_u32 m0, s17, 4096
  s_nop 0
  buffer_load_dwordx4 v17, s[8:11], s20 offen lds
  s_add_u32 s20, s19, 327680
  s_add_u32 m0, s17, 5120
  s_nop 0
  buffer_load_dwordx4 v17, s[8:11], s20 offen lds
  s_add_u32 s20, s19, 393216
  s_add_u32 m0, s17, 6144
  s_nop 0
  buffer_load_dwordx4 v17, s[8:11], s20 offen lds
  s_add_u32 s20, s19, 458752
  s_add_u32 m0, s17, 7168
  s_nop 0
  buffer_load_dwordx4 v17, s[8:11], s20 offen lds
  s_lshl_b32 s19, s13, 1
  s_add_u32 s19, s19, 1
  s_lshl_b32 s19, s19, 19
  s_lshl_b32 s20, s12, 8
  s_add_u32 s19, s19, s20
  s_add_u32 s20, s19, 0
  s_add_u32 m0, s17, 8192
  s_nop 0
  buffer_load_dwordx4 v17, s[8:11], s20 offen lds
  s_add_u32 s20, s19, 65536
  s_add_u32 m0, s17, 9216
  s_nop 0
  buffer_load_dwordx4 v17, s[8:11], s20 offen lds
  s_add_u32 s20, s19, 131072
  s_add_u32 m0, s17, 10240
  s_nop 0
  buffer_load_dwordx4 v17, s[8:11], s20 offen lds
  s_add_u32 s20, s19, 196608
  s_add_u32 m0, s17, 11264
  s_nop 0
  buffer_load_dwordx4 v17, s[8:11], s20 offen lds
  s_add_u32 s20, s19, 262144
  s_add_u32 m0, s17, 12288
  s_nop 0
  buffer_load_dwordx4 v17, s[8:11], s20 offen lds
  s_add_u32 s20, s19, 327680
  s_add_u32 m0, s17, 13312
  s_nop 0
  buffer_load_dwordx4 v17, s[8:11], s20 offen lds
  s_add_u32 s20, s19, 393216
  s_add_u32 m0, s17, 14336
  s_nop 0
  buffer_load_dwordx4 v17, s[8:11], s20 offen lds
  s_add_u32 s20, s19, 458752
  s_add_u32 m0, s17, 15360
  s_nop 0
  buffer_load_dwordx4 v17, s[8:11], s20 offen lds
  s_and_b32 s19, s13, 1
  s_add_u32 s19, s19, 8
  s_lshl_b32 s19, s19, 19
  s_lshl_b32 s20, s12, 8
  s_add_u32 s19, s19, s20
  s_add_u32 s20, s19, 0
  s_add_u32 m0, s17, 16384
  s_nop 0
  buffer_load_dwordx4 v17, s[8:11], s20 offen lds
  s_add_u32 s20, s19, 65536
  s_add_u32 m0, s17, 17408
  s_nop 0
  buffer_load_dwordx4 v17, s[8:11], s20 offen lds
  s_add_u32 s20, s19, 131072
  s_add_u32 m0, s17, 18432
  s_nop 0
  buffer_load_dwordx4 v17, s[8:11], s20 offen lds
  s_add_u32 s20, s19, 196608
  s_add_u32 m0, s17, 19456
  s_nop 0
  buffer_load_dwordx4 v17, s[8:11], s20 offen lds
  s_add_u32 s20, s19, 262144
  s_add_u32 m0, s17, 20480
  s_nop 0
  buffer_load_dwordx4 v17, s[8:11], s20 offen lds
  s_add_u32 s20, s19, 327680
  s_add_u32 m0, s17, 21504
  s_nop 0
  buffer_load_dwordx4 v17, s[8:11], s20 offen lds
  s_add_u32 s20, s19, 393216
  s_add_u32 m0, s17, 22528
  s_nop 0
  buffer_load_dwordx4 v17, s[8:11], s20 offen lds
  s_add_u32 s20, s19, 458752
  s_add_u32 m0, s17, 23552
  s_nop 0
  buffer_load_dwordx4 v17, s[8:11], s20 offen lds
  s_xor_b32 s19, s13, 2
  s_lshl_b32 s19, s19, 1
  s_lshl_b32 s19, s19, 19
  s_lshl_b32 s20, s12, 8
  s_add_u32 s19, s19, s20
  s_add_u32 s20, s19, 0
  s_add_u32 m0, s17, 24576
  s_nop 0
  buffer_load_dwordx4 v17, s[8:11], s20 offen lds
  s_add_u32 s20, s19, 65536
  s_add_u32 m0, s17, 25600
  s_nop 0
  buffer_load_dwordx4 v17, s[8:11], s20 offen lds
  s_add_u32 s20, s19, 131072
  s_add_u32 m0, s17, 26624
  s_nop 0
  buffer_load_dwordx4 v17, s[8:11], s20 offen lds
  s_add_u32 s20, s19, 196608
  s_add_u32 m0, s17, 27648
  s_nop 0
  buffer_load_dwordx4 v17, s[8:11], s20 offen lds
  s_add_u32 s20, s19, 262144
  s_add_u32 m0, s17, 28672
  s_nop 0
  buffer_load_dwordx4 v17, s[8:11], s20 offen lds
  s_add_u32 s20, s19, 327680
  s_add_u32 m0, s17, 29696
  s_nop 0
  buffer_load_dwordx4 v17, s[8:11], s20 offen lds
  s_add_u32 s20, s19, 393216
  s_add_u32 m0, s17, 30720
  s_nop 0
  buffer_load_dwordx4 v17, s[8:11], s20 offen lds
  s_add_u32 s20, s19, 458752
  s_add_u32 m0, s17, 31744
  s_nop 0
  buffer_load_dwordx4 v17, s[8:11], s20 offen lds
  s_xor_b32 s19, s13, 2
  s_lshl_b32 s19, s19, 1
  s_add_u32 s19, s19, 1
  s_lshl_b32 s19, s19, 19
  s_lshl_b32 s20, s12, 8
  s_add_u32 s19, s19, s20
  s_add_u32 s20, s19, 0
  s_add_u32 m0, s17, 32768
  s_nop 0
  buffer_load_dwordx4 v17, s[8:11], s20 offen lds
  s_add_u32 s20, s19, 65536
  s_add_u32 m0, s17, 33792
  s_nop 0
  buffer_load_dwordx4 v17, s[8:11], s20 offen lds
  s_add_u32 s20, s19, 131072
  s_add_u32 m0, s17, 34816
  s_nop 0
  buffer_load_dwordx4 v17, s[8:11], s20 offen lds
  s_add_u32 s20, s19, 196608
  s_add_u32 m0, s17, 35840
  s_nop 0
  buffer_load_dwordx4 v17, s[8:11], s20 offen lds
  s_add_u32 s20, s19, 262144
  s_add_u32 m0, s17, 36864
  s_nop 0
  buffer_load_dwordx4 v17, s[8:11], s20 offen lds
  s_add_u32 s20, s19, 327680
  s_add_u32 m0, s17, 37888
  s_nop 0
  buffer_load_dwordx4 v17, s[8:11], s20 offen lds
  s_add_u32 s20, s19, 393216
  s_add_u32 m0, s17, 38912
  s_nop 0
  buffer_load_dwordx4 v17, s[8:11], s20 offen lds
  s_add_u32 s20, s19, 458752
  s_add_u32 m0, s17, 39936
  s_nop 0
  buffer_load_dwordx4 v17, s[8:11], s20 offen lds
  v_lshlrev_b32 v26, 7, v28
  v_lshl_add_u32 v26, v13, 2, v26
  s_and_b32 s15, s13, 1
  s_lshl_b32 s15, s15, 6
  v_add_u32 v26, s15, v26
  v_add_u32 v25, s17, v26
  s_xor_b32 s15, s13, 1
  s_mul_i32 s15, s15, 40960
  v_add_u32 v29, s15, v26
  s_waitcnt vmcnt(24)
  s_barrier
  v_add_u32 v23, 0, v25
  v_add_u32 v24, 1024, v25
  v_add_u32 v30, 4096, v25
  v_add_u32 v31, 5120, v25
  ds_read2_b32 v[32:33], v23 offset0:0 offset1:32
  ds_read2_b32 v[34:35], v24 offset0:0 offset1:32
  ds_read2_b32 v[36:37], v23 offset0:64 offset1:96
  ds_read2_b32 v[38:39], v24 offset0:64 offset1:96
  ds_read2_b32 v[40:41], v30 offset0:0 offset1:32
  ds_read2_b32 v[42:43], v31 offset0:0 offset1:32
  ds_read2_b32 v[44:45], v30 offset0:64 offset1:96
  ds_read2_b32 v[46:47], v31 offset0:64 offset1:96
  s_waitcnt lgkmcnt(0)
  v_perm_b32 v64, v33, v32, s45
  v_perm_b32 v65, v35, v34, s45
  v_perm_b32 v66, v37, v36, s45
  v_perm_b32 v67, v39, v38, s45
  v_perm_b32 v68, v41, v40, s45
  v_perm_b32 v69, v43, v42, s45
  v_perm_b32 v70, v45, v44, s45
  v_perm_b32 v71, v47, v46, s45
  v_accvgpr_write_b32 a0, v64
  v_accvgpr_write_b32 a1, v65
  v_accvgpr_write_b32 a2, v66
  v_accvgpr_write_b32 a3, v67
  v_accvgpr_write_b32 a4, v68
  v_accvgpr_write_b32 a5, v69
  v_accvgpr_write_b32 a6, v70
  v_accvgpr_write_b32 a7, v71
  v_perm_b32 v72, v33, v32, s46
  v_perm_b32 v73, v35, v34, s46
  v_perm_b32 v74, v37, v36, s46
  v_perm_b32 v75, v39, v38, s46
  v_perm_b32 v76, v41, v40, s46
  v_perm_b32 v77, v43, v42, s46
  v_perm_b32 v78, v45, v44, s46
  v_perm_b32 v79, v47, v46, s46
  v_accvgpr_write_b32 a16, v72
  v_accvgpr_write_b32 a17, v73
  v_accvgpr_write_b32 a18, v74
  v_accvgpr_write_b32 a19, v75
  v_accvgpr_write_b32 a20, v76
  v_accvgpr_write_b32 a21, v77
  v_accvgpr_write_b32 a22, v78
  v_accvgpr_write_b32 a23, v79
  v_add_u32 v23, 0, v29
  v_add_u32 v24, 1024, v29
  v_add_u32 v30, 4096, v29
  v_add_u32 v31, 5120, v29
  ds_read2_b32 v[32:33], v23 offset0:0 offset1:32
  ds_read2_b32 v[34:35], v24 offset0:0 offset1:32
  ds_read2_b32 v[36:37], v23 offset0:64 offset1:96
  ds_read2_b32 v[38:39], v24 offset0:64 offset1:96
  ds_read2_b32 v[40:41], v30 offset0:0 offset1:32
  ds_read2_b32 v[42:43], v31 offset0:0 offset1:32
  ds_read2_b32 v[44:45], v30 offset0:64 offset1:96
  ds_read2_b32 v[46:47], v31 offset0:64 offset1:96
  s_waitcnt lgkmcnt(0)
  v_perm_b32 v64, v33, v32, s45
  v_perm_b32 v65, v35, v34, s45
  v_perm_b32 v66, v37, v36, s45
  v_perm_b32 v67, v39, v38, s45
  v_perm_b32 v68, v41, v40, s45
  v_perm_b32 v69, v43, v42, s45
  v_perm_b32 v70, v45, v44, s45
  v_perm_b32 v71, v47, v46, s45
  v_accvgpr_write_b32 a128, v64
  v_accvgpr_write_b32 a129, v65
  v_accvgpr_write_b32 a130, v66
  v_accvgpr_write_b32 a131, v67
  v_accvgpr_write_b32 a132, v68
  v_accvgpr_write_b32 a133, v69
  v_accvgpr_write_b32 a134, v70
  v_accvgpr_write_b32 a135, v71
  v_perm_b32 v72, v33, v32, s46
  v_perm_b32 v73, v35, v34, s46
  v_perm_b32 v74, v37, v36, s46
  v_perm_b32 v75, v39, v38, s46
  v_perm_b32 v76, v41, v40, s46
  v_perm_b32 v77, v43, v42, s46
  v_perm_b32 v78, v45, v44, s46
  v_perm_b32 v79, v47, v46, s46
  v_accvgpr_write_b32 a144, v72
  v_accvgpr_write_b32 a145, v73
  v_accvgpr_write_b32 a146, v74
  v_accvgpr_write_b32 a147, v75
  v_accvgpr_write_b32 a148, v76
  v_accvgpr_write_b32 a149, v77
  v_accvgpr_write_b32 a150, v78
  v_accvgpr_write_b32 a151, v79
  v_add_u32 v23, 8192, v25
  v_add_u32 v24, 9216, v25
  v_add_u32 v30, 12288, v25
  v_add_u32 v31, 13312, v25
  ds_read2_b32 v[32:33], v23 offset0:0 offset1:32
  ds_read2_b32 v[34:35], v24 offset0:0 offset1:32
  ds_read2_b32 v[36:37], v23 offset0:64 offset1:96
  ds_read2_b32 v[38:39], v24 offset0:64 offset1:96
  ds_read2_b32 v[40:41], v30 offset0:0 offset1:32
  ds_read2_b32 v[42:43], v31 offset0:0 offset1:32
  ds_read2_b32 v[44:45], v30 offset0:64 offset1:96
  ds_read2_b32 v[46:47], v31 offset0:64 offset1:96
  s_waitcnt lgkmcnt(0)
  v_perm_b32 v64, v33, v32, s45
  v_perm_b32 v65, v35, v34, s45
  v_perm_b32 v66, v37, v36, s45
  v_perm_b32 v67, v39, v38, s45
  v_perm_b32 v68, v41, v40, s45
  v_perm_b32 v69, v43, v42, s45
  v_perm_b32 v70, v45, v44, s45
  v_perm_b32 v71, v47, v46, s45
  v_accvgpr_write_b32 a32, v64
  v_accvgpr_write_b32 a33, v65
  v_accvgpr_write_b32 a34, v66
  v_accvgpr_write_b32 a35, v67
  v_accvgpr_write_b32 a36, v68
  v_accvgpr_write_b32 a37, v69
  v_accvgpr_write_b32 a38, v70
  v_accvgpr_write_b32 a39, v71
  v_perm_b32 v72, v33, v32, s46
  v_perm_b32 v73, v35, v34, s46
  v_perm_b32 v74, v37, v36, s46
  v_perm_b32 v75, v39, v38, s46
  v_perm_b32 v76, v41, v40, s46
  v_perm_b32 v77, v43, v42, s46
  v_perm_b32 v78, v45, v44, s46
  v_perm_b32 v79, v47, v46, s46
  v_accvgpr_write_b32 a48, v72
  v_accvgpr_write_b32 a49, v73
  v_accvgpr_write_b32 a50, v74
  v_accvgpr_write_b32 a51, v75
  v_accvgpr_write_b32 a52, v76
  v_accvgpr_write_b32 a53, v77
  v_accvgpr_write_b32 a54, v78
  v_accvgpr_write_b32 a55, v79
  v_add_u32 v23, 8192, v29
  v_add_u32 v24, 9216, v29
  v_add_u32 v30, 12288, v29
  v_add_u32 v31, 13312, v29
  ds_read2_b32 v[32:33], v23 offset0:0 offset1:32
  ds_read2_b32 v[34:35], v24 offset0:0 offset1:32
  ds_read2_b32 v[36:37], v23 offset0:64 offset1:96
  ds_read2_b32 v[38:39], v24 offset0:64 offset1:96
  ds_read2_b32 v[40:41], v30 offset0:0 offset1:32
  ds_read2_b32 v[42:43], v31 offset0:0 offset1:32
  ds_read2_b32 v[44:45], v30 offset0:64 offset1:96
  ds_read2_b32 v[46:47], v31 offset0:64 offset1:96
  s_waitcnt lgkmcnt(0)
  v_perm_b32 v64, v33, v32, s45
  v_perm_b32 v65, v35, v34, s45
  v_perm_b32 v66, v37, v36, s45
  v_perm_b32 v67, v39, v38, s45
  v_perm_b32 v68, v41, v40, s45
  v_perm_b32 v69, v43, v42, s45
  v_perm_b32 v70, v45, v44, s45
  v_perm_b32 v71, v47, v46, s45
  v_accvgpr_write_b32 a160, v64
  v_accvgpr_write_b32 a161, v65
  v_accvgpr_write_b32 a162, v66
  v_accvgpr_write_b32 a163, v67
  v_accvgpr_write_b32 a164, v68
  v_accvgpr_write_b32 a165, v69
  v_accvgpr_write_b32 a166, v70
  v_accvgpr_write_b32 a167, v71
  v_perm_b32 v72, v33, v32, s46
  v_perm_b32 v73, v35, v34, s46
  v_perm_b32 v74, v37, v36, s46
  v_perm_b32 v75, v39, v38, s46
  v_perm_b32 v76, v41, v40, s46
  v_perm_b32 v77, v43, v42, s46
  v_perm_b32 v78, v45, v44, s46
  v_perm_b32 v79, v47, v46, s46
  v_accvgpr_write_b32 a176, v72
  v_accvgpr_write_b32 a177, v73
  v_accvgpr_write_b32 a178, v74
  v_accvgpr_write_b32 a179, v75
  v_accvgpr_write_b32 a180, v76
  v_accvgpr_write_b32 a181, v77
  v_accvgpr_write_b32 a182, v78
  v_accvgpr_write_b32 a183, v79
  s_waitcnt vmcnt(16)
  s_barrier
  s_mov_b32 s8, s60
  s_and_b32 s9, s61, 0xffff
  s_mov_b32 s10, 5242880
  s_mov_b32 s11, 0x00020000
  s_lshl_b32 s19, s13, 1
  s_lshl_b32 s19, s19, 19
  s_lshl_b32 s20, s12, 8
  s_add_u32 s19, s19, s20
  s_add_u32 s20, s19, 0
  s_add_u32 m0, s17, 0
  s_nop 0
  buffer_load_dwordx4 v17, s[8:11], s20 offen lds
  s_add_u32 s20, s19, 65536
  s_add_u32 m0, s17, 1024
  s_nop 0
  buffer_load_dwordx4 v17, s[8:11], s20 offen lds
  s_add_u32 s20, s19, 131072
  s_add_u32 m0, s17, 2048
  s_nop 0
  buffer_load_dwordx4 v17, s[8:11], s20 offen lds
  s_add_u32 s20, s19, 196608
  s_add_u32 m0, s17, 3072
  s_nop 0
  buffer_load_dwordx4 v17, s[8:11], s20 offen lds
  s_add_u32 s20, s19, 262144
  s_add_u32 m0, s17, 4096
  s_nop 0
  buffer_load_dwordx4 v17, s[8:11], s20 offen lds
  s_add_u32 s20, s19, 327680
  s_add_u32 m0, s17, 5120
  s_nop 0
  buffer_load_dwordx4 v17, s[8:11], s20 offen lds
  s_add_u32 s20, s19, 393216
  s_add_u32 m0, s17, 6144
  s_nop 0
  buffer_load_dwordx4 v17, s[8:11], s20 offen lds
  s_add_u32 s20, s19, 458752
  s_add_u32 m0, s17, 7168
  s_nop 0
  buffer_load_dwordx4 v17, s[8:11], s20 offen lds
  s_lshl_b32 s19, s13, 1
  s_add_u32 s19, s19, 1
  s_lshl_b32 s19, s19, 19
  s_lshl_b32 s20, s12, 8
  s_add_u32 s19, s19, s20
  s_add_u32 s20, s19, 0
  s_add_u32 m0, s17, 8192
  s_nop 0
  buffer_load_dwordx4 v17, s[8:11], s20 offen lds
  s_add_u32 s20, s19, 65536
  s_add_u32 m0, s17, 9216
  s_nop 0
  buffer_load_dwordx4 v17, s[8:11], s20 offen lds
  s_add_u32 s20, s19, 131072
  s_add_u32 m0, s17, 10240
  s_nop 0
  buffer_load_dwordx4 v17, s[8:11], s20 offen lds
  s_add_u32 s20, s19, 196608
  s_add_u32 m0, s17, 11264
  s_nop 0
  buffer_load_dwordx4 v17, s[8:11], s20 offen lds
  s_add_u32 s20, s19, 262144
  s_add_u32 m0, s17, 12288
  s_nop 0
  buffer_load_dwordx4 v17, s[8:11], s20 offen lds
  s_add_u32 s20, s19, 327680
  s_add_u32 m0, s17, 13312
  s_nop 0
  buffer_load_dwordx4 v17, s[8:11], s20 offen lds
  s_add_u32 s20, s19, 393216
  s_add_u32 m0, s17, 14336
  s_nop 0
  buffer_load_dwordx4 v17, s[8:11], s20 offen lds
  s_add_u32 s20, s19, 458752
  s_add_u32 m0, s17, 15360
  s_nop 0
  buffer_load_dwordx4 v17, s[8:11], s20 offen lds
  v_add_u32 v23, 16384, v25
  v_add_u32 v24, 17408, v25
  v_add_u32 v30, 20480, v25
  v_add_u32 v31, 21504, v25
  ds_read2_b32 v[32:33], v23 offset0:0 offset1:32
  ds_read2_b32 v[34:35], v24 offset0:0 offset1:32
  ds_read2_b32 v[36:37], v23 offset0:64 offset1:96
  ds_read2_b32 v[38:39], v24 offset0:64 offset1:96
  ds_read2_b32 v[40:41], v30 offset0:0 offset1:32
  ds_read2_b32 v[42:43], v31 offset0:0 offset1:32
  ds_read2_b32 v[44:45], v30 offset0:64 offset1:96
  ds_read2_b32 v[46:47], v31 offset0:64 offset1:96
  s_waitcnt lgkmcnt(0)
  v_perm_b32 v64, v33, v32, s45
  v_perm_b32 v65, v35, v34, s45
  v_perm_b32 v66, v37, v36, s45
  v_perm_b32 v67, v39, v38, s45
  v_perm_b32 v68, v41, v40, s45
  v_perm_b32 v69, v43, v42, s45
  v_perm_b32 v70, v45, v44, s45
  v_perm_b32 v71, v47, v46, s45
  v_accvgpr_write_b32 a64, v64
  v_accvgpr_write_b32 a65, v65
  v_accvgpr_write_b32 a66, v66
  v_accvgpr_write_b32 a67, v67
  v_accvgpr_write_b32 a68, v68
  v_accvgpr_write_b32 a69, v69
  v_accvgpr_write_b32 a70, v70
  v_accvgpr_write_b32 a71, v71
  v_perm_b32 v72, v33, v32, s46
  v_perm_b32 v73, v35, v34, s46
  v_perm_b32 v74, v37, v36, s46
  v_perm_b32 v75, v39, v38, s46
  v_perm_b32 v76, v41, v40, s46
  v_perm_b32 v77, v43, v42, s46
  v_perm_b32 v78, v45, v44, s46
  v_perm_b32 v79, v47, v46, s46
  v_accvgpr_write_b32 a80, v72
  v_accvgpr_write_b32 a81, v73
  v_accvgpr_write_b32 a82, v74
  v_accvgpr_write_b32 a83, v75
  v_accvgpr_write_b32 a84, v76
  v_accvgpr_write_b32 a85, v77
  v_accvgpr_write_b32 a86, v78
  v_accvgpr_write_b32 a87, v79
  v_add_u32 v23, 16384, v29
  v_add_u32 v24, 17408, v29
  v_add_u32 v30, 20480, v29
  v_add_u32 v31, 21504, v29
  ds_read2_b32 v[32:33], v23 offset0:0 offset1:32
  ds_read2_b32 v[34:35], v24 offset0:0 offset1:32
  ds_read2_b32 v[36:37], v23 offset0:64 offset1:96
  ds_read2_b32 v[38:39], v24 offset0:64 offset1:96
  ds_read2_b32 v[40:41], v30 offset0:0 offset1:32
  ds_read2_b32 v[42:43], v31 offset0:0 offset1:32
  ds_read2_b32 v[44:45], v30 offset0:64 offset1:96
  ds_read2_b32 v[46:47], v31 offset0:64 offset1:96
  s_waitcnt lgkmcnt(0)
  v_perm_b32 v64, v33, v32, s45
  v_perm_b32 v65, v35, v34, s45
  v_perm_b32 v66, v37, v36, s45
  v_perm_b32 v67, v39, v38, s45
  v_perm_b32 v68, v41, v40, s45
  v_perm_b32 v69, v43, v42, s45
  v_perm_b32 v70, v45, v44, s45
  v_perm_b32 v71, v47, v46, s45
  v_accvgpr_write_b32 a96, v64
  v_accvgpr_write_b32 a97, v65
  v_accvgpr_write_b32 a98, v66
  v_accvgpr_write_b32 a99, v67
  v_accvgpr_write_b32 a100, v68
  v_accvgpr_write_b32 a101, v69
  v_accvgpr_write_b32 a102, v70
  v_accvgpr_write_b32 a103, v71
  v_perm_b32 v72, v33, v32, s46
  v_perm_b32 v73, v35, v34, s46
  v_perm_b32 v74, v37, v36, s46
  v_perm_b32 v75, v39, v38, s46
  v_perm_b32 v76, v41, v40, s46
  v_perm_b32 v77, v43, v42, s46
  v_perm_b32 v78, v45, v44, s46
  v_perm_b32 v79, v47, v46, s46
  v_accvgpr_write_b32 a112, v72
  v_accvgpr_write_b32 a113, v73
  v_accvgpr_write_b32 a114, v74
  v_accvgpr_write_b32 a115, v75
  v_accvgpr_write_b32 a116, v76
  v_accvgpr_write_b32 a117, v77
  v_accvgpr_write_b32 a118, v78
  v_accvgpr_write_b32 a119, v79
  s_waitcnt vmcnt(16)
  s_barrier
  s_mov_b32 s8, s60
  s_and_b32 s9, s61, 0xffff
  s_mov_b32 s10, 5242880
  s_mov_b32 s11, 0x00020000
  s_and_b32 s19, s13, 1
  s_add_u32 s19, s19, 8
  s_lshl_b32 s19, s19, 19
  s_lshl_b32 s20, s12, 8
  s_add_u32 s19, s19, s20
  s_add_u32 s20, s19, 0
  s_add_u32 m0, s17, 16384
  s_nop 0
  buffer_load_dwordx4 v17, s[8:11], s20 offen lds
  s_add_u32 s20, s19, 65536
  s_add_u32 m0, s17, 17408
  s_nop 0
  buffer_load_dwordx4 v17, s[8:11], s20 offen lds
  s_add_u32 s20, s19, 131072
  s_add_u32 m0, s17, 18432
  s_nop 0
  buffer_load_dwordx4 v17, s[8:11], s20 offen lds
  s_add_u32 s20, s19, 196608
  s_add_u32 m0, s17, 19456
  s_nop 0
  buffer_load_dwordx4 v17, s[8:11], s20 offen lds
  s_add_u32 s20, s19, 262144
  s_add_u32 m0, s17, 20480
  s_nop 0
  buffer_load_dwordx4 v17, s[8:11], s20 offen lds
  s_add_u32 s20, s19, 327680
  s_add_u32 m0, s17, 21504
  s_nop 0
  buffer_load_dwordx4 v17, s[8:11], s20 offen lds
  s_add_u32 s20, s19, 393216
  s_add_u32 m0, s17, 22528
  s_nop 0
  buffer_load_dwordx4 v17, s[8:11], s20 offen lds
  s_add_u32 s20, s19, 458752
  s_add_u32 m0, s17, 23552
  s_nop 0
  buffer_load_dwordx4 v17, s[8:11], s20 offen lds
  v_add_u32 v23, 24576, v25
  v_add_u32 v24, 25600, v25
  v_add_u32 v30, 28672, v25
  v_add_u32 v31, 29696, v25
  ds_read2_b32 v[32:33], v23 offset0:0 offset1:32
  ds_read2_b32 v[34:35], v24 offset0:0 offset1:32
  ds_read2_b32 v[36:37], v23 offset0:64 offset1:96
  ds_read2_b32 v[38:39], v24 offset0:64 offset1:96
  ds_read2_b32 v[40:41], v30 offset0:0 offset1:32
  ds_read2_b32 v[42:43], v31 offset0:0 offset1:32
  ds_read2_b32 v[44:45], v30 offset0:64 offset1:96
  ds_read2_b32 v[46:47], v31 offset0:64 offset1:96
  s_waitcnt lgkmcnt(0)
  v_perm_b32 v64, v33, v32, s45
  v_perm_b32 v65, v35, v34, s45
  v_perm_b32 v66, v37, v36, s45
  v_perm_b32 v67, v39, v38, s45
  v_perm_b32 v68, v41, v40, s45
  v_perm_b32 v69, v43, v42, s45
  v_perm_b32 v70, v45, v44, s45
  v_perm_b32 v71, v47, v46, s45
  v_accvgpr_write_b32 a192, v64
  v_accvgpr_write_b32 a193, v65
  v_accvgpr_write_b32 a194, v66
  v_accvgpr_write_b32 a195, v67
  v_accvgpr_write_b32 a196, v68
  v_accvgpr_write_b32 a197, v69
  v_accvgpr_write_b32 a198, v70
  v_accvgpr_write_b32 a199, v71
  v_perm_b32 v72, v33, v32, s46
  v_perm_b32 v73, v35, v34, s46
  v_perm_b32 v74, v37, v36, s46
  v_perm_b32 v75, v39, v38, s46
  v_perm_b32 v76, v41, v40, s46
  v_perm_b32 v77, v43, v42, s46
  v_perm_b32 v78, v45, v44, s46
  v_perm_b32 v79, v47, v46, s46
  v_accvgpr_write_b32 a208, v72
  v_accvgpr_write_b32 a209, v73
  v_accvgpr_write_b32 a210, v74
  v_accvgpr_write_b32 a211, v75
  v_accvgpr_write_b32 a212, v76
  v_accvgpr_write_b32 a213, v77
  v_accvgpr_write_b32 a214, v78
  v_accvgpr_write_b32 a215, v79
  v_add_u32 v23, 24576, v29
  v_add_u32 v24, 25600, v29
  v_add_u32 v30, 28672, v29
  v_add_u32 v31, 29696, v29
  ds_read2_b32 v[32:33], v23 offset0:0 offset1:32
  ds_read2_b32 v[34:35], v24 offset0:0 offset1:32
  ds_read2_b32 v[36:37], v23 offset0:64 offset1:96
  ds_read2_b32 v[38:39], v24 offset0:64 offset1:96
  ds_read2_b32 v[40:41], v30 offset0:0 offset1:32
  ds_read2_b32 v[42:43], v31 offset0:0 offset1:32
  ds_read2_b32 v[44:45], v30 offset0:64 offset1:96
  ds_read2_b32 v[46:47], v31 offset0:64 offset1:96
  s_waitcnt lgkmcnt(0)
  v_perm_b32 v192, v33, v32, s45
  v_perm_b32 v193, v35, v34, s45
  v_perm_b32 v194, v37, v36, s45
  v_perm_b32 v195, v39, v38, s45
  v_perm_b32 v196, v41, v40, s45
  v_perm_b32 v197, v43, v42, s45
  v_perm_b32 v198, v45, v44, s45
  v_perm_b32 v199, v47, v46, s45
  v_perm_b32 v208, v33, v32, s46
  v_perm_b32 v209, v35, v34, s46
  v_perm_b32 v210, v37, v36, s46
  v_perm_b32 v211, v39, v38, s46
  v_perm_b32 v212, v41, v40, s46
  v_perm_b32 v213, v43, v42, s46
  v_perm_b32 v214, v45, v44, s46
  v_perm_b32 v215, v47, v46, s46
  v_add_u32 v23, 32768, v25
  v_add_u32 v24, 33792, v25
  v_add_u32 v30, 36864, v25
  v_add_u32 v31, 37888, v25
  ds_read2_b32 v[32:33], v23 offset0:0 offset1:32
  ds_read2_b32 v[34:35], v24 offset0:0 offset1:32
  ds_read2_b32 v[36:37], v23 offset0:64 offset1:96
  ds_read2_b32 v[38:39], v24 offset0:64 offset1:96
  ds_read2_b32 v[40:41], v30 offset0:0 offset1:32
  ds_read2_b32 v[42:43], v31 offset0:0 offset1:32
  ds_read2_b32 v[44:45], v30 offset0:64 offset1:96
  ds_read2_b32 v[46:47], v31 offset0:64 offset1:96
  s_waitcnt lgkmcnt(0)
  v_perm_b32 v64, v33, v32, s45
  v_perm_b32 v65, v35, v34, s45
  v_perm_b32 v66, v37, v36, s45
  v_perm_b32 v67, v39, v38, s45
  v_perm_b32 v68, v41, v40, s45
  v_perm_b32 v69, v43, v42, s45
  v_perm_b32 v70, v45, v44, s45
  v_perm_b32 v71, v47, v46, s45
  v_accvgpr_write_b32 a224, v64
  v_accvgpr_write_b32 a225, v65
  v_accvgpr_write_b32 a226, v66
  v_accvgpr_write_b32 a227, v67
  v_accvgpr_write_b32 a228, v68
  v_accvgpr_write_b32 a229, v69
  v_accvgpr_write_b32 a230, v70
  v_accvgpr_write_b32 a231, v71
  v_perm_b32 v72, v33, v32, s46
  v_perm_b32 v73, v35, v34, s46
  v_perm_b32 v74, v37, v36, s46
  v_perm_b32 v75, v39, v38, s46
  v_perm_b32 v76, v41, v40, s46
  v_perm_b32 v77, v43, v42, s46
  v_perm_b32 v78, v45, v44, s46
  v_perm_b32 v79, v47, v46, s46
  v_accvgpr_write_b32 a240, v72
  v_accvgpr_write_b32 a241, v73
  v_accvgpr_write_b32 a242, v74
  v_accvgpr_write_b32 a243, v75
  v_accvgpr_write_b32 a244, v76
  v_accvgpr_write_b32 a245, v77
  v_accvgpr_write_b32 a246, v78
  v_accvgpr_write_b32 a247, v79
  v_add_u32 v23, 32768, v29
  v_add_u32 v24, 33792, v29
  v_add_u32 v30, 36864, v29
  v_add_u32 v31, 37888, v29
  ds_read2_b32 v[32:33], v23 offset0:0 offset1:32
  ds_read2_b32 v[34:35], v24 offset0:0 offset1:32
  ds_read2_b32 v[36:37], v23 offset0:64 offset1:96
  ds_read2_b32 v[38:39], v24 offset0:64 offset1:96
  ds_read2_b32 v[40:41], v30 offset0:0 offset1:32
  ds_read2_b32 v[42:43], v31 offset0:0 offset1:32
  ds_read2_b32 v[44:45], v30 offset0:64 offset1:96
  ds_read2_b32 v[46:47], v31 offset0:64 offset1:96
  s_waitcnt lgkmcnt(0)
  v_perm_b32 v224, v33, v32, s45
  v_perm_b32 v225, v35, v34, s45
  v_perm_b32 v226, v37, v36, s45
  v_perm_b32 v227, v39, v38, s45
  v_perm_b32 v228, v41, v40, s45
  v_perm_b32 v229, v43, v42, s45
  v_perm_b32 v230, v45, v44, s45
  v_perm_b32 v231, v47, v46, s45
  v_perm_b32 v240, v33, v32, s46
  v_perm_b32 v241, v35, v34, s46
  v_perm_b32 v242, v37, v36, s46
  v_perm_b32 v243, v39, v38, s46
  v_perm_b32 v244, v41, v40, s46
  v_perm_b32 v245, v43, v42, s46
  v_perm_b32 v246, v45, v44, s46
  v_perm_b32 v247, v47, v46, s46
  s_waitcnt vmcnt(8)
  s_barrier
  s_mov_b32 s8, s60
  s_and_b32 s9, s61, 0xffff
  s_mov_b32 s10, 5242880
  s_mov_b32 s11, 0x00020000
  s_xor_b32 s19, s13, 2
  s_lshl_b32 s19, s19, 1
  s_lshl_b32 s19, s19, 19
  s_lshl_b32 s20, s12, 8
  s_add_u32 s19, s19, s20
  s_add_u32 s20, s19, 0
  s_add_u32 m0, s17, 24576
  s_nop 0
  buffer_load_dwordx4 v17, s[8:11], s20 offen lds
  s_add_u32 s20, s19, 65536
  s_add_u32 m0, s17, 25600
  s_nop 0
  buffer_load_dwordx4 v17, s[8:11], s20 offen lds
  s_add_u32 s20, s19, 131072
  s_add_u32 m0, s17, 26624
  s_nop 0
  buffer_load_dwordx4 v17, s[8:11], s20 offen lds
  s_add_u32 s20, s19, 196608
  s_add_u32 m0, s17, 27648
  s_nop 0
  buffer_load_dwordx4 v17, s[8:11], s20 offen lds
  s_add_u32 s20, s19, 262144
  s_add_u32 m0, s17, 28672
  s_nop 0
  buffer_load_dwordx4 v17, s[8:11], s20 offen lds
  s_add_u32 s20, s19, 327680
  s_add_u32 m0, s17, 29696
  s_nop 0
  buffer_load_dwordx4 v17, s[8:11], s20 offen lds
  s_add_u32 s20, s19, 393216
  s_add_u32 m0, s17, 30720
  s_nop 0
  buffer_load_dwordx4 v17, s[8:11], s20 offen lds
  s_add_u32 s20, s19, 458752
  s_add_u32 m0, s17, 31744
  s_nop 0
  buffer_load_dwordx4 v17, s[8:11], s20 offen lds
  s_xor_b32 s19, s13, 2
  s_lshl_b32 s19, s19, 1
  s_add_u32 s19, s19, 1
  s_lshl_b32 s19, s19, 19
  s_lshl_b32 s20, s12, 8
  s_add_u32 s19, s19, s20
  s_add_u32 s20, s19, 0
  s_add_u32 m0, s17, 32768
  s_nop 0
  buffer_load_dwordx4 v17, s[8:11], s20 offen lds
  s_add_u32 s20, s19, 65536
  s_add_u32 m0, s17, 33792
  s_nop 0
  buffer_load_dwordx4 v17, s[8:11], s20 offen lds
  s_add_u32 s20, s19, 131072
  s_add_u32 m0, s17, 34816
  s_nop 0
  buffer_load_dwordx4 v17, s[8:11], s20 offen lds
  s_add_u32 s20, s19, 196608
  s_add_u32 m0, s17, 35840
  s_nop 0
  buffer_load_dwordx4 v17, s[8:11], s20 offen lds
  s_add_u32 s20, s19, 262144
  s_add_u32 m0, s17, 36864
  s_nop 0
  buffer_load_dwordx4 v17, s[8:11], s20 offen lds
  s_add_u32 s20, s19, 327680
  s_add_u32 m0, s17, 37888
  s_nop 0
  buffer_load_dwordx4 v17, s[8:11], s20 offen lds
  s_add_u32 s20, s19, 393216
  s_add_u32 m0, s17, 38912
  s_nop 0
  buffer_load_dwordx4 v17, s[8:11], s20 offen lds
  s_add_u32 s20, s19, 458752
  s_add_u32 m0, s17, 39936
  s_nop 0
  buffer_load_dwordx4 v17, s[8:11], s20 offen lds
  v_add_u32 v23, 0, v25
  v_add_u32 v24, 1024, v25
  v_add_u32 v30, 4096, v25
  v_add_u32 v31, 5120, v25
  ds_read2_b32 v[32:33], v23 offset0:0 offset1:32
  ds_read2_b32 v[34:35], v24 offset0:0 offset1:32
  ds_read2_b32 v[36:37], v23 offset0:64 offset1:96
  ds_read2_b32 v[38:39], v24 offset0:64 offset1:96
  ds_read2_b32 v[40:41], v30 offset0:0 offset1:32
  ds_read2_b32 v[42:43], v31 offset0:0 offset1:32
  ds_read2_b32 v[44:45], v30 offset0:64 offset1:96
  ds_read2_b32 v[46:47], v31 offset0:64 offset1:96
  s_waitcnt lgkmcnt(0)
  v_perm_b32 v64, v33, v32, s45
  v_perm_b32 v65, v35, v34, s45
  v_perm_b32 v66, v37, v36, s45
  v_perm_b32 v67, v39, v38, s45
  v_perm_b32 v68, v41, v40, s45
  v_perm_b32 v69, v43, v42, s45
  v_perm_b32 v70, v45, v44, s45
  v_perm_b32 v71, v47, v46, s45
  v_accvgpr_write_b32 a8, v64
  v_accvgpr_write_b32 a9, v65
  v_accvgpr_write_b32 a10, v66
  v_accvgpr_write_b32 a11, v67
  v_accvgpr_write_b32 a12, v68
  v_accvgpr_write_b32 a13, v69
  v_accvgpr_write_b32 a14, v70
  v_accvgpr_write_b32 a15, v71
  v_perm_b32 v72, v33, v32, s46
  v_perm_b32 v73, v35, v34, s46
  v_perm_b32 v74, v37, v36, s46
  v_perm_b32 v75, v39, v38, s46
  v_perm_b32 v76, v41, v40, s46
  v_perm_b32 v77, v43, v42, s46
  v_perm_b32 v78, v45, v44, s46
  v_perm_b32 v79, v47, v46, s46
  v_accvgpr_write_b32 a24, v72
  v_accvgpr_write_b32 a25, v73
  v_accvgpr_write_b32 a26, v74
  v_accvgpr_write_b32 a27, v75
  v_accvgpr_write_b32 a28, v76
  v_accvgpr_write_b32 a29, v77
  v_accvgpr_write_b32 a30, v78
  v_accvgpr_write_b32 a31, v79
  v_add_u32 v23, 0, v29
  v_add_u32 v24, 1024, v29
  v_add_u32 v30, 4096, v29
  v_add_u32 v31, 5120, v29
  ds_read2_b32 v[32:33], v23 offset0:0 offset1:32
  ds_read2_b32 v[34:35], v24 offset0:0 offset1:32
  ds_read2_b32 v[36:37], v23 offset0:64 offset1:96
  ds_read2_b32 v[38:39], v24 offset0:64 offset1:96
  ds_read2_b32 v[40:41], v30 offset0:0 offset1:32
  ds_read2_b32 v[42:43], v31 offset0:0 offset1:32
  ds_read2_b32 v[44:45], v30 offset0:64 offset1:96
  ds_read2_b32 v[46:47], v31 offset0:64 offset1:96
  s_waitcnt lgkmcnt(0)
  v_perm_b32 v64, v33, v32, s45
  v_perm_b32 v65, v35, v34, s45
  v_perm_b32 v66, v37, v36, s45
  v_perm_b32 v67, v39, v38, s45
  v_perm_b32 v68, v41, v40, s45
  v_perm_b32 v69, v43, v42, s45
  v_perm_b32 v70, v45, v44, s45
  v_perm_b32 v71, v47, v46, s45
  v_accvgpr_write_b32 a136, v64
  v_accvgpr_write_b32 a137, v65
  v_accvgpr_write_b32 a138, v66
  v_accvgpr_write_b32 a139, v67
  v_accvgpr_write_b32 a140, v68
  v_accvgpr_write_b32 a141, v69
  v_accvgpr_write_b32 a142, v70
  v_accvgpr_write_b32 a143, v71
  v_perm_b32 v72, v33, v32, s46
  v_perm_b32 v73, v35, v34, s46
  v_perm_b32 v74, v37, v36, s46
  v_perm_b32 v75, v39, v38, s46
  v_perm_b32 v76, v41, v40, s46
  v_perm_b32 v77, v43, v42, s46
  v_perm_b32 v78, v45, v44, s46
  v_perm_b32 v79, v47, v46, s46
  v_accvgpr_write_b32 a152, v72
  v_accvgpr_write_b32 a153, v73
  v_accvgpr_write_b32 a154, v74
  v_accvgpr_write_b32 a155, v75
  v_accvgpr_write_b32 a156, v76
  v_accvgpr_write_b32 a157, v77
  v_accvgpr_write_b32 a158, v78
  v_accvgpr_write_b32 a159, v79
  v_add_u32 v23, 8192, v25
  v_add_u32 v24, 9216, v25
  v_add_u32 v30, 12288, v25
  v_add_u32 v31, 13312, v25
  ds_read2_b32 v[32:33], v23 offset0:0 offset1:32
  ds_read2_b32 v[34:35], v24 offset0:0 offset1:32
  ds_read2_b32 v[36:37], v23 offset0:64 offset1:96
  ds_read2_b32 v[38:39], v24 offset0:64 offset1:96
  ds_read2_b32 v[40:41], v30 offset0:0 offset1:32
  ds_read2_b32 v[42:43], v31 offset0:0 offset1:32
  ds_read2_b32 v[44:45], v30 offset0:64 offset1:96
  ds_read2_b32 v[46:47], v31 offset0:64 offset1:96
  s_waitcnt lgkmcnt(0)
  v_perm_b32 v64, v33, v32, s45
  v_perm_b32 v65, v35, v34, s45
  v_perm_b32 v66, v37, v36, s45
  v_perm_b32 v67, v39, v38, s45
  v_perm_b32 v68, v41, v40, s45
  v_perm_b32 v69, v43, v42, s45
  v_perm_b32 v70, v45, v44, s45
  v_perm_b32 v71, v47, v46, s45
  v_accvgpr_write_b32 a40, v64
  v_accvgpr_write_b32 a41, v65
  v_accvgpr_write_b32 a42, v66
  v_accvgpr_write_b32 a43, v67
  v_accvgpr_write_b32 a44, v68
  v_accvgpr_write_b32 a45, v69
  v_accvgpr_write_b32 a46, v70
  v_accvgpr_write_b32 a47, v71
  v_perm_b32 v72, v33, v32, s46
  v_perm_b32 v73, v35, v34, s46
  v_perm_b32 v74, v37, v36, s46
  v_perm_b32 v75, v39, v38, s46
  v_perm_b32 v76, v41, v40, s46
  v_perm_b32 v77, v43, v42, s46
  v_perm_b32 v78, v45, v44, s46
  v_perm_b32 v79, v47, v46, s46
  v_accvgpr_write_b32 a56, v72
  v_accvgpr_write_b32 a57, v73
  v_accvgpr_write_b32 a58, v74
  v_accvgpr_write_b32 a59, v75
  v_accvgpr_write_b32 a60, v76
  v_accvgpr_write_b32 a61, v77
  v_accvgpr_write_b32 a62, v78
  v_accvgpr_write_b32 a63, v79
  v_add_u32 v23, 8192, v29
  v_add_u32 v24, 9216, v29
  v_add_u32 v30, 12288, v29
  v_add_u32 v31, 13312, v29
  ds_read2_b32 v[32:33], v23 offset0:0 offset1:32
  ds_read2_b32 v[34:35], v24 offset0:0 offset1:32
  ds_read2_b32 v[36:37], v23 offset0:64 offset1:96
  ds_read2_b32 v[38:39], v24 offset0:64 offset1:96
  ds_read2_b32 v[40:41], v30 offset0:0 offset1:32
  ds_read2_b32 v[42:43], v31 offset0:0 offset1:32
  ds_read2_b32 v[44:45], v30 offset0:64 offset1:96
  ds_read2_b32 v[46:47], v31 offset0:64 offset1:96
  s_waitcnt lgkmcnt(0)
  v_perm_b32 v64, v33, v32, s45
  v_perm_b32 v65, v35, v34, s45
  v_perm_b32 v66, v37, v36, s45
  v_perm_b32 v67, v39, v38, s45
  v_perm_b32 v68, v41, v40, s45
  v_perm_b32 v69, v43, v42, s45
  v_perm_b32 v70, v45, v44, s45
  v_perm_b32 v71, v47, v46, s45
  v_accvgpr_write_b32 a168, v64
  v_accvgpr_write_b32 a169, v65
  v_accvgpr_write_b32 a170, v66
  v_accvgpr_write_b32 a171, v67
  v_accvgpr_write_b32 a172, v68
  v_accvgpr_write_b32 a173, v69
  v_accvgpr_write_b32 a174, v70
  v_accvgpr_write_b32 a175, v71
  v_perm_b32 v72, v33, v32, s46
  v_perm_b32 v73, v35, v34, s46
  v_perm_b32 v74, v37, v36, s46
  v_perm_b32 v75, v39, v38, s46
  v_perm_b32 v76, v41, v40, s46
  v_perm_b32 v77, v43, v42, s46
  v_perm_b32 v78, v45, v44, s46
  v_perm_b32 v79, v47, v46, s46
  v_accvgpr_write_b32 a184, v72
  v_accvgpr_write_b32 a185, v73
  v_accvgpr_write_b32 a186, v74
  v_accvgpr_write_b32 a187, v75
  v_accvgpr_write_b32 a188, v76
  v_accvgpr_write_b32 a189, v77
  v_accvgpr_write_b32 a190, v78
  v_accvgpr_write_b32 a191, v79
  s_waitcnt vmcnt(16)
  s_barrier
  v_add_u32 v23, 16384, v25
  v_add_u32 v24, 17408, v25
  v_add_u32 v30, 20480, v25
  v_add_u32 v31, 21504, v25
  ds_read2_b32 v[32:33], v23 offset0:0 offset1:32
  ds_read2_b32 v[34:35], v24 offset0:0 offset1:32
  ds_read2_b32 v[36:37], v23 offset0:64 offset1:96
  ds_read2_b32 v[38:39], v24 offset0:64 offset1:96
  ds_read2_b32 v[40:41], v30 offset0:0 offset1:32
  ds_read2_b32 v[42:43], v31 offset0:0 offset1:32
  ds_read2_b32 v[44:45], v30 offset0:64 offset1:96
  ds_read2_b32 v[46:47], v31 offset0:64 offset1:96
  s_waitcnt lgkmcnt(0)
  v_perm_b32 v64, v33, v32, s45
  v_perm_b32 v65, v35, v34, s45
  v_perm_b32 v66, v37, v36, s45
  v_perm_b32 v67, v39, v38, s45
  v_perm_b32 v68, v41, v40, s45
  v_perm_b32 v69, v43, v42, s45
  v_perm_b32 v70, v45, v44, s45
  v_perm_b32 v71, v47, v46, s45
  v_accvgpr_write_b32 a72, v64
  v_accvgpr_write_b32 a73, v65
  v_accvgpr_write_b32 a74, v66
  v_accvgpr_write_b32 a75, v67
  v_accvgpr_write_b32 a76, v68
  v_accvgpr_write_b32 a77, v69
  v_accvgpr_write_b32 a78, v70
  v_accvgpr_write_b32 a79, v71
  v_perm_b32 v72, v33, v32, s46
  v_perm_b32 v73, v35, v34, s46
  v_perm_b32 v74, v37, v36, s46
  v_perm_b32 v75, v39, v38, s46
  v_perm_b32 v76, v41, v40, s46
  v_perm_b32 v77, v43, v42, s46
  v_perm_b32 v78, v45, v44, s46
  v_perm_b32 v79, v47, v46, s46
  v_accvgpr_write_b32 a88, v72
  v_accvgpr_write_b32 a89, v73
  v_accvgpr_write_b32 a90, v74
  v_accvgpr_write_b32 a91, v75
  v_accvgpr_write_b32 a92, v76
  v_accvgpr_write_b32 a93, v77
  v_accvgpr_write_b32 a94, v78
  v_accvgpr_write_b32 a95, v79
  v_add_u32 v23, 16384, v29
  v_add_u32 v24, 17408, v29
  v_add_u32 v30, 20480, v29
  v_add_u32 v31, 21504, v29
  ds_read2_b32 v[32:33], v23 offset0:0 offset1:32
  ds_read2_b32 v[34:35], v24 offset0:0 offset1:32
  ds_read2_b32 v[36:37], v23 offset0:64 offset1:96
  ds_read2_b32 v[38:39], v24 offset0:64 offset1:96
  ds_read2_b32 v[40:41], v30 offset0:0 offset1:32
  ds_read2_b32 v[42:43], v31 offset0:0 offset1:32
  ds_read2_b32 v[44:45], v30 offset0:64 offset1:96
  ds_read2_b32 v[46:47], v31 offset0:64 offset1:96
  s_waitcnt lgkmcnt(0)
  v_perm_b32 v64, v33, v32, s45
  v_perm_b32 v65, v35, v34, s45
  v_perm_b32 v66, v37, v36, s45
  v_perm_b32 v67, v39, v38, s45
  v_perm_b32 v68, v41, v40, s45
  v_perm_b32 v69, v43, v42, s45
  v_perm_b32 v70, v45, v44, s45
  v_perm_b32 v71, v47, v46, s45
  v_accvgpr_write_b32 a104, v64
  v_accvgpr_write_b32 a105, v65
  v_accvgpr_write_b32 a106, v66
  v_accvgpr_write_b32 a107, v67
  v_accvgpr_write_b32 a108, v68
  v_accvgpr_write_b32 a109, v69
  v_accvgpr_write_b32 a110, v70
  v_accvgpr_write_b32 a111, v71
  v_perm_b32 v72, v33, v32, s46
  v_perm_b32 v73, v35, v34, s46
  v_perm_b32 v74, v37, v36, s46
  v_perm_b32 v75, v39, v38, s46
  v_perm_b32 v76, v41, v40, s46
  v_perm_b32 v77, v43, v42, s46
  v_perm_b32 v78, v45, v44, s46
  v_perm_b32 v79, v47, v46, s46
  v_accvgpr_write_b32 a120, v72
  v_accvgpr_write_b32 a121, v73
  v_accvgpr_write_b32 a122, v74
  v_accvgpr_write_b32 a123, v75
  v_accvgpr_write_b32 a124, v76
  v_accvgpr_write_b32 a125, v77
  v_accvgpr_write_b32 a126, v78
  v_accvgpr_write_b32 a127, v79
  s_waitcnt vmcnt(0)
  s_barrier
  v_add_u32 v23, 24576, v25
  v_add_u32 v24, 25600, v25
  v_add_u32 v30, 28672, v25
  v_add_u32 v31, 29696, v25
  ds_read2_b32 v[32:33], v23 offset0:0 offset1:32
  ds_read2_b32 v[34:35], v24 offset0:0 offset1:32
  ds_read2_b32 v[36:37], v23 offset0:64 offset1:96
  ds_read2_b32 v[38:39], v24 offset0:64 offset1:96
  ds_read2_b32 v[40:41], v30 offset0:0 offset1:32
  ds_read2_b32 v[42:43], v31 offset0:0 offset1:32
  ds_read2_b32 v[44:45], v30 offset0:64 offset1:96
  ds_read2_b32 v[46:47], v31 offset0:64 offset1:96
  s_waitcnt lgkmcnt(0)
  v_perm_b32 v64, v33, v32, s45
  v_perm_b32 v65, v35, v34, s45
  v_perm_b32 v66, v37, v36, s45
  v_perm_b32 v67, v39, v38, s45
  v_perm_b32 v68, v41, v40, s45
  v_perm_b32 v69, v43, v42, s45
  v_perm_b32 v70, v45, v44, s45
  v_perm_b32 v71, v47, v46, s45
  v_accvgpr_write_b32 a200, v64
  v_accvgpr_write_b32 a201, v65
  v_accvgpr_write_b32 a202, v66
  v_accvgpr_write_b32 a203, v67
  v_accvgpr_write_b32 a204, v68
  v_accvgpr_write_b32 a205, v69
  v_accvgpr_write_b32 a206, v70
  v_accvgpr_write_b32 a207, v71
  v_perm_b32 v72, v33, v32, s46
  v_perm_b32 v73, v35, v34, s46
  v_perm_b32 v74, v37, v36, s46
  v_perm_b32 v75, v39, v38, s46
  v_perm_b32 v76, v41, v40, s46
  v_perm_b32 v77, v43, v42, s46
  v_perm_b32 v78, v45, v44, s46
  v_perm_b32 v79, v47, v46, s46
  v_accvgpr_write_b32 a216, v72
  v_accvgpr_write_b32 a217, v73
  v_accvgpr_write_b32 a218, v74
  v_accvgpr_write_b32 a219, v75
  v_accvgpr_write_b32 a220, v76
  v_accvgpr_write_b32 a221, v77
  v_accvgpr_write_b32 a222, v78
  v_accvgpr_write_b32 a223, v79
  v_add_u32 v23, 24576, v29
  v_add_u32 v24, 25600, v29
  v_add_u32 v30, 28672, v29
  v_add_u32 v31, 29696, v29
  ds_read2_b32 v[32:33], v23 offset0:0 offset1:32
  ds_read2_b32 v[34:35], v24 offset0:0 offset1:32
  ds_read2_b32 v[36:37], v23 offset0:64 offset1:96
  ds_read2_b32 v[38:39], v24 offset0:64 offset1:96
  ds_read2_b32 v[40:41], v30 offset0:0 offset1:32
  ds_read2_b32 v[42:43], v31 offset0:0 offset1:32
  ds_read2_b32 v[44:45], v30 offset0:64 offset1:96
  ds_read2_b32 v[46:47], v31 offset0:64 offset1:96
  s_waitcnt lgkmcnt(0)
  v_perm_b32 v200, v33, v32, s45
  v_perm_b32 v201, v35, v34, s45
  v_perm_b32 v202, v37, v36, s45
  v_perm_b32 v203, v39, v38, s45
  v_perm_b32 v204, v41, v40, s45
  v_perm_b32 v205, v43, v42, s45
  v_perm_b32 v206, v45, v44, s45
  v_perm_b32 v207, v47, v46, s45
  v_perm_b32 v216, v33, v32, s46
  v_perm_b32 v217, v35, v34, s46
  v_perm_b32 v218, v37, v36, s46
  v_perm_b32 v219, v39, v38, s46
  v_perm_b32 v220, v41, v40, s46
  v_perm_b32 v221, v43, v42, s46
  v_perm_b32 v222, v45, v44, s46
  v_perm_b32 v223, v47, v46, s46
  v_add_u32 v23, 32768, v25
  v_add_u32 v24, 33792, v25
  v_add_u32 v30, 36864, v25
  v_add_u32 v31, 37888, v25
  ds_read2_b32 v[32:33], v23 offset0:0 offset1:32
  ds_read2_b32 v[34:35], v24 offset0:0 offset1:32
  ds_read2_b32 v[36:37], v23 offset0:64 offset1:96
  ds_read2_b32 v[38:39], v24 offset0:64 offset1:96
  ds_read2_b32 v[40:41], v30 offset0:0 offset1:32
  ds_read2_b32 v[42:43], v31 offset0:0 offset1:32
  ds_read2_b32 v[44:45], v30 offset0:64 offset1:96
  ds_read2_b32 v[46:47], v31 offset0:64 offset1:96
  s_waitcnt lgkmcnt(0)
  v_perm_b32 v64, v33, v32, s45
  v_perm_b32 v65, v35, v34, s45
  v_perm_b32 v66, v37, v36, s45
  v_perm_b32 v67, v39, v38, s45
  v_perm_b32 v68, v41, v40, s45
  v_perm_b32 v69, v43, v42, s45
  v_perm_b32 v70, v45, v44, s45
  v_perm_b32 v71, v47, v46, s45
  v_accvgpr_write_b32 a232, v64
  v_accvgpr_write_b32 a233, v65
  v_accvgpr_write_b32 a234, v66
  v_accvgpr_write_b32 a235, v67
  v_accvgpr_write_b32 a236, v68
  v_accvgpr_write_b32 a237, v69
  v_accvgpr_write_b32 a238, v70
  v_accvgpr_write_b32 a239, v71
  v_perm_b32 v72, v33, v32, s46
  v_perm_b32 v73, v35, v34, s46
  v_perm_b32 v74, v37, v36, s46
  v_perm_b32 v75, v39, v38, s46
  v_perm_b32 v76, v41, v40, s46
  v_perm_b32 v77, v43, v42, s46
  v_perm_b32 v78, v45, v44, s46
  v_perm_b32 v79, v47, v46, s46
  v_accvgpr_write_b32 a248, v72
  v_accvgpr_write_b32 a249, v73
  v_accvgpr_write_b32 a250, v74
  v_accvgpr_write_b32 a251, v75
  v_accvgpr_write_b32 a252, v76
  v_accvgpr_write_b32 a253, v77
  v_accvgpr_write_b32 a254, v78
  v_accvgpr_write_b32 a255, v79
  v_add_u32 v23, 32768, v29
  v_add_u32 v24, 33792, v29
  v_add_u32 v30, 36864, v29
  v_add_u32 v31, 37888, v29
  ds_read2_b32 v[32:33], v23 offset0:0 offset1:32
  ds_read2_b32 v[34:35], v24 offset0:0 offset1:32
  ds_read2_b32 v[36:37], v23 offset0:64 offset1:96
  ds_read2_b32 v[38:39], v24 offset0:64 offset1:96
  ds_read2_b32 v[40:41], v30 offset0:0 offset1:32
  ds_read2_b32 v[42:43], v31 offset0:0 offset1:32
  ds_read2_b32 v[44:45], v30 offset0:64 offset1:96
  ds_read2_b32 v[46:47], v31 offset0:64 offset1:96
  s_waitcnt lgkmcnt(0)
  v_perm_b32 v232, v33, v32, s45
  v_perm_b32 v233, v35, v34, s45
  v_perm_b32 v234, v37, v36, s45
  v_perm_b32 v235, v39, v38, s45
  v_perm_b32 v236, v41, v40, s45
  v_perm_b32 v237, v43, v42, s45
  v_perm_b32 v238, v45, v44, s45
  v_perm_b32 v239, v47, v46, s45
  v_perm_b32 v248, v33, v32, s46
  v_perm_b32 v249, v35, v34, s46
  v_perm_b32 v250, v37, v36, s46
  v_perm_b32 v251, v39, v38, s46
  v_perm_b32 v252, v41, v40, s46
  v_perm_b32 v253, v43, v42, s46
  v_perm_b32 v254, v45, v44, s46
  v_perm_b32 v255, v47, v46, s46
  s_waitcnt vmcnt(0)
  s_barrier
  s_mul_i32 s17, s13, 36864
  s_add_u32 s17, s17, 16384
  v_and_b32 v26, 1, v12
  v_lshlrev_b32 v26, 2, v26
  v_sub_u32 v26, v13, v26
  v_mov_b32 v23, 0x3f80
  v_mov_b32 v24, 0x3f800000
  v_mov_b32 v32, 0
  v_cmp_eq_u32 vcc, 0, v26
  s_nop 1
  v_cndmask_b32 v32, v32, v23, vcc
  v_cmp_eq_u32 vcc, 1, v26
  s_nop 1
  v_cndmask_b32 v32, v32, v24, vcc
  v_mov_b32 v33, 0
  v_cmp_eq_u32 vcc, 2, v26
  s_nop 1
  v_cndmask_b32 v33, v33, v23, vcc
  v_cmp_eq_u32 vcc, 3, v26
  s_nop 1
  v_cndmask_b32 v33, v33, v24, vcc
  v_mov_b32 v34, 0
  v_cmp_eq_u32 vcc, 8, v26
  s_nop 1
  v_cndmask_b32 v34, v34, v23, vcc
  v_cmp_eq_u32 vcc, 9, v26
  s_nop 1
  v_cndmask_b32 v34, v34, v24, vcc
  v_mov_b32 v35, 0
  v_cmp_eq_u32 vcc, 10, v26
  s_nop 1
  v_cndmask_b32 v35, v35, v23, vcc
  v_cmp_eq_u32 vcc, 11, v26
  s_nop 1
  v_cndmask_b32 v35, v35, v24, vcc
  v_and_b32 v27, 0x1f0, v1
  ds_write_b128 v27, v[32:35] offset:15360
  v_mov_b32 v26, v13
  v_mov_b32 v36, 0
  v_cmp_eq_u32 vcc, 0, v26
  s_nop 1
  v_cndmask_b32 v36, v36, v23, vcc
  v_cmp_eq_u32 vcc, 1, v26
  s_nop 1
  v_cndmask_b32 v36, v36, v24, vcc
  v_mov_b32 v37, 0
  v_cmp_eq_u32 vcc, 2, v26
  s_nop 1
  v_cndmask_b32 v37, v37, v23, vcc
  v_cmp_eq_u32 vcc, 3, v26
  s_nop 1
  v_cndmask_b32 v37, v37, v24, vcc
  v_mov_b32 v38, 0
  v_cmp_eq_u32 vcc, 4, v26
  s_nop 1
  v_cndmask_b32 v38, v38, v23, vcc
  v_cmp_eq_u32 vcc, 5, v26
  s_nop 1
  v_cndmask_b32 v38, v38, v24, vcc
  v_mov_b32 v39, 0
  v_cmp_eq_u32 vcc, 6, v26
  s_nop 1
  v_cndmask_b32 v39, v39, v23, vcc
  v_cmp_eq_u32 vcc, 7, v26
  s_nop 1
  v_cndmask_b32 v39, v39, v24, vcc
  v_and_b32 v27, 0xf0, v1
  ds_write_b128 v27, v[36:39] offset:15872
  v_and_b32 v26, 8, v13
  v_bfe_u32 v27, v13, 1, 2
  v_add_u32 v26, v26, v27
  v_and_b32 v27, 1, v13
  v_lshl_add_u32 v26, v27, 2, v26
  v_mov_b32 v36, 0
  v_cmp_eq_u32 vcc, 0, v26
  s_nop 1
  v_cndmask_b32 v36, v36, v23, vcc
  v_cmp_eq_u32 vcc, 1, v26
  s_nop 1
  v_cndmask_b32 v36, v36, v24, vcc
  v_mov_b32 v37, 0
  v_cmp_eq_u32 vcc, 2, v26
  s_nop 1
  v_cndmask_b32 v37, v37, v23, vcc
  v_cmp_eq_u32 vcc, 3, v26
  s_nop 1
  v_cndmask_b32 v37, v37, v24, vcc
  v_mov_b32 v38, 0
  v_cmp_eq_u32 vcc, 4, v26
  s_nop 1
  v_cndmask_b32 v38, v38, v23, vcc
  v_cmp_eq_u32 vcc, 5, v26
  s_nop 1
  v_cndmask_b32 v38, v38, v24, vcc
  v_mov_b32 v39, 0
  v_cmp_eq_u32 vcc, 6, v26
  s_nop 1
  v_cndmask_b32 v39, v39, v23, vcc
  v_cmp_eq_u32 vcc, 7, v26
  s_nop 1
  v_cndmask_b32 v39, v39, v24, vcc
  v_and_b32 v27, 0xf0, v1
  ds_write_b128 v27, v[36:39] offset:16128
  s_waitcnt vmcnt(0)
  s_waitcnt lgkmcnt(0)
  s_barrier
  v_lshrrev_b32 v41, 4, v1
  v_lshrrev_b32 v40, 5, v41
  v_and_b32 v42, 31, v41
  v_lshlrev_b32 v3, 10, v40
  v_lshl_add_u32 v3, v42, 4, v3
  v_and_b32 v43, 7, v41
  v_lshlrev_b32 v4, 8, v40
  v_lshl_add_u32 v4, v43, 4, v4
  v_lshrrev_b32 v43, 1, v42
  v_lshlrev_b32 v5, 8, v40
  v_lshl_add_u32 v5, v43, 4, v5
  v_and_b32 v44, 1, v41
  v_lshl_add_u32 v5, v44, 3, v5
  s_lshl_b32 s15, s13, 10
  v_add_u32 v5, s15, v5
  v_add_u32 v46, s15, v1
  v_lshlrev_b32 v7, 9, v40
  v_lshl_add_u32 v7, v43, 4, v7
  v_lshl_add_u32 v7, v44, 8, v7
  s_lshl_b32 s15, s13, 11
  v_add_u32 v7, s15, v7
  v_and_b32 v6, 3, v41
  v_bfe_u32 v43, v41, 3, 2
  v_lshl_add_u32 v6, v43, 2, v6
  v_bfe_u32 v43, v41, 2, 1
  v_lshl_add_u32 v6, v43, 4, v6
  v_lshlrev_b32 v43, 4, v40
  v_sub_u32 v6, v6, v43
  v_and_b32 v43, 0x1f0, v1
  ds_read_b64 v[44:45], v43 offset:15360
  v_mbcnt_lo_u32_b32 v40, -1, 0
  v_mbcnt_hi_u32_b32 v40, -1, v40
  v_lshlrev_b32 v40, 2, v40
Liw_6:
  buffer_load_dword v41, v40, s[76:79], 0 offen offset:160 sc1
  s_waitcnt vmcnt(0)
  v_readlane_b32 s15, v41, 0
  v_readlane_b32 s16, v41, 1
  s_nop 0
  s_add_u32 s15, s15, s16
  v_readlane_b32 s16, v41, 2
  s_nop 0
  s_add_u32 s15, s15, s16
  v_readlane_b32 s16, v41, 3
  s_nop 0
  s_add_u32 s15, s15, s16
  v_readlane_b32 s16, v41, 4
  s_nop 0
  s_add_u32 s15, s15, s16
  v_readlane_b32 s16, v41, 5
  s_nop 0
  s_add_u32 s15, s15, s16
  v_readlane_b32 s16, v41, 6
  s_nop 0
  s_add_u32 s15, s15, s16
  v_readlane_b32 s16, v41, 7
  s_nop 0
  s_add_u32 s15, s15, s16
  s_add_u32 s0, s0, 1
  s_cmp_ge_u32 s15, 160
  s_cbranch_scc1 Liw_6_ok
  s_sleep 4
  s_cmp_lt_u32 s0, 1572864
  s_cbranch_scc1 Liw_6
Liw_6_ok:
  s_barrier
  s_lshl_b32 s19, s12, 13
  s_lshl_b32 s20, s12, 13
  s_lshl_b32 s15, s13, 11
  s_add_u32 s20, s20, s15
  s_add_u32 s20, s20, 78643200
  s_lshr_b32 s21, s12, 3
  s_lshl_b32 s21, s21, 7
  s_add_u32 s21, s21, 3735552
  s_lshl_b32 s22, s12, 7
  s_add_u32 s22, s22, 3670016
  s_add_u32 s17, s15, 70254592
  s_add_u32 s18, s39, 70254592
  s_mov_b32 s14, s3
  s_mul_i32 s15, s3, 262144
  s_add_u32 s19, s19, s15
  s_add_u32 s20, s20, s15
  s_lshl_b32 s15, s3, 9
  s_add_u32 s21, s21, s15
  s_mul_i32 s15, s3, 10240
  s_add_u32 s17, s17, s15
  s_add_u32 s18, s18, s15
  s_mov_b32 s49, 0
  s_add_u32 s15, s14, 0
  s_lshr_b32 s15, s15, 2
  s_min_u32 s15, s15, 15
  s_cmp_lt_u32 s15, s49
  s_cbranch_scc1 Lakv_7_ok
Lakv_7_sp:
  v_lshrrev_b32 v11, 2, v1
  buffer_load_dword v11, v11, s[4:7], s22 offen sc1
  s_waitcnt vmcnt(0)
  v_cmp_le_u32 vcc, 4, v11
  s_add_u32 s0, s0, 1
  s_and_b32 s49, vcc_lo, 0xffff
  s_ff0_i32_b32 s49, s49
  s_cmp_lt_u32 s15, s49
  s_cbranch_scc1 Lakv_7_ok
  s_cmp_lt_u32 s0, 1572864
  s_cbranch_scc1 Lakv_7_sp
Lakv_7_ok:
  s_mov_b32 s92, 0
  s_add_u32 s23, s19, 19922944
  s_add_u32 s24, s19, 53477376
  buffer_load_dwordx4 v[80:83], v3, s[4:7], s23 offen offset:0 sc1
  buffer_load_dwordx4 v[48:51], v1, s[4:7], s24 offen offset:0 sc1
  buffer_load_dwordx4 v[84:87], v3, s[4:7], s23 offen offset:512 sc1
  buffer_load_dwordx4 v[52:55], v1, s[4:7], s24 offen offset:1024 sc1
  buffer_load_dwordx4 v[88:91], v3, s[4:7], s23 offen offset:2048 sc1
  buffer_load_dwordx4 v[56:59], v1, s[4:7], s24 offen offset:2048 sc1
  buffer_load_dwordx4 v[92:95], v3, s[4:7], s23 offen offset:2560 sc1
  buffer_load_dwordx4 v[60:63], v1, s[4:7], s24 offen offset:3072 sc1
  s_add_u32 s23, s19, 19927040
  s_add_u32 s24, s19, 53481472
  buffer_load_dwordx4 v[96:99], v3, s[4:7], s23 offen offset:0 sc1
  buffer_load_dwordx4 v[64:67], v1, s[4:7], s24 offen offset:0 sc1
  buffer_load_dwordx4 v[100:103], v3, s[4:7], s23 offen offset:512 sc1
  buffer_load_dwordx4 v[68:71], v1, s[4:7], s24 offen offset:1024 sc1
  buffer_load_dwordx4 v[104:107], v3, s[4:7], s23 offen offset:2048 sc1
  buffer_load_dwordx4 v[72:75], v1, s[4:7], s24 offen offset:2048 sc1
  buffer_load_dwordx4 v[108:111], v3, s[4:7], s23 offen offset:2560 sc1
  buffer_load_dwordx4 v[76:79], v1, s[4:7], s24 offen offset:3072 sc1
  s_add_u32 s23, s19, 36700160
  buffer_load_dwordx4 v[112:115], v7, s[4:7], s23 offen offset:0 sc1
  buffer_load_dwordx4 v[116:119], v7, s[4:7], s23 offen offset:1024 sc1
  s_mov_b32 s27, 2147479552
  buffer_store_dword v10, off, s[4:7], s27
  buffer_store_dword v10, off, s[4:7], s27
Latt_8:
  v_mov_b64 v[24:25], 0
  v_mov_b64 v[26:27], 0
  v_mov_b64 v[28:29], 0
  v_mov_b64 v[30:31], 0
  v_mov_b64 v[32:33], 0
  v_mov_b64 v[34:35], 0
  v_mov_b64 v[36:37], 0
  v_mov_b64 v[38:39], 0
  v_add_u32 v9, s39, v1
  s_waitcnt vmcnt(18)
  v_mfma_f32_32x32x16_bf16 v[120:135], v[80:83], v[48:51], 0
  s_waitcnt vmcnt(16)
  v_mfma_f32_32x32x16_bf16 v[120:135], v[84:87], v[52:55], v[120:135]
  s_waitcnt vmcnt(14)
  v_mfma_f32_32x32x16_bf16 v[120:135], v[88:91], v[56:59], v[120:135]
  s_waitcnt vmcnt(12)
  v_mfma_f32_32x32x16_bf16 v[120:135], v[92:95], v[60:63], v[120:135]
  s_waitcnt vmcnt(10)
  v_mfma_f32_32x32x16_bf16 v[120:135], v[96:99], v[64:67], v[120:135]
  s_waitcnt vmcnt(8)
  v_mfma_f32_32x32x16_bf16 v[120:135], v[100:103], v[68:71], v[120:135]
  s_waitcnt vmcnt(6)
  v_mfma_f32_32x32x16_bf16 v[120:135], v[104:107], v[72:75], v[120:135]
  s_waitcnt vmcnt(4)
  v_mfma_f32_32x32x16_bf16 v[120:135], v[108:111], v[76:79], v[120:135]
  v_mov_b32 v170, 0xff800000
  v_cmp_gt_i32 vcc, 0, v6
  v_cmp_gt_i32 s[50:51], 1, v6
  s_nop 8
  v_cndmask_b32 v120, v120, v170, vcc
  v_cndmask_b32 v121, v121, v170, s[50:51]
  v_cmp_gt_i32 vcc, 2, v6
  v_cmp_gt_i32 s[50:51], 3, v6
  s_nop 0
  v_cndmask_b32 v122, v122, v170, vcc
  v_cndmask_b32 v123, v123, v170, s[50:51]
  v_cmp_gt_i32 vcc, 4, v6
  v_cmp_gt_i32 s[50:51], 5, v6
  s_nop 0
  v_cndmask_b32 v124, v124, v170, vcc
  v_cndmask_b32 v125, v125, v170, s[50:51]
  v_cmp_gt_i32 vcc, 6, v6
  v_cmp_gt_i32 s[50:51], 7, v6
  s_nop 0
  v_cndmask_b32 v126, v126, v170, vcc
  v_cndmask_b32 v127, v127, v170, s[50:51]
  v_cmp_gt_i32 vcc, 8, v6
  v_cmp_gt_i32 s[50:51], 9, v6
  s_nop 0
  v_cndmask_b32 v128, v128, v170, vcc
  v_cndmask_b32 v129, v129, v170, s[50:51]
  v_cmp_gt_i32 vcc, 10, v6
  v_cmp_gt_i32 s[50:51], 11, v6
  s_nop 0
  v_cndmask_b32 v130, v130, v170, vcc
  v_cndmask_b32 v131, v131, v170, s[50:51]
  v_cmp_gt_i32 vcc, 12, v6
  v_cmp_gt_i32 s[50:51], 13, v6
  s_nop 0
  v_cndmask_b32 v132, v132, v170, vcc
  v_cndmask_b32 v133, v133, v170, s[50:51]
  v_cmp_gt_i32 vcc, 14, v6
  v_cmp_gt_i32 s[50:51], 15, v6
  s_nop 0
  v_cndmask_b32 v134, v134, v170, vcc
  v_cndmask_b32 v135, v135, v170, s[50:51]
  v_max3_f32 v168, v120, v121, v122
  v_max3_f32 v168, v168, v123, v124
  v_max3_f32 v168, v168, v125, v126
  v_max3_f32 v168, v168, v127, v128
  v_max3_f32 v168, v168, v129, v130
  v_max3_f32 v168, v168, v131, v132
  v_max3_f32 v168, v168, v133, v134
  v_max_f32 v168, v168, v135
  s_waitcnt vmcnt(0)
  s_mov_b64 exec, 1
  v_mov_b32 v10, 1
  buffer_atomic_add v10, off, s[4:7], s27
  s_mov_b64 exec, -1
  s_cmp_ge_u32 s14, 64
  s_cbranch_scc1 Latt_8_done
Lapoll_9:
  buffer_load_dwordx4 v[12:15], v1, s[4:7], s17 offen sc1
  buffer_load_dwordx4 v[16:19], v1, s[4:7], s17 offen offset:1024 sc1
  buffer_load_dwordx4 v[20:23], v1, s[4:7], s18 offen sc1
  s_add_u32 s0, s0, 1
  s_waitcnt vmcnt(0)
  v_max3_u32 v10, v12, v13, v14
  v_max3_u32 v10, v10, v15, v16
  v_max3_u32 v10, v10, v17, v18
  v_max3_u32 v10, v10, v19, v20
  v_max3_u32 v10, v10, v21, v22
  v_max_u32 v10, v10, v23
  v_cmp_eq_u32 vcc, -1, v10
  s_cbranch_vccz Lago_10
  s_sleep 2
  s_cmp_lt_u32 s0, 1572864
  s_cbranch_scc1 Lapoll_9
Lago_10:
  ds_write_b128 v2, v[12:15]
  ds_write_b128 v2, v[16:19] offset:1024
  ds_write_b128 v9, v[20:23]
  v_smfmac_f32_16x16x64_bf16 v[24:27], v[12:15], a[0:7], v0
  v_smfmac_f32_16x16x64_bf16 v[32:35], v[12:15], a[16:23], v0
  v_smfmac_f32_16x16x64_bf16 v[28:31], v[12:15], a[8:15], v0
  v_xor_b32 v9, 0x400, v9
  v_smfmac_f32_16x16x64_bf16 v[36:39], v[12:15], a[24:31], v0
  v_smfmac_f32_16x16x64_bf16 v[24:27], v[16:19], a[32:39], v0
  v_smfmac_f32_16x16x64_bf16 v[32:35], v[16:19], a[48:55], v0
  s_waitcnt lgkmcnt(0)
  s_barrier
  ds_read_b128 v[12:15], v9
  v_smfmac_f32_16x16x64_bf16 v[28:31], v[16:19], a[40:47], v0
  v_xor_b32 v9, 2048, v2
  v_smfmac_f32_16x16x64_bf16 v[36:39], v[16:19], a[56:63], v0
  ds_read_b128 v[16:19], v9 offset:0
  v_smfmac_f32_16x16x64_bf16 v[24:27], v[20:23], a[64:71], v0
  v_smfmac_f32_16x16x64_bf16 v[32:35], v[20:23], a[80:87], v0
  v_smfmac_f32_16x16x64_bf16 v[28:31], v[20:23], a[72:79], v0
  v_smfmac_f32_16x16x64_bf16 v[36:39], v[20:23], a[88:95], v0
  ds_read_b128 v[20:23], v9 offset:1024
  s_waitcnt lgkmcnt(2)
  v_smfmac_f32_16x16x64_bf16 v[24:27], v[12:15], a[96:103], v0
  v_smfmac_f32_16x16x64_bf16 v[32:35], v[12:15], a[112:119], v0
  v_smfmac_f32_16x16x64_bf16 v[28:31], v[12:15], a[104:111], v0
  v_xor_b32 v9, 4096, v2
  v_smfmac_f32_16x16x64_bf16 v[36:39], v[12:15], a[120:127], v0
  ds_read_b128 v[12:15], v9 offset:0
  s_waitcnt lgkmcnt(2)
  v_smfmac_f32_16x16x64_bf16 v[24:27], v[16:19], a[128:135], v0
  v_smfmac_f32_16x16x64_bf16 v[32:35], v[16:19], a[144:151], v0
  v_smfmac_f32_16x16x64_bf16 v[28:31], v[16:19], a[136:143], v0
  v_smfmac_f32_16x16x64_bf16 v[36:39], v[16:19], a[152:159], v0
  ds_read_b128 v[16:19], v9 offset:1024
  s_waitcnt lgkmcnt(2)
  v_smfmac_f32_16x16x64_bf16 v[24:27], v[20:23], a[160:167], v0
  v_smfmac_f32_16x16x64_bf16 v[32:35], v[20:23], a[176:183], v0
  v_smfmac_f32_16x16x64_bf16 v[28:31], v[20:23], a[168:175], v0
  v_xor_b32 v9, 6144, v2
  v_smfmac_f32_16x16x64_bf16 v[36:39], v[20:23], a[184:191], v0
  ds_read_b128 v[20:23], v9 offset:0
  s_waitcnt lgkmcnt(2)
  v_smfmac_f32_16x16x64_bf16 v[24:27], v[12:15], a[192:199], v0
  v_smfmac_f32_16x16x64_bf16 v[32:35], v[12:15], a[208:215], v0
  v_smfmac_f32_16x16x64_bf16 v[28:31], v[12:15], a[200:207], v0
  v_smfmac_f32_16x16x64_bf16 v[36:39], v[12:15], a[216:223], v0
  ds_read_b128 v[12:15], v9 offset:1024
  s_waitcnt lgkmcnt(2)
  v_smfmac_f32_16x16x64_bf16 v[24:27], v[16:19], a[224:231], v0
  v_smfmac_f32_16x16x64_bf16 v[32:35], v[16:19], a[240:247], v0
  v_smfmac_f32_16x16x64_bf16 v[28:31], v[16:19], a[232:239], v0
  v_smfmac_f32_16x16x64_bf16 v[36:39], v[16:19], a[248:255], v0
  s_waitcnt lgkmcnt(1)
  v_smfmac_f32_16x16x64_bf16 v[24:27], v[20:23], v[192:199], v0
  v_smfmac_f32_16x16x64_bf16 v[32:35], v[20:23], v[208:215], v0
  v_smfmac_f32_16x16x64_bf16 v[28:31], v[20:23], v[200:207], v0
  v_smfmac_f32_16x16x64_bf16 v[36:39], v[20:23], v[216:223], v0
  s_waitcnt lgkmcnt(0)
  v_smfmac_f32_16x16x64_bf16 v[24:27], v[12:15], v[224:231], v0
  v_smfmac_f32_16x16x64_bf16 v[32:35], v[12:15], v[240:247], v0
  v_smfmac_f32_16x16x64_bf16 v[28:31], v[12:15], v[232:239], v0
  v_smfmac_f32_16x16x64_bf16 v[36:39], v[12:15], v[248:255], v0
  v_cvt_pk_bf16_f32 v24, v24, v25
  v_cvt_pk_bf16_f32 v25, v26, v27
  v_cvt_pk_bf16_f32 v32, v32, v33
  v_cvt_pk_bf16_f32 v33, v34, v35
  v_mfma_f32_16x16x16_bf16 v[12:15], v[24:25], v[44:45], 0
  s_nop 0
  v_mfma_f32_16x16x16_bf16 v[16:19], v[32:33], v[44:45], 0
  v_cvt_pk_bf16_f32 v28, v28, v29
  v_cvt_pk_bf16_f32 v29, v30, v31
  v_cvt_pk_bf16_f32 v30, v36, v37
  v_cvt_pk_bf16_f32 v31, v38, v39
  ds_write_b128 v46, v[28:31] offset:20480
  s_nop 2
  v_cvt_pk_bf16_f32 v24, v12, v16
  v_cvt_pk_bf16_f32 v25, v13, v17
  v_cvt_pk_bf16_f32 v26, v14, v18
  v_cvt_pk_bf16_f32 v27, v15, v19
  ds_write_b128 v46, v[24:27] offset:16384
  s_mov_b32 s27, s21
  s_add_u32 s19, s19, 524288
  s_add_u32 s21, s21, 1024
  s_add_u32 s17, s17, 20480
  s_add_u32 s18, s18, 20480
  s_add_u32 s14, s14, 2
  s_waitcnt lgkmcnt(0)
  s_barrier
  ds_read_b128 v[80:83], v4 offset:16384
  ds_read_b128 v[84:87], v4 offset:16896
  ds_read_b128 v[88:91], v4 offset:17408
  ds_read_b128 v[92:95], v4 offset:17920
  ds_read_b128 v[96:99], v4 offset:18432
  ds_read_b128 v[100:103], v4 offset:18944
  ds_read_b128 v[104:107], v4 offset:19456
  ds_read_b128 v[108:111], v4 offset:19968
  ds_read_b64 v[184:185], v5 offset:20480
  ds_read_b64 v[186:187], v5 offset:20992
  s_add_u32 s15, s14, 0
  s_lshr_b32 s15, s15, 2
  s_min_u32 s15, s15, 15
  s_cmp_lt_u32 s15, s49
  s_cbranch_scc1 Lakv_11_ok
Lakv_11_sp:
  v_lshrrev_b32 v11, 2, v1
  buffer_load_dword v11, v11, s[4:7], s22 offen sc1
  s_waitcnt vmcnt(0)
  v_cmp_le_u32 vcc, 4, v11
  s_add_u32 s0, s0, 1
  s_and_b32 s49, vcc_lo, 0xffff
  s_ff0_i32_b32 s49, s49
  s_cmp_lt_u32 s15, s49
  s_cbranch_scc1 Lakv_11_ok
  s_cmp_lt_u32 s0, 1572864
  s_cbranch_scc1 Lakv_11_sp
Lakv_11_ok:
  s_waitcnt lgkmcnt(9)
  v_mfma_f32_32x32x16_bf16 v[136:151], v[80:83], v[48:51], 0
  s_waitcnt lgkmcnt(8)
  v_mfma_f32_32x32x16_bf16 v[136:151], v[84:87], v[52:55], v[136:151]
  s_waitcnt lgkmcnt(7)
  v_mfma_f32_32x32x16_bf16 v[136:151], v[88:91], v[56:59], v[136:151]
  s_waitcnt lgkmcnt(6)
  v_mfma_f32_32x32x16_bf16 v[136:151], v[92:95], v[60:63], v[136:151]
  s_waitcnt lgkmcnt(5)
  v_mfma_f32_32x32x16_bf16 v[136:151], v[96:99], v[64:67], v[136:151]
  s_waitcnt lgkmcnt(4)
  v_mfma_f32_32x32x16_bf16 v[136:151], v[100:103], v[68:71], v[136:151]
  s_waitcnt lgkmcnt(3)
  v_mfma_f32_32x32x16_bf16 v[136:151], v[104:107], v[72:75], v[136:151]
  s_waitcnt lgkmcnt(2)
  v_mfma_f32_32x32x16_bf16 v[136:151], v[108:111], v[76:79], v[136:151]
  s_add_u32 s23, s19, 19922944
  s_add_u32 s24, s19, 53477376
  buffer_load_dwordx4 v[80:83], v3, s[4:7], s23 offen offset:0 sc1
  buffer_load_dwordx4 v[48:51], v1, s[4:7], s24 offen offset:0 sc1
  buffer_load_dwordx4 v[84:87], v3, s[4:7], s23 offen offset:512 sc1
  buffer_load_dwordx4 v[52:55], v1, s[4:7], s24 offen offset:1024 sc1
  buffer_load_dwordx4 v[88:91], v3, s[4:7], s23 offen offset:2048 sc1
  buffer_load_dwordx4 v[56:59], v1, s[4:7], s24 offen offset:2048 sc1
  buffer_load_dwordx4 v[92:95], v3, s[4:7], s23 offen offset:2560 sc1
  buffer_load_dwordx4 v[60:63], v1, s[4:7], s24 offen offset:3072 sc1
  s_add_u32 s23, s19, 19927040
  s_add_u32 s24, s19, 53481472
  buffer_load_dwordx4 v[96:99], v3, s[4:7], s23 offen offset:0 sc1
  buffer_load_dwordx4 v[64:67], v1, s[4:7], s24 offen offset:0 sc1
  buffer_load_dwordx4 v[100:103], v3, s[4:7], s23 offen offset:512 sc1
  buffer_load_dwordx4 v[68:71], v1, s[4:7], s24 offen offset:1024 sc1
  buffer_load_dwordx4 v[104:107], v3, s[4:7], s23 offen offset:2048 sc1
  buffer_load_dwordx4 v[72:75], v1, s[4:7], s24 offen offset:2048 sc1
  buffer_load_dwordx4 v[108:111], v3, s[4:7], s23 offen offset:2560 sc1
  buffer_load_dwordx4 v[76:79], v1, s[4:7], s24 offen offset:3072 sc1
  v_max3_f32 v168, v168, v136, v137
  v_max3_f32 v168, v168, v138, v139
  v_mov_b32 v169, v168
  s_nop 1
  v_permlane32_swap_b32 v168, v169
  v_max_f32 v168, v168, v169
  v_mul_f32 v168, s40, v168
  v_fma_f32 v120, v120, s40, -v168
  v_fma_f32 v121, v121, s40, -v168
  v_fma_f32 v122, v122, s40, -v168
  v_fma_f32 v123, v123, s40, -v168
  v_fma_f32 v124, v124, s40, -v168
  v_fma_f32 v125, v125, s40, -v168
  v_fma_f32 v126, v126, s40, -v168
  v_fma_f32 v127, v127, s40, -v168
  v_fma_f32 v128, v128, s40, -v168
  v_fma_f32 v129, v129, s40, -v168
  v_fma_f32 v130, v130, s40, -v168
  v_fma_f32 v131, v131, s40, -v168
  v_fma_f32 v132, v132, s40, -v168
  v_fma_f32 v133, v133, s40, -v168
  v_fma_f32 v134, v134, s40, -v168
  v_fma_f32 v135, v135, s40, -v168
  v_fma_f32 v136, v136, s40, -v168
  v_fma_f32 v137, v137, s40, -v168
  v_fma_f32 v138, v138, s40, -v168
  v_fma_f32 v139, v139, s40, -v168
  v_exp_f32 v120, v120
  v_exp_f32 v121, v121
  v_exp_f32 v122, v122
  v_exp_f32 v123, v123
  v_exp_f32 v124, v124
  v_exp_f32 v125, v125
  v_exp_f32 v126, v126
  v_exp_f32 v127, v127
  v_exp_f32 v128, v128
  v_exp_f32 v129, v129
  v_exp_f32 v130, v130
  v_exp_f32 v131, v131
  v_exp_f32 v132, v132
  v_exp_f32 v133, v133
  v_exp_f32 v134, v134
  v_exp_f32 v135, v135
  v_exp_f32 v136, v136
  v_exp_f32 v137, v137
  v_exp_f32 v138, v138
  v_exp_f32 v139, v139
  v_cvt_pk_bf16_f32 v172, v120, v121
  v_cvt_pk_bf16_f32 v173, v122, v123
  v_cvt_pk_bf16_f32 v174, v124, v125
  v_cvt_pk_bf16_f32 v175, v126, v127
  v_cvt_pk_bf16_f32 v176, v128, v129
  v_cvt_pk_bf16_f32 v177, v130, v131
  v_cvt_pk_bf16_f32 v178, v132, v133
  v_cvt_pk_bf16_f32 v179, v134, v135
  v_cvt_pk_bf16_f32 v180, v136, v137
  v_cvt_pk_bf16_f32 v181, v138, v139
  v_mov_b64 v[182:183], v[180:181]
  s_waitcnt lgkmcnt(0)
  v_mfma_f32_32x32x16_bf16 v[152:167], v[112:115], v[172:175], 0
  v_mfma_f32_32x32x16_bf16 v[152:167], v[116:119], v[176:179], v[152:167]
  v_mfma_f32_32x32x16_bf16 v[152:167], v[184:187], v[180:183], v[152:167]
  s_add_u32 s23, s19, 36700160
  buffer_load_dwordx4 v[112:115], v7, s[4:7], s23 offen offset:0 sc1
  buffer_load_dwordx4 v[116:119], v7, s[4:7], s23 offen offset:1024 sc1
  v_pk_add_f32 v[120:121], v[120:121], v[122:123]
  v_pk_add_f32 v[124:125], v[124:125], v[126:127]
  v_pk_add_f32 v[128:129], v[128:129], v[130:131]
  v_pk_add_f32 v[132:133], v[132:133], v[134:135]
  v_pk_add_f32 v[136:137], v[136:137], v[138:139]
  v_pk_add_f32 v[120:121], v[120:121], v[124:125]
  v_pk_add_f32 v[128:129], v[128:129], v[132:133]
  v_pk_add_f32 v[120:121], v[120:121], v[128:129]
  v_pk_add_f32 v[120:121], v[120:121], v[136:137]
  v_add_f32 v168, v120, v121
  v_mov_b32 v169, v168
  s_nop 1
  v_permlane32_swap_b32 v168, v169
  v_add_f32 v168, v168, v169
  v_rcp_f32 v168, v168
  s_nop 0
  v_pk_mul_f32 v[152:153], v[152:153], v[168:169] op_sel_hi:[1,0]
  v_pk_mul_f32 v[154:155], v[154:155], v[168:169] op_sel_hi:[1,0]
  v_pk_mul_f32 v[156:157], v[156:157], v[168:169] op_sel_hi:[1,0]
  v_pk_mul_f32 v[158:159], v[158:159], v[168:169] op_sel_hi:[1,0]
  v_pk_mul_f32 v[160:161], v[160:161], v[168:169] op_sel_hi:[1,0]
  v_pk_mul_f32 v[162:163], v[162:163], v[168:169] op_sel_hi:[1,0]
  v_pk_mul_f32 v[164:165], v[164:165], v[168:169] op_sel_hi:[1,0]
  v_pk_mul_f32 v[166:167], v[166:167], v[168:169] op_sel_hi:[1,0]
  v_cvt_pk_bf16_f32 v136, v152, v153
  v_cvt_pk_bf16_f32 v137, v154, v155
  v_cvt_pk_bf16_f32 v138, v156, v157
  v_cvt_pk_bf16_f32 v139, v158, v159
  v_cvt_pk_bf16_f32 v140, v160, v161
  v_cvt_pk_bf16_f32 v141, v162, v163
  v_cvt_pk_bf16_f32 v142, v164, v165
  v_cvt_pk_bf16_f32 v143, v166, v167
  buffer_store_dwordx4 v[136:139], v1, s[4:7], s20 offen sc1
  buffer_store_dwordx4 v[140:143], v1, s[4:7], s20 offen offset:1024 sc1
  s_add_u32 s20, s20, 524288
  s_branch Latt_8
Latt_8_done:
  s_lshl_b32 s19, s12, 13
  s_lshl_b32 s20, s12, 13
  s_lshl_b32 s15, s13, 11
  s_add_u32 s20, s20, s15
  s_add_u32 s20, s20, 179306496
  s_lshr_b32 s21, s12, 3
  s_lshl_b32 s21, s21, 7
  s_add_u32 s21, s21, 3866624
  s_lshl_b32 s22, s12, 7
  s_add_u32 s22, s22, 3801088
  s_add_u32 s17, s15, 170917888
  s_add_u32 s18, s39, 170917888
  s_mov_b32 s14, s3
  s_mul_i32 s15, s3, 262144
  s_add_u32 s19, s19, s15
  s_add_u32 s20, s20, s15
  s_lshl_b32 s15, s3, 9
  s_add_u32 s21, s21, s15
  s_mul_i32 s15, s3, 10240
  s_add_u32 s17, s17, s15
  s_add_u32 s18, s18, s15
  s_mov_b32 s49, 0
  s_add_u32 s15, s14, 0
  s_lshr_b32 s15, s15, 2
  s_min_u32 s15, s15, 15
  s_cmp_lt_u32 s15, s49
  s_cbranch_scc1 Lakv_12_ok
Lakv_12_sp:
  v_lshrrev_b32 v11, 2, v1
  buffer_load_dword v11, v11, s[4:7], s22 offen sc1
  s_waitcnt vmcnt(0)
  v_cmp_le_u32 vcc, 4, v11
  s_add_u32 s0, s0, 1
  s_and_b32 s49, vcc_lo, 0xffff
  s_ff0_i32_b32 s49, s49
  s_cmp_lt_u32 s15, s49
  s_cbranch_scc1 Lakv_12_ok
  s_cmp_lt_u32 s0, 1572864
  s_cbranch_scc1 Lakv_12_sp
Lakv_12_ok:
  s_mov_b32 s92, 0
  s_add_u32 s23, s19, 120586240
  s_add_u32 s24, s19, 154140672
  buffer_load_dwordx4 v[80:83], v3, s[4:7], s23 offen offset:0 sc1
  buffer_load_dwordx4 v[48:51], v1, s[4:7], s24 offen offset:0 sc1
  buffer_load_dwordx4 v[84:87], v3, s[4:7], s23 offen offset:512 sc1
  buffer_load_dwordx4 v[52:55], v1, s[4:7], s24 offen offset:1024 sc1
  buffer_load_dwordx4 v[88:91], v3, s[4:7], s23 offen offset:2048 sc1
  buffer_load_dwordx4 v[56:59], v1, s[4:7], s24 offen offset:2048 sc1
  buffer_load_dwordx4 v[92:95], v3, s[4:7], s23 offen offset:2560 sc1
  buffer_load_dwordx4 v[60:63], v1, s[4:7], s24 offen offset:3072 sc1
  s_add_u32 s23, s19, 120590336
  s_add_u32 s24, s19, 154144768
  buffer_load_dwordx4 v[96:99], v3, s[4:7], s23 offen offset:0 sc1
  buffer_load_dwordx4 v[64:67], v1, s[4:7], s24 offen offset:0 sc1
  buffer_load_dwordx4 v[100:103], v3, s[4:7], s23 offen offset:512 sc1
  buffer_load_dwordx4 v[68:71], v1, s[4:7], s24 offen offset:1024 sc1
  buffer_load_dwordx4 v[104:107], v3, s[4:7], s23 offen offset:2048 sc1
  buffer_load_dwordx4 v[72:75], v1, s[4:7], s24 offen offset:2048 sc1
  buffer_load_dwordx4 v[108:111], v3, s[4:7], s23 offen offset:2560 sc1
  buffer_load_dwordx4 v[76:79], v1, s[4:7], s24 offen offset:3072 sc1
  s_add_u32 s23, s19, 137363456
  buffer_load_dwordx4 v[112:115], v7, s[4:7], s23 offen offset:0 sc1
  buffer_load_dwordx4 v[116:119], v7, s[4:7], s23 offen offset:1024 sc1
  s_mov_b32 s27, 2147479552
  buffer_store_dword v10, off, s[4:7], s27
  buffer_store_dword v10, off, s[4:7], s27
Latt_13:
  v_mov_b64 v[24:25], 0
  v_mov_b64 v[26:27], 0
  v_mov_b64 v[28:29], 0
  v_mov_b64 v[30:31], 0
  v_mov_b64 v[32:33], 0
  v_mov_b64 v[34:35], 0
  v_mov_b64 v[36:37], 0
  v_mov_b64 v[38:39], 0
  v_add_u32 v9, s39, v1
  s_waitcnt vmcnt(18)
  v_mfma_f32_32x32x16_bf16 v[120:135], v[80:83], v[48:51], 0
  s_waitcnt vmcnt(16)
  v_mfma_f32_32x32x16_bf16 v[120:135], v[84:87], v[52:55], v[120:135]
  s_waitcnt vmcnt(14)
  v_mfma_f32_32x32x16_bf16 v[120:135], v[88:91], v[56:59], v[120:135]
  s_waitcnt vmcnt(12)
  v_mfma_f32_32x32x16_bf16 v[120:135], v[92:95], v[60:63], v[120:135]
  s_waitcnt vmcnt(10)
  v_mfma_f32_32x32x16_bf16 v[120:135], v[96:99], v[64:67], v[120:135]
  s_waitcnt vmcnt(8)
  v_mfma_f32_32x32x16_bf16 v[120:135], v[100:103], v[68:71], v[120:135]
  s_waitcnt vmcnt(6)
  v_mfma_f32_32x32x16_bf16 v[120:135], v[104:107], v[72:75], v[120:135]
  s_waitcnt vmcnt(4)
  v_mfma_f32_32x32x16_bf16 v[120:135], v[108:111], v[76:79], v[120:135]
  v_mov_b32 v170, 0xff800000
  v_cmp_gt_i32 vcc, 0, v6
  v_cmp_gt_i32 s[50:51], 1, v6
  s_nop 8
  v_cndmask_b32 v120, v120, v170, vcc
  v_cndmask_b32 v121, v121, v170, s[50:51]
  v_cmp_gt_i32 vcc, 2, v6
  v_cmp_gt_i32 s[50:51], 3, v6
  s_nop 0
  v_cndmask_b32 v122, v122, v170, vcc
  v_cndmask_b32 v123, v123, v170, s[50:51]
  v_cmp_gt_i32 vcc, 4, v6
  v_cmp_gt_i32 s[50:51], 5, v6
  s_nop 0
  v_cndmask_b32 v124, v124, v170, vcc
  v_cndmask_b32 v125, v125, v170, s[50:51]
  v_cmp_gt_i32 vcc, 6, v6
  v_cmp_gt_i32 s[50:51], 7, v6
  s_nop 0
  v_cndmask_b32 v126, v126, v170, vcc
  v_cndmask_b32 v127, v127, v170, s[50:51]
  v_cmp_gt_i32 vcc, 8, v6
  v_cmp_gt_i32 s[50:51], 9, v6
  s_nop 0
  v_cndmask_b32 v128, v128, v170, vcc
  v_cndmask_b32 v129, v129, v170, s[50:51]
  v_cmp_gt_i32 vcc, 10, v6
  v_cmp_gt_i32 s[50:51], 11, v6
  s_nop 0
  v_cndmask_b32 v130, v130, v170, vcc
  v_cndmask_b32 v131, v131, v170, s[50:51]
  v_cmp_gt_i32 vcc, 12, v6
  v_cmp_gt_i32 s[50:51], 13, v6
  s_nop 0
  v_cndmask_b32 v132, v132, v170, vcc
  v_cndmask_b32 v133, v133, v170, s[50:51]
  v_cmp_gt_i32 vcc, 14, v6
  v_cmp_gt_i32 s[50:51], 15, v6
  s_nop 0
  v_cndmask_b32 v134, v134, v170, vcc
  v_cndmask_b32 v135, v135, v170, s[50:51]
  v_max3_f32 v168, v120, v121, v122
  v_max3_f32 v168, v168, v123, v124
  v_max3_f32 v168, v168, v125, v126
  v_max3_f32 v168, v168, v127, v128
  v_max3_f32 v168, v168, v129, v130
  v_max3_f32 v168, v168, v131, v132
  v_max3_f32 v168, v168, v133, v134
  v_max_f32 v168, v168, v135
  s_waitcnt vmcnt(0)
  s_mov_b64 exec, 1
  v_mov_b32 v10, 1
  buffer_atomic_add v10, off, s[4:7], s27
  s_mov_b64 exec, -1
  s_cmp_ge_u32 s14, 64
  s_cbranch_scc1 Latt_13_done
Lapoll_14:
  buffer_load_dwordx4 v[12:15], v1, s[4:7], s17 offen sc1
  buffer_load_dwordx4 v[16:19], v1, s[4:7], s17 offen offset:1024 sc1
  buffer_load_dwordx4 v[20:23], v1, s[4:7], s18 offen sc1
  s_add_u32 s0, s0, 1
  s_waitcnt vmcnt(0)
  v_max3_u32 v10, v12, v13, v14
  v_max3_u32 v10, v10, v15, v16
  v_max3_u32 v10, v10, v17, v18
  v_max3_u32 v10, v10, v19, v20
  v_max3_u32 v10, v10, v21, v22
  v_max_u32 v10, v10, v23
  v_cmp_eq_u32 vcc, -1, v10
  s_cbranch_vccz Lago_15
  s_sleep 2
  s_cmp_lt_u32 s0, 1572864
  s_cbranch_scc1 Lapoll_14
Lago_15:
  ds_write_b128 v2, v[12:15]
  ds_write_b128 v2, v[16:19] offset:1024
  ds_write_b128 v9, v[20:23]
  v_smfmac_f32_16x16x64_bf16 v[24:27], v[12:15], a[0:7], v0
  v_smfmac_f32_16x16x64_bf16 v[32:35], v[12:15], a[16:23], v0
  v_smfmac_f32_16x16x64_bf16 v[28:31], v[12:15], a[8:15], v0
  v_xor_b32 v9, 0x400, v9
  v_smfmac_f32_16x16x64_bf16 v[36:39], v[12:15], a[24:31], v0
  v_smfmac_f32_16x16x64_bf16 v[24:27], v[16:19], a[32:39], v0
  v_smfmac_f32_16x16x64_bf16 v[32:35], v[16:19], a[48:55], v0
  s_waitcnt lgkmcnt(0)
  s_barrier
  ds_read_b128 v[12:15], v9
  v_smfmac_f32_16x16x64_bf16 v[28:31], v[16:19], a[40:47], v0
  v_xor_b32 v9, 2048, v2
  v_smfmac_f32_16x16x64_bf16 v[36:39], v[16:19], a[56:63], v0
  ds_read_b128 v[16:19], v9 offset:0
  v_smfmac_f32_16x16x64_bf16 v[24:27], v[20:23], a[64:71], v0
  v_smfmac_f32_16x16x64_bf16 v[32:35], v[20:23], a[80:87], v0
  v_smfmac_f32_16x16x64_bf16 v[28:31], v[20:23], a[72:79], v0
  v_smfmac_f32_16x16x64_bf16 v[36:39], v[20:23], a[88:95], v0
  ds_read_b128 v[20:23], v9 offset:1024
  s_waitcnt lgkmcnt(2)
  v_smfmac_f32_16x16x64_bf16 v[24:27], v[12:15], a[96:103], v0
  v_smfmac_f32_16x16x64_bf16 v[32:35], v[12:15], a[112:119], v0
  v_smfmac_f32_16x16x64_bf16 v[28:31], v[12:15], a[104:111], v0
  v_xor_b32 v9, 4096, v2
  v_smfmac_f32_16x16x64_bf16 v[36:39], v[12:15], a[120:127], v0
  ds_read_b128 v[12:15], v9 offset:0
  s_waitcnt lgkmcnt(2)
  v_smfmac_f32_16x16x64_bf16 v[24:27], v[16:19], a[128:135], v0
  v_smfmac_f32_16x16x64_bf16 v[32:35], v[16:19], a[144:151], v0
  v_smfmac_f32_16x16x64_bf16 v[28:31], v[16:19], a[136:143], v0
  v_smfmac_f32_16x16x64_bf16 v[36:39], v[16:19], a[152:159], v0
  ds_read_b128 v[16:19], v9 offset:1024
  s_waitcnt lgkmcnt(2)
  v_smfmac_f32_16x16x64_bf16 v[24:27], v[20:23], a[160:167], v0
  v_smfmac_f32_16x16x64_bf16 v[32:35], v[20:23], a[176:183], v0
  v_smfmac_f32_16x16x64_bf16 v[28:31], v[20:23], a[168:175], v0
  v_xor_b32 v9, 6144, v2
  v_smfmac_f32_16x16x64_bf16 v[36:39], v[20:23], a[184:191], v0
  ds_read_b128 v[20:23], v9 offset:0
  s_waitcnt lgkmcnt(2)
  v_smfmac_f32_16x16x64_bf16 v[24:27], v[12:15], a[192:199], v0
  v_smfmac_f32_16x16x64_bf16 v[32:35], v[12:15], a[208:215], v0
  v_smfmac_f32_16x16x64_bf16 v[28:31], v[12:15], a[200:207], v0
  v_smfmac_f32_16x16x64_bf16 v[36:39], v[12:15], a[216:223], v0
  ds_read_b128 v[12:15], v9 offset:1024
  s_waitcnt lgkmcnt(2)
  v_smfmac_f32_16x16x64_bf16 v[24:27], v[16:19], a[224:231], v0
  v_smfmac_f32_16x16x64_bf16 v[32:35], v[16:19], a[240:247], v0
  v_smfmac_f32_16x16x64_bf16 v[28:31], v[16:19], a[232:239], v0
  v_smfmac_f32_16x16x64_bf16 v[36:39], v[16:19], a[248:255], v0
  s_waitcnt lgkmcnt(1)
  v_smfmac_f32_16x16x64_bf16 v[24:27], v[20:23], v[192:199], v0
  v_smfmac_f32_16x16x64_bf16 v[32:35], v[20:23], v[208:215], v0
  v_smfmac_f32_16x16x64_bf16 v[28:31], v[20:23], v[200:207], v0
  v_smfmac_f32_16x16x64_bf16 v[36:39], v[20:23], v[216:223], v0
  s_waitcnt lgkmcnt(0)
  v_smfmac_f32_16x16x64_bf16 v[24:27], v[12:15], v[224:231], v0
  v_smfmac_f32_16x16x64_bf16 v[32:35], v[12:15], v[240:247], v0
  v_smfmac_f32_16x16x64_bf16 v[28:31], v[12:15], v[232:239], v0
  v_smfmac_f32_16x16x64_bf16 v[36:39], v[12:15], v[248:255], v0
  v_cvt_pk_bf16_f32 v24, v24, v25
  v_cvt_pk_bf16_f32 v25, v26, v27
  v_cvt_pk_bf16_f32 v32, v32, v33
  v_cvt_pk_bf16_f32 v33, v34, v35
  v_mfma_f32_16x16x16_bf16 v[12:15], v[24:25], v[44:45], 0
  s_nop 0
  v_mfma_f32_16x16x16_bf16 v[16:19], v[32:33], v[44:45], 0
  v_cvt_pk_bf16_f32 v28, v28, v29
  v_cvt_pk_bf16_f32 v29, v30, v31
  v_cvt_pk_bf16_f32 v30, v36, v37
  v_cvt_pk_bf16_f32 v31, v38, v39
  ds_write_b128 v46, v[28:31] offset:20480
  s_nop 2
  v_cvt_pk_bf16_f32 v24, v12, v16
  v_cvt_pk_bf16_f32 v25, v13, v17
  v_cvt_pk_bf16_f32 v26, v14, v18
  v_cvt_pk_bf16_f32 v27, v15, v19
  ds_write_b128 v46, v[24:27] offset:16384
  s_mov_b32 s27, s21
  s_add_u32 s19, s19, 524288
  s_add_u32 s21, s21, 1024
  s_add_u32 s17, s17, 20480
  s_add_u32 s18, s18, 20480
  s_add_u32 s14, s14, 2
  s_waitcnt lgkmcnt(0)
  s_barrier
  ds_read_b128 v[80:83], v4 offset:16384
  ds_read_b128 v[84:87], v4 offset:16896
  ds_read_b128 v[88:91], v4 offset:17408
  ds_read_b128 v[92:95], v4 offset:17920
  ds_read_b128 v[96:99], v4 offset:18432
  ds_read_b128 v[100:103], v4 offset:18944
  ds_read_b128 v[104:107], v4 offset:19456
  ds_read_b128 v[108:111], v4 offset:19968
  ds_read_b64 v[184:185], v5 offset:20480
  ds_read_b64 v[186:187], v5 offset:20992
  s_add_u32 s15, s14, 0
  s_lshr_b32 s15, s15, 2
  s_min_u32 s15, s15, 15
  s_cmp_lt_u32 s15, s49
  s_cbranch_scc1 Lakv_16_ok
Lakv_16_sp:
  v_lshrrev_b32 v11, 2, v1
  buffer_load_dword v11, v11, s[4:7], s22 offen sc1
  s_waitcnt vmcnt(0)
  v_cmp_le_u32 vcc, 4, v11
  s_add_u32 s0, s0, 1
  s_and_b32 s49, vcc_lo, 0xffff
  s_ff0_i32_b32 s49, s49
  s_cmp_lt_u32 s15, s49
  s_cbranch_scc1 Lakv_16_ok
  s_cmp_lt_u32 s0, 1572864
  s_cbranch_scc1 Lakv_16_sp
Lakv_16_ok:
  s_waitcnt lgkmcnt(9)
  v_mfma_f32_32x32x16_bf16 v[136:151], v[80:83], v[48:51], 0
  s_waitcnt lgkmcnt(8)
  v_mfma_f32_32x32x16_bf16 v[136:151], v[84:87], v[52:55], v[136:151]
  s_waitcnt lgkmcnt(7)
  v_mfma_f32_32x32x16_bf16 v[136:151], v[88:91], v[56:59], v[136:151]
  s_waitcnt lgkmcnt(6)
  v_mfma_f32_32x32x16_bf16 v[136:151], v[92:95], v[60:63], v[136:151]
  s_waitcnt lgkmcnt(5)
  v_mfma_f32_32x32x16_bf16 v[136:151], v[96:99], v[64:67], v[136:151]
  s_waitcnt lgkmcnt(4)
  v_mfma_f32_32x32x16_bf16 v[136:151], v[100:103], v[68:71], v[136:151]
  s_waitcnt lgkmcnt(3)
  v_mfma_f32_32x32x16_bf16 v[136:151], v[104:107], v[72:75], v[136:151]
  s_waitcnt lgkmcnt(2)
  v_mfma_f32_32x32x16_bf16 v[136:151], v[108:111], v[76:79], v[136:151]
  s_add_u32 s23, s19, 120586240
  s_add_u32 s24, s19, 154140672
  buffer_load_dwordx4 v[80:83], v3, s[4:7], s23 offen offset:0 sc1
  buffer_load_dwordx4 v[48:51], v1, s[4:7], s24 offen offset:0 sc1
  buffer_load_dwordx4 v[84:87], v3, s[4:7], s23 offen offset:512 sc1
  buffer_load_dwordx4 v[52:55], v1, s[4:7], s24 offen offset:1024 sc1
  buffer_load_dwordx4 v[88:91], v3, s[4:7], s23 offen offset:2048 sc1
  buffer_load_dwordx4 v[56:59], v1, s[4:7], s24 offen offset:2048 sc1
  buffer_load_dwordx4 v[92:95], v3, s[4:7], s23 offen offset:2560 sc1
  buffer_load_dwordx4 v[60:63], v1, s[4:7], s24 offen offset:3072 sc1
  s_add_u32 s23, s19, 120590336
  s_add_u32 s24, s19, 154144768
  buffer_load_dwordx4 v[96:99], v3, s[4:7], s23 offen offset:0 sc1
  buffer_load_dwordx4 v[64:67], v1, s[4:7], s24 offen offset:0 sc1
  buffer_load_dwordx4 v[100:103], v3, s[4:7], s23 offen offset:512 sc1
  buffer_load_dwordx4 v[68:71], v1, s[4:7], s24 offen offset:1024 sc1
  buffer_load_dwordx4 v[104:107], v3, s[4:7], s23 offen offset:2048 sc1
  buffer_load_dwordx4 v[72:75], v1, s[4:7], s24 offen offset:2048 sc1
  buffer_load_dwordx4 v[108:111], v3, s[4:7], s23 offen offset:2560 sc1
  buffer_load_dwordx4 v[76:79], v1, s[4:7], s24 offen offset:3072 sc1
  v_max3_f32 v168, v168, v136, v137
  v_max3_f32 v168, v168, v138, v139
  v_mov_b32 v169, v168
  s_nop 1
  v_permlane32_swap_b32 v168, v169
  v_max_f32 v168, v168, v169
  v_mul_f32 v168, s40, v168
  v_fma_f32 v120, v120, s40, -v168
  v_fma_f32 v121, v121, s40, -v168
  v_fma_f32 v122, v122, s40, -v168
  v_fma_f32 v123, v123, s40, -v168
  v_fma_f32 v124, v124, s40, -v168
  v_fma_f32 v125, v125, s40, -v168
  v_fma_f32 v126, v126, s40, -v168
  v_fma_f32 v127, v127, s40, -v168
  v_fma_f32 v128, v128, s40, -v168
  v_fma_f32 v129, v129, s40, -v168
  v_fma_f32 v130, v130, s40, -v168
  v_fma_f32 v131, v131, s40, -v168
  v_fma_f32 v132, v132, s40, -v168
  v_fma_f32 v133, v133, s40, -v168
  v_fma_f32 v134, v134, s40, -v168
  v_fma_f32 v135, v135, s40, -v168
  v_fma_f32 v136, v136, s40, -v168
  v_fma_f32 v137, v137, s40, -v168
  v_fma_f32 v138, v138, s40, -v168
  v_fma_f32 v139, v139, s40, -v168
  v_exp_f32 v120, v120
  v_exp_f32 v121, v121
  v_exp_f32 v122, v122
  v_exp_f32 v123, v123
  v_exp_f32 v124, v124
  v_exp_f32 v125, v125
  v_exp_f32 v126, v126
  v_exp_f32 v127, v127
  v_exp_f32 v128, v128
  v_exp_f32 v129, v129
  v_exp_f32 v130, v130
  v_exp_f32 v131, v131
  v_exp_f32 v132, v132
  v_exp_f32 v133, v133
  v_exp_f32 v134, v134
  v_exp_f32 v135, v135
  v_exp_f32 v136, v136
  v_exp_f32 v137, v137
  v_exp_f32 v138, v138
  v_exp_f32 v139, v139
  v_cvt_pk_bf16_f32 v172, v120, v121
  v_cvt_pk_bf16_f32 v173, v122, v123
  v_cvt_pk_bf16_f32 v174, v124, v125
  v_cvt_pk_bf16_f32 v175, v126, v127
  v_cvt_pk_bf16_f32 v176, v128, v129
  v_cvt_pk_bf16_f32 v177, v130, v131
  v_cvt_pk_bf16_f32 v178, v132, v133
  v_cvt_pk_bf16_f32 v179, v134, v135
  v_cvt_pk_bf16_f32 v180, v136, v137
  v_cvt_pk_bf16_f32 v181, v138, v139
  v_mov_b64 v[182:183], v[180:181]
  s_waitcnt lgkmcnt(0)
  v_mfma_f32_32x32x16_bf16 v[152:167], v[112:115], v[172:175], 0
  v_mfma_f32_32x32x16_bf16 v[152:167], v[116:119], v[176:179], v[152:167]
  v_mfma_f32_32x32x16_bf16 v[152:167], v[184:187], v[180:183], v[152:167]
  s_add_u32 s23, s19, 137363456
  buffer_load_dwordx4 v[112:115], v7, s[4:7], s23 offen offset:0 sc1
  buffer_load_dwordx4 v[116:119], v7, s[4:7], s23 offen offset:1024 sc1
  v_pk_add_f32 v[120:121], v[120:121], v[122:123]
  v_pk_add_f32 v[124:125], v[124:125], v[126:127]
  v_pk_add_f32 v[128:129], v[128:129], v[130:131]
  v_pk_add_f32 v[132:133], v[132:133], v[134:135]
  v_pk_add_f32 v[136:137], v[136:137], v[138:139]
  v_pk_add_f32 v[120:121], v[120:121], v[124:125]
  v_pk_add_f32 v[128:129], v[128:129], v[132:133]
  v_pk_add_f32 v[120:121], v[120:121], v[128:129]
  v_pk_add_f32 v[120:121], v[120:121], v[136:137]
  v_add_f32 v168, v120, v121
  v_mov_b32 v169, v168
  s_nop 1
  v_permlane32_swap_b32 v168, v169
  v_add_f32 v168, v168, v169
  v_rcp_f32 v168, v168
  s_nop 0
  v_pk_mul_f32 v[152:153], v[152:153], v[168:169] op_sel_hi:[1,0]
  v_pk_mul_f32 v[154:155], v[154:155], v[168:169] op_sel_hi:[1,0]
  v_pk_mul_f32 v[156:157], v[156:157], v[168:169] op_sel_hi:[1,0]
  v_pk_mul_f32 v[158:159], v[158:159], v[168:169] op_sel_hi:[1,0]
  v_pk_mul_f32 v[160:161], v[160:161], v[168:169] op_sel_hi:[1,0]
  v_pk_mul_f32 v[162:163], v[162:163], v[168:169] op_sel_hi:[1,0]
  v_pk_mul_f32 v[164:165], v[164:165], v[168:169] op_sel_hi:[1,0]
  v_pk_mul_f32 v[166:167], v[166:167], v[168:169] op_sel_hi:[1,0]
  v_cvt_pk_bf16_f32 v136, v152, v153
  v_cvt_pk_bf16_f32 v137, v154, v155
  v_cvt_pk_bf16_f32 v138, v156, v157
  v_cvt_pk_bf16_f32 v139, v158, v159
  v_cvt_pk_bf16_f32 v140, v160, v161
  v_cvt_pk_bf16_f32 v141, v162, v163
  v_cvt_pk_bf16_f32 v142, v164, v165
  v_cvt_pk_bf16_f32 v143, v166, v167
  buffer_store_dwordx4 v[136:139], v1, s[4:7], s20 offen sc1
  buffer_store_dwordx4 v[140:143], v1, s[4:7], s20 offen offset:1024 sc1
  s_add_u32 s20, s20, 524288
  s_branch Latt_13
Latt_13_done:
  s_endpgm
mk_gw:
  s_sub_u32 s19, s19, s24
  s_mul_i32 s35, s18, 22
  s_mul_i32 s24, s18, 24
  s_sub_u32 s24, s24, 8
  s_cmp_lt_u32 s18, 4
  s_cselect_b32 s35, s35, s24
  s_add_u32 s35, s35, s19
  s_lshl_b32 s24, s20, 2
  s_cmp_ge_u32 s19, s24
  s_cbranch_scc1 Lri_17_sp
  s_mul_i32 s51, s18, 20
  s_lshl_b32 s24, s18, 4
  s_add_u32 s24, s24, 16
  s_cmp_lt_u32 s18, 4
  s_cselect_b32 s51, s51, s24
  s_add_u32 s51, s51, s19
  s_cmp_lt_u32 s51, 40
  s_cselect_b32 s24, 20, 28
  s_add_u32 s50, s51, s24
  s_branch Lri_17
Lri_17_sp:
  s_lshl_b32 s51, s18, 1
  s_sub_u32 s51, s51, 20
  s_lshl_b32 s24, s18, 3
  s_sub_u32 s24, s24, 40
  s_cmp_lt_u32 s18, 4
  s_cselect_b32 s51, s51, s24
  s_add_u32 s51, s51, s19
  s_cmp_lt_u32 s51, 28
  s_cselect_b32 s24, 40, 128
  s_cmp_lt_u32 s51, 20
  s_cselect_b32 s24, 0, s24
  s_add_u32 s50, s51, s24
Lri_17:
  s_lshl_b32 s24, s35, 12
  v_lshlrev_b32 v40, 4, v0
  v_add_u32 v40, s24, v40
  v_mov_b32 v44, -1
  v_mov_b32 v48, 0
  v_mov_b32 v45, -1
  v_mov_b32 v49, 0
  v_mov_b32 v46, -1
  v_mov_b32 v50, 0
  v_mov_b32 v47, -1
  v_mov_b32 v51, 0
  v_mov_b32 v41, 0x80000000
  s_mov_b32 s25, 70254592
  buffer_store_dwordx4 v[44:47], v40, s[4:7], s25 offen sc1
  s_mov_b32 s25, 170917888
  buffer_store_dwordx4 v[44:47], v40, s[4:7], s25 offen sc1
  v_cmp_gt_u32 vcc, 0x5c000, v40
  s_nop 1
  v_cndmask_b32 v42, v41, v40, vcc
  s_mov_b32 s25, 81920
  buffer_store_dwordx4 v[44:47], v42, s[4:7], s25 offen sc1
  v_cmp_gt_u32 vcc, 0x40000, v40
  s_nop 1
  v_cndmask_b32 v42, v41, v40, vcc
  s_mov_b32 s25, 3670016
  buffer_store_dwordx4 v[48:51], v42, s[4:7], s25 offen sc1
  s_mov_b32 s52, s66
  s_and_b32 s53, s67, 0xffff
  s_mov_b32 s54, 10240
  s_mov_b32 s55, 0x00020000
  v_lshrrev_b32 v43, 4, v40
  v_and_b32 v52, 7, v43
  v_mul_u32_u24 v52, 0x500, v52
  v_lshrrev_b32 v53, 3, v43
  v_lshl_add_u32 v52, v53, 4, v52
  v_cmp_gt_u32 vcc, 640, v43
  s_nop 1
  v_cndmask_b32 v52, v41, v52, vcc
  v_cndmask_b32 v53, v41, v40, vcc
  buffer_load_dwordx4 v[56:59], v52, s[52:55], 0 offen
  s_mov_b32 s25, 65536
  s_waitcnt vmcnt(0)
  buffer_store_dwordx4 v[56:59], v53, s[4:7], s25 offen sc1
  s_waitcnt vmcnt(0)
  s_barrier
  s_lshl_b32 s24, s80, 2
  s_add_u32 s24, s24, 160
  s_cmp_eq_u32 s17, 0
  s_cselect_b32 s24, s24, 0x1000
  s_mov_b64 exec, 1
  v_mov_b32 v40, 1
  buffer_atomic_add v40, off, s[76:79], s24
  s_mov_b64 exec, -1
  s_lshl_b32 s24, s20, 2
  s_cmp_ge_u32 s19, s24
  s_cbranch_scc1 mk_nq0
  s_lshr_b32 s23, s19, 2
  s_mul_i32 s23, s23, 7
  s_add_u32 s23, s23, s18
  s_and_b32 s26, s19, 3
  s_mul_i32 s30, s19, 13108
  s_lshr_b32 s30, s30, 16
  s_mul_i32 s30, s30, 5
  s_sub_u32 s30, s19, s30
  s_lshl_b32 s30, s30, 1
  s_mov_b32 s8, s58
  s_and_b32 s9, s59, 0xffff
  s_mov_b32 s10, 5242880
  s_mov_b32 s11, 0x00020000
  s_mov_b32 s12, s60
  s_and_b32 s13, s61, 0xffff
  s_mov_b32 s14, 5242880
  s_mov_b32 s15, 0x00020000
  s_mov_b32 s36, s56
  s_and_b32 s37, s57, 0xffff
  s_mov_b32 s38, 5242880
  s_mov_b32 s39, 0x00020000
  v_lshrrev_b32 v3, 2, v1
  v_lshlrev_b32 v3, 13, v3
  v_and_b32 v4, 3, v1
  v_lshl_add_u32 v6, v4, 4, v3
  s_lshl_b32 s28, s23, 8
  s_lshl_b32 s25, s26, 6
  s_add_u32 s28, s28, s25
  s_lshl_b32 s25, s17, 17
  s_add_u32 s28, s28, s25
  s_lshl_b32 s25, s30, 19
  s_add_u32 s25, s25, s28
  s_add_u32 m0, s29, 0
  s_nop 0
  buffer_load_dwordx4 v6, s[8:11], s25 offen lds
  s_add_u32 m0, s29, 40960
  s_nop 0
  buffer_load_dwordx4 v6, s[12:15], s25 offen lds
  s_add_u32 m0, s29, 81920
  s_nop 0
  buffer_load_dwordx4 v6, s[36:39], s25 offen lds
  s_add_u32 s30, s30, 1
  s_cmp_eq_u32 s30, 10
  s_cselect_b32 s30, 0, s30
  s_lshl_b32 s25, s30, 19
  s_add_u32 s25, s25, s28
  s_add_u32 m0, s29, 4096
  s_nop 0
  buffer_load_dwordx4 v6, s[8:11], s25 offen lds
  s_add_u32 m0, s29, 45056
  s_nop 0
  buffer_load_dwordx4 v6, s[12:15], s25 offen lds
  s_add_u32 m0, s29, 86016
  s_nop 0
  buffer_load_dwordx4 v6, s[36:39], s25 offen lds
  s_add_u32 s30, s30, 1
  s_cmp_eq_u32 s30, 10
  s_cselect_b32 s30, 0, s30
  s_lshl_b32 s25, s30, 19
  s_add_u32 s25, s25, s28
  s_add_u32 m0, s29, 8192
  s_nop 0
  buffer_load_dwordx4 v6, s[8:11], s25 offen lds
  s_add_u32 m0, s29, 49152
  s_nop 0
  buffer_load_dwordx4 v6, s[12:15], s25 offen lds
  s_add_u32 m0, s29, 90112
  s_nop 0
  buffer_load_dwordx4 v6, s[36:39], s25 offen lds
  s_add_u32 s30, s30, 1
  s_cmp_eq_u32 s30, 10
  s_cselect_b32 s30, 0, s30
  s_lshl_b32 s25, s30, 19
  s_add_u32 s25, s25, s28
  s_add_u32 m0, s29, 12288
  s_nop 0
  buffer_load_dwordx4 v6, s[8:11], s25 offen lds
  s_add_u32 m0, s29, 53248
  s_nop 0
  buffer_load_dwordx4 v6, s[12:15], s25 offen lds
  s_add_u32 m0, s29, 94208
  s_nop 0
  buffer_load_dwordx4 v6, s[36:39], s25 offen lds
  s_add_u32 s30, s30, 1
  s_cmp_eq_u32 s30, 10
  s_cselect_b32 s30, 0, s30
  s_lshl_b32 s25, s30, 19
  s_add_u32 s25, s25, s28
  s_add_u32 m0, s29, 16384
  s_nop 0
  buffer_load_dwordx4 v6, s[8:11], s25 offen lds
  s_add_u32 m0, s29, 57344
  s_nop 0
  buffer_load_dwordx4 v6, s[12:15], s25 offen lds
  s_add_u32 m0, s29, 98304
  s_nop 0
  buffer_load_dwordx4 v6, s[36:39], s25 offen lds
  s_add_u32 s30, s30, 1
  s_cmp_eq_u32 s30, 10
  s_cselect_b32 s30, 0, s30
  s_lshl_b32 s25, s30, 19
  s_add_u32 s25, s25, s28
  s_add_u32 m0, s29, 20480
  s_nop 0
  buffer_load_dwordx4 v6, s[8:11], s25 offen lds
  s_add_u32 m0, s29, 61440
  s_nop 0
  buffer_load_dwordx4 v6, s[12:15], s25 offen lds
  s_add_u32 m0, s29, 102400
  s_nop 0
  buffer_load_dwordx4 v6, s[36:39], s25 offen lds
  s_add_u32 s30, s30, 1
  s_cmp_eq_u32 s30, 10
  s_cselect_b32 s30, 0, s30
  s_lshl_b32 s25, s30, 19
  s_add_u32 s25, s25, s28
  s_add_u32 m0, s29, 24576
  s_nop 0
  buffer_load_dwordx4 v6, s[8:11], s25 offen lds
  s_add_u32 m0, s29, 65536
  s_nop 0
  buffer_load_dwordx4 v6, s[12:15], s25 offen lds
  s_add_u32 m0, s29, 106496
  s_nop 0
  buffer_load_dwordx4 v6, s[36:39], s25 offen lds
  s_add_u32 s30, s30, 1
  s_cmp_eq_u32 s30, 10
  s_cselect_b32 s30, 0, s30
  s_lshl_b32 s25, s30, 19
  s_add_u32 s25, s25, s28
  s_add_u32 m0, s29, 28672
  s_nop 0
  buffer_load_dwordx4 v6, s[8:11], s25 offen lds
  s_add_u32 m0, s29, 69632
  s_nop 0
  buffer_load_dwordx4 v6, s[12:15], s25 offen lds
  s_add_u32 m0, s29, 110592
  s_nop 0
  buffer_load_dwordx4 v6, s[36:39], s25 offen lds
  s_add_u32 s30, s30, 1
  s_cmp_eq_u32 s30, 10
  s_cselect_b32 s30, 0, s30
  s_lshl_b32 s25, s30, 19
  s_add_u32 s25, s25, s28
  s_add_u32 m0, s29, 32768
  s_nop 0
  buffer_load_dwordx4 v6, s[8:11], s25 offen lds
  s_add_u32 m0, s29, 73728
  s_nop 0
  buffer_load_dwordx4 v6, s[12:15], s25 offen lds
  s_add_u32 m0, s29, 114688
  s_nop 0
  buffer_load_dwordx4 v6, s[36:39], s25 offen lds
  s_add_u32 s30, s30, 1
  s_cmp_eq_u32 s30, 10
  s_cselect_b32 s30, 0, s30
  s_lshl_b32 s25, s30, 19
  s_add_u32 s25, s25, s28
  s_add_u32 m0, s29, 36864
  s_nop 0
  buffer_load_dwordx4 v6, s[8:11], s25 offen lds
  s_add_u32 m0, s29, 77824
  s_nop 0
  buffer_load_dwordx4 v6, s[12:15], s25 offen lds
  s_add_u32 m0, s29, 118784
  s_nop 0
  buffer_load_dwordx4 v6, s[36:39], s25 offen lds
  s_add_u32 s30, s30, 1
  s_cmp_eq_u32 s30, 10
  s_cselect_b32 s30, 0, s30
  v_mbcnt_lo_u32_b32 v40, -1, 0
  v_mbcnt_hi_u32_b32 v40, -1, v40
  v_lshlrev_b32 v40, 2, v40
Liw_18:
  buffer_load_dword v41, v40, s[76:79], 0 offen offset:160 sc1
  s_waitcnt vmcnt(0)
  v_readlane_b32 s24, v41, 0
  v_readlane_b32 s25, v41, 1
  s_nop 0
  s_add_u32 s24, s24, s25
  v_readlane_b32 s25, v41, 2
  s_nop 0
  s_add_u32 s24, s24, s25
  v_readlane_b32 s25, v41, 3
  s_nop 0
  s_add_u32 s24, s24, s25
  v_readlane_b32 s25, v41, 4
  s_nop 0
  s_add_u32 s24, s24, s25
  v_readlane_b32 s25, v41, 5
  s_nop 0
  s_add_u32 s24, s24, s25
  v_readlane_b32 s25, v41, 6
  s_nop 0
  s_add_u32 s24, s24, s25
  v_readlane_b32 s25, v41, 7
  s_nop 0
  s_add_u32 s24, s24, s25
  s_add_u32 s0, s0, 1
  s_cmp_ge_u32 s24, 160
  s_cbranch_scc1 Liw_18_ok
  s_sleep 4
  s_cmp_lt_u32 s0, 1572864
  s_cbranch_scc1 Liw_18
Liw_18_ok:
  s_barrier
  s_lshr_b32 s23, s19, 2
  s_mul_i32 s23, s23, 7
  s_add_u32 s23, s23, s18
  s_and_b32 s26, s19, 3
  s_mul_i32 s30, s19, 13108
  s_lshr_b32 s30, s30, 16
  s_mul_i32 s30, s30, 5
  s_sub_u32 s30, s19, s30
  s_lshl_b32 s30, s30, 1
  v_lshrrev_b32 v3, 5, v1
  v_mul_u32_u24 v3, 8, v3
  v_bfe_u32 v4, v1, 2, 2
  v_add_u32 v3, v3, v4
  v_mul_u32_u24 v8, 64, v3
  v_bfe_u32 v4, v1, 1, 1
  v_lshl_add_u32 v8, v4, 3, v8
  v_bfe_u32 v4, v1, 4, 1
  v_lshl_add_u32 v8, v4, 4, v8
  v_bfe_u32 v4, v1, 0, 1
  v_lshl_add_u32 v8, v4, 5, v8
  v_add_u32 v8, 0, v8
  v_lshrrev_b32 v3, 5, v1
  v_mul_u32_u24 v3, 8, v3
  v_bfe_u32 v4, v1, 2, 2
  v_add_u32 v3, v3, v4
  v_mul_u32_u24 v10, 64, v3
  v_bfe_u32 v4, v1, 0, 1
  v_lshl_add_u32 v10, v4, 3, v10
  v_bfe_u32 v4, v1, 1, 1
  v_lshl_add_u32 v10, v4, 4, v10
  v_bfe_u32 v4, v1, 4, 1
  v_lshl_add_u32 v10, v4, 5, v10
  v_add_u32 v10, 40960, v10
  v_lshrrev_b32 v3, 5, v1
  v_mul_u32_u24 v3, 8, v3
  v_bfe_u32 v4, v1, 2, 2
  v_add_u32 v3, v3, v4
  v_mul_u32_u24 v12, 64, v3
  v_bfe_u32 v4, v1, 1, 1
  v_lshl_add_u32 v12, v4, 3, v12
  v_bfe_u32 v4, v1, 0, 1
  v_lshl_add_u32 v12, v4, 4, v12
  v_bfe_u32 v4, v1, 4, 1
  v_lshl_add_u32 v12, v4, 5, v12
  v_add_u32 v12, 81920, v12
  v_lshrrev_b32 v3, 5, v1
  v_lshlrev_b32 v7, 9, v3
  v_bfe_u32 v3, v1, 1, 4
  v_lshl_add_u32 v7, v3, 4, v7
  v_and_b32 v3, 1, v1
  v_lshl_add_u32 v7, v3, 8, v7
  s_mul_i32 s27, s17, 40960
  s_add_u32 s27, s27, 16777216
  s_lshl_b32 s28, s17, 5
  s_add_u32 s28, s28, s23
  s_lshl_b32 s28, s28, 13
  s_lshl_b32 s25, s26, 11
  s_add_u32 s28, s28, s25
  s_lshl_b32 s31, s23, 7
  s_add_u32 s31, s31, 3670016
  s_mov_b32 s34, 3674112
  s_mov_b32 s74, 0
  s_mov_b32 s22, 0
Lwqf_19:
  s_add_u32 s24, s22, 0
  s_min_u32 s24, s24, 15
  s_cmp_lt_u32 s24, s74
  s_cbranch_scc1 Lxr_20_ok
  s_cmp_lg_u32 s17, 0
  s_cbranch_scc1 Lxr_20_w
  v_lshlrev_b32 v5, 7, v1
Lxr_20_sp:
  buffer_load_dword v3, v5, s[4:7], s34 offen sc1
  s_waitcnt vmcnt(0)
  v_cmp_le_u32 vcc, 16, v3
  s_add_u32 s0, s0, 1
  s_and_b32 s74, vcc_lo, 0xffff
  s_ff0_i32_b32 s74, s74
  s_cmp_lt_u32 s24, s74
  s_cbranch_scc1 Lxr_20_got
  s_sleep 2
  s_cmp_lt_u32 s0, 1572864
  s_cbranch_scc1 Lxr_20_sp
Lxr_20_got:
  v_mov_b32 v3, s74
  v_mov_b32 v5, 123392
  ds_write_b32 v5, v3
  s_waitcnt lgkmcnt(0)
Lxr_20_w:
  s_barrier
  v_mov_b32 v5, 123392
  ds_read_b32 v3, v5
  s_waitcnt lgkmcnt(0)
  v_readfirstlane_b32 s74, v3
  s_barrier
Lxr_20_ok:
  s_lshl_b32 s75, s30, 12
  s_add_u32 s75, s75, s27
  s_add_u32 s30, s30, 1
  s_cmp_eq_u32 s30, 10
  s_cselect_b32 s30, 0, s30
  buffer_load_dwordx4 v[96:99], v2, s[4:7], s75 offen offset:0 sc1
  buffer_load_dwordx4 v[100:103], v2, s[4:7], s75 offen offset:1024 sc1
  buffer_load_dwordx4 v[104:107], v2, s[4:7], s75 offen offset:2048 sc1
  buffer_load_dwordx4 v[108:111], v2, s[4:7], s75 offen offset:3072 sc1
  s_lshl_b32 s75, s30, 12
  s_add_u32 s75, s75, s27
  s_add_u32 s30, s30, 1
  s_cmp_eq_u32 s30, 10
  s_cselect_b32 s30, 0, s30
  buffer_load_dwordx4 v[112:115], v2, s[4:7], s75 offen offset:0 sc1
  buffer_load_dwordx4 v[116:119], v2, s[4:7], s75 offen offset:1024 sc1
  buffer_load_dwordx4 v[120:123], v2, s[4:7], s75 offen offset:2048 sc1
  buffer_load_dwordx4 v[124:127], v2, s[4:7], s75 offen offset:3072 sc1
  s_lshl_b32 s75, s30, 12
  s_add_u32 s75, s75, s27
  s_add_u32 s30, s30, 1
  s_cmp_eq_u32 s30, 10
  s_cselect_b32 s30, 0, s30
  buffer_load_dwordx4 v[128:131], v2, s[4:7], s75 offen offset:0 sc1
  buffer_load_dwordx4 v[132:135], v2, s[4:7], s75 offen offset:1024 sc1
  buffer_load_dwordx4 v[136:139], v2, s[4:7], s75 offen offset:2048 sc1
  buffer_load_dwordx4 v[140:143], v2, s[4:7], s75 offen offset:3072 sc1
  s_lshl_b32 s75, s30, 12
  s_add_u32 s75, s75, s27
  s_add_u32 s30, s30, 1
  s_cmp_eq_u32 s30, 10
  s_cselect_b32 s30, 0, s30
  buffer_load_dwordx4 v[144:147], v2, s[4:7], s75 offen offset:0 sc1
  buffer_load_dwordx4 v[148:151], v2, s[4:7], s75 offen offset:1024 sc1
  buffer_load_dwordx4 v[152:155], v2, s[4:7], s75 offen offset:2048 sc1
  buffer_load_dwordx4 v[156:159], v2, s[4:7], s75 offen offset:3072 sc1
  s_lshl_b32 s75, s30, 12
  s_add_u32 s75, s75, s27
  s_add_u32 s30, s30, 1
  s_cmp_eq_u32 s30, 10
  s_cselect_b32 s30, 0, s30
  buffer_load_dwordx4 v[160:163], v2, s[4:7], s75 offen offset:0 sc1
  buffer_load_dwordx4 v[164:167], v2, s[4:7], s75 offen offset:1024 sc1
  buffer_load_dwordx4 v[168:171], v2, s[4:7], s75 offen offset:2048 sc1
  buffer_load_dwordx4 v[172:175], v2, s[4:7], s75 offen offset:3072 sc1
  s_lshl_b32 s75, s30, 12
  s_add_u32 s75, s75, s27
  s_add_u32 s30, s30, 1
  s_cmp_eq_u32 s30, 10
  s_cselect_b32 s30, 0, s30
  buffer_load_dwordx4 v[176:179], v2, s[4:7], s75 offen offset:0 sc1
  buffer_load_dwordx4 v[180:183], v2, s[4:7], s75 offen offset:1024 sc1
  buffer_load_dwordx4 v[184:187], v2, s[4:7], s75 offen offset:2048 sc1
  buffer_load_dwordx4 v[188:191], v2, s[4:7], s75 offen offset:3072 sc1
  s_lshl_b32 s75, s30, 12
  s_add_u32 s75, s75, s27
  s_add_u32 s30, s30, 1
  s_cmp_eq_u32 s30, 10
  s_cselect_b32 s30, 0, s30
  buffer_load_dwordx4 v[192:195], v2, s[4:7], s75 offen offset:0 sc1
  buffer_load_dwordx4 v[196:199], v2, s[4:7], s75 offen offset:1024 sc1
  buffer_load_dwordx4 v[200:203], v2, s[4:7], s75 offen offset:2048 sc1
  buffer_load_dwordx4 v[204:207], v2, s[4:7], s75 offen offset:3072 sc1
  s_lshl_b32 s75, s30, 12
  s_add_u32 s75, s75, s27
  s_add_u32 s30, s30, 1
  s_cmp_eq_u32 s30, 10
  s_cselect_b32 s30, 0, s30
  buffer_load_dwordx4 v[208:211], v2, s[4:7], s75 offen offset:0 sc1
  buffer_load_dwordx4 v[212:215], v2, s[4:7], s75 offen offset:1024 sc1
  buffer_load_dwordx4 v[216:219], v2, s[4:7], s75 offen offset:2048 sc1
  buffer_load_dwordx4 v[220:223], v2, s[4:7], s75 offen offset:3072 sc1
  s_lshl_b32 s75, s30, 12
  s_add_u32 s75, s75, s27
  s_add_u32 s30, s30, 1
  s_cmp_eq_u32 s30, 10
  s_cselect_b32 s30, 0, s30
  buffer_load_dwordx4 v[224:227], v2, s[4:7], s75 offen offset:0 sc1
  buffer_load_dwordx4 v[228:231], v2, s[4:7], s75 offen offset:1024 sc1
  buffer_load_dwordx4 v[232:235], v2, s[4:7], s75 offen offset:2048 sc1
  buffer_load_dwordx4 v[236:239], v2, s[4:7], s75 offen offset:3072 sc1
  s_lshl_b32 s75, s30, 12
  s_add_u32 s75, s75, s27
  s_add_u32 s30, s30, 1
  s_cmp_eq_u32 s30, 10
  s_cselect_b32 s30, 0, s30
  buffer_load_dwordx4 v[240:243], v2, s[4:7], s75 offen offset:0 sc1
  buffer_load_dwordx4 v[244:247], v2, s[4:7], s75 offen offset:1024 sc1
  buffer_load_dwordx4 v[248:251], v2, s[4:7], s75 offen offset:2048 sc1
  buffer_load_dwordx4 v[252:255], v2, s[4:7], s75 offen offset:3072 sc1
  s_add_u32 s27, s27, 163840
  s_waitcnt vmcnt(40)
  s_barrier
  ds_read_b64_tr_b16 v[16:17], v8 offset:0
  ds_read_b64_tr_b16 v[18:19], v8 offset:256
  ds_read_b64_tr_b16 v[20:21], v10 offset:0
  ds_read_b64_tr_b16 v[22:23], v10 offset:256
  ds_read_b64_tr_b16 v[24:25], v12 offset:0
  ds_read_b64_tr_b16 v[26:27], v12 offset:256
  ds_read_b64_tr_b16 v[28:29], v8 offset:1024
  ds_read_b64_tr_b16 v[30:31], v8 offset:1280
  ds_read_b64_tr_b16 v[32:33], v10 offset:1024
  ds_read_b64_tr_b16 v[34:35], v10 offset:1280
  ds_read_b64_tr_b16 v[36:37], v12 offset:1024
  ds_read_b64_tr_b16 v[38:39], v12 offset:1280
  s_waitcnt vmcnt(39) lgkmcnt(6)
  v_mfma_f32_32x32x16_bf16 a[0:15], v[16:19], v[96:99], 0
  v_mfma_f32_32x32x16_bf16 a[16:31], v[96:99], v[20:23], 0
  v_mfma_f32_32x32x16_bf16 a[32:47], v[24:27], v[96:99], 0
  ds_read_b64_tr_b16 v[16:17], v8 offset:2048
  ds_read_b64_tr_b16 v[18:19], v8 offset:2304
  ds_read_b64_tr_b16 v[20:21], v10 offset:2048
  ds_read_b64_tr_b16 v[22:23], v10 offset:2304
  ds_read_b64_tr_b16 v[24:25], v12 offset:2048
  ds_read_b64_tr_b16 v[26:27], v12 offset:2304
  s_waitcnt vmcnt(38) lgkmcnt(6)
  v_mfma_f32_32x32x16_bf16 a[0:15], v[28:31], v[100:103], a[0:15]
  v_mfma_f32_32x32x16_bf16 a[16:31], v[100:103], v[32:35], a[16:31]
  v_mfma_f32_32x32x16_bf16 a[32:47], v[36:39], v[100:103], a[32:47]
  ds_read_b64_tr_b16 v[28:29], v8 offset:3072
  ds_read_b64_tr_b16 v[30:31], v8 offset:3328
  ds_read_b64_tr_b16 v[32:33], v10 offset:3072
  ds_read_b64_tr_b16 v[34:35], v10 offset:3328
  ds_read_b64_tr_b16 v[36:37], v12 offset:3072
  ds_read_b64_tr_b16 v[38:39], v12 offset:3328
  s_waitcnt vmcnt(37) lgkmcnt(6)
  v_mfma_f32_32x32x16_bf16 a[0:15], v[16:19], v[104:107], a[0:15]
  v_mfma_f32_32x32x16_bf16 a[16:31], v[104:107], v[20:23], a[16:31]
  v_mfma_f32_32x32x16_bf16 a[32:47], v[24:27], v[104:107], a[32:47]
  ds_read_b64_tr_b16 v[16:17], v8 offset:4096
  ds_read_b64_tr_b16 v[18:19], v8 offset:4352
  ds_read_b64_tr_b16 v[20:21], v10 offset:4096
  ds_read_b64_tr_b16 v[22:23], v10 offset:4352
  ds_read_b64_tr_b16 v[24:25], v12 offset:4096
  ds_read_b64_tr_b16 v[26:27], v12 offset:4352
  s_waitcnt vmcnt(36) lgkmcnt(6)
  v_mfma_f32_32x32x16_bf16 a[0:15], v[28:31], v[108:111], a[0:15]
  v_mfma_f32_32x32x16_bf16 a[16:31], v[108:111], v[32:35], a[16:31]
  v_mfma_f32_32x32x16_bf16 a[32:47], v[36:39], v[108:111], a[32:47]
  ds_read_b64_tr_b16 v[28:29], v8 offset:5120
  ds_read_b64_tr_b16 v[30:31], v8 offset:5376
  ds_read_b64_tr_b16 v[32:33], v10 offset:5120
  ds_read_b64_tr_b16 v[34:35], v10 offset:5376
  ds_read_b64_tr_b16 v[36:37], v12 offset:5120
  ds_read_b64_tr_b16 v[38:39], v12 offset:5376
  s_waitcnt vmcnt(35) lgkmcnt(6)
  v_mfma_f32_32x32x16_bf16 a[0:15], v[16:19], v[112:115], a[0:15]
  v_mfma_f32_32x32x16_bf16 a[16:31], v[112:115], v[20:23], a[16:31]
  v_mfma_f32_32x32x16_bf16 a[32:47], v[24:27], v[112:115], a[32:47]
  ds_read_b64_tr_b16 v[16:17], v8 offset:6144
  ds_read_b64_tr_b16 v[18:19], v8 offset:6400
  ds_read_b64_tr_b16 v[20:21], v10 offset:6144
  ds_read_b64_tr_b16 v[22:23], v10 offset:6400
  ds_read_b64_tr_b16 v[24:25], v12 offset:6144
  ds_read_b64_tr_b16 v[26:27], v12 offset:6400
  s_waitcnt vmcnt(34) lgkmcnt(6)
  v_mfma_f32_32x32x16_bf16 a[0:15], v[28:31], v[116:119], a[0:15]
  v_mfma_f32_32x32x16_bf16 a[16:31], v[116:119], v[32:35], a[16:31]
  v_mfma_f32_32x32x16_bf16 a[32:47], v[36:39], v[116:119], a[32:47]
  ds_read_b64_tr_b16 v[28:29], v8 offset:7168
  ds_read_b64_tr_b16 v[30:31], v8 offset:7424
  ds_read_b64_tr_b16 v[32:33], v10 offset:7168
  ds_read_b64_tr_b16 v[34:35], v10 offset:7424
  ds_read_b64_tr_b16 v[36:37], v12 offset:7168
  ds_read_b64_tr_b16 v[38:39], v12 offset:7424
  s_waitcnt vmcnt(33) lgkmcnt(6)
  v_mfma_f32_32x32x16_bf16 a[0:15], v[16:19], v[120:123], a[0:15]
  v_mfma_f32_32x32x16_bf16 a[16:31], v[120:123], v[20:23], a[16:31]
  v_mfma_f32_32x32x16_bf16 a[32:47], v[24:27], v[120:123], a[32:47]
  ds_read_b64_tr_b16 v[16:17], v8 offset:8192
  ds_read_b64_tr_b16 v[18:19], v8 offset:8448
  ds_read_b64_tr_b16 v[20:21], v10 offset:8192
  ds_read_b64_tr_b16 v[22:23], v10 offset:8448
  ds_read_b64_tr_b16 v[24:25], v12 offset:8192
  ds_read_b64_tr_b16 v[26:27], v12 offset:8448
  s_waitcnt vmcnt(32) lgkmcnt(6)
  v_mfma_f32_32x32x16_bf16 a[0:15], v[28:31], v[124:127], a[0:15]
  v_mfma_f32_32x32x16_bf16 a[16:31], v[124:127], v[32:35], a[16:31]
  v_mfma_f32_32x32x16_bf16 a[32:47], v[36:39], v[124:127], a[32:47]
  ds_read_b64_tr_b16 v[28:29], v8 offset:9216
  ds_read_b64_tr_b16 v[30:31], v8 offset:9472
  ds_read_b64_tr_b16 v[32:33], v10 offset:9216
  ds_read_b64_tr_b16 v[34:35], v10 offset:9472
  ds_read_b64_tr_b16 v[36:37], v12 offset:9216
  ds_read_b64_tr_b16 v[38:39], v12 offset:9472
  s_waitcnt vmcnt(31) lgkmcnt(6)
  v_mfma_f32_32x32x16_bf16 a[0:15], v[16:19], v[128:131], a[0:15]
  v_mfma_f32_32x32x16_bf16 a[16:31], v[128:131], v[20:23], a[16:31]
  v_mfma_f32_32x32x16_bf16 a[32:47], v[24:27], v[128:131], a[32:47]
  ds_read_b64_tr_b16 v[16:17], v8 offset:10240
  ds_read_b64_tr_b16 v[18:19], v8 offset:10496
  ds_read_b64_tr_b16 v[20:21], v10 offset:10240
  ds_read_b64_tr_b16 v[22:23], v10 offset:10496
  ds_read_b64_tr_b16 v[24:25], v12 offset:10240
  ds_read_b64_tr_b16 v[26:27], v12 offset:10496
  s_waitcnt vmcnt(30) lgkmcnt(6)
  v_mfma_f32_32x32x16_bf16 a[0:15], v[28:31], v[132:135], a[0:15]
  v_mfma_f32_32x32x16_bf16 a[16:31], v[132:135], v[32:35], a[16:31]
  v_mfma_f32_32x32x16_bf16 a[32:47], v[36:39], v[132:135], a[32:47]
  ds_read_b64_tr_b16 v[28:29], v8 offset:11264
  ds_read_b64_tr_b16 v[30:31], v8 offset:11520
  ds_read_b64_tr_b16 v[32:33], v10 offset:11264
  ds_read_b64_tr_b16 v[34:35], v10 offset:11520
  ds_read_b64_tr_b16 v[36:37], v12 offset:11264
  ds_read_b64_tr_b16 v[38:39], v12 offset:11520
  s_waitcnt vmcnt(29) lgkmcnt(6)
  v_mfma_f32_32x32x16_bf16 a[0:15], v[16:19], v[136:139], a[0:15]
  v_mfma_f32_32x32x16_bf16 a[16:31], v[136:139], v[20:23], a[16:31]
  v_mfma_f32_32x32x16_bf16 a[32:47], v[24:27], v[136:139], a[32:47]
  ds_read_b64_tr_b16 v[16:17], v8 offset:12288
  ds_read_b64_tr_b16 v[18:19], v8 offset:12544
  ds_read_b64_tr_b16 v[20:21], v10 offset:12288
  ds_read_b64_tr_b16 v[22:23], v10 offset:12544
  ds_read_b64_tr_b16 v[24:25], v12 offset:12288
  ds_read_b64_tr_b16 v[26:27], v12 offset:12544
  s_waitcnt vmcnt(28) lgkmcnt(6)
  v_mfma_f32_32x32x16_bf16 a[0:15], v[28:31], v[140:143], a[0:15]
  v_mfma_f32_32x32x16_bf16 a[16:31], v[140:143], v[32:35], a[16:31]
  v_mfma_f32_32x32x16_bf16 a[32:47], v[36:39], v[140:143], a[32:47]
  ds_read_b64_tr_b16 v[28:29], v8 offset:13312
  ds_read_b64_tr_b16 v[30:31], v8 offset:13568
  ds_read_b64_tr_b16 v[32:33], v10 offset:13312
  ds_read_b64_tr_b16 v[34:35], v10 offset:13568
  ds_read_b64_tr_b16 v[36:37], v12 offset:13312
  ds_read_b64_tr_b16 v[38:39], v12 offset:13568
  s_waitcnt vmcnt(27) lgkmcnt(6)
  v_mfma_f32_32x32x16_bf16 a[0:15], v[16:19], v[144:147], a[0:15]
  v_mfma_f32_32x32x16_bf16 a[16:31], v[144:147], v[20:23], a[16:31]
  v_mfma_f32_32x32x16_bf16 a[32:47], v[24:27], v[144:147], a[32:47]
  ds_read_b64_tr_b16 v[16:17], v8 offset:14336
  ds_read_b64_tr_b16 v[18:19], v8 offset:14592
  ds_read_b64_tr_b16 v[20:21], v10 offset:14336
  ds_read_b64_tr_b16 v[22:23], v10 offset:14592
  ds_read_b64_tr_b16 v[24:25], v12 offset:14336
  ds_read_b64_tr_b16 v[26:27], v12 offset:14592
  s_waitcnt vmcnt(26) lgkmcnt(6)
  v_mfma_f32_32x32x16_bf16 a[0:15], v[28:31], v[148:151], a[0:15]
  v_mfma_f32_32x32x16_bf16 a[16:31], v[148:151], v[32:35], a[16:31]
  v_mfma_f32_32x32x16_bf16 a[32:47], v[36:39], v[148:151], a[32:47]
  ds_read_b64_tr_b16 v[28:29], v8 offset:15360
  ds_read_b64_tr_b16 v[30:31], v8 offset:15616
  ds_read_b64_tr_b16 v[32:33], v10 offset:15360
  ds_read_b64_tr_b16 v[34:35], v10 offset:15616
  ds_read_b64_tr_b16 v[36:37], v12 offset:15360
  ds_read_b64_tr_b16 v[38:39], v12 offset:15616
  s_waitcnt vmcnt(25) lgkmcnt(6)
  v_mfma_f32_32x32x16_bf16 a[0:15], v[16:19], v[152:155], a[0:15]
  v_mfma_f32_32x32x16_bf16 a[16:31], v[152:155], v[20:23], a[16:31]
  v_mfma_f32_32x32x16_bf16 a[32:47], v[24:27], v[152:155], a[32:47]
  ds_read_b64_tr_b16 v[16:17], v8 offset:16384
  ds_read_b64_tr_b16 v[18:19], v8 offset:16640
  ds_read_b64_tr_b16 v[20:21], v10 offset:16384
  ds_read_b64_tr_b16 v[22:23], v10 offset:16640
  ds_read_b64_tr_b16 v[24:25], v12 offset:16384
  ds_read_b64_tr_b16 v[26:27], v12 offset:16640
  s_waitcnt vmcnt(24) lgkmcnt(6)
  v_mfma_f32_32x32x16_bf16 a[0:15], v[28:31], v[156:159], a[0:15]
  v_mfma_f32_32x32x16_bf16 a[16:31], v[156:159], v[32:35], a[16:31]
  v_mfma_f32_32x32x16_bf16 a[32:47], v[36:39], v[156:159], a[32:47]
  ds_read_b64_tr_b16 v[28:29], v8 offset:17408
  ds_read_b64_tr_b16 v[30:31], v8 offset:17664
  ds_read_b64_tr_b16 v[32:33], v10 offset:17408
  ds_read_b64_tr_b16 v[34:35], v10 offset:17664
  ds_read_b64_tr_b16 v[36:37], v12 offset:17408
  ds_read_b64_tr_b16 v[38:39], v12 offset:17664
  s_waitcnt vmcnt(23) lgkmcnt(6)
  v_mfma_f32_32x32x16_bf16 a[0:15], v[16:19], v[160:163], a[0:15]
  v_mfma_f32_32x32x16_bf16 a[16:31], v[160:163], v[20:23], a[16:31]
  v_mfma_f32_32x32x16_bf16 a[32:47], v[24:27], v[160:163], a[32:47]
  ds_read_b64_tr_b16 v[16:17], v8 offset:18432
  ds_read_b64_tr_b16 v[18:19], v8 offset:18688
  ds_read_b64_tr_b16 v[20:21], v10 offset:18432
  ds_read_b64_tr_b16 v[22:23], v10 offset:18688
  ds_read_b64_tr_b16 v[24:25], v12 offset:18432
  ds_read_b64_tr_b16 v[26:27], v12 offset:18688
  s_waitcnt vmcnt(22) lgkmcnt(6)
  v_mfma_f32_32x32x16_bf16 a[0:15], v[28:31], v[164:167], a[0:15]
  v_mfma_f32_32x32x16_bf16 a[16:31], v[164:167], v[32:35], a[16:31]
  v_mfma_f32_32x32x16_bf16 a[32:47], v[36:39], v[164:167], a[32:47]
  ds_read_b64_tr_b16 v[28:29], v8 offset:19456
  ds_read_b64_tr_b16 v[30:31], v8 offset:19712
  ds_read_b64_tr_b16 v[32:33], v10 offset:19456
  ds_read_b64_tr_b16 v[34:35], v10 offset:19712
  ds_read_b64_tr_b16 v[36:37], v12 offset:19456
  ds_read_b64_tr_b16 v[38:39], v12 offset:19712
  s_waitcnt vmcnt(21) lgkmcnt(6)
  v_mfma_f32_32x32x16_bf16 a[0:15], v[16:19], v[168:171], a[0:15]
  v_mfma_f32_32x32x16_bf16 a[16:31], v[168:171], v[20:23], a[16:31]
  v_mfma_f32_32x32x16_bf16 a[32:47], v[24:27], v[168:171], a[32:47]
  ds_read_b64_tr_b16 v[16:17], v8 offset:20480
  ds_read_b64_tr_b16 v[18:19], v8 offset:20736
  ds_read_b64_tr_b16 v[20:21], v10 offset:20480
  ds_read_b64_tr_b16 v[22:23], v10 offset:20736
  ds_read_b64_tr_b16 v[24:25], v12 offset:20480
  ds_read_b64_tr_b16 v[26:27], v12 offset:20736
  s_waitcnt vmcnt(20) lgkmcnt(6)
  v_mfma_f32_32x32x16_bf16 a[0:15], v[28:31], v[172:175], a[0:15]
  v_mfma_f32_32x32x16_bf16 a[16:31], v[172:175], v[32:35], a[16:31]
  v_mfma_f32_32x32x16_bf16 a[32:47], v[36:39], v[172:175], a[32:47]
  ds_read_b64_tr_b16 v[28:29], v8 offset:21504
  ds_read_b64_tr_b16 v[30:31], v8 offset:21760
  ds_read_b64_tr_b16 v[32:33], v10 offset:21504
  ds_read_b64_tr_b16 v[34:35], v10 offset:21760
  ds_read_b64_tr_b16 v[36:37], v12 offset:21504
  ds_read_b64_tr_b16 v[38:39], v12 offset:21760
  s_waitcnt vmcnt(19) lgkmcnt(6)
  v_mfma_f32_32x32x16_bf16 a[0:15], v[16:19], v[176:179], a[0:15]
  v_mfma_f32_32x32x16_bf16 a[16:31], v[176:179], v[20:23], a[16:31]
  v_mfma_f32_32x32x16_bf16 a[32:47], v[24:27], v[176:179], a[32:47]
  ds_read_b64_tr_b16 v[16:17], v8 offset:22528
  ds_read_b64_tr_b16 v[18:19], v8 offset:22784
  ds_read_b64_tr_b16 v[20:21], v10 offset:22528
  ds_read_b64_tr_b16 v[22:23], v10 offset:22784
  ds_read_b64_tr_b16 v[24:25], v12 offset:22528
  ds_read_b64_tr_b16 v[26:27], v12 offset:22784
  s_waitcnt vmcnt(18) lgkmcnt(6)
  v_mfma_f32_32x32x16_bf16 a[0:15], v[28:31], v[180:183], a[0:15]
  v_mfma_f32_32x32x16_bf16 a[16:31], v[180:183], v[32:35], a[16:31]
  v_mfma_f32_32x32x16_bf16 a[32:47], v[36:39], v[180:183], a[32:47]
  ds_read_b64_tr_b16 v[28:29], v8 offset:23552
  ds_read_b64_tr_b16 v[30:31], v8 offset:23808
  ds_read_b64_tr_b16 v[32:33], v10 offset:23552
  ds_read_b64_tr_b16 v[34:35], v10 offset:23808
  ds_read_b64_tr_b16 v[36:37], v12 offset:23552
  ds_read_b64_tr_b16 v[38:39], v12 offset:23808
  s_waitcnt vmcnt(17) lgkmcnt(6)
  v_mfma_f32_32x32x16_bf16 a[0:15], v[16:19], v[184:187], a[0:15]
  v_mfma_f32_32x32x16_bf16 a[16:31], v[184:187], v[20:23], a[16:31]
  v_mfma_f32_32x32x16_bf16 a[32:47], v[24:27], v[184:187], a[32:47]
  ds_read_b64_tr_b16 v[16:17], v8 offset:24576
  ds_read_b64_tr_b16 v[18:19], v8 offset:24832
  ds_read_b64_tr_b16 v[20:21], v10 offset:24576
  ds_read_b64_tr_b16 v[22:23], v10 offset:24832
  ds_read_b64_tr_b16 v[24:25], v12 offset:24576
  ds_read_b64_tr_b16 v[26:27], v12 offset:24832
  s_waitcnt vmcnt(16) lgkmcnt(6)
  v_mfma_f32_32x32x16_bf16 a[0:15], v[28:31], v[188:191], a[0:15]
  v_mfma_f32_32x32x16_bf16 a[16:31], v[188:191], v[32:35], a[16:31]
  v_mfma_f32_32x32x16_bf16 a[32:47], v[36:39], v[188:191], a[32:47]
  ds_read_b64_tr_b16 v[28:29], v8 offset:25600
  ds_read_b64_tr_b16 v[30:31], v8 offset:25856
  ds_read_b64_tr_b16 v[32:33], v10 offset:25600
  ds_read_b64_tr_b16 v[34:35], v10 offset:25856
  ds_read_b64_tr_b16 v[36:37], v12 offset:25600
  ds_read_b64_tr_b16 v[38:39], v12 offset:25856
  s_waitcnt vmcnt(15) lgkmcnt(6)
  v_mfma_f32_32x32x16_bf16 a[0:15], v[16:19], v[192:195], a[0:15]
  v_mfma_f32_32x32x16_bf16 a[16:31], v[192:195], v[20:23], a[16:31]
  v_mfma_f32_32x32x16_bf16 a[32:47], v[24:27], v[192:195], a[32:47]
  ds_read_b64_tr_b16 v[16:17], v8 offset:26624
  ds_read_b64_tr_b16 v[18:19], v8 offset:26880
  ds_read_b64_tr_b16 v[20:21], v10 offset:26624
  ds_read_b64_tr_b16 v[22:23], v10 offset:26880
  ds_read_b64_tr_b16 v[24:25], v12 offset:26624
  ds_read_b64_tr_b16 v[26:27], v12 offset:26880
  s_waitcnt vmcnt(14) lgkmcnt(6)
  v_mfma_f32_32x32x16_bf16 a[0:15], v[28:31], v[196:199], a[0:15]
  v_mfma_f32_32x32x16_bf16 a[16:31], v[196:199], v[32:35], a[16:31]
  v_mfma_f32_32x32x16_bf16 a[32:47], v[36:39], v[196:199], a[32:47]
  ds_read_b64_tr_b16 v[28:29], v8 offset:27648
  ds_read_b64_tr_b16 v[30:31], v8 offset:27904
  ds_read_b64_tr_b16 v[32:33], v10 offset:27648
  ds_read_b64_tr_b16 v[34:35], v10 offset:27904
  ds_read_b64_tr_b16 v[36:37], v12 offset:27648
  ds_read_b64_tr_b16 v[38:39], v12 offset:27904
  s_waitcnt vmcnt(13) lgkmcnt(6)
  v_mfma_f32_32x32x16_bf16 a[0:15], v[16:19], v[200:203], a[0:15]
  v_mfma_f32_32x32x16_bf16 a[16:31], v[200:203], v[20:23], a[16:31]
  v_mfma_f32_32x32x16_bf16 a[32:47], v[24:27], v[200:203], a[32:47]
  ds_read_b64_tr_b16 v[16:17], v8 offset:28672
  ds_read_b64_tr_b16 v[18:19], v8 offset:28928
  ds_read_b64_tr_b16 v[20:21], v10 offset:28672
  ds_read_b64_tr_b16 v[22:23], v10 offset:28928
  ds_read_b64_tr_b16 v[24:25], v12 offset:28672
  ds_read_b64_tr_b16 v[26:27], v12 offset:28928
  s_waitcnt vmcnt(12) lgkmcnt(6)
  v_mfma_f32_32x32x16_bf16 a[0:15], v[28:31], v[204:207], a[0:15]
  v_mfma_f32_32x32x16_bf16 a[16:31], v[204:207], v[32:35], a[16:31]
  v_mfma_f32_32x32x16_bf16 a[32:47], v[36:39], v[204:207], a[32:47]
  ds_read_b64_tr_b16 v[28:29], v8 offset:29696
  ds_read_b64_tr_b16 v[30:31], v8 offset:29952
  ds_read_b64_tr_b16 v[32:33], v10 offset:29696
  ds_read_b64_tr_b16 v[34:35], v10 offset:29952
  ds_read_b64_tr_b16 v[36:37], v12 offset:29696
  ds_read_b64_tr_b16 v[38:39], v12 offset:29952
  s_waitcnt vmcnt(11) lgkmcnt(6)
  v_mfma_f32_32x32x16_bf16 a[0:15], v[16:19], v[208:211], a[0:15]
  v_mfma_f32_32x32x16_bf16 a[16:31], v[208:211], v[20:23], a[16:31]
  v_mfma_f32_32x32x16_bf16 a[32:47], v[24:27], v[208:211], a[32:47]
  ds_read_b64_tr_b16 v[16:17], v8 offset:30720
  ds_read_b64_tr_b16 v[18:19], v8 offset:30976
  ds_read_b64_tr_b16 v[20:21], v10 offset:30720
  ds_read_b64_tr_b16 v[22:23], v10 offset:30976
  ds_read_b64_tr_b16 v[24:25], v12 offset:30720
  ds_read_b64_tr_b16 v[26:27], v12 offset:30976
  s_waitcnt vmcnt(10) lgkmcnt(6)
  v_mfma_f32_32x32x16_bf16 a[0:15], v[28:31], v[212:215], a[0:15]
  v_mfma_f32_32x32x16_bf16 a[16:31], v[212:215], v[32:35], a[16:31]
  v_mfma_f32_32x32x16_bf16 a[32:47], v[36:39], v[212:215], a[32:47]
  ds_read_b64_tr_b16 v[28:29], v8 offset:31744
  ds_read_b64_tr_b16 v[30:31], v8 offset:32000
  ds_read_b64_tr_b16 v[32:33], v10 offset:31744
  ds_read_b64_tr_b16 v[34:35], v10 offset:32000
  ds_read_b64_tr_b16 v[36:37], v12 offset:31744
  ds_read_b64_tr_b16 v[38:39], v12 offset:32000
  s_waitcnt vmcnt(9) lgkmcnt(6)
  v_mfma_f32_32x32x16_bf16 a[0:15], v[16:19], v[216:219], a[0:15]
  v_mfma_f32_32x32x16_bf16 a[16:31], v[216:219], v[20:23], a[16:31]
  v_mfma_f32_32x32x16_bf16 a[32:47], v[24:27], v[216:219], a[32:47]
  ds_read_b64_tr_b16 v[16:17], v8 offset:32768
  ds_read_b64_tr_b16 v[18:19], v8 offset:33024
  ds_read_b64_tr_b16 v[20:21], v10 offset:32768
  ds_read_b64_tr_b16 v[22:23], v10 offset:33024
  ds_read_b64_tr_b16 v[24:25], v12 offset:32768
  ds_read_b64_tr_b16 v[26:27], v12 offset:33024
  s_waitcnt vmcnt(8) lgkmcnt(6)
  v_mfma_f32_32x32x16_bf16 a[0:15], v[28:31], v[220:223], a[0:15]
  v_mfma_f32_32x32x16_bf16 a[16:31], v[220:223], v[32:35], a[16:31]
  v_mfma_f32_32x32x16_bf16 a[32:47], v[36:39], v[220:223], a[32:47]
  ds_read_b64_tr_b16 v[28:29], v8 offset:33792
  ds_read_b64_tr_b16 v[30:31], v8 offset:34048
  ds_read_b64_tr_b16 v[32:33], v10 offset:33792
  ds_read_b64_tr_b16 v[34:35], v10 offset:34048
  ds_read_b64_tr_b16 v[36:37], v12 offset:33792
  ds_read_b64_tr_b16 v[38:39], v12 offset:34048
  s_waitcnt vmcnt(7) lgkmcnt(6)
  v_mfma_f32_32x32x16_bf16 a[0:15], v[16:19], v[224:227], a[0:15]
  v_mfma_f32_32x32x16_bf16 a[16:31], v[224:227], v[20:23], a[16:31]
  v_mfma_f32_32x32x16_bf16 a[32:47], v[24:27], v[224:227], a[32:47]
  ds_read_b64_tr_b16 v[16:17], v8 offset:34816
  ds_read_b64_tr_b16 v[18:19], v8 offset:35072
  ds_read_b64_tr_b16 v[20:21], v10 offset:34816
  ds_read_b64_tr_b16 v[22:23], v10 offset:35072
  ds_read_b64_tr_b16 v[24:25], v12 offset:34816
  ds_read_b64_tr_b16 v[26:27], v12 offset:35072
  s_waitcnt vmcnt(6) lgkmcnt(6)
  v_mfma_f32_32x32x16_bf16 a[0:15], v[28:31], v[228:231], a[0:15]
  v_mfma_f32_32x32x16_bf16 a[16:31], v[228:231], v[32:35], a[16:31]
  v_mfma_f32_32x32x16_bf16 a[32:47], v[36:39], v[228:231], a[32:47]
  ds_read_b64_tr_b16 v[28:29], v8 offset:35840
  ds_read_b64_tr_b16 v[30:31], v8 offset:36096
  ds_read_b64_tr_b16 v[32:33], v10 offset:35840
  ds_read_b64_tr_b16 v[34:35], v10 offset:36096
  ds_read_b64_tr_b16 v[36:37], v12 offset:35840
  ds_read_b64_tr_b16 v[38:39], v12 offset:36096
  s_waitcnt vmcnt(5) lgkmcnt(6)
  v_mfma_f32_32x32x16_bf16 a[0:15], v[16:19], v[232:235], a[0:15]
  v_mfma_f32_32x32x16_bf16 a[16:31], v[232:235], v[20:23], a[16:31]
  v_mfma_f32_32x32x16_bf16 a[32:47], v[24:27], v[232:235], a[32:47]
  ds_read_b64_tr_b16 v[16:17], v8 offset:36864
  ds_read_b64_tr_b16 v[18:19], v8 offset:37120
  ds_read_b64_tr_b16 v[20:21], v10 offset:36864
  ds_read_b64_tr_b16 v[22:23], v10 offset:37120
  ds_read_b64_tr_b16 v[24:25], v12 offset:36864
  ds_read_b64_tr_b16 v[26:27], v12 offset:37120
  s_waitcnt vmcnt(4) lgkmcnt(6)
  v_mfma_f32_32x32x16_bf16 a[0:15], v[28:31], v[236:239], a[0:15]
  v_mfma_f32_32x32x16_bf16 a[16:31], v[236:239], v[32:35], a[16:31]
  v_mfma_f32_32x32x16_bf16 a[32:47], v[36:39], v[236:239], a[32:47]
  ds_read_b64_tr_b16 v[28:29], v8 offset:37888
  ds_read_b64_tr_b16 v[30:31], v8 offset:38144
  ds_read_b64_tr_b16 v[32:33], v10 offset:37888
  ds_read_b64_tr_b16 v[34:35], v10 offset:38144
  ds_read_b64_tr_b16 v[36:37], v12 offset:37888
  ds_read_b64_tr_b16 v[38:39], v12 offset:38144
  s_waitcnt vmcnt(3) lgkmcnt(6)
  v_mfma_f32_32x32x16_bf16 a[0:15], v[16:19], v[240:243], a[0:15]
  v_mfma_f32_32x32x16_bf16 a[16:31], v[240:243], v[20:23], a[16:31]
  v_mfma_f32_32x32x16_bf16 a[32:47], v[24:27], v[240:243], a[32:47]
  ds_read_b64_tr_b16 v[16:17], v8 offset:38912
  ds_read_b64_tr_b16 v[18:19], v8 offset:39168
  ds_read_b64_tr_b16 v[20:21], v10 offset:38912
  ds_read_b64_tr_b16 v[22:23], v10 offset:39168
  ds_read_b64_tr_b16 v[24:25], v12 offset:38912
  ds_read_b64_tr_b16 v[26:27], v12 offset:39168
  s_waitcnt vmcnt(2) lgkmcnt(6)
  v_mfma_f32_32x32x16_bf16 a[0:15], v[28:31], v[244:247], a[0:15]
  v_mfma_f32_32x32x16_bf16 a[16:31], v[244:247], v[32:35], a[16:31]
  v_mfma_f32_32x32x16_bf16 a[32:47], v[36:39], v[244:247], a[32:47]
  ds_read_b64_tr_b16 v[28:29], v8 offset:39936
  ds_read_b64_tr_b16 v[30:31], v8 offset:40192
  ds_read_b64_tr_b16 v[32:33], v10 offset:39936
  ds_read_b64_tr_b16 v[34:35], v10 offset:40192
  ds_read_b64_tr_b16 v[36:37], v12 offset:39936
  ds_read_b64_tr_b16 v[38:39], v12 offset:40192
  s_waitcnt vmcnt(1) lgkmcnt(6)
  v_mfma_f32_32x32x16_bf16 a[0:15], v[16:19], v[248:251], a[0:15]
  v_mfma_f32_32x32x16_bf16 a[16:31], v[248:251], v[20:23], a[16:31]
  v_mfma_f32_32x32x16_bf16 a[32:47], v[24:27], v[248:251], a[32:47]
  s_waitcnt vmcnt(0) lgkmcnt(0)
  v_mfma_f32_32x32x16_bf16 a[0:15], v[28:31], v[252:255], a[0:15]
  v_mfma_f32_32x32x16_bf16 a[16:31], v[252:255], v[32:35], a[16:31]
  v_mfma_f32_32x32x16_bf16 a[32:47], v[36:39], v[252:255], a[32:47]
  v_accvgpr_read_b32 v40, a0
  v_accvgpr_read_b32 v41, a1
  v_accvgpr_read_b32 v42, a2
  v_accvgpr_read_b32 v43, a3
  v_accvgpr_read_b32 v44, a4
  v_accvgpr_read_b32 v45, a5
  v_accvgpr_read_b32 v46, a6
  v_accvgpr_read_b32 v47, a7
  v_accvgpr_read_b32 v48, a8
  v_accvgpr_read_b32 v49, a9
  v_accvgpr_read_b32 v50, a10
  v_accvgpr_read_b32 v51, a11
  v_accvgpr_read_b32 v52, a12
  v_accvgpr_read_b32 v53, a13
  v_accvgpr_read_b32 v54, a14
  v_accvgpr_read_b32 v55, a15
  v_cvt_pk_bf16_f32 v56, v40, v41
  v_cvt_pk_bf16_f32 v57, v42, v43
  v_cvt_pk_bf16_f32 v58, v44, v45
  v_cvt_pk_bf16_f32 v59, v46, v47
  v_cvt_pk_bf16_f32 v60, v48, v49
  v_cvt_pk_bf16_f32 v61, v50, v51
  v_cvt_pk_bf16_f32 v62, v52, v53
  v_cvt_pk_bf16_f32 v63, v54, v55
  s_add_u32 s25, s28, 19922944
  buffer_store_dwordx4 v[56:59], v2, s[4:7], s25 offen sc1
  buffer_store_dwordx4 v[60:63], v2, s[4:7], s25 offen offset:1024 sc1
  v_accvgpr_read_b32 v40, a16
  v_accvgpr_read_b32 v41, a17
  v_accvgpr_read_b32 v42, a18
  v_accvgpr_read_b32 v43, a19
  v_accvgpr_read_b32 v44, a20
  v_accvgpr_read_b32 v45, a21
  v_accvgpr_read_b32 v46, a22
  v_accvgpr_read_b32 v47, a23
  v_accvgpr_read_b32 v48, a24
  v_accvgpr_read_b32 v49, a25
  v_accvgpr_read_b32 v50, a26
  v_accvgpr_read_b32 v51, a27
  v_accvgpr_read_b32 v52, a28
  v_accvgpr_read_b32 v53, a29
  v_accvgpr_read_b32 v54, a30
  v_accvgpr_read_b32 v55, a31
  v_cvt_pk_bf16_f32 v64, v40, v41
  v_cvt_pk_bf16_f32 v65, v42, v43
  v_cvt_pk_bf16_f32 v66, v44, v45
  v_cvt_pk_bf16_f32 v67, v46, v47
  v_cvt_pk_bf16_f32 v68, v48, v49
  v_cvt_pk_bf16_f32 v69, v50, v51
  v_cvt_pk_bf16_f32 v70, v52, v53
  v_cvt_pk_bf16_f32 v71, v54, v55
  s_add_u32 s25, s28, 36700160
  buffer_store_dwordx4 v[64:67], v7, s[4:7], s25 offen sc1
  buffer_store_dwordx4 v[68:71], v7, s[4:7], s25 offen offset:1024 sc1
  v_accvgpr_read_b32 v40, a32
  v_accvgpr_read_b32 v41, a33
  v_accvgpr_read_b32 v42, a34
  v_accvgpr_read_b32 v43, a35
  v_accvgpr_read_b32 v44, a36
  v_accvgpr_read_b32 v45, a37
  v_accvgpr_read_b32 v46, a38
  v_accvgpr_read_b32 v47, a39
  v_accvgpr_read_b32 v48, a40
  v_accvgpr_read_b32 v49, a41
  v_accvgpr_read_b32 v50, a42
  v_accvgpr_read_b32 v51, a43
  v_accvgpr_read_b32 v52, a44
  v_accvgpr_read_b32 v53, a45
  v_accvgpr_read_b32 v54, a46
  v_accvgpr_read_b32 v55, a47
  v_cvt_pk_bf16_f32 v72, v40, v41
  v_cvt_pk_bf16_f32 v73, v42, v43
  v_cvt_pk_bf16_f32 v74, v44, v45
  v_cvt_pk_bf16_f32 v75, v46, v47
  v_cvt_pk_bf16_f32 v76, v48, v49
  v_cvt_pk_bf16_f32 v77, v50, v51
  v_cvt_pk_bf16_f32 v78, v52, v53
  v_cvt_pk_bf16_f32 v79, v54, v55
  s_add_u32 s25, s28, 53477376
  buffer_store_dwordx4 v[72:75], v2, s[4:7], s25 offen sc1
  buffer_store_dwordx4 v[76:79], v2, s[4:7], s25 offen offset:1024 sc1
  s_add_u32 s28, s28, 1048576
  s_waitcnt vmcnt(0)
  s_barrier
  s_cmp_eq_u32 s17, 0
  s_cselect_b32 s25, s31, 2147479552
  s_mov_b64 exec, 1
  v_mov_b32 v4, 1
  buffer_atomic_add v4, off, s[4:7], s25
  s_mov_b64 exec, -1
  s_add_u32 s31, s31, 4
  s_add_u32 s22, s22, 1
  s_cmp_lt_u32 s22, 2
  s_cbranch_scc1 Lwqf_19
  s_mov_b32 s81, s27
  s_mov_b32 s82, s28
  s_mov_b32 s72, s31
  s_mov_b32 s73, s34
  v_lshrrev_b32 v3, 3, v0
  v_lshlrev_b32 v6, 9, v3
  v_and_b32 v3, 7, v0
  v_lshl_add_u32 v6, v3, 4, v6
  v_lshlrev_b32 v8, 4, v3
  v_add_u32 v8, 122880, v8
  s_lshl_b32 s24, s17, 2
  v_add_u32 v7, s24, v8
  s_cmp_lt_u32 s17, 2
  s_cselect_b32 s34, 1.0, 0
  s_mov_b32 s26, 0x60000000
  s_cselect_b32 s26, 32768, s26
  s_add_u32 s21, s51, 32
Llnf_21:
  s_lshr_b32 s24, s21, 4
  s_lshl_b32 s22, s24, 7
  s_lshr_b32 s27, s21, 2
  s_mul_i32 s27, s27, 40960
  s_and_b32 s24, s21, 3
  s_lshl_b32 s24, s24, 7
  s_add_u32 s27, s27, s24
  s_mov_b32 s68, s64
  s_and_b32 s69, s65, 0xffff
  s_mov_b32 s70, 2621440
  s_mov_b32 s71, 0x00020000
  s_lshr_b32 s25, s21, 2
  s_lshl_b32 s25, s25, 5
  s_and_b32 s24, s21, 3
  s_lshl_b32 s24, s24, 2
  s_add_u32 s25, s25, s24
  s_mul_i32 s25, s25, 1280
  v_bfe_u32 v3, v0, 2, 1
  v_lshlrev_b32 v3, 4, v3
  v_and_b32 v4, 3, v0
  v_add_u32 v3, v3, v4
  v_mul_u32_u24 v3, 0x500, v3
  v_lshrrev_b32 v4, 3, v0
  v_lshl_add_u32 v3, v4, 4, v3
  s_add_u32 s24, s25, s26
  s_cmp_lt_u32 s17, 2
  s_cselect_b32 s24, s25, s24
  buffer_load_dwordx4 v[12:15], v3, s[68:71], s25 offen offset:0
  buffer_load_dwordx4 v[16:19], v3, s[68:71], s25 offen offset:512
  buffer_load_dwordx4 v[20:23], v3, s[68:71], s24 offen offset:1024
  s_waitcnt vmcnt(0)
  v_lshlrev_b32 v24, 16, v12
  v_and_b32 v25, 0xffff0000, v12
  v_lshlrev_b32 v26, 16, v13
  v_and_b32 v27, 0xffff0000, v13
  v_lshlrev_b32 v28, 16, v14
  v_and_b32 v29, 0xffff0000, v14
  v_lshlrev_b32 v30, 16, v15
  v_and_b32 v31, 0xffff0000, v15
  v_lshlrev_b32 v32, 16, v16
  v_and_b32 v33, 0xffff0000, v16
  v_lshlrev_b32 v34, 16, v17
  v_and_b32 v35, 0xffff0000, v17
  v_lshlrev_b32 v36, 16, v18
  v_and_b32 v37, 0xffff0000, v18
  v_lshlrev_b32 v38, 16, v19
  v_and_b32 v39, 0xffff0000, v19
  v_lshlrev_b32 v40, 16, v20
  v_and_b32 v41, 0xffff0000, v20
  v_lshlrev_b32 v42, 16, v21
  v_and_b32 v43, 0xffff0000, v21
  v_lshlrev_b32 v44, 16, v22
  v_and_b32 v45, 0xffff0000, v22
  v_lshlrev_b32 v46, 16, v23
  v_and_b32 v47, 0xffff0000, v23
  v_add_f32 v9, v24, v25
  v_add_f32 v10, v26, v27
  v_add_f32 v9, v9, v28
  v_add_f32 v10, v10, v29
  v_add_f32 v9, v9, v30
  v_add_f32 v10, v10, v31
  v_add_f32 v9, v9, v32
  v_add_f32 v10, v10, v33
  v_add_f32 v9, v9, v34
  v_add_f32 v10, v10, v35
  v_add_f32 v9, v9, v36
  v_add_f32 v10, v10, v37
  v_add_f32 v9, v9, v38
  v_add_f32 v10, v10, v39
  v_add_f32 v9, v9, v40
  v_add_f32 v10, v10, v41
  v_add_f32 v9, v9, v42
  v_add_f32 v10, v10, v43
  v_add_f32 v9, v9, v44
  v_add_f32 v10, v10, v45
  v_add_f32 v9, v9, v46
  v_add_f32 v10, v10, v47
  v_add_f32 v9, v9, v10
  s_nop 1
  v_add_f32_dpp v9, v9, v9 row_ror:8 row_mask:0xf bank_mask:0xf
  v_mov_b32 v10, v9
  s_nop 1
  v_permlane16_swap_b32 v9, v10
  v_add_f32 v9, v9, v10
  v_mov_b32 v10, v9
  s_nop 1
  v_permlane32_swap_b32 v9, v10
  v_add_f32 v9, v9, v10
  ds_write_b32 v7, v9 offset:0
  s_waitcnt lgkmcnt(0)
  s_barrier
  ds_read_b128 v[48:51], v8 offset:0
  s_waitcnt lgkmcnt(0)
  v_add_f32 v48, v48, v49
  v_add_f32 v50, v50, v51
  v_add_f32 v9, v48, v50
  v_mul_f32 v9, 0x3acccccd, v9
  v_mov_b32 v11, 0
  v_mov_b32 v52, 0
  v_sub_f32 v10, v24, v9
  v_fmac_f32 v11, v10, v10
  v_sub_f32 v10, v25, v9
  v_fmac_f32 v11, v10, v10
  v_sub_f32 v10, v26, v9
  v_fmac_f32 v11, v10, v10
  v_sub_f32 v10, v27, v9
  v_fmac_f32 v11, v10, v10
  v_sub_f32 v10, v28, v9
  v_fmac_f32 v11, v10, v10
  v_sub_f32 v10, v29, v9
  v_fmac_f32 v11, v10, v10
  v_sub_f32 v10, v30, v9
  v_fmac_f32 v11, v10, v10
  v_sub_f32 v10, v31, v9
  v_fmac_f32 v11, v10, v10
  v_sub_f32 v10, v32, v9
  v_fmac_f32 v11, v10, v10
  v_sub_f32 v10, v33, v9
  v_fmac_f32 v11, v10, v10
  v_sub_f32 v10, v34, v9
  v_fmac_f32 v11, v10, v10
  v_sub_f32 v10, v35, v9
  v_fmac_f32 v11, v10, v10
  v_sub_f32 v10, v36, v9
  v_fmac_f32 v11, v10, v10
  v_sub_f32 v10, v37, v9
  v_fmac_f32 v11, v10, v10
  v_sub_f32 v10, v38, v9
  v_fmac_f32 v11, v10, v10
  v_sub_f32 v10, v39, v9
  v_fmac_f32 v11, v10, v10
  v_sub_f32 v10, v40, v9
  v_fmac_f32 v52, v10, v10
  v_sub_f32 v10, v41, v9
  v_fmac_f32 v52, v10, v10
  v_sub_f32 v10, v42, v9
  v_fmac_f32 v52, v10, v10
  v_sub_f32 v10, v43, v9
  v_fmac_f32 v52, v10, v10
  v_sub_f32 v10, v44, v9
  v_fmac_f32 v52, v10, v10
  v_sub_f32 v10, v45, v9
  v_fmac_f32 v52, v10, v10
  v_sub_f32 v10, v46, v9
  v_fmac_f32 v52, v10, v10
  v_sub_f32 v10, v47, v9
  v_fmac_f32 v52, v10, v10
  v_fmac_f32 v11, s34, v52
  s_nop 1
  v_add_f32_dpp v11, v11, v11 row_ror:8 row_mask:0xf bank_mask:0xf
  v_mov_b32 v10, v11
  s_nop 1
  v_permlane16_swap_b32 v11, v10
  v_add_f32 v11, v11, v10
  v_mov_b32 v10, v11
  s_nop 1
  v_permlane32_swap_b32 v11, v10
  v_add_f32 v11, v11, v10
  ds_write_b32 v7, v11 offset:128
  s_waitcnt lgkmcnt(0)
  s_barrier
  ds_read_b128 v[48:51], v8 offset:128
  s_waitcnt lgkmcnt(0)
  v_add_f32 v48, v48, v49
  v_add_f32 v50, v50, v51
  v_add_f32 v11, v48, v50
  v_mul_f32 v11, 0x3acccccd, v11
  v_cvt_pk_bf16_f32 v9, v9, v9
  v_and_b32 v9, 0xffff0000, v9
  v_cvt_pk_bf16_f32 v11, v11, v11
  v_and_b32 v11, 0xffff0000, v11
  v_add_f32 v11, 0x3727c5ac, v11
  v_cvt_pk_bf16_f32 v11, v11, v11
  v_and_b32 v11, 0xffff0000, v11
  v_sqrt_f32 v11, v11
  s_nop 0
  v_cvt_pk_bf16_f32 v11, v11, v11
  v_and_b32 v11, 0xffff0000, v11
  v_rcp_f32 v11, v11
  v_sub_f32 v24, v24, v9
  v_sub_f32 v25, v25, v9
  v_cvt_pk_bf16_f32 v12, v24, v25
  v_sub_f32 v26, v26, v9
  v_sub_f32 v27, v27, v9
  v_cvt_pk_bf16_f32 v13, v26, v27
  v_sub_f32 v28, v28, v9
  v_sub_f32 v29, v29, v9
  v_cvt_pk_bf16_f32 v14, v28, v29
  v_sub_f32 v30, v30, v9
  v_sub_f32 v31, v31, v9
  v_cvt_pk_bf16_f32 v15, v30, v31
  v_sub_f32 v32, v32, v9
  v_sub_f32 v33, v33, v9
  v_cvt_pk_bf16_f32 v16, v32, v33
  v_sub_f32 v34, v34, v9
  v_sub_f32 v35, v35, v9
  v_cvt_pk_bf16_f32 v17, v34, v35
  v_sub_f32 v36, v36, v9
  v_sub_f32 v37, v37, v9
  v_cvt_pk_bf16_f32 v18, v36, v37
  v_sub_f32 v38, v38, v9
  v_sub_f32 v39, v39, v9
  v_cvt_pk_bf16_f32 v19, v38, v39
  v_sub_f32 v40, v40, v9
  v_sub_f32 v41, v41, v9
  v_cvt_pk_bf16_f32 v20, v40, v41
  v_sub_f32 v42, v42, v9
  v_sub_f32 v43, v43, v9
  v_cvt_pk_bf16_f32 v21, v42, v43
  v_sub_f32 v44, v44, v9
  v_sub_f32 v45, v45, v9
  v_cvt_pk_bf16_f32 v22, v44, v45
  v_sub_f32 v46, v46, v9
  v_sub_f32 v47, v47, v9
  v_cvt_pk_bf16_f32 v23, v46, v47
  v_lshlrev_b32 v24, 16, v12
  v_and_b32 v25, 0xffff0000, v12
  v_mul_f32 v24, v24, v11
  v_mul_f32 v25, v25, v11
  v_cvt_pk_bf16_f32 v12, v24, v25
  v_lshlrev_b32 v26, 16, v13
  v_and_b32 v27, 0xffff0000, v13
  v_mul_f32 v26, v26, v11
  v_mul_f32 v27, v27, v11
  v_cvt_pk_bf16_f32 v13, v26, v27
  v_lshlrev_b32 v28, 16, v14
  v_and_b32 v29, 0xffff0000, v14
  v_mul_f32 v28, v28, v11
  v_mul_f32 v29, v29, v11
  v_cvt_pk_bf16_f32 v14, v28, v29
  v_lshlrev_b32 v30, 16, v15
  v_and_b32 v31, 0xffff0000, v15
  v_mul_f32 v30, v30, v11
  v_mul_f32 v31, v31, v11
  v_cvt_pk_bf16_f32 v15, v30, v31
  v_lshlrev_b32 v32, 16, v16
  v_and_b32 v33, 0xffff0000, v16
  v_mul_f32 v32, v32, v11
  v_mul_f32 v33, v33, v11
  v_cvt_pk_bf16_f32 v16, v32, v33
  v_lshlrev_b32 v34, 16, v17
  v_and_b32 v35, 0xffff0000, v17
  v_mul_f32 v34, v34, v11
  v_mul_f32 v35, v35, v11
  v_cvt_pk_bf16_f32 v17, v34, v35
  v_lshlrev_b32 v36, 16, v18
  v_and_b32 v37, 0xffff0000, v18
  v_mul_f32 v36, v36, v11
  v_mul_f32 v37, v37, v11
  v_cvt_pk_bf16_f32 v18, v36, v37
  v_lshlrev_b32 v38, 16, v19
  v_and_b32 v39, 0xffff0000, v19
  v_mul_f32 v38, v38, v11
  v_mul_f32 v39, v39, v11
  v_cvt_pk_bf16_f32 v19, v38, v39
  v_lshlrev_b32 v40, 16, v20
  v_and_b32 v41, 0xffff0000, v20
  v_mul_f32 v40, v40, v11
  v_mul_f32 v41, v41, v11
  v_cvt_pk_bf16_f32 v20, v40, v41
  v_lshlrev_b32 v42, 16, v21
  v_and_b32 v43, 0xffff0000, v21
  v_mul_f32 v42, v42, v11
  v_mul_f32 v43, v43, v11
  v_cvt_pk_bf16_f32 v21, v42, v43
  v_lshlrev_b32 v44, 16, v22
  v_and_b32 v45, 0xffff0000, v22
  v_mul_f32 v44, v44, v11
  v_mul_f32 v45, v45, v11
  v_cvt_pk_bf16_f32 v22, v44, v45
  v_lshlrev_b32 v46, 16, v23
  v_and_b32 v47, 0xffff0000, v23
  v_mul_f32 v46, v46, v11
  v_mul_f32 v47, v47, v11
  v_cvt_pk_bf16_f32 v23, v46, v47
  s_add_u32 s25, s27, 16777216
  buffer_store_dwordx4 v[12:15], v6, s[4:7], s25 offen sc1
  s_add_u32 s25, s27, 16793600
  buffer_store_dwordx4 v[16:19], v6, s[4:7], s25 offen sc1
  s_add_u32 s25, s27, s26
  s_add_u32 s25, s25, 16777216
  buffer_store_dwordx4 v[20:23], v6, s[4:7], s25 offen sc1
  s_add_u32 s24, s22, 3674112
  s_waitcnt vmcnt(0)
  s_barrier
  v_cmp_eq_u32 vcc, 0, v0
  s_nop 0
  s_and_saveexec_b64 s[32:33], vcc
  s_cbranch_execz Lsig_22
  v_mov_b32 v3, 0
  v_mov_b32 v4, 1
  buffer_atomic_add v4, v3, s[4:7], s24 offen
Lsig_22:
  s_mov_b64 exec, s[32:33]
  s_mov_b32 s27, s81
  s_mov_b32 s28, s82
  s_mov_b32 s31, s72
  s_mov_b32 s34, s73
  v_lshrrev_b32 v3, 5, v1
  v_mul_u32_u24 v3, 8, v3
  v_bfe_u32 v4, v1, 2, 2
  v_add_u32 v3, v3, v4
  v_mul_u32_u24 v8, 64, v3
  v_bfe_u32 v4, v1, 1, 1
  v_lshl_add_u32 v8, v4, 3, v8
  v_bfe_u32 v4, v1, 4, 1
  v_lshl_add_u32 v8, v4, 4, v8
  v_bfe_u32 v4, v1, 0, 1
  v_lshl_add_u32 v8, v4, 5, v8
  v_add_u32 v8, 0, v8
  v_lshrrev_b32 v3, 5, v1
  v_mul_u32_u24 v3, 8, v3
  v_bfe_u32 v4, v1, 2, 2
  v_add_u32 v3, v3, v4
  v_mul_u32_u24 v10, 64, v3
  v_bfe_u32 v4, v1, 0, 1
  v_lshl_add_u32 v10, v4, 3, v10
  v_bfe_u32 v4, v1, 1, 1
  v_lshl_add_u32 v10, v4, 4, v10
  v_bfe_u32 v4, v1, 4, 1
  v_lshl_add_u32 v10, v4, 5, v10
  v_add_u32 v10, 40960, v10
  v_lshrrev_b32 v3, 5, v1
  v_mul_u32_u24 v3, 8, v3
  v_bfe_u32 v4, v1, 2, 2
  v_add_u32 v3, v3, v4
  v_mul_u32_u24 v12, 64, v3
  v_bfe_u32 v4, v1, 1, 1
  v_lshl_add_u32 v12, v4, 3, v12
  v_bfe_u32 v4, v1, 0, 1
  v_lshl_add_u32 v12, v4, 4, v12
  v_bfe_u32 v4, v1, 4, 1
  v_lshl_add_u32 v12, v4, 5, v12
  v_add_u32 v12, 81920, v12
  v_lshrrev_b32 v3, 5, v1
  v_lshlrev_b32 v7, 9, v3
  v_bfe_u32 v3, v1, 1, 4
  v_lshl_add_u32 v7, v3, 4, v7
  v_and_b32 v3, 1, v1
  v_lshl_add_u32 v7, v3, 8, v7
  s_mov_b32 s22, 2
  s_add_u32 s24, s22, 0
  s_min_u32 s24, s24, 15
  s_cmp_lt_u32 s24, s74
  s_cbranch_scc1 Lxr_23_ok
  s_cmp_lg_u32 s17, 0
  s_cbranch_scc1 Lxr_23_w
  v_lshlrev_b32 v5, 7, v1
Lxr_23_sp:
  buffer_load_dword v3, v5, s[4:7], s34 offen sc1
  s_waitcnt vmcnt(0)
  v_cmp_le_u32 vcc, 16, v3
  s_add_u32 s0, s0, 1
  s_and_b32 s74, vcc_lo, 0xffff
  s_ff0_i32_b32 s74, s74
  s_cmp_lt_u32 s24, s74
  s_cbranch_scc1 Lxr_23_got
  s_sleep 2
  s_cmp_lt_u32 s0, 1572864
  s_cbranch_scc1 Lxr_23_sp
Lxr_23_got:
  v_mov_b32 v3, s74
  v_mov_b32 v5, 123392
  ds_write_b32 v5, v3
  s_waitcnt lgkmcnt(0)
Lxr_23_w:
  s_barrier
  v_mov_b32 v5, 123392
  ds_read_b32 v3, v5
  s_waitcnt lgkmcnt(0)
  v_readfirstlane_b32 s74, v3
  s_barrier
Lxr_23_ok:
  s_lshl_b32 s75, s30, 12
  s_add_u32 s75, s75, s27
  s_add_u32 s30, s30, 1
  s_cmp_eq_u32 s30, 10
  s_cselect_b32 s30, 0, s30
  buffer_load_dwordx4 v[96:99], v2, s[4:7], s75 offen offset:0 sc1
  buffer_load_dwordx4 v[100:103], v2, s[4:7], s75 offen offset:1024 sc1
  buffer_load_dwordx4 v[104:107], v2, s[4:7], s75 offen offset:2048 sc1
  buffer_load_dwordx4 v[108:111], v2, s[4:7], s75 offen offset:3072 sc1
  s_lshl_b32 s75, s30, 12
  s_add_u32 s75, s75, s27
  s_add_u32 s30, s30, 1
  s_cmp_eq_u32 s30, 10
  s_cselect_b32 s30, 0, s30
  buffer_load_dwordx4 v[112:115], v2, s[4:7], s75 offen offset:0 sc1
  buffer_load_dwordx4 v[116:119], v2, s[4:7], s75 offen offset:1024 sc1
  buffer_load_dwordx4 v[120:123], v2, s[4:7], s75 offen offset:2048 sc1
  buffer_load_dwordx4 v[124:127], v2, s[4:7], s75 offen offset:3072 sc1
  s_lshl_b32 s75, s30, 12
  s_add_u32 s75, s75, s27
  s_add_u32 s30, s30, 1
  s_cmp_eq_u32 s30, 10
  s_cselect_b32 s30, 0, s30
  buffer_load_dwordx4 v[128:131], v2, s[4:7], s75 offen offset:0 sc1
  buffer_load_dwordx4 v[132:135], v2, s[4:7], s75 offen offset:1024 sc1
  buffer_load_dwordx4 v[136:139], v2, s[4:7], s75 offen offset:2048 sc1
  buffer_load_dwordx4 v[140:143], v2, s[4:7], s75 offen offset:3072 sc1
  s_lshl_b32 s75, s30, 12
  s_add_u32 s75, s75, s27
  s_add_u32 s30, s30, 1
  s_cmp_eq_u32 s30, 10
  s_cselect_b32 s30, 0, s30
  buffer_load_dwordx4 v[144:147], v2, s[4:7], s75 offen offset:0 sc1
  buffer_load_dwordx4 v[148:151], v2, s[4:7], s75 offen offset:1024 sc1
  buffer_load_dwordx4 v[152:155], v2, s[4:7], s75 offen offset:2048 sc1
  buffer_load_dwordx4 v[156:159], v2, s[4:7], s75 offen offset:3072 sc1
  s_lshl_b32 s75, s30, 12
  s_add_u32 s75, s75, s27
  s_add_u32 s30, s30, 1
  s_cmp_eq_u32 s30, 10
  s_cselect_b32 s30, 0, s30
  buffer_load_dwordx4 v[160:163], v2, s[4:7], s75 offen offset:0 sc1
  buffer_load_dwordx4 v[164:167], v2, s[4:7], s75 offen offset:1024 sc1
  buffer_load_dwordx4 v[168:171], v2, s[4:7], s75 offen offset:2048 sc1
  buffer_load_dwordx4 v[172:175], v2, s[4:7], s75 offen offset:3072 sc1
  s_lshl_b32 s75, s30, 12
  s_add_u32 s75, s75, s27
  s_add_u32 s30, s30, 1
  s_cmp_eq_u32 s30, 10
  s_cselect_b32 s30, 0, s30
  buffer_load_dwordx4 v[176:179], v2, s[4:7], s75 offen offset:0 sc1
  buffer_load_dwordx4 v[180:183], v2, s[4:7], s75 offen offset:1024 sc1
  buffer_load_dwordx4 v[184:187], v2, s[4:7], s75 offen offset:2048 sc1
  buffer_load_dwordx4 v[188:191], v2, s[4:7], s75 offen offset:3072 sc1
  s_lshl_b32 s75, s30, 12
  s_add_u32 s75, s75, s27
  s_add_u32 s30, s30, 1
  s_cmp_eq_u32 s30, 10
  s_cselect_b32 s30, 0, s30
  buffer_load_dwordx4 v[192:195], v2, s[4:7], s75 offen offset:0 sc1
  buffer_load_dwordx4 v[196:199], v2, s[4:7], s75 offen offset:1024 sc1
  buffer_load_dwordx4 v[200:203], v2, s[4:7], s75 offen offset:2048 sc1
  buffer_load_dwordx4 v[204:207], v2, s[4:7], s75 offen offset:3072 sc1
  s_lshl_b32 s75, s30, 12
  s_add_u32 s75, s75, s27
  s_add_u32 s30, s30, 1
  s_cmp_eq_u32 s30, 10
  s_cselect_b32 s30, 0, s30
  buffer_load_dwordx4 v[208:211], v2, s[4:7], s75 offen offset:0 sc1
  buffer_load_dwordx4 v[212:215], v2, s[4:7], s75 offen offset:1024 sc1
  buffer_load_dwordx4 v[216:219], v2, s[4:7], s75 offen offset:2048 sc1
  buffer_load_dwordx4 v[220:223], v2, s[4:7], s75 offen offset:3072 sc1
  s_lshl_b32 s75, s30, 12
  s_add_u32 s75, s75, s27
  s_add_u32 s30, s30, 1
  s_cmp_eq_u32 s30, 10
  s_cselect_b32 s30, 0, s30
  buffer_load_dwordx4 v[224:227], v2, s[4:7], s75 offen offset:0 sc1
  buffer_load_dwordx4 v[228:231], v2, s[4:7], s75 offen offset:1024 sc1
  buffer_load_dwordx4 v[232:235], v2, s[4:7], s75 offen offset:2048 sc1
  buffer_load_dwordx4 v[236:239], v2, s[4:7], s75 offen offset:3072 sc1
  s_lshl_b32 s75, s30, 12
  s_add_u32 s75, s75, s27
  s_add_u32 s30, s30, 1
  s_cmp_eq_u32 s30, 10
  s_cselect_b32 s30, 0, s30
  buffer_load_dwordx4 v[240:243], v2, s[4:7], s75 offen offset:0 sc1
  buffer_load_dwordx4 v[244:247], v2, s[4:7], s75 offen offset:1024 sc1
  buffer_load_dwordx4 v[248:251], v2, s[4:7], s75 offen offset:2048 sc1
  buffer_load_dwordx4 v[252:255], v2, s[4:7], s75 offen offset:3072 sc1
  s_add_u32 s27, s27, 163840
  s_mov_b32 s25, 2147479552
  buffer_store_dword v3, off, s[4:7], s25
  buffer_store_dword v3, off, s[4:7], s25
  buffer_store_dword v3, off, s[4:7], s25
  buffer_store_dword v3, off, s[4:7], s25
  buffer_store_dword v3, off, s[4:7], s25
  buffer_store_dword v3, off, s[4:7], s25
Lwq_24:
  s_add_u32 s24, s22, 1
  s_min_u32 s24, s24, 15
  s_cmp_lt_u32 s24, s74
  s_cbranch_scc1 Lxr_25_ok
  s_cmp_lg_u32 s17, 0
  s_cbranch_scc1 Lxr_25_w
  v_lshlrev_b32 v5, 7, v1
Lxr_25_sp:
  buffer_load_dword v3, v5, s[4:7], s34 offen sc1
  s_waitcnt vmcnt(0)
  v_cmp_le_u32 vcc, 16, v3
  s_add_u32 s0, s0, 1
  s_and_b32 s74, vcc_lo, 0xffff
  s_ff0_i32_b32 s74, s74
  s_cmp_lt_u32 s24, s74
  s_cbranch_scc1 Lxr_25_got
  s_sleep 2
  s_cmp_lt_u32 s0, 1572864
  s_cbranch_scc1 Lxr_25_sp
Lxr_25_got:
  v_mov_b32 v3, s74
  v_mov_b32 v5, 123392
  ds_write_b32 v5, v3
  s_waitcnt lgkmcnt(0)
Lxr_25_w:
  s_barrier
  v_mov_b32 v5, 123392
  ds_read_b32 v3, v5
  s_waitcnt lgkmcnt(0)
  v_readfirstlane_b32 s74, v3
  s_barrier
Lxr_25_ok:
  s_cmp_eq_u32 s22, 15
  s_cselect_b32 s27, 2146430976, s27
  ds_read_b64_tr_b16 v[16:17], v8 offset:0
  ds_read_b64_tr_b16 v[18:19], v8 offset:256
  ds_read_b64_tr_b16 v[20:21], v10 offset:0
  ds_read_b64_tr_b16 v[22:23], v10 offset:256
  ds_read_b64_tr_b16 v[24:25], v12 offset:0
  ds_read_b64_tr_b16 v[26:27], v12 offset:256
  ds_read_b64_tr_b16 v[28:29], v8 offset:1024
  ds_read_b64_tr_b16 v[30:31], v8 offset:1280
  ds_read_b64_tr_b16 v[32:33], v10 offset:1024
  ds_read_b64_tr_b16 v[34:35], v10 offset:1280
  ds_read_b64_tr_b16 v[36:37], v12 offset:1024
  ds_read_b64_tr_b16 v[38:39], v12 offset:1280
  s_waitcnt vmcnt(45) lgkmcnt(6)
  v_mfma_f32_32x32x16_bf16 a[0:15], v[16:19], v[96:99], 0
  v_mfma_f32_32x32x16_bf16 a[16:31], v[96:99], v[20:23], 0
  v_mfma_f32_32x32x16_bf16 a[32:47], v[24:27], v[96:99], 0
  s_lshl_b32 s75, s30, 12
  s_add_u32 s75, s75, s27
  s_add_u32 s30, s30, 1
  s_cmp_eq_u32 s30, 10
  s_cselect_b32 s30, 0, s30
  buffer_load_dwordx4 v[96:99], v2, s[4:7], s75 offen offset:0 sc1
  ds_read_b64_tr_b16 v[16:17], v8 offset:2048
  ds_read_b64_tr_b16 v[18:19], v8 offset:2304
  ds_read_b64_tr_b16 v[20:21], v10 offset:2048
  ds_read_b64_tr_b16 v[22:23], v10 offset:2304
  ds_read_b64_tr_b16 v[24:25], v12 offset:2048
  ds_read_b64_tr_b16 v[26:27], v12 offset:2304
  s_waitcnt vmcnt(45) lgkmcnt(6)
  v_mfma_f32_32x32x16_bf16 a[0:15], v[28:31], v[100:103], a[0:15]
  v_mfma_f32_32x32x16_bf16 a[16:31], v[100:103], v[32:35], a[16:31]
  v_mfma_f32_32x32x16_bf16 a[32:47], v[36:39], v[100:103], a[32:47]
  buffer_load_dwordx4 v[100:103], v2, s[4:7], s75 offen offset:1024 sc1
  ds_read_b64_tr_b16 v[28:29], v8 offset:3072
  ds_read_b64_tr_b16 v[30:31], v8 offset:3328
  ds_read_b64_tr_b16 v[32:33], v10 offset:3072
  ds_read_b64_tr_b16 v[34:35], v10 offset:3328
  ds_read_b64_tr_b16 v[36:37], v12 offset:3072
  ds_read_b64_tr_b16 v[38:39], v12 offset:3328
  s_waitcnt vmcnt(45) lgkmcnt(6)
  v_mfma_f32_32x32x16_bf16 a[0:15], v[16:19], v[104:107], a[0:15]
  v_mfma_f32_32x32x16_bf16 a[16:31], v[104:107], v[20:23], a[16:31]
  v_mfma_f32_32x32x16_bf16 a[32:47], v[24:27], v[104:107], a[32:47]
  buffer_load_dwordx4 v[104:107], v2, s[4:7], s75 offen offset:2048 sc1
  ds_read_b64_tr_b16 v[16:17], v8 offset:4096
  ds_read_b64_tr_b16 v[18:19], v8 offset:4352
  ds_read_b64_tr_b16 v[20:21], v10 offset:4096
  ds_read_b64_tr_b16 v[22:23], v10 offset:4352
  ds_read_b64_tr_b16 v[24:25], v12 offset:4096
  ds_read_b64_tr_b16 v[26:27], v12 offset:4352
  s_waitcnt vmcnt(45) lgkmcnt(6)
  v_mfma_f32_32x32x16_bf16 a[0:15], v[28:31], v[108:111], a[0:15]
  v_mfma_f32_32x32x16_bf16 a[16:31], v[108:111], v[32:35], a[16:31]
  v_mfma_f32_32x32x16_bf16 a[32:47], v[36:39], v[108:111], a[32:47]
  buffer_load_dwordx4 v[108:111], v2, s[4:7], s75 offen offset:3072 sc1
  ds_read_b64_tr_b16 v[28:29], v8 offset:5120
  ds_read_b64_tr_b16 v[30:31], v8 offset:5376
  ds_read_b64_tr_b16 v[32:33], v10 offset:5120
  ds_read_b64_tr_b16 v[34:35], v10 offset:5376
  ds_read_b64_tr_b16 v[36:37], v12 offset:5120
  ds_read_b64_tr_b16 v[38:39], v12 offset:5376
  s_waitcnt vmcnt(45) lgkmcnt(6)
  v_mfma_f32_32x32x16_bf16 a[0:15], v[16:19], v[112:115], a[0:15]
  v_mfma_f32_32x32x16_bf16 a[16:31], v[112:115], v[20:23], a[16:31]
  v_mfma_f32_32x32x16_bf16 a[32:47], v[24:27], v[112:115], a[32:47]
  s_lshl_b32 s75, s30, 12
  s_add_u32 s75, s75, s27
  s_add_u32 s30, s30, 1
  s_cmp_eq_u32 s30, 10
  s_cselect_b32 s30, 0, s30
  buffer_load_dwordx4 v[112:115], v2, s[4:7], s75 offen offset:0 sc1
  ds_read_b64_tr_b16 v[16:17], v8 offset:6144
  ds_read_b64_tr_b16 v[18:19], v8 offset:6400
  ds_read_b64_tr_b16 v[20:21], v10 offset:6144
  ds_read_b64_tr_b16 v[22:23], v10 offset:6400
  ds_read_b64_tr_b16 v[24:25], v12 offset:6144
  ds_read_b64_tr_b16 v[26:27], v12 offset:6400
  s_waitcnt vmcnt(45) lgkmcnt(6)
  v_mfma_f32_32x32x16_bf16 a[0:15], v[28:31], v[116:119], a[0:15]
  v_mfma_f32_32x32x16_bf16 a[16:31], v[116:119], v[32:35], a[16:31]
  v_mfma_f32_32x32x16_bf16 a[32:47], v[36:39], v[116:119], a[32:47]
  buffer_load_dwordx4 v[116:119], v2, s[4:7], s75 offen offset:1024 sc1
  ds_read_b64_tr_b16 v[28:29], v8 offset:7168
  ds_read_b64_tr_b16 v[30:31], v8 offset:7424
  ds_read_b64_tr_b16 v[32:33], v10 offset:7168
  ds_read_b64_tr_b16 v[34:35], v10 offset:7424
  ds_read_b64_tr_b16 v[36:37], v12 offset:7168
  ds_read_b64_tr_b16 v[38:39], v12 offset:7424
  s_waitcnt vmcnt(45) lgkmcnt(6)
  v_mfma_f32_32x32x16_bf16 a[0:15], v[16:19], v[120:123], a[0:15]
  v_mfma_f32_32x32x16_bf16 a[16:31], v[120:123], v[20:23], a[16:31]
  v_mfma_f32_32x32x16_bf16 a[32:47], v[24:27], v[120:123], a[32:47]
  buffer_load_dwordx4 v[120:123], v2, s[4:7], s75 offen offset:2048 sc1
  ds_read_b64_tr_b16 v[16:17], v8 offset:8192
  ds_read_b64_tr_b16 v[18:19], v8 offset:8448
  ds_read_b64_tr_b16 v[20:21], v10 offset:8192
  ds_read_b64_tr_b16 v[22:23], v10 offset:8448
  ds_read_b64_tr_b16 v[24:25], v12 offset:8192
  ds_read_b64_tr_b16 v[26:27], v12 offset:8448
  s_waitcnt vmcnt(45) lgkmcnt(6)
  v_mfma_f32_32x32x16_bf16 a[0:15], v[28:31], v[124:127], a[0:15]
  v_mfma_f32_32x32x16_bf16 a[16:31], v[124:127], v[32:35], a[16:31]
  v_mfma_f32_32x32x16_bf16 a[32:47], v[36:39], v[124:127], a[32:47]
  buffer_load_dwordx4 v[124:127], v2, s[4:7], s75 offen offset:3072 sc1
  ds_read_b64_tr_b16 v[28:29], v8 offset:9216
  ds_read_b64_tr_b16 v[30:31], v8 offset:9472
  ds_read_b64_tr_b16 v[32:33], v10 offset:9216
  ds_read_b64_tr_b16 v[34:35], v10 offset:9472
  ds_read_b64_tr_b16 v[36:37], v12 offset:9216
  ds_read_b64_tr_b16 v[38:39], v12 offset:9472
  s_waitcnt vmcnt(45) lgkmcnt(6)
  v_mfma_f32_32x32x16_bf16 a[0:15], v[16:19], v[128:131], a[0:15]
  v_mfma_f32_32x32x16_bf16 a[16:31], v[128:131], v[20:23], a[16:31]
  v_mfma_f32_32x32x16_bf16 a[32:47], v[24:27], v[128:131], a[32:47]
  s_lshl_b32 s75, s30, 12
  s_add_u32 s75, s75, s27
  s_add_u32 s30, s30, 1
  s_cmp_eq_u32 s30, 10
  s_cselect_b32 s30, 0, s30
  buffer_load_dwordx4 v[128:131], v2, s[4:7], s75 offen offset:0 sc1
  ds_read_b64_tr_b16 v[16:17], v8 offset:10240
  ds_read_b64_tr_b16 v[18:19], v8 offset:10496
  ds_read_b64_tr_b16 v[20:21], v10 offset:10240
  ds_read_b64_tr_b16 v[22:23], v10 offset:10496
  ds_read_b64_tr_b16 v[24:25], v12 offset:10240
  ds_read_b64_tr_b16 v[26:27], v12 offset:10496
  s_waitcnt vmcnt(45) lgkmcnt(6)
  v_mfma_f32_32x32x16_bf16 a[0:15], v[28:31], v[132:135], a[0:15]
  v_mfma_f32_32x32x16_bf16 a[16:31], v[132:135], v[32:35], a[16:31]
  v_mfma_f32_32x32x16_bf16 a[32:47], v[36:39], v[132:135], a[32:47]
  buffer_load_dwordx4 v[132:135], v2, s[4:7], s75 offen offset:1024 sc1
  ds_read_b64_tr_b16 v[28:29], v8 offset:11264
  ds_read_b64_tr_b16 v[30:31], v8 offset:11520
  ds_read_b64_tr_b16 v[32:33], v10 offset:11264
  ds_read_b64_tr_b16 v[34:35], v10 offset:11520
  ds_read_b64_tr_b16 v[36:37], v12 offset:11264
  ds_read_b64_tr_b16 v[38:39], v12 offset:11520
  s_waitcnt vmcnt(45) lgkmcnt(6)
  v_mfma_f32_32x32x16_bf16 a[0:15], v[16:19], v[136:139], a[0:15]
  v_mfma_f32_32x32x16_bf16 a[16:31], v[136:139], v[20:23], a[16:31]
  v_mfma_f32_32x32x16_bf16 a[32:47], v[24:27], v[136:139], a[32:47]
  buffer_load_dwordx4 v[136:139], v2, s[4:7], s75 offen offset:2048 sc1
  ds_read_b64_tr_b16 v[16:17], v8 offset:12288
  ds_read_b64_tr_b16 v[18:19], v8 offset:12544
  ds_read_b64_tr_b16 v[20:21], v10 offset:12288
  ds_read_b64_tr_b16 v[22:23], v10 offset:12544
  ds_read_b64_tr_b16 v[24:25], v12 offset:12288
  ds_read_b64_tr_b16 v[26:27], v12 offset:12544
  s_waitcnt vmcnt(45) lgkmcnt(6)
  v_mfma_f32_32x32x16_bf16 a[0:15], v[28:31], v[140:143], a[0:15]
  v_mfma_f32_32x32x16_bf16 a[16:31], v[140:143], v[32:35], a[16:31]
  v_mfma_f32_32x32x16_bf16 a[32:47], v[36:39], v[140:143], a[32:47]
  buffer_load_dwordx4 v[140:143], v2, s[4:7], s75 offen offset:3072 sc1
  ds_read_b64_tr_b16 v[28:29], v8 offset:13312
  ds_read_b64_tr_b16 v[30:31], v8 offset:13568
  ds_read_b64_tr_b16 v[32:33], v10 offset:13312
  ds_read_b64_tr_b16 v[34:35], v10 offset:13568
  ds_read_b64_tr_b16 v[36:37], v12 offset:13312
  ds_read_b64_tr_b16 v[38:39], v12 offset:13568
  s_waitcnt vmcnt(45) lgkmcnt(6)
  v_mfma_f32_32x32x16_bf16 a[0:15], v[16:19], v[144:147], a[0:15]
  v_mfma_f32_32x32x16_bf16 a[16:31], v[144:147], v[20:23], a[16:31]
  v_mfma_f32_32x32x16_bf16 a[32:47], v[24:27], v[144:147], a[32:47]
  s_lshl_b32 s75, s30, 12
  s_add_u32 s75, s75, s27
  s_add_u32 s30, s30, 1
  s_cmp_eq_u32 s30, 10
  s_cselect_b32 s30, 0, s30
  buffer_load_dwordx4 v[144:147], v2, s[4:7], s75 offen offset:0 sc1
  ds_read_b64_tr_b16 v[16:17], v8 offset:14336
  ds_read_b64_tr_b16 v[18:19], v8 offset:14592
  ds_read_b64_tr_b16 v[20:21], v10 offset:14336
  ds_read_b64_tr_b16 v[22:23], v10 offset:14592
  ds_read_b64_tr_b16 v[24:25], v12 offset:14336
  ds_read_b64_tr_b16 v[26:27], v12 offset:14592
  s_waitcnt vmcnt(45) lgkmcnt(6)
  v_mfma_f32_32x32x16_bf16 a[0:15], v[28:31], v[148:151], a[0:15]
  v_mfma_f32_32x32x16_bf16 a[16:31], v[148:151], v[32:35], a[16:31]
  v_mfma_f32_32x32x16_bf16 a[32:47], v[36:39], v[148:151], a[32:47]
  buffer_load_dwordx4 v[148:151], v2, s[4:7], s75 offen offset:1024 sc1
  ds_read_b64_tr_b16 v[28:29], v8 offset:15360
  ds_read_b64_tr_b16 v[30:31], v8 offset:15616
  ds_read_b64_tr_b16 v[32:33], v10 offset:15360
  ds_read_b64_tr_b16 v[34:35], v10 offset:15616
  ds_read_b64_tr_b16 v[36:37], v12 offset:15360
  ds_read_b64_tr_b16 v[38:39], v12 offset:15616
  s_waitcnt vmcnt(45) lgkmcnt(6)
  v_mfma_f32_32x32x16_bf16 a[0:15], v[16:19], v[152:155], a[0:15]
  v_mfma_f32_32x32x16_bf16 a[16:31], v[152:155], v[20:23], a[16:31]
  v_mfma_f32_32x32x16_bf16 a[32:47], v[24:27], v[152:155], a[32:47]
  buffer_load_dwordx4 v[152:155], v2, s[4:7], s75 offen offset:2048 sc1
  ds_read_b64_tr_b16 v[16:17], v8 offset:16384
  ds_read_b64_tr_b16 v[18:19], v8 offset:16640
  ds_read_b64_tr_b16 v[20:21], v10 offset:16384
  ds_read_b64_tr_b16 v[22:23], v10 offset:16640
  ds_read_b64_tr_b16 v[24:25], v12 offset:16384
  ds_read_b64_tr_b16 v[26:27], v12 offset:16640
  s_waitcnt vmcnt(45) lgkmcnt(6)
  v_mfma_f32_32x32x16_bf16 a[0:15], v[28:31], v[156:159], a[0:15]
  v_mfma_f32_32x32x16_bf16 a[16:31], v[156:159], v[32:35], a[16:31]
  v_mfma_f32_32x32x16_bf16 a[32:47], v[36:39], v[156:159], a[32:47]
  buffer_load_dwordx4 v[156:159], v2, s[4:7], s75 offen offset:3072 sc1
  ds_read_b64_tr_b16 v[28:29], v8 offset:17408
  ds_read_b64_tr_b16 v[30:31], v8 offset:17664
  ds_read_b64_tr_b16 v[32:33], v10 offset:17408
  ds_read_b64_tr_b16 v[34:35], v10 offset:17664
  ds_read_b64_tr_b16 v[36:37], v12 offset:17408
  ds_read_b64_tr_b16 v[38:39], v12 offset:17664
  s_waitcnt vmcnt(45) lgkmcnt(6)
  v_mfma_f32_32x32x16_bf16 a[0:15], v[16:19], v[160:163], a[0:15]
  v_mfma_f32_32x32x16_bf16 a[16:31], v[160:163], v[20:23], a[16:31]
  v_mfma_f32_32x32x16_bf16 a[32:47], v[24:27], v[160:163], a[32:47]
  s_lshl_b32 s75, s30, 12
  s_add_u32 s75, s75, s27
  s_add_u32 s30, s30, 1
  s_cmp_eq_u32 s30, 10
  s_cselect_b32 s30, 0, s30
  buffer_load_dwordx4 v[160:163], v2, s[4:7], s75 offen offset:0 sc1
  ds_read_b64_tr_b16 v[16:17], v8 offset:18432
  ds_read_b64_tr_b16 v[18:19], v8 offset:18688
  ds_read_b64_tr_b16 v[20:21], v10 offset:18432
  ds_read_b64_tr_b16 v[22:23], v10 offset:18688
  ds_read_b64_tr_b16 v[24:25], v12 offset:18432
  ds_read_b64_tr_b16 v[26:27], v12 offset:18688
  s_waitcnt vmcnt(45) lgkmcnt(6)
  v_mfma_f32_32x32x16_bf16 a[0:15], v[28:31], v[164:167], a[0:15]
  v_mfma_f32_32x32x16_bf16 a[16:31], v[164:167], v[32:35], a[16:31]
  v_mfma_f32_32x32x16_bf16 a[32:47], v[36:39], v[164:167], a[32:47]
  buffer_load_dwordx4 v[164:167], v2, s[4:7], s75 offen offset:1024 sc1
  ds_read_b64_tr_b16 v[28:29], v8 offset:19456
  ds_read_b64_tr_b16 v[30:31], v8 offset:19712
  ds_read_b64_tr_b16 v[32:33], v10 offset:19456
  ds_read_b64_tr_b16 v[34:35], v10 offset:19712
  ds_read_b64_tr_b16 v[36:37], v12 offset:19456
  ds_read_b64_tr_b16 v[38:39], v12 offset:19712
  s_waitcnt vmcnt(45) lgkmcnt(6)
  v_mfma_f32_32x32x16_bf16 a[0:15], v[16:19], v[168:171], a[0:15]
  v_mfma_f32_32x32x16_bf16 a[16:31], v[168:171], v[20:23], a[16:31]
  v_mfma_f32_32x32x16_bf16 a[32:47], v[24:27], v[168:171], a[32:47]
  buffer_load_dwordx4 v[168:171], v2, s[4:7], s75 offen offset:2048 sc1
  ds_read_b64_tr_b16 v[16:17], v8 offset:20480
  ds_read_b64_tr_b16 v[18:19], v8 offset:20736
  ds_read_b64_tr_b16 v[20:21], v10 offset:20480
  ds_read_b64_tr_b16 v[22:23], v10 offset:20736
  ds_read_b64_tr_b16 v[24:25], v12 offset:20480
  ds_read_b64_tr_b16 v[26:27], v12 offset:20736
  s_waitcnt vmcnt(45) lgkmcnt(6)
  v_mfma_f32_32x32x16_bf16 a[0:15], v[28:31], v[172:175], a[0:15]
  v_mfma_f32_32x32x16_bf16 a[16:31], v[172:175], v[32:35], a[16:31]
  v_mfma_f32_32x32x16_bf16 a[32:47], v[36:39], v[172:175], a[32:47]
  buffer_load_dwordx4 v[172:175], v2, s[4:7], s75 offen offset:3072 sc1
  ds_read_b64_tr_b16 v[28:29], v8 offset:21504
  ds_read_b64_tr_b16 v[30:31], v8 offset:21760
  ds_read_b64_tr_b16 v[32:33], v10 offset:21504
  ds_read_b64_tr_b16 v[34:35], v10 offset:21760
  ds_read_b64_tr_b16 v[36:37], v12 offset:21504
  ds_read_b64_tr_b16 v[38:39], v12 offset:21760
  s_waitcnt vmcnt(45) lgkmcnt(6)
  v_mfma_f32_32x32x16_bf16 a[0:15], v[16:19], v[176:179], a[0:15]
  v_mfma_f32_32x32x16_bf16 a[16:31], v[176:179], v[20:23], a[16:31]
  v_mfma_f32_32x32x16_bf16 a[32:47], v[24:27], v[176:179], a[32:47]
  s_lshl_b32 s75, s30, 12
  s_add_u32 s75, s75, s27
  s_add_u32 s30, s30, 1
  s_cmp_eq_u32 s30, 10
  s_cselect_b32 s30, 0, s30
  buffer_load_dwordx4 v[176:179], v2, s[4:7], s75 offen offset:0 sc1
  ds_read_b64_tr_b16 v[16:17], v8 offset:22528
  ds_read_b64_tr_b16 v[18:19], v8 offset:22784
  ds_read_b64_tr_b16 v[20:21], v10 offset:22528
  ds_read_b64_tr_b16 v[22:23], v10 offset:22784
  ds_read_b64_tr_b16 v[24:25], v12 offset:22528
  ds_read_b64_tr_b16 v[26:27], v12 offset:22784
  s_waitcnt vmcnt(45) lgkmcnt(6)
  v_mfma_f32_32x32x16_bf16 a[0:15], v[28:31], v[180:183], a[0:15]
  v_mfma_f32_32x32x16_bf16 a[16:31], v[180:183], v[32:35], a[16:31]
  v_mfma_f32_32x32x16_bf16 a[32:47], v[36:39], v[180:183], a[32:47]
  buffer_load_dwordx4 v[180:183], v2, s[4:7], s75 offen offset:1024 sc1
  ds_read_b64_tr_b16 v[28:29], v8 offset:23552
  ds_read_b64_tr_b16 v[30:31], v8 offset:23808
  ds_read_b64_tr_b16 v[32:33], v10 offset:23552
  ds_read_b64_tr_b16 v[34:35], v10 offset:23808
  ds_read_b64_tr_b16 v[36:37], v12 offset:23552
  ds_read_b64_tr_b16 v[38:39], v12 offset:23808
  s_waitcnt vmcnt(45) lgkmcnt(6)
  v_mfma_f32_32x32x16_bf16 a[0:15], v[16:19], v[184:187], a[0:15]
  v_mfma_f32_32x32x16_bf16 a[16:31], v[184:187], v[20:23], a[16:31]
  v_mfma_f32_32x32x16_bf16 a[32:47], v[24:27], v[184:187], a[32:47]
  buffer_load_dwordx4 v[184:187], v2, s[4:7], s75 offen offset:2048 sc1
  ds_read_b64_tr_b16 v[16:17], v8 offset:24576
  ds_read_b64_tr_b16 v[18:19], v8 offset:24832
  ds_read_b64_tr_b16 v[20:21], v10 offset:24576
  ds_read_b64_tr_b16 v[22:23], v10 offset:24832
  ds_read_b64_tr_b16 v[24:25], v12 offset:24576
  ds_read_b64_tr_b16 v[26:27], v12 offset:24832
  s_waitcnt vmcnt(45) lgkmcnt(6)
  v_mfma_f32_32x32x16_bf16 a[0:15], v[28:31], v[188:191], a[0:15]
  v_mfma_f32_32x32x16_bf16 a[16:31], v[188:191], v[32:35], a[16:31]
  v_mfma_f32_32x32x16_bf16 a[32:47], v[36:39], v[188:191], a[32:47]
  buffer_load_dwordx4 v[188:191], v2, s[4:7], s75 offen offset:3072 sc1
  ds_read_b64_tr_b16 v[28:29], v8 offset:25600
  ds_read_b64_tr_b16 v[30:31], v8 offset:25856
  ds_read_b64_tr_b16 v[32:33], v10 offset:25600
  ds_read_b64_tr_b16 v[34:35], v10 offset:25856
  ds_read_b64_tr_b16 v[36:37], v12 offset:25600
  ds_read_b64_tr_b16 v[38:39], v12 offset:25856
  s_waitcnt vmcnt(45) lgkmcnt(6)
  v_mfma_f32_32x32x16_bf16 a[0:15], v[16:19], v[192:195], a[0:15]
  v_mfma_f32_32x32x16_bf16 a[16:31], v[192:195], v[20:23], a[16:31]
  v_mfma_f32_32x32x16_bf16 a[32:47], v[24:27], v[192:195], a[32:47]
  s_lshl_b32 s75, s30, 12
  s_add_u32 s75, s75, s27
  s_add_u32 s30, s30, 1
  s_cmp_eq_u32 s30, 10
  s_cselect_b32 s30, 0, s30
  buffer_load_dwordx4 v[192:195], v2, s[4:7], s75 offen offset:0 sc1
  ds_read_b64_tr_b16 v[16:17], v8 offset:26624
  ds_read_b64_tr_b16 v[18:19], v8 offset:26880
  ds_read_b64_tr_b16 v[20:21], v10 offset:26624
  ds_read_b64_tr_b16 v[22:23], v10 offset:26880
  ds_read_b64_tr_b16 v[24:25], v12 offset:26624
  ds_read_b64_tr_b16 v[26:27], v12 offset:26880
  s_waitcnt vmcnt(45) lgkmcnt(6)
  v_mfma_f32_32x32x16_bf16 a[0:15], v[28:31], v[196:199], a[0:15]
  v_mfma_f32_32x32x16_bf16 a[16:31], v[196:199], v[32:35], a[16:31]
  v_mfma_f32_32x32x16_bf16 a[32:47], v[36:39], v[196:199], a[32:47]
  buffer_load_dwordx4 v[196:199], v2, s[4:7], s75 offen offset:1024 sc1
  ds_read_b64_tr_b16 v[28:29], v8 offset:27648
  ds_read_b64_tr_b16 v[30:31], v8 offset:27904
  ds_read_b64_tr_b16 v[32:33], v10 offset:27648
  ds_read_b64_tr_b16 v[34:35], v10 offset:27904
  ds_read_b64_tr_b16 v[36:37], v12 offset:27648
  ds_read_b64_tr_b16 v[38:39], v12 offset:27904
  s_waitcnt vmcnt(45) lgkmcnt(6)
  v_mfma_f32_32x32x16_bf16 a[0:15], v[16:19], v[200:203], a[0:15]
  v_mfma_f32_32x32x16_bf16 a[16:31], v[200:203], v[20:23], a[16:31]
  v_mfma_f32_32x32x16_bf16 a[32:47], v[24:27], v[200:203], a[32:47]
  buffer_load_dwordx4 v[200:203], v2, s[4:7], s75 offen offset:2048 sc1
  ds_read_b64_tr_b16 v[16:17], v8 offset:28672
  ds_read_b64_tr_b16 v[18:19], v8 offset:28928
  ds_read_b64_tr_b16 v[20:21], v10 offset:28672
  ds_read_b64_tr_b16 v[22:23], v10 offset:28928
  ds_read_b64_tr_b16 v[24:25], v12 offset:28672
  ds_read_b64_tr_b16 v[26:27], v12 offset:28928
  s_waitcnt vmcnt(45) lgkmcnt(6)
  v_mfma_f32_32x32x16_bf16 a[0:15], v[28:31], v[204:207], a[0:15]
  v_mfma_f32_32x32x16_bf16 a[16:31], v[204:207], v[32:35], a[16:31]
  v_mfma_f32_32x32x16_bf16 a[32:47], v[36:39], v[204:207], a[32:47]
  buffer_load_dwordx4 v[204:207], v2, s[4:7], s75 offen offset:3072 sc1
  ds_read_b64_tr_b16 v[28:29], v8 offset:29696
  ds_read_b64_tr_b16 v[30:31], v8 offset:29952
  ds_read_b64_tr_b16 v[32:33], v10 offset:29696
  ds_read_b64_tr_b16 v[34:35], v10 offset:29952
  ds_read_b64_tr_b16 v[36:37], v12 offset:29696
  ds_read_b64_tr_b16 v[38:39], v12 offset:29952
  s_waitcnt vmcnt(45) lgkmcnt(6)
  v_mfma_f32_32x32x16_bf16 a[0:15], v[16:19], v[208:211], a[0:15]
  v_mfma_f32_32x32x16_bf16 a[16:31], v[208:211], v[20:23], a[16:31]
  v_mfma_f32_32x32x16_bf16 a[32:47], v[24:27], v[208:211], a[32:47]
  s_lshl_b32 s75, s30, 12
  s_add_u32 s75, s75, s27
  s_add_u32 s30, s30, 1
  s_cmp_eq_u32 s30, 10
  s_cselect_b32 s30, 0, s30
  buffer_load_dwordx4 v[208:211], v2, s[4:7], s75 offen offset:0 sc1
  ds_read_b64_tr_b16 v[16:17], v8 offset:30720
  ds_read_b64_tr_b16 v[18:19], v8 offset:30976
  ds_read_b64_tr_b16 v[20:21], v10 offset:30720
  ds_read_b64_tr_b16 v[22:23], v10 offset:30976
  ds_read_b64_tr_b16 v[24:25], v12 offset:30720
  ds_read_b64_tr_b16 v[26:27], v12 offset:30976
  s_waitcnt vmcnt(45) lgkmcnt(6)
  v_mfma_f32_32x32x16_bf16 a[0:15], v[28:31], v[212:215], a[0:15]
  v_mfma_f32_32x32x16_bf16 a[16:31], v[212:215], v[32:35], a[16:31]
  v_mfma_f32_32x32x16_bf16 a[32:47], v[36:39], v[212:215], a[32:47]
  buffer_load_dwordx4 v[212:215], v2, s[4:7], s75 offen offset:1024 sc1
  ds_read_b64_tr_b16 v[28:29], v8 offset:31744
  ds_read_b64_tr_b16 v[30:31], v8 offset:32000
  ds_read_b64_tr_b16 v[32:33], v10 offset:31744
  ds_read_b64_tr_b16 v[34:35], v10 offset:32000
  ds_read_b64_tr_b16 v[36:37], v12 offset:31744
  ds_read_b64_tr_b16 v[38:39], v12 offset:32000
  s_waitcnt vmcnt(45) lgkmcnt(6)
  v_mfma_f32_32x32x16_bf16 a[0:15], v[16:19], v[216:219], a[0:15]
  v_mfma_f32_32x32x16_bf16 a[16:31], v[216:219], v[20:23], a[16:31]
  v_mfma_f32_32x32x16_bf16 a[32:47], v[24:27], v[216:219], a[32:47]
  buffer_load_dwordx4 v[216:219], v2, s[4:7], s75 offen offset:2048 sc1
  ds_read_b64_tr_b16 v[16:17], v8 offset:32768
  ds_read_b64_tr_b16 v[18:19], v8 offset:33024
  ds_read_b64_tr_b16 v[20:21], v10 offset:32768
  ds_read_b64_tr_b16 v[22:23], v10 offset:33024
  ds_read_b64_tr_b16 v[24:25], v12 offset:32768
  ds_read_b64_tr_b16 v[26:27], v12 offset:33024
  s_waitcnt vmcnt(45) lgkmcnt(6)
  v_mfma_f32_32x32x16_bf16 a[0:15], v[28:31], v[220:223], a[0:15]
  v_mfma_f32_32x32x16_bf16 a[16:31], v[220:223], v[32:35], a[16:31]
  v_mfma_f32_32x32x16_bf16 a[32:47], v[36:39], v[220:223], a[32:47]
  buffer_load_dwordx4 v[220:223], v2, s[4:7], s75 offen offset:3072 sc1
  ds_read_b64_tr_b16 v[28:29], v8 offset:33792
  ds_read_b64_tr_b16 v[30:31], v8 offset:34048
  ds_read_b64_tr_b16 v[32:33], v10 offset:33792
  ds_read_b64_tr_b16 v[34:35], v10 offset:34048
  ds_read_b64_tr_b16 v[36:37], v12 offset:33792
  ds_read_b64_tr_b16 v[38:39], v12 offset:34048
  s_waitcnt vmcnt(45) lgkmcnt(6)
  v_mfma_f32_32x32x16_bf16 a[0:15], v[16:19], v[224:227], a[0:15]
  v_mfma_f32_32x32x16_bf16 a[16:31], v[224:227], v[20:23], a[16:31]
  v_mfma_f32_32x32x16_bf16 a[32:47], v[24:27], v[224:227], a[32:47]
  s_lshl_b32 s75, s30, 12
  s_add_u32 s75, s75, s27
  s_add_u32 s30, s30, 1
  s_cmp_eq_u32 s30, 10
  s_cselect_b32 s30, 0, s30
  buffer_load_dwordx4 v[224:227], v2, s[4:7], s75 offen offset:0 sc1
  ds_read_b64_tr_b16 v[16:17], v8 offset:34816
  ds_read_b64_tr_b16 v[18:19], v8 offset:35072
  ds_read_b64_tr_b16 v[20:21], v10 offset:34816
  ds_read_b64_tr_b16 v[22:23], v10 offset:35072
  ds_read_b64_tr_b16 v[24:25], v12 offset:34816
  ds_read_b64_tr_b16 v[26:27], v12 offset:35072
  s_waitcnt vmcnt(45) lgkmcnt(6)
  v_mfma_f32_32x32x16_bf16 a[0:15], v[28:31], v[228:231], a[0:15]
  v_mfma_f32_32x32x16_bf16 a[16:31], v[228:231], v[32:35], a[16:31]
  v_mfma_f32_32x32x16_bf16 a[32:47], v[36:39], v[228:231], a[32:47]
  buffer_load_dwordx4 v[228:231], v2, s[4:7], s75 offen offset:1024 sc1
  ds_read_b64_tr_b16 v[28:29], v8 offset:35840
  ds_read_b64_tr_b16 v[30:31], v8 offset:36096
  ds_read_b64_tr_b16 v[32:33], v10 offset:35840
  ds_read_b64_tr_b16 v[34:35], v10 offset:36096
  ds_read_b64_tr_b16 v[36:37], v12 offset:35840
  ds_read_b64_tr_b16 v[38:39], v12 offset:36096
  s_waitcnt vmcnt(45) lgkmcnt(6)
  v_mfma_f32_32x32x16_bf16 a[0:15], v[16:19], v[232:235], a[0:15]
  v_mfma_f32_32x32x16_bf16 a[16:31], v[232:235], v[20:23], a[16:31]
  v_mfma_f32_32x32x16_bf16 a[32:47], v[24:27], v[232:235], a[32:47]
  buffer_load_dwordx4 v[232:235], v2, s[4:7], s75 offen offset:2048 sc1
  ds_read_b64_tr_b16 v[16:17], v8 offset:36864
  ds_read_b64_tr_b16 v[18:19], v8 offset:37120
  ds_read_b64_tr_b16 v[20:21], v10 offset:36864
  ds_read_b64_tr_b16 v[22:23], v10 offset:37120
  ds_read_b64_tr_b16 v[24:25], v12 offset:36864
  ds_read_b64_tr_b16 v[26:27], v12 offset:37120
  s_waitcnt vmcnt(45) lgkmcnt(6)
  v_mfma_f32_32x32x16_bf16 a[0:15], v[28:31], v[236:239], a[0:15]
  v_mfma_f32_32x32x16_bf16 a[16:31], v[236:239], v[32:35], a[16:31]
  v_mfma_f32_32x32x16_bf16 a[32:47], v[36:39], v[236:239], a[32:47]
  buffer_load_dwordx4 v[236:239], v2, s[4:7], s75 offen offset:3072 sc1
  ds_read_b64_tr_b16 v[28:29], v8 offset:37888
  ds_read_b64_tr_b16 v[30:31], v8 offset:38144
  ds_read_b64_tr_b16 v[32:33], v10 offset:37888
  ds_read_b64_tr_b16 v[34:35], v10 offset:38144
  ds_read_b64_tr_b16 v[36:37], v12 offset:37888
  ds_read_b64_tr_b16 v[38:39], v12 offset:38144
  s_waitcnt vmcnt(45) lgkmcnt(6)
  v_mfma_f32_32x32x16_bf16 a[0:15], v[16:19], v[240:243], a[0:15]
  v_mfma_f32_32x32x16_bf16 a[16:31], v[240:243], v[20:23], a[16:31]
  v_mfma_f32_32x32x16_bf16 a[32:47], v[24:27], v[240:243], a[32:47]
  s_lshl_b32 s75, s30, 12
  s_add_u32 s75, s75, s27
  s_add_u32 s30, s30, 1
  s_cmp_eq_u32 s30, 10
  s_cselect_b32 s30, 0, s30
  buffer_load_dwordx4 v[240:243], v2, s[4:7], s75 offen offset:0 sc1
  ds_read_b64_tr_b16 v[16:17], v8 offset:38912
  ds_read_b64_tr_b16 v[18:19], v8 offset:39168
  ds_read_b64_tr_b16 v[20:21], v10 offset:38912
  ds_read_b64_tr_b16 v[22:23], v10 offset:39168
  ds_read_b64_tr_b16 v[24:25], v12 offset:38912
  ds_read_b64_tr_b16 v[26:27], v12 offset:39168
  s_waitcnt vmcnt(45) lgkmcnt(6)
  v_mfma_f32_32x32x16_bf16 a[0:15], v[28:31], v[244:247], a[0:15]
  v_mfma_f32_32x32x16_bf16 a[16:31], v[244:247], v[32:35], a[16:31]
  v_mfma_f32_32x32x16_bf16 a[32:47], v[36:39], v[244:247], a[32:47]
  buffer_load_dwordx4 v[244:247], v2, s[4:7], s75 offen offset:1024 sc1
  ds_read_b64_tr_b16 v[28:29], v8 offset:39936
  ds_read_b64_tr_b16 v[30:31], v8 offset:40192
  ds_read_b64_tr_b16 v[32:33], v10 offset:39936
  ds_read_b64_tr_b16 v[34:35], v10 offset:40192
  ds_read_b64_tr_b16 v[36:37], v12 offset:39936
  ds_read_b64_tr_b16 v[38:39], v12 offset:40192
  s_waitcnt vmcnt(45) lgkmcnt(6)
  v_mfma_f32_32x32x16_bf16 a[0:15], v[16:19], v[248:251], a[0:15]
  v_mfma_f32_32x32x16_bf16 a[16:31], v[248:251], v[20:23], a[16:31]
  v_mfma_f32_32x32x16_bf16 a[32:47], v[24:27], v[248:251], a[32:47]
  buffer_load_dwordx4 v[248:251], v2, s[4:7], s75 offen offset:2048 sc1
  s_cmp_eq_u32 s22, 2
  s_cbranch_scc1 Lwqs_26
  s_waitcnt vmcnt(39)
  s_barrier
  s_cmp_eq_u32 s17, 0
  s_cselect_b32 s25, s31, 2147479552
  s_mov_b64 exec, 1
  v_mov_b32 v4, 1
  buffer_atomic_add v4, off, s[4:7], s25
  s_mov_b64 exec, -1
  s_add_u32 s31, s31, 4
Lwqs_26:
  s_waitcnt vmcnt(45) lgkmcnt(0)
  v_mfma_f32_32x32x16_bf16 a[0:15], v[28:31], v[252:255], a[0:15]
  v_mfma_f32_32x32x16_bf16 a[16:31], v[252:255], v[32:35], a[16:31]
  v_mfma_f32_32x32x16_bf16 a[32:47], v[36:39], v[252:255], a[32:47]
  buffer_load_dwordx4 v[252:255], v2, s[4:7], s75 offen offset:3072 sc1
  s_add_u32 s27, s27, 163840
  v_accvgpr_read_b32 v40, a0
  v_accvgpr_read_b32 v41, a1
  v_accvgpr_read_b32 v42, a2
  v_accvgpr_read_b32 v43, a3
  v_accvgpr_read_b32 v44, a4
  v_accvgpr_read_b32 v45, a5
  v_accvgpr_read_b32 v46, a6
  v_accvgpr_read_b32 v47, a7
  v_accvgpr_read_b32 v48, a8
  v_accvgpr_read_b32 v49, a9
  v_accvgpr_read_b32 v50, a10
  v_accvgpr_read_b32 v51, a11
  v_accvgpr_read_b32 v52, a12
  v_accvgpr_read_b32 v53, a13
  v_accvgpr_read_b32 v54, a14
  v_accvgpr_read_b32 v55, a15
  v_cvt_pk_bf16_f32 v56, v40, v41
  v_cvt_pk_bf16_f32 v57, v42, v43
  v_cvt_pk_bf16_f32 v58, v44, v45
  v_cvt_pk_bf16_f32 v59, v46, v47
  v_cvt_pk_bf16_f32 v60, v48, v49
  v_cvt_pk_bf16_f32 v61, v50, v51
  v_cvt_pk_bf16_f32 v62, v52, v53
  v_cvt_pk_bf16_f32 v63, v54, v55
  s_add_u32 s25, s28, 19922944
  buffer_store_dwordx4 v[56:59], v2, s[4:7], s25 offen sc1
  buffer_store_dwordx4 v[60:63], v2, s[4:7], s25 offen offset:1024 sc1
  v_accvgpr_read_b32 v40, a16
  v_accvgpr_read_b32 v41, a17
  v_accvgpr_read_b32 v42, a18
  v_accvgpr_read_b32 v43, a19
  v_accvgpr_read_b32 v44, a20
  v_accvgpr_read_b32 v45, a21
  v_accvgpr_read_b32 v46, a22
  v_accvgpr_read_b32 v47, a23
  v_accvgpr_read_b32 v48, a24
  v_accvgpr_read_b32 v49, a25
  v_accvgpr_read_b32 v50, a26
  v_accvgpr_read_b32 v51, a27
  v_accvgpr_read_b32 v52, a28
  v_accvgpr_read_b32 v53, a29
  v_accvgpr_read_b32 v54, a30
  v_accvgpr_read_b32 v55, a31
  v_cvt_pk_bf16_f32 v64, v40, v41
  v_cvt_pk_bf16_f32 v65, v42, v43
  v_cvt_pk_bf16_f32 v66, v44, v45
  v_cvt_pk_bf16_f32 v67, v46, v47
  v_cvt_pk_bf16_f32 v68, v48, v49
  v_cvt_pk_bf16_f32 v69, v50, v51
  v_cvt_pk_bf16_f32 v70, v52, v53
  v_cvt_pk_bf16_f32 v71, v54, v55
  s_add_u32 s25, s28, 36700160
  buffer_store_dwordx4 v[64:67], v7, s[4:7], s25 offen sc1
  buffer_store_dwordx4 v[68:71], v7, s[4:7], s25 offen offset:1024 sc1
  v_accvgpr_read_b32 v40, a32
  v_accvgpr_read_b32 v41, a33
  v_accvgpr_read_b32 v42, a34
  v_accvgpr_read_b32 v43, a35
  v_accvgpr_read_b32 v44, a36
  v_accvgpr_read_b32 v45, a37
  v_accvgpr_read_b32 v46, a38
  v_accvgpr_read_b32 v47, a39
  v_accvgpr_read_b32 v48, a40
  v_accvgpr_read_b32 v49, a41
  v_accvgpr_read_b32 v50, a42
  v_accvgpr_read_b32 v51, a43
  v_accvgpr_read_b32 v52, a44
  v_accvgpr_read_b32 v53, a45
  v_accvgpr_read_b32 v54, a46
  v_accvgpr_read_b32 v55, a47
  v_cvt_pk_bf16_f32 v72, v40, v41
  v_cvt_pk_bf16_f32 v73, v42, v43
  v_cvt_pk_bf16_f32 v74, v44, v45
  v_cvt_pk_bf16_f32 v75, v46, v47
  v_cvt_pk_bf16_f32 v76, v48, v49
  v_cvt_pk_bf16_f32 v77, v50, v51
  v_cvt_pk_bf16_f32 v78, v52, v53
  v_cvt_pk_bf16_f32 v79, v54, v55
  s_add_u32 s25, s28, 53477376
  buffer_store_dwordx4 v[72:75], v2, s[4:7], s25 offen sc1
  buffer_store_dwordx4 v[76:79], v2, s[4:7], s25 offen offset:1024 sc1
  s_add_u32 s28, s28, 1048576
  s_add_u32 s22, s22, 1
  s_cmp_lt_u32 s22, 16
  s_cbranch_scc1 Lwq_24
  s_waitcnt vmcnt(0)
  s_barrier
  s_cmp_eq_u32 s17, 0
  s_cselect_b32 s25, s31, 2147479552
  s_mov_b64 exec, 1
  v_mov_b32 v4, 1
  buffer_atomic_add v4, off, s[4:7], s25
  s_mov_b64 exec, -1
  s_add_u32 s31, s31, 4
  s_branch mk_dq0
mk_nq0:
  v_mbcnt_lo_u32_b32 v40, -1, 0
  v_mbcnt_hi_u32_b32 v40, -1, v40
  v_lshlrev_b32 v40, 2, v40
Liw_27:
  buffer_load_dword v41, v40, s[76:79], 0 offen offset:160 sc1
  s_waitcnt vmcnt(0)
  v_readlane_b32 s24, v41, 0
  v_readlane_b32 s25, v41, 1
  s_nop 0
  s_add_u32 s24, s24, s25
  v_readlane_b32 s25, v41, 2
  s_nop 0
  s_add_u32 s24, s24, s25
  v_readlane_b32 s25, v41, 3
  s_nop 0
  s_add_u32 s24, s24, s25
  v_readlane_b32 s25, v41, 4
  s_nop 0
  s_add_u32 s24, s24, s25
  v_readlane_b32 s25, v41, 5
  s_nop 0
  s_add_u32 s24, s24, s25
  v_readlane_b32 s25, v41, 6
  s_nop 0
  s_add_u32 s24, s24, s25
  v_readlane_b32 s25, v41, 7
  s_nop 0
  s_add_u32 s24, s24, s25
  s_add_u32 s0, s0, 1
  s_cmp_ge_u32 s24, 160
  s_cbranch_scc1 Liw_27_ok
  s_sleep 4
  s_cmp_lt_u32 s0, 1572864
  s_cbranch_scc1 Liw_27
Liw_27_ok:
  s_barrier
  v_lshrrev_b32 v3, 3, v0
  v_lshlrev_b32 v6, 9, v3
  v_and_b32 v3, 7, v0
  v_lshl_add_u32 v6, v3, 4, v6
  v_lshlrev_b32 v8, 4, v3
  v_add_u32 v8, 122880, v8
  s_lshl_b32 s24, s17, 2
  v_add_u32 v7, s24, v8
  s_cmp_lt_u32 s17, 2
  s_cselect_b32 s34, 1.0, 0
  s_mov_b32 s26, 0x60000000
  s_cselect_b32 s26, 32768, s26
  s_add_u32 s21, s51, 0
Llnf_28:
  s_lshr_b32 s24, s21, 4
  s_lshl_b32 s22, s24, 7
  s_lshr_b32 s27, s21, 2
  s_mul_i32 s27, s27, 40960
  s_and_b32 s24, s21, 3
  s_lshl_b32 s24, s24, 7
  s_add_u32 s27, s27, s24
  s_mov_b32 s68, s64
  s_and_b32 s69, s65, 0xffff
  s_mov_b32 s70, 2621440
  s_mov_b32 s71, 0x00020000
  s_lshr_b32 s25, s21, 2
  s_lshl_b32 s25, s25, 5
  s_and_b32 s24, s21, 3
  s_lshl_b32 s24, s24, 2
  s_add_u32 s25, s25, s24
  s_mul_i32 s25, s25, 1280
  v_bfe_u32 v3, v0, 2, 1
  v_lshlrev_b32 v3, 4, v3
  v_and_b32 v4, 3, v0
  v_add_u32 v3, v3, v4
  v_mul_u32_u24 v3, 0x500, v3
  v_lshrrev_b32 v4, 3, v0
  v_lshl_add_u32 v3, v4, 4, v3
  s_add_u32 s24, s25, s26
  s_cmp_lt_u32 s17, 2
  s_cselect_b32 s24, s25, s24
  buffer_load_dwordx4 v[12:15], v3, s[68:71], s25 offen offset:0
  buffer_load_dwordx4 v[16:19], v3, s[68:71], s25 offen offset:512
  buffer_load_dwordx4 v[20:23], v3, s[68:71], s24 offen offset:1024
  s_waitcnt vmcnt(0)
  v_lshlrev_b32 v24, 16, v12
  v_and_b32 v25, 0xffff0000, v12
  v_lshlrev_b32 v26, 16, v13
  v_and_b32 v27, 0xffff0000, v13
  v_lshlrev_b32 v28, 16, v14
  v_and_b32 v29, 0xffff0000, v14
  v_lshlrev_b32 v30, 16, v15
  v_and_b32 v31, 0xffff0000, v15
  v_lshlrev_b32 v32, 16, v16
  v_and_b32 v33, 0xffff0000, v16
  v_lshlrev_b32 v34, 16, v17
  v_and_b32 v35, 0xffff0000, v17
  v_lshlrev_b32 v36, 16, v18
  v_and_b32 v37, 0xffff0000, v18
  v_lshlrev_b32 v38, 16, v19
  v_and_b32 v39, 0xffff0000, v19
  v_lshlrev_b32 v40, 16, v20
  v_and_b32 v41, 0xffff0000, v20
  v_lshlrev_b32 v42, 16, v21
  v_and_b32 v43, 0xffff0000, v21
  v_lshlrev_b32 v44, 16, v22
  v_and_b32 v45, 0xffff0000, v22
  v_lshlrev_b32 v46, 16, v23
  v_and_b32 v47, 0xffff0000, v23
  v_add_f32 v9, v24, v25
  v_add_f32 v10, v26, v27
  v_add_f32 v9, v9, v28
  v_add_f32 v10, v10, v29
  v_add_f32 v9, v9, v30
  v_add_f32 v10, v10, v31
  v_add_f32 v9, v9, v32
  v_add_f32 v10, v10, v33
  v_add_f32 v9, v9, v34
  v_add_f32 v10, v10, v35
  v_add_f32 v9, v9, v36
  v_add_f32 v10, v10, v37
  v_add_f32 v9, v9, v38
  v_add_f32 v10, v10, v39
  v_add_f32 v9, v9, v40
  v_add_f32 v10, v10, v41
  v_add_f32 v9, v9, v42
  v_add_f32 v10, v10, v43
  v_add_f32 v9, v9, v44
  v_add_f32 v10, v10, v45
  v_add_f32 v9, v9, v46
  v_add_f32 v10, v10, v47
  v_add_f32 v9, v9, v10
  s_nop 1
  v_add_f32_dpp v9, v9, v9 row_ror:8 row_mask:0xf bank_mask:0xf
  v_mov_b32 v10, v9
  s_nop 1
  v_permlane16_swap_b32 v9, v10
  v_add_f32 v9, v9, v10
  v_mov_b32 v10, v9
  s_nop 1
  v_permlane32_swap_b32 v9, v10
  v_add_f32 v9, v9, v10
  ds_write_b32 v7, v9 offset:0
  s_waitcnt lgkmcnt(0)
  s_barrier
  ds_read_b128 v[48:51], v8 offset:0
  s_waitcnt lgkmcnt(0)
  v_add_f32 v48, v48, v49
  v_add_f32 v50, v50, v51
  v_add_f32 v9, v48, v50
  v_mul_f32 v9, 0x3acccccd, v9
  v_mov_b32 v11, 0
  v_mov_b32 v52, 0
  v_sub_f32 v10, v24, v9
  v_fmac_f32 v11, v10, v10
  v_sub_f32 v10, v25, v9
  v_fmac_f32 v11, v10, v10
  v_sub_f32 v10, v26, v9
  v_fmac_f32 v11, v10, v10
  v_sub_f32 v10, v27, v9
  v_fmac_f32 v11, v10, v10
  v_sub_f32 v10, v28, v9
  v_fmac_f32 v11, v10, v10
  v_sub_f32 v10, v29, v9
  v_fmac_f32 v11, v10, v10
  v_sub_f32 v10, v30, v9
  v_fmac_f32 v11, v10, v10
  v_sub_f32 v10, v31, v9
  v_fmac_f32 v11, v10, v10
  v_sub_f32 v10, v32, v9
  v_fmac_f32 v11, v10, v10
  v_sub_f32 v10, v33, v9
  v_fmac_f32 v11, v10, v10
  v_sub_f32 v10, v34, v9
  v_fmac_f32 v11, v10, v10
  v_sub_f32 v10, v35, v9
  v_fmac_f32 v11, v10, v10
  v_sub_f32 v10, v36, v9
  v_fmac_f32 v11, v10, v10
  v_sub_f32 v10, v37, v9
  v_fmac_f32 v11, v10, v10
  v_sub_f32 v10, v38, v9
  v_fmac_f32 v11, v10, v10
  v_sub_f32 v10, v39, v9
  v_fmac_f32 v11, v10, v10
  v_sub_f32 v10, v40, v9
  v_fmac_f32 v52, v10, v10
  v_sub_f32 v10, v41, v9
  v_fmac_f32 v52, v10, v10
  v_sub_f32 v10, v42, v9
  v_fmac_f32 v52, v10, v10
  v_sub_f32 v10, v43, v9
  v_fmac_f32 v52, v10, v10
  v_sub_f32 v10, v44, v9
  v_fmac_f32 v52, v10, v10
  v_sub_f32 v10, v45, v9
  v_fmac_f32 v52, v10, v10
  v_sub_f32 v10, v46, v9
  v_fmac_f32 v52, v10, v10
  v_sub_f32 v10, v47, v9
  v_fmac_f32 v52, v10, v10
  v_fmac_f32 v11, s34, v52
  s_nop 1
  v_add_f32_dpp v11, v11, v11 row_ror:8 row_mask:0xf bank_mask:0xf
  v_mov_b32 v10, v11
  s_nop 1
  v_permlane16_swap_b32 v11, v10
  v_add_f32 v11, v11, v10
  v_mov_b32 v10, v11
  s_nop 1
  v_permlane32_swap_b32 v11, v10
  v_add_f32 v11, v11, v10
  ds_write_b32 v7, v11 offset:128
  s_waitcnt lgkmcnt(0)
  s_barrier
  ds_read_b128 v[48:51], v8 offset:128
  s_waitcnt lgkmcnt(0)
  v_add_f32 v48, v48, v49
  v_add_f32 v50, v50, v51
  v_add_f32 v11, v48, v50
  v_mul_f32 v11, 0x3acccccd, v11
  v_cvt_pk_bf16_f32 v9, v9, v9
  v_and_b32 v9, 0xffff0000, v9
  v_cvt_pk_bf16_f32 v11, v11, v11
  v_and_b32 v11, 0xffff0000, v11
  v_add_f32 v11, 0x3727c5ac, v11
  v_cvt_pk_bf16_f32 v11, v11, v11
  v_and_b32 v11, 0xffff0000, v11
  v_sqrt_f32 v11, v11
  s_nop 0
  v_cvt_pk_bf16_f32 v11, v11, v11
  v_and_b32 v11, 0xffff0000, v11
  v_rcp_f32 v11, v11
  v_sub_f32 v24, v24, v9
  v_sub_f32 v25, v25, v9
  v_cvt_pk_bf16_f32 v12, v24, v25
  v_sub_f32 v26, v26, v9
  v_sub_f32 v27, v27, v9
  v_cvt_pk_bf16_f32 v13, v26, v27
  v_sub_f32 v28, v28, v9
  v_sub_f32 v29, v29, v9
  v_cvt_pk_bf16_f32 v14, v28, v29
  v_sub_f32 v30, v30, v9
  v_sub_f32 v31, v31, v9
  v_cvt_pk_bf16_f32 v15, v30, v31
  v_sub_f32 v32, v32, v9
  v_sub_f32 v33, v33, v9
  v_cvt_pk_bf16_f32 v16, v32, v33
  v_sub_f32 v34, v34, v9
  v_sub_f32 v35, v35, v9
  v_cvt_pk_bf16_f32 v17, v34, v35
  v_sub_f32 v36, v36, v9
  v_sub_f32 v37, v37, v9
  v_cvt_pk_bf16_f32 v18, v36, v37
  v_sub_f32 v38, v38, v9
  v_sub_f32 v39, v39, v9
  v_cvt_pk_bf16_f32 v19, v38, v39
  v_sub_f32 v40, v40, v9
  v_sub_f32 v41, v41, v9
  v_cvt_pk_bf16_f32 v20, v40, v41
  v_sub_f32 v42, v42, v9
  v_sub_f32 v43, v43, v9
  v_cvt_pk_bf16_f32 v21, v42, v43
  v_sub_f32 v44, v44, v9
  v_sub_f32 v45, v45, v9
  v_cvt_pk_bf16_f32 v22, v44, v45
  v_sub_f32 v46, v46, v9
  v_sub_f32 v47, v47, v9
  v_cvt_pk_bf16_f32 v23, v46, v47
  v_lshlrev_b32 v24, 16, v12
  v_and_b32 v25, 0xffff0000, v12
  v_mul_f32 v24, v24, v11
  v_mul_f32 v25, v25, v11
  v_cvt_pk_bf16_f32 v12, v24, v25
  v_lshlrev_b32 v26, 16, v13
  v_and_b32 v27, 0xffff0000, v13
  v_mul_f32 v26, v26, v11
  v_mul_f32 v27, v27, v11
  v_cvt_pk_bf16_f32 v13, v26, v27
  v_lshlrev_b32 v28, 16, v14
  v_and_b32 v29, 0xffff0000, v14
  v_mul_f32 v28, v28, v11
  v_mul_f32 v29, v29, v11
  v_cvt_pk_bf16_f32 v14, v28, v29
  v_lshlrev_b32 v30, 16, v15
  v_and_b32 v31, 0xffff0000, v15
  v_mul_f32 v30, v30, v11
  v_mul_f32 v31, v31, v11
  v_cvt_pk_bf16_f32 v15, v30, v31
  v_lshlrev_b32 v32, 16, v16
  v_and_b32 v33, 0xffff0000, v16
  v_mul_f32 v32, v32, v11
  v_mul_f32 v33, v33, v11
  v_cvt_pk_bf16_f32 v16, v32, v33
  v_lshlrev_b32 v34, 16, v17
  v_and_b32 v35, 0xffff0000, v17
  v_mul_f32 v34, v34, v11
  v_mul_f32 v35, v35, v11
  v_cvt_pk_bf16_f32 v17, v34, v35
  v_lshlrev_b32 v36, 16, v18
  v_and_b32 v37, 0xffff0000, v18
  v_mul_f32 v36, v36, v11
  v_mul_f32 v37, v37, v11
  v_cvt_pk_bf16_f32 v18, v36, v37
  v_lshlrev_b32 v38, 16, v19
  v_and_b32 v39, 0xffff0000, v19
  v_mul_f32 v38, v38, v11
  v_mul_f32 v39, v39, v11
  v_cvt_pk_bf16_f32 v19, v38, v39
  v_lshlrev_b32 v40, 16, v20
  v_and_b32 v41, 0xffff0000, v20
  v_mul_f32 v40, v40, v11
  v_mul_f32 v41, v41, v11
  v_cvt_pk_bf16_f32 v20, v40, v41
  v_lshlrev_b32 v42, 16, v21
  v_and_b32 v43, 0xffff0000, v21
  v_mul_f32 v42, v42, v11
  v_mul_f32 v43, v43, v11
  v_cvt_pk_bf16_f32 v21, v42, v43
  v_lshlrev_b32 v44, 16, v22
  v_and_b32 v45, 0xffff0000, v22
  v_mul_f32 v44, v44, v11
  v_mul_f32 v45, v45, v11
  v_cvt_pk_bf16_f32 v22, v44, v45
  v_lshlrev_b32 v46, 16, v23
  v_and_b32 v47, 0xffff0000, v23
  v_mul_f32 v46, v46, v11
  v_mul_f32 v47, v47, v11
  v_cvt_pk_bf16_f32 v23, v46, v47
  s_add_u32 s25, s27, 16777216
  buffer_store_dwordx4 v[12:15], v6, s[4:7], s25 offen sc1
  s_add_u32 s25, s27, 16793600
  buffer_store_dwordx4 v[16:19], v6, s[4:7], s25 offen sc1
  s_add_u32 s25, s27, s26
  s_add_u32 s25, s25, 16777216
  buffer_store_dwordx4 v[20:23], v6, s[4:7], s25 offen sc1
  s_add_u32 s24, s22, 3674112
  s_waitcnt vmcnt(0)
  s_barrier
  v_cmp_eq_u32 vcc, 0, v0
  s_nop 0
  s_and_saveexec_b64 s[32:33], vcc
  s_cbranch_execz Lsig_29
  v_mov_b32 v3, 0
  v_mov_b32 v4, 1
  buffer_atomic_add v4, v3, s[4:7], s24 offen
Lsig_29:
  s_mov_b64 exec, s[32:33]
  s_cmp_lt_u32 s21, 32
  s_cselect_b32 s24, 160, 32
  s_add_u32 s21, s21, s24
  s_cmp_lt_u32 s21, 256
  s_cbranch_scc1 Llnf_28
mk_dq0:
  s_cmp_lt_u32 s50, 60
  s_cbranch_scc0 mk_nwo0
  s_mov_b32 s24, s50
  s_mul_i32 s22, s24, 3277
  s_lshr_b32 s22, s22, 16
  s_mul_i32 s25, s22, 20
  s_sub_u32 s23, s24, s25
  s_mov_b32 s8, s62
  s_and_b32 s9, s63, 0xffff
  s_mov_b32 s10, 5242880
  s_mov_b32 s11, 0x00020000
  v_lshrrev_b32 v3, 2, v1
  v_mul_u32_u24 v3, 0x500, v3
  v_and_b32 v4, 3, v1
  v_lshl_add_u32 v6, v4, 4, v3
  v_lshrrev_b32 v3, 5, v1
  v_mul_u32_u24 v3, 4, v3
  v_bfe_u32 v4, v1, 2, 2
  v_add_u32 v3, v3, v4
  v_mul_u32_u24 v7, 64, v3
  v_bfe_u32 v4, v1, 1, 1
  v_lshl_add_u32 v7, v4, 3, v7
  v_bfe_u32 v4, v1, 4, 1
  v_lshl_add_u32 v7, v4, 4, v7
  v_bfe_u32 v4, v1, 0, 1
  v_lshl_add_u32 v7, v4, 5, v7
  s_lshl_b32 s26, s17, 15
  v_add_u32 v7, s26, v7
  s_mul_i32 s28, s17, 1310720
  s_lshl_b32 s25, s23, 6
  s_add_u32 s28, s28, s25
  s_add_u32 m0, s26, 0
  s_nop 0
  buffer_load_dwordx4 v6, s[8:11], s28 offen lds
  s_add_u32 s28, s28, 20480
  s_add_u32 m0, s26, 1024
  s_nop 0
  buffer_load_dwordx4 v6, s[8:11], s28 offen lds
  s_add_u32 s28, s28, 20480
  s_add_u32 m0, s26, 2048
  s_nop 0
  buffer_load_dwordx4 v6, s[8:11], s28 offen lds
  s_add_u32 s28, s28, 20480
  s_add_u32 m0, s26, 3072
  s_nop 0
  buffer_load_dwordx4 v6, s[8:11], s28 offen lds
  s_add_u32 s28, s28, 20480
  s_add_u32 m0, s26, 4096
  s_nop 0
  buffer_load_dwordx4 v6, s[8:11], s28 offen lds
  s_add_u32 s28, s28, 20480
  s_add_u32 m0, s26, 5120
  s_nop 0
  buffer_load_dwordx4 v6, s[8:11], s28 offen lds
  s_add_u32 s28, s28, 20480
  s_add_u32 m0, s26, 6144
  s_nop 0
  buffer_load_dwordx4 v6, s[8:11], s28 offen lds
  s_add_u32 s28, s28, 20480
  s_add_u32 m0, s26, 7168
  s_nop 0
  buffer_load_dwordx4 v6, s[8:11], s28 offen lds
  s_add_u32 s28, s28, 20480
  s_add_u32 m0, s26, 8192
  s_nop 0
  buffer_load_dwordx4 v6, s[8:11], s28 offen lds
  s_add_u32 s28, s28, 20480
  s_add_u32 m0, s26, 9216
  s_nop 0
  buffer_load_dwordx4 v6, s[8:11], s28 offen lds
  s_add_u32 s28, s28, 20480
  s_add_u32 m0, s26, 10240
  s_nop 0
  buffer_load_dwordx4 v6, s[8:11], s28 offen lds
  s_add_u32 s28, s28, 20480
  s_add_u32 m0, s26, 11264
  s_nop 0
  buffer_load_dwordx4 v6, s[8:11], s28 offen lds
  s_add_u32 s28, s28, 20480
  s_add_u32 m0, s26, 12288
  s_nop 0
  buffer_load_dwordx4 v6, s[8:11], s28 offen lds
  s_add_u32 s28, s28, 20480
  s_add_u32 m0, s26, 13312
  s_nop 0
  buffer_load_dwordx4 v6, s[8:11], s28 offen lds
  s_add_u32 s28, s28, 20480
  s_add_u32 m0, s26, 14336
  s_nop 0
  buffer_load_dwordx4 v6, s[8:11], s28 offen lds
  s_add_u32 s28, s28, 20480
  s_add_u32 m0, s26, 15360
  s_nop 0
  buffer_load_dwordx4 v6, s[8:11], s28 offen lds
  s_add_u32 s28, s28, 20480
  s_add_u32 m0, s26, 16384
  s_nop 0
  buffer_load_dwordx4 v6, s[8:11], s28 offen lds
  s_add_u32 s28, s28, 20480
  s_add_u32 m0, s26, 17408
  s_nop 0
  buffer_load_dwordx4 v6, s[8:11], s28 offen lds
  s_add_u32 s28, s28, 20480
  s_add_u32 m0, s26, 18432
  s_nop 0
  buffer_load_dwordx4 v6, s[8:11], s28 offen lds
  s_add_u32 s28, s28, 20480
  s_add_u32 m0, s26, 19456
  s_nop 0
  buffer_load_dwordx4 v6, s[8:11], s28 offen lds
  s_add_u32 s28, s28, 20480
  s_add_u32 m0, s26, 20480
  s_nop 0
  buffer_load_dwordx4 v6, s[8:11], s28 offen lds
  s_add_u32 s28, s28, 20480
  s_add_u32 m0, s26, 21504
  s_nop 0
  buffer_load_dwordx4 v6, s[8:11], s28 offen lds
  s_add_u32 s28, s28, 20480
  s_add_u32 m0, s26, 22528
  s_nop 0
  buffer_load_dwordx4 v6, s[8:11], s28 offen lds
  s_add_u32 s28, s28, 20480
  s_add_u32 m0, s26, 23552
  s_nop 0
  buffer_load_dwordx4 v6, s[8:11], s28 offen lds
  s_add_u32 s28, s28, 20480
  s_add_u32 m0, s26, 24576
  s_nop 0
  buffer_load_dwordx4 v6, s[8:11], s28 offen lds
  s_add_u32 s28, s28, 20480
  s_add_u32 m0, s26, 25600
  s_nop 0
  buffer_load_dwordx4 v6, s[8:11], s28 offen lds
  s_add_u32 s28, s28, 20480
  s_add_u32 m0, s26, 26624
  s_nop 0
  buffer_load_dwordx4 v6, s[8:11], s28 offen lds
  s_add_u32 s28, s28, 20480
  s_add_u32 m0, s26, 27648
  s_nop 0
  buffer_load_dwordx4 v6, s[8:11], s28 offen lds
  s_add_u32 s28, s28, 20480
  s_add_u32 m0, s26, 28672
  s_nop 0
  buffer_load_dwordx4 v6, s[8:11], s28 offen lds
  s_add_u32 s28, s28, 20480
  s_add_u32 m0, s26, 29696
  s_nop 0
  buffer_load_dwordx4 v6, s[8:11], s28 offen lds
  s_add_u32 s28, s28, 20480
  s_add_u32 m0, s26, 30720
  s_nop 0
  buffer_load_dwordx4 v6, s[8:11], s28 offen lds
  s_add_u32 s28, s28, 20480
  s_add_u32 m0, s26, 31744
  s_nop 0
  buffer_load_dwordx4 v6, s[8:11], s28 offen lds
  s_add_u32 s28, s28, 20480
  s_waitcnt vmcnt(24)
  ds_read_b64_tr_b16 a[0:1], v7 offset:0
  ds_read_b64_tr_b16 a[2:3], v7 offset:512
  ds_read_b64_tr_b16 a[4:5], v7 offset:1024
  ds_read_b64_tr_b16 a[6:7], v7 offset:1536
  ds_read_b64_tr_b16 a[8:9], v7 offset:2048
  ds_read_b64_tr_b16 a[10:11], v7 offset:2560
  ds_read_b64_tr_b16 a[12:13], v7 offset:3072
  ds_read_b64_tr_b16 a[14:15], v7 offset:3584
  s_waitcnt lgkmcnt(0)
  ds_read_b64_tr_b16 a[16:17], v7 offset:4096
  ds_read_b64_tr_b16 a[18:19], v7 offset:4608
  ds_read_b64_tr_b16 a[20:21], v7 offset:5120
  ds_read_b64_tr_b16 a[22:23], v7 offset:5632
  ds_read_b64_tr_b16 a[24:25], v7 offset:6144
  ds_read_b64_tr_b16 a[26:27], v7 offset:6656
  ds_read_b64_tr_b16 a[28:29], v7 offset:7168
  ds_read_b64_tr_b16 a[30:31], v7 offset:7680
  s_waitcnt lgkmcnt(0)
  s_waitcnt vmcnt(16)
  ds_read_b64_tr_b16 a[32:33], v7 offset:8192
  ds_read_b64_tr_b16 a[34:35], v7 offset:8704
  ds_read_b64_tr_b16 a[36:37], v7 offset:9216
  ds_read_b64_tr_b16 a[38:39], v7 offset:9728
  ds_read_b64_tr_b16 a[40:41], v7 offset:10240
  ds_read_b64_tr_b16 a[42:43], v7 offset:10752
  ds_read_b64_tr_b16 a[44:45], v7 offset:11264
  ds_read_b64_tr_b16 a[46:47], v7 offset:11776
  s_waitcnt lgkmcnt(0)
  ds_read_b64_tr_b16 a[48:49], v7 offset:12288
  ds_read_b64_tr_b16 a[50:51], v7 offset:12800
  ds_read_b64_tr_b16 a[52:53], v7 offset:13312
  ds_read_b64_tr_b16 a[54:55], v7 offset:13824
  ds_read_b64_tr_b16 a[56:57], v7 offset:14336
  ds_read_b64_tr_b16 a[58:59], v7 offset:14848
  ds_read_b64_tr_b16 a[60:61], v7 offset:15360
  ds_read_b64_tr_b16 a[62:63], v7 offset:15872
  s_waitcnt lgkmcnt(0)
  s_waitcnt vmcnt(8)
  ds_read_b64_tr_b16 a[64:65], v7 offset:16384
  ds_read_b64_tr_b16 a[66:67], v7 offset:16896
  ds_read_b64_tr_b16 a[68:69], v7 offset:17408
  ds_read_b64_tr_b16 a[70:71], v7 offset:17920
  ds_read_b64_tr_b16 a[72:73], v7 offset:18432
  ds_read_b64_tr_b16 a[74:75], v7 offset:18944
  ds_read_b64_tr_b16 a[76:77], v7 offset:19456
  ds_read_b64_tr_b16 a[78:79], v7 offset:19968
  s_waitcnt lgkmcnt(0)
  ds_read_b64_tr_b16 a[80:81], v7 offset:20480
  ds_read_b64_tr_b16 a[82:83], v7 offset:20992
  ds_read_b64_tr_b16 a[84:85], v7 offset:21504
  ds_read_b64_tr_b16 a[86:87], v7 offset:22016
  ds_read_b64_tr_b16 a[88:89], v7 offset:22528
  ds_read_b64_tr_b16 a[90:91], v7 offset:23040
  ds_read_b64_tr_b16 a[92:93], v7 offset:23552
  ds_read_b64_tr_b16 a[94:95], v7 offset:24064
  s_waitcnt lgkmcnt(0)
  s_waitcnt vmcnt(0)
  ds_read_b64_tr_b16 a[96:97], v7 offset:24576
  ds_read_b64_tr_b16 a[98:99], v7 offset:25088
  ds_read_b64_tr_b16 a[100:101], v7 offset:25600
  ds_read_b64_tr_b16 a[102:103], v7 offset:26112
  ds_read_b64_tr_b16 a[104:105], v7 offset:26624
  ds_read_b64_tr_b16 a[106:107], v7 offset:27136
  ds_read_b64_tr_b16 a[108:109], v7 offset:27648
  ds_read_b64_tr_b16 a[110:111], v7 offset:28160
  s_waitcnt lgkmcnt(0)
  ds_read_b64_tr_b16 a[112:113], v7 offset:28672
  ds_read_b64_tr_b16 a[114:115], v7 offset:29184
  ds_read_b64_tr_b16 a[116:117], v7 offset:29696
  ds_read_b64_tr_b16 a[118:119], v7 offset:30208
  ds_read_b64_tr_b16 a[120:121], v7 offset:30720
  ds_read_b64_tr_b16 a[122:123], v7 offset:31232
  ds_read_b64_tr_b16 a[124:125], v7 offset:31744
  ds_read_b64_tr_b16 a[126:127], v7 offset:32256
  s_waitcnt lgkmcnt(0)
  s_add_u32 m0, s26, 0
  s_nop 0
  buffer_load_dwordx4 v6, s[8:11], s28 offen lds
  s_add_u32 s28, s28, 20480
  s_add_u32 m0, s26, 1024
  s_nop 0
  buffer_load_dwordx4 v6, s[8:11], s28 offen lds
  s_add_u32 s28, s28, 20480
  s_add_u32 m0, s26, 2048
  s_nop 0
  buffer_load_dwordx4 v6, s[8:11], s28 offen lds
  s_add_u32 s28, s28, 20480
  s_add_u32 m0, s26, 3072
  s_nop 0
  buffer_load_dwordx4 v6, s[8:11], s28 offen lds
  s_add_u32 s28, s28, 20480
  s_add_u32 m0, s26, 4096
  s_nop 0
  buffer_load_dwordx4 v6, s[8:11], s28 offen lds
  s_add_u32 s28, s28, 20480
  s_add_u32 m0, s26, 5120
  s_nop 0
  buffer_load_dwordx4 v6, s[8:11], s28 offen lds
  s_add_u32 s28, s28, 20480
  s_add_u32 m0, s26, 6144
  s_nop 0
  buffer_load_dwordx4 v6, s[8:11], s28 offen lds
  s_add_u32 s28, s28, 20480
  s_add_u32 m0, s26, 7168
  s_nop 0
  buffer_load_dwordx4 v6, s[8:11], s28 offen lds
  s_add_u32 s28, s28, 20480
  s_add_u32 m0, s26, 8192
  s_nop 0
  buffer_load_dwordx4 v6, s[8:11], s28 offen lds
  s_add_u32 s28, s28, 20480
  s_add_u32 m0, s26, 9216
  s_nop 0
  buffer_load_dwordx4 v6, s[8:11], s28 offen lds
  s_add_u32 s28, s28, 20480
  s_add_u32 m0, s26, 10240
  s_nop 0
  buffer_load_dwordx4 v6, s[8:11], s28 offen lds
  s_add_u32 s28, s28, 20480
  s_add_u32 m0, s26, 11264
  s_nop 0
  buffer_load_dwordx4 v6, s[8:11], s28 offen lds
  s_add_u32 s28, s28, 20480
  s_add_u32 m0, s26, 12288
  s_nop 0
  buffer_load_dwordx4 v6, s[8:11], s28 offen lds
  s_add_u32 s28, s28, 20480
  s_add_u32 m0, s26, 13312
  s_nop 0
  buffer_load_dwordx4 v6, s[8:11], s28 offen lds
  s_add_u32 s28, s28, 20480
  s_add_u32 m0, s26, 14336
  s_nop 0
  buffer_load_dwordx4 v6, s[8:11], s28 offen lds
  s_add_u32 s28, s28, 20480
  s_add_u32 m0, s26, 15360
  s_nop 0
  buffer_load_dwordx4 v6, s[8:11], s28 offen lds
  s_add_u32 s28, s28, 20480
  s_add_u32 m0, s26, 16384
  s_nop 0
  buffer_load_dwordx4 v6, s[8:11], s28 offen lds
  s_add_u32 s28, s28, 20480
  s_add_u32 m0, s26, 17408
  s_nop 0
  buffer_load_dwordx4 v6, s[8:11], s28 offen lds
  s_add_u32 s28, s28, 20480
  s_add_u32 m0, s26, 18432
  s_nop 0
  buffer_load_dwordx4 v6, s[8:11], s28 offen lds
  s_add_u32 s28, s28, 20480
  s_add_u32 m0, s26, 19456
  s_nop 0
  buffer_load_dwordx4 v6, s[8:11], s28 offen lds
  s_add_u32 s28, s28, 20480
  s_add_u32 m0, s26, 20480
  s_nop 0
  buffer_load_dwordx4 v6, s[8:11], s28 offen lds
  s_add_u32 s28, s28, 20480
  s_add_u32 m0, s26, 21504
  s_nop 0
  buffer_load_dwordx4 v6, s[8:11], s28 offen lds
  s_add_u32 s28, s28, 20480
  s_add_u32 m0, s26, 22528
  s_nop 0
  buffer_load_dwordx4 v6, s[8:11], s28 offen lds
  s_add_u32 s28, s28, 20480
  s_add_u32 m0, s26, 23552
  s_nop 0
  buffer_load_dwordx4 v6, s[8:11], s28 offen lds
  s_add_u32 s28, s28, 20480
  s_add_u32 m0, s26, 24576
  s_nop 0
  buffer_load_dwordx4 v6, s[8:11], s28 offen lds
  s_add_u32 s28, s28, 20480
  s_add_u32 m0, s26, 25600
  s_nop 0
  buffer_load_dwordx4 v6, s[8:11], s28 offen lds
  s_add_u32 s28, s28, 20480
  s_add_u32 m0, s26, 26624
  s_nop 0
  buffer_load_dwordx4 v6, s[8:11], s28 offen lds
  s_add_u32 s28, s28, 20480
  s_add_u32 m0, s26, 27648
  s_nop 0
  buffer_load_dwordx4 v6, s[8:11], s28 offen lds
  s_add_u32 s28, s28, 20480
  s_add_u32 m0, s26, 28672
  s_nop 0
  buffer_load_dwordx4 v6, s[8:11], s28 offen lds
  s_add_u32 s28, s28, 20480
  s_add_u32 m0, s26, 29696
  s_nop 0
  buffer_load_dwordx4 v6, s[8:11], s28 offen lds
  s_add_u32 s28, s28, 20480
  s_add_u32 m0, s26, 30720
  s_nop 0
  buffer_load_dwordx4 v6, s[8:11], s28 offen lds
  s_add_u32 s28, s28, 20480
  s_add_u32 m0, s26, 31744
  s_nop 0
  buffer_load_dwordx4 v6, s[8:11], s28 offen lds
  s_add_u32 s28, s28, 20480
  s_waitcnt vmcnt(24)
  ds_read_b64_tr_b16 a[128:129], v7 offset:0
  ds_read_b64_tr_b16 a[130:131], v7 offset:512
  ds_read_b64_tr_b16 a[132:133], v7 offset:1024
  ds_read_b64_tr_b16 a[134:135], v7 offset:1536
  ds_read_b64_tr_b16 a[136:137], v7 offset:2048
  ds_read_b64_tr_b16 a[138:139], v7 offset:2560
  ds_read_b64_tr_b16 a[140:141], v7 offset:3072
  ds_read_b64_tr_b16 a[142:143], v7 offset:3584
  s_waitcnt lgkmcnt(0)
  ds_read_b64_tr_b16 a[144:145], v7 offset:4096
  ds_read_b64_tr_b16 a[146:147], v7 offset:4608
  ds_read_b64_tr_b16 a[148:149], v7 offset:5120
  ds_read_b64_tr_b16 a[150:151], v7 offset:5632
  ds_read_b64_tr_b16 a[152:153], v7 offset:6144
  ds_read_b64_tr_b16 a[154:155], v7 offset:6656
  ds_read_b64_tr_b16 a[156:157], v7 offset:7168
  ds_read_b64_tr_b16 a[158:159], v7 offset:7680
  s_waitcnt lgkmcnt(0)
  s_waitcnt vmcnt(16)
  ds_read_b64_tr_b16 a[160:161], v7 offset:8192
  ds_read_b64_tr_b16 a[162:163], v7 offset:8704
  ds_read_b64_tr_b16 a[164:165], v7 offset:9216
  ds_read_b64_tr_b16 a[166:167], v7 offset:9728
  ds_read_b64_tr_b16 a[168:169], v7 offset:10240
  ds_read_b64_tr_b16 a[170:171], v7 offset:10752
  ds_read_b64_tr_b16 a[172:173], v7 offset:11264
  ds_read_b64_tr_b16 a[174:175], v7 offset:11776
  s_waitcnt lgkmcnt(0)
  ds_read_b64_tr_b16 a[176:177], v7 offset:12288
  ds_read_b64_tr_b16 a[178:179], v7 offset:12800
  ds_read_b64_tr_b16 a[180:181], v7 offset:13312
  ds_read_b64_tr_b16 a[182:183], v7 offset:13824
  ds_read_b64_tr_b16 a[184:185], v7 offset:14336
  ds_read_b64_tr_b16 a[186:187], v7 offset:14848
  ds_read_b64_tr_b16 a[188:189], v7 offset:15360
  ds_read_b64_tr_b16 a[190:191], v7 offset:15872
  s_waitcnt lgkmcnt(0)
  s_waitcnt vmcnt(8)
  ds_read_b64_tr_b16 a[192:193], v7 offset:16384
  ds_read_b64_tr_b16 a[194:195], v7 offset:16896
  ds_read_b64_tr_b16 a[196:197], v7 offset:17408
  ds_read_b64_tr_b16 a[198:199], v7 offset:17920
  ds_read_b64_tr_b16 a[200:201], v7 offset:18432
  ds_read_b64_tr_b16 a[202:203], v7 offset:18944
  ds_read_b64_tr_b16 a[204:205], v7 offset:19456
  ds_read_b64_tr_b16 a[206:207], v7 offset:19968
  s_waitcnt lgkmcnt(0)
  ds_read_b64_tr_b16 a[208:209], v7 offset:20480
  ds_read_b64_tr_b16 a[210:211], v7 offset:20992
  ds_read_b64_tr_b16 a[212:213], v7 offset:21504
  ds_read_b64_tr_b16 a[214:215], v7 offset:22016
  ds_read_b64_tr_b16 a[216:217], v7 offset:22528
  ds_read_b64_tr_b16 a[218:219], v7 offset:23040
  ds_read_b64_tr_b16 a[220:221], v7 offset:23552
  ds_read_b64_tr_b16 a[222:223], v7 offset:24064
  s_waitcnt lgkmcnt(0)
  s_waitcnt vmcnt(0)
  ds_read_b64_tr_b16 a[224:225], v7 offset:24576
  ds_read_b64_tr_b16 a[226:227], v7 offset:25088
  ds_read_b64_tr_b16 a[228:229], v7 offset:25600
  ds_read_b64_tr_b16 a[230:231], v7 offset:26112
  ds_read_b64_tr_b16 a[232:233], v7 offset:26624
  ds_read_b64_tr_b16 a[234:235], v7 offset:27136
  ds_read_b64_tr_b16 a[236:237], v7 offset:27648
  ds_read_b64_tr_b16 a[238:239], v7 offset:28160
  s_waitcnt lgkmcnt(0)
  ds_read_b64_tr_b16 a[240:241], v7 offset:28672
  ds_read_b64_tr_b16 a[242:243], v7 offset:29184
  ds_read_b64_tr_b16 a[244:245], v7 offset:29696
  ds_read_b64_tr_b16 a[246:247], v7 offset:30208
  ds_read_b64_tr_b16 a[248:249], v7 offset:30720
  ds_read_b64_tr_b16 a[250:251], v7 offset:31232
  ds_read_b64_tr_b16 a[252:253], v7 offset:31744
  ds_read_b64_tr_b16 a[254:255], v7 offset:32256
  s_waitcnt lgkmcnt(0)
  s_barrier
  v_and_b32 v3, 3, v1
  v_bfe_u32 v4, v1, 3, 2
  v_lshl_add_u32 v3, v4, 2, v3
  v_bfe_u32 v4, v1, 2, 1
  v_lshl_add_u32 v3, v4, 4, v3
  v_mul_u32_u24 v8, 0x500, v3
  v_lshrrev_b32 v3, 5, v1
  v_lshl_add_u32 v8, v3, 5, v8
  s_lshl_b32 s25, s23, 6
  s_lshl_b32 s24, s17, 3
  s_add_u32 s25, s25, s24
  v_add_u32 v8, s25, v8
  v_add_u32 v9, s29, v2
  s_lshl_b32 s25, s17, 12
  v_add_u32 v10, s25, v2
  s_mov_b32 s68, s64
  s_and_b32 s69, s65, 0xffff
  s_mov_b32 s70, 2621440
  s_mov_b32 s71, 0x00020000
  s_add_u32 s21, s22, 8
  s_cmp_eq_u32 s22, 0
  s_cselect_b32 s21, 0, s21
  s_mov_b32 s31, 3
  s_mov_b32 s92, 0
Lwotop_30:
  s_mul_i32 s27, s21, 40960
  buffer_load_dwordx2 v[12:13], v8, s[68:71], s27 offen
  s_lshl_b32 s24, s21, 2
  s_add_u32 s24, s24, s17
  s_lshl_b32 s24, s24, 7
  s_add_u32 s24, s24, 3735552
  v_mov_b32 v3, 0
Lwf_31:
  buffer_load_dword v4, v3, s[4:7], s24 offen sc1
  s_waitcnt vmcnt(0)
  v_readfirstlane_b32 s25, v4
  s_add_u32 s0, s0, 1
  s_cmp_ge_u32 s25, 32
  s_cbranch_scc1 Lwf_31_ok
  s_sleep 4
  s_cmp_lt_u32 s0, 1572864
  s_cbranch_scc1 Lwf_31
Lwf_31_ok:
  s_lshl_b32 s24, s21, 18
  s_lshl_b32 s25, s17, 16
  s_add_u32 s24, s24, s25
  s_add_u32 s24, s24, 78643200
  buffer_load_dwordx4 v[64:67], v2, s[4:7], s24 offen offset:0 sc1
  buffer_load_dwordx4 v[68:71], v2, s[4:7], s24 offen offset:1024 sc1
  buffer_load_dwordx4 v[72:75], v2, s[4:7], s24 offen offset:2048 sc1
  buffer_load_dwordx4 v[76:79], v2, s[4:7], s24 offen offset:3072 sc1
  s_add_u32 s24, s24, 4096
  buffer_load_dwordx4 v[80:83], v2, s[4:7], s24 offen offset:0 sc1
  buffer_load_dwordx4 v[84:87], v2, s[4:7], s24 offen offset:1024 sc1
  buffer_load_dwordx4 v[88:91], v2, s[4:7], s24 offen offset:2048 sc1
  buffer_load_dwordx4 v[92:95], v2, s[4:7], s24 offen offset:3072 sc1
  s_add_u32 s24, s24, 4096
  buffer_load_dwordx4 v[96:99], v2, s[4:7], s24 offen offset:0 sc1
  buffer_load_dwordx4 v[100:103], v2, s[4:7], s24 offen offset:1024 sc1
  buffer_load_dwordx4 v[104:107], v2, s[4:7], s24 offen offset:2048 sc1
  buffer_load_dwordx4 v[108:111], v2, s[4:7], s24 offen offset:3072 sc1
  s_add_u32 s24, s24, 4096
  buffer_load_dwordx4 v[112:115], v2, s[4:7], s24 offen offset:0 sc1
  buffer_load_dwordx4 v[116:119], v2, s[4:7], s24 offen offset:1024 sc1
  buffer_load_dwordx4 v[120:123], v2, s[4:7], s24 offen offset:2048 sc1
  buffer_load_dwordx4 v[124:127], v2, s[4:7], s24 offen offset:3072 sc1
  s_add_u32 s24, s24, 4096
  buffer_load_dwordx4 v[128:131], v2, s[4:7], s24 offen offset:0 sc1
  buffer_load_dwordx4 v[132:135], v2, s[4:7], s24 offen offset:1024 sc1
  buffer_load_dwordx4 v[136:139], v2, s[4:7], s24 offen offset:2048 sc1
  buffer_load_dwordx4 v[140:143], v2, s[4:7], s24 offen offset:3072 sc1
  s_add_u32 s24, s24, 4096
  buffer_load_dwordx4 v[144:147], v2, s[4:7], s24 offen offset:0 sc1
  buffer_load_dwordx4 v[148:151], v2, s[4:7], s24 offen offset:1024 sc1
  buffer_load_dwordx4 v[152:155], v2, s[4:7], s24 offen offset:2048 sc1
  buffer_load_dwordx4 v[156:159], v2, s[4:7], s24 offen offset:3072 sc1
  s_add_u32 s24, s24, 4096
  buffer_load_dwordx4 v[160:163], v2, s[4:7], s24 offen offset:0 sc1
  buffer_load_dwordx4 v[164:167], v2, s[4:7], s24 offen offset:1024 sc1
  buffer_load_dwordx4 v[168:171], v2, s[4:7], s24 offen offset:2048 sc1
  buffer_load_dwordx4 v[172:175], v2, s[4:7], s24 offen offset:3072 sc1
  s_add_u32 s24, s24, 4096
  buffer_load_dwordx4 v[176:179], v2, s[4:7], s24 offen offset:0 sc1
  buffer_load_dwordx4 v[180:183], v2, s[4:7], s24 offen offset:1024 sc1
  buffer_load_dwordx4 v[184:187], v2, s[4:7], s24 offen offset:2048 sc1
  buffer_load_dwordx4 v[188:191], v2, s[4:7], s24 offen offset:3072 sc1
  s_add_u32 s24, s24, 4096
  buffer_load_dwordx4 v[192:195], v2, s[4:7], s24 offen offset:0 sc1
  buffer_load_dwordx4 v[196:199], v2, s[4:7], s24 offen offset:1024 sc1
  buffer_load_dwordx4 v[200:203], v2, s[4:7], s24 offen offset:2048 sc1
  buffer_load_dwordx4 v[204:207], v2, s[4:7], s24 offen offset:3072 sc1
  s_add_u32 s24, s24, 4096
  buffer_load_dwordx4 v[208:211], v2, s[4:7], s24 offen offset:0 sc1
  buffer_load_dwordx4 v[212:215], v2, s[4:7], s24 offen offset:1024 sc1
  buffer_load_dwordx4 v[216:219], v2, s[4:7], s24 offen offset:2048 sc1
  buffer_load_dwordx4 v[220:223], v2, s[4:7], s24 offen offset:3072 sc1
  s_waitcnt vmcnt(39)
  v_mfma_f32_32x32x16_bf16 v[16:31], a[0:3], v[64:67], 0
  s_add_u32 s24, s24, 4096
  buffer_load_dwordx4 v[64:67], v2, s[4:7], s24 offen offset:0 sc1
  s_waitcnt vmcnt(39)
  v_mfma_f32_32x32x16_bf16 v[32:47], a[4:7], v[68:71], 0
  buffer_load_dwordx4 v[68:71], v2, s[4:7], s24 offen offset:1024 sc1
  s_waitcnt vmcnt(39)
  v_mfma_f32_32x32x16_bf16 v[16:31], a[8:11], v[72:75], v[16:31]
  buffer_load_dwordx4 v[72:75], v2, s[4:7], s24 offen offset:2048 sc1
  s_waitcnt vmcnt(39)
  v_mfma_f32_32x32x16_bf16 v[32:47], a[12:15], v[76:79], v[32:47]
  buffer_load_dwordx4 v[76:79], v2, s[4:7], s24 offen offset:3072 sc1
  s_waitcnt vmcnt(39)
  v_mfma_f32_32x32x16_bf16 v[16:31], a[16:19], v[80:83], v[16:31]
  s_add_u32 s24, s24, 4096
  buffer_load_dwordx4 v[80:83], v2, s[4:7], s24 offen offset:0 sc1
  s_waitcnt vmcnt(39)
  v_mfma_f32_32x32x16_bf16 v[32:47], a[20:23], v[84:87], v[32:47]
  buffer_load_dwordx4 v[84:87], v2, s[4:7], s24 offen offset:1024 sc1
  s_waitcnt vmcnt(39)
  v_mfma_f32_32x32x16_bf16 v[16:31], a[24:27], v[88:91], v[16:31]
  buffer_load_dwordx4 v[88:91], v2, s[4:7], s24 offen offset:2048 sc1
  s_waitcnt vmcnt(39)
  v_mfma_f32_32x32x16_bf16 v[32:47], a[28:31], v[92:95], v[32:47]
  buffer_load_dwordx4 v[92:95], v2, s[4:7], s24 offen offset:3072 sc1
  s_waitcnt vmcnt(39)
  v_mfma_f32_32x32x16_bf16 v[16:31], a[32:35], v[96:99], v[16:31]
  s_add_u32 s24, s24, 4096
  buffer_load_dwordx4 v[96:99], v2, s[4:7], s24 offen offset:0 sc1
  s_waitcnt vmcnt(39)
  v_mfma_f32_32x32x16_bf16 v[32:47], a[36:39], v[100:103], v[32:47]
  buffer_load_dwordx4 v[100:103], v2, s[4:7], s24 offen offset:1024 sc1
  s_waitcnt vmcnt(39)
  v_mfma_f32_32x32x16_bf16 v[16:31], a[40:43], v[104:107], v[16:31]
  buffer_load_dwordx4 v[104:107], v2, s[4:7], s24 offen offset:2048 sc1
  s_waitcnt vmcnt(39)
  v_mfma_f32_32x32x16_bf16 v[32:47], a[44:47], v[108:111], v[32:47]
  buffer_load_dwordx4 v[108:111], v2, s[4:7], s24 offen offset:3072 sc1
  s_waitcnt vmcnt(39)
  v_mfma_f32_32x32x16_bf16 v[16:31], a[48:51], v[112:115], v[16:31]
  s_add_u32 s24, s24, 4096
  buffer_load_dwordx4 v[112:115], v2, s[4:7], s24 offen offset:0 sc1
  s_waitcnt vmcnt(39)
  v_mfma_f32_32x32x16_bf16 v[32:47], a[52:55], v[116:119], v[32:47]
  buffer_load_dwordx4 v[116:119], v2, s[4:7], s24 offen offset:1024 sc1
  s_waitcnt vmcnt(39)
  v_mfma_f32_32x32x16_bf16 v[16:31], a[56:59], v[120:123], v[16:31]
  buffer_load_dwordx4 v[120:123], v2, s[4:7], s24 offen offset:2048 sc1
  s_waitcnt vmcnt(39)
  v_mfma_f32_32x32x16_bf16 v[32:47], a[60:63], v[124:127], v[32:47]
  buffer_load_dwordx4 v[124:127], v2, s[4:7], s24 offen offset:3072 sc1
  s_waitcnt vmcnt(39)
  v_mfma_f32_32x32x16_bf16 v[16:31], a[64:67], v[128:131], v[16:31]
  s_add_u32 s24, s24, 4096
  buffer_load_dwordx4 v[128:131], v2, s[4:7], s24 offen offset:0 sc1
  s_waitcnt vmcnt(39)
  v_mfma_f32_32x32x16_bf16 v[32:47], a[68:71], v[132:135], v[32:47]
  buffer_load_dwordx4 v[132:135], v2, s[4:7], s24 offen offset:1024 sc1
  s_waitcnt vmcnt(39)
  v_mfma_f32_32x32x16_bf16 v[16:31], a[72:75], v[136:139], v[16:31]
  buffer_load_dwordx4 v[136:139], v2, s[4:7], s24 offen offset:2048 sc1
  s_waitcnt vmcnt(39)
  v_mfma_f32_32x32x16_bf16 v[32:47], a[76:79], v[140:143], v[32:47]
  buffer_load_dwordx4 v[140:143], v2, s[4:7], s24 offen offset:3072 sc1
  s_waitcnt vmcnt(39)
  v_mfma_f32_32x32x16_bf16 v[16:31], a[80:83], v[144:147], v[16:31]
  s_add_u32 s24, s24, 4096
  buffer_load_dwordx4 v[144:147], v2, s[4:7], s24 offen offset:0 sc1
  s_waitcnt vmcnt(39)
  v_mfma_f32_32x32x16_bf16 v[32:47], a[84:87], v[148:151], v[32:47]
  buffer_load_dwordx4 v[148:151], v2, s[4:7], s24 offen offset:1024 sc1
  s_waitcnt vmcnt(39)
  v_mfma_f32_32x32x16_bf16 v[16:31], a[88:91], v[152:155], v[16:31]
  buffer_load_dwordx4 v[152:155], v2, s[4:7], s24 offen offset:2048 sc1
  s_waitcnt vmcnt(39)
  v_mfma_f32_32x32x16_bf16 v[32:47], a[92:95], v[156:159], v[32:47]
  buffer_load_dwordx4 v[156:159], v2, s[4:7], s24 offen offset:3072 sc1
  s_waitcnt vmcnt(39)
  v_mfma_f32_32x32x16_bf16 v[16:31], a[96:99], v[160:163], v[16:31]
  s_waitcnt vmcnt(38)
  v_mfma_f32_32x32x16_bf16 v[32:47], a[100:103], v[164:167], v[32:47]
  s_waitcnt vmcnt(37)
  v_mfma_f32_32x32x16_bf16 v[16:31], a[104:107], v[168:171], v[16:31]
  s_waitcnt vmcnt(36)
  v_mfma_f32_32x32x16_bf16 v[32:47], a[108:111], v[172:175], v[32:47]
  s_waitcnt vmcnt(35)
  v_mfma_f32_32x32x16_bf16 v[16:31], a[112:115], v[176:179], v[16:31]
  s_waitcnt vmcnt(34)
  v_mfma_f32_32x32x16_bf16 v[32:47], a[116:119], v[180:183], v[32:47]
  s_waitcnt vmcnt(33)
  v_mfma_f32_32x32x16_bf16 v[16:31], a[120:123], v[184:187], v[16:31]
  s_waitcnt vmcnt(32)
  v_mfma_f32_32x32x16_bf16 v[32:47], a[124:127], v[188:191], v[32:47]
  s_waitcnt vmcnt(31)
  v_mfma_f32_32x32x16_bf16 v[16:31], a[128:131], v[192:195], v[16:31]
  s_waitcnt vmcnt(30)
  v_mfma_f32_32x32x16_bf16 v[32:47], a[132:135], v[196:199], v[32:47]
  s_waitcnt vmcnt(29)
  v_mfma_f32_32x32x16_bf16 v[16:31], a[136:139], v[200:203], v[16:31]
  s_waitcnt vmcnt(28)
  v_mfma_f32_32x32x16_bf16 v[32:47], a[140:143], v[204:207], v[32:47]
  s_waitcnt vmcnt(27)
  v_mfma_f32_32x32x16_bf16 v[16:31], a[144:147], v[208:211], v[16:31]
  s_waitcnt vmcnt(26)
  v_mfma_f32_32x32x16_bf16 v[32:47], a[148:151], v[212:215], v[32:47]
  s_waitcnt vmcnt(25)
  v_mfma_f32_32x32x16_bf16 v[16:31], a[152:155], v[216:219], v[16:31]
  s_waitcnt vmcnt(24)
  v_mfma_f32_32x32x16_bf16 v[32:47], a[156:159], v[220:223], v[32:47]
  s_waitcnt vmcnt(23)
  v_mfma_f32_32x32x16_bf16 v[16:31], a[160:163], v[64:67], v[16:31]
  s_waitcnt vmcnt(22)
  v_mfma_f32_32x32x16_bf16 v[32:47], a[164:167], v[68:71], v[32:47]
  s_waitcnt vmcnt(21)
  v_mfma_f32_32x32x16_bf16 v[16:31], a[168:171], v[72:75], v[16:31]
  s_waitcnt vmcnt(20)
  v_mfma_f32_32x32x16_bf16 v[32:47], a[172:175], v[76:79], v[32:47]
  s_waitcnt vmcnt(19)
  v_mfma_f32_32x32x16_bf16 v[16:31], a[176:179], v[80:83], v[16:31]
  s_waitcnt vmcnt(18)
  v_mfma_f32_32x32x16_bf16 v[32:47], a[180:183], v[84:87], v[32:47]
  s_waitcnt vmcnt(17)
  v_mfma_f32_32x32x16_bf16 v[16:31], a[184:187], v[88:91], v[16:31]
  s_waitcnt vmcnt(16)
  v_mfma_f32_32x32x16_bf16 v[32:47], a[188:191], v[92:95], v[32:47]
  s_waitcnt vmcnt(15)
  v_mfma_f32_32x32x16_bf16 v[16:31], a[192:195], v[96:99], v[16:31]
  s_waitcnt vmcnt(14)
  v_mfma_f32_32x32x16_bf16 v[32:47], a[196:199], v[100:103], v[32:47]
  s_waitcnt vmcnt(13)
  v_mfma_f32_32x32x16_bf16 v[16:31], a[200:203], v[104:107], v[16:31]
  s_waitcnt vmcnt(12)
  v_mfma_f32_32x32x16_bf16 v[32:47], a[204:207], v[108:111], v[32:47]
  s_waitcnt vmcnt(11)
  v_mfma_f32_32x32x16_bf16 v[16:31], a[208:211], v[112:115], v[16:31]
  s_waitcnt vmcnt(10)
  v_mfma_f32_32x32x16_bf16 v[32:47], a[212:215], v[116:119], v[32:47]
  s_waitcnt vmcnt(9)
  v_mfma_f32_32x32x16_bf16 v[16:31], a[216:219], v[120:123], v[16:31]
  s_waitcnt vmcnt(8)
  v_mfma_f32_32x32x16_bf16 v[32:47], a[220:223], v[124:127], v[32:47]
  s_waitcnt vmcnt(7)
  v_mfma_f32_32x32x16_bf16 v[16:31], a[224:227], v[128:131], v[16:31]
  s_waitcnt vmcnt(6)
  v_mfma_f32_32x32x16_bf16 v[32:47], a[228:231], v[132:135], v[32:47]
  s_waitcnt vmcnt(5)
  v_mfma_f32_32x32x16_bf16 v[16:31], a[232:235], v[136:139], v[16:31]
  s_waitcnt vmcnt(4)
  v_mfma_f32_32x32x16_bf16 v[32:47], a[236:239], v[140:143], v[32:47]
  s_waitcnt vmcnt(3)
  v_mfma_f32_32x32x16_bf16 v[16:31], a[240:243], v[144:147], v[16:31]
  s_waitcnt vmcnt(2)
  v_mfma_f32_32x32x16_bf16 v[32:47], a[244:247], v[148:151], v[32:47]
  s_waitcnt vmcnt(1)
  v_mfma_f32_32x32x16_bf16 v[16:31], a[248:251], v[152:155], v[16:31]
  s_waitcnt vmcnt(0)
  v_mfma_f32_32x32x16_bf16 v[32:47], a[252:255], v[156:159], v[32:47]
  s_nop 11
  v_pk_add_f32 v[16:17], v[16:17], v[32:33]
  v_pk_add_f32 v[18:19], v[18:19], v[34:35]
  v_pk_add_f32 v[20:21], v[20:21], v[36:37]
  v_pk_add_f32 v[22:23], v[22:23], v[38:39]
  v_pk_add_f32 v[24:25], v[24:25], v[40:41]
  v_pk_add_f32 v[26:27], v[26:27], v[42:43]
  v_pk_add_f32 v[28:29], v[28:29], v[44:45]
  v_pk_add_f32 v[30:31], v[30:31], v[46:47]
  ds_write_b128 v9, v[16:19] offset:0
  ds_write_b128 v9, v[20:23] offset:4096
  ds_write_b128 v9, v[24:27] offset:8192
  ds_write_b128 v9, v[28:31] offset:12288
  s_waitcnt lgkmcnt(0)
  s_barrier
  ds_read_b128 v[16:19], v10 offset:0
  ds_read_b128 v[20:23], v10 offset:1024
  ds_read_b128 v[24:27], v10 offset:2048
  ds_read_b128 v[28:31], v10 offset:3072
  s_waitcnt lgkmcnt(0)
  s_barrier
  v_pk_add_f32 v[16:17], v[16:17], v[20:21]
  v_pk_add_f32 v[24:25], v[24:25], v[28:29]
  v_pk_add_f32 v[18:19], v[18:19], v[22:23]
  v_pk_add_f32 v[26:27], v[26:27], v[30:31]
  v_pk_add_f32 v[16:17], v[16:17], v[24:25]
  v_pk_add_f32 v[18:19], v[18:19], v[26:27]
  v_cvt_pk_bf16_f32 v20, v16, v17
  v_cvt_pk_bf16_f32 v21, v18, v19
  v_lshlrev_b32 v16, 16, v20
  v_and_b32 v17, 0xffff0000, v20
  v_lshlrev_b32 v18, 16, v21
  v_and_b32 v19, 0xffff0000, v21
  v_lshlrev_b32 v24, 16, v12
  v_and_b32 v25, 0xffff0000, v12
  v_lshlrev_b32 v26, 16, v13
  v_and_b32 v27, 0xffff0000, v13
  v_add_f32 v16, v16, v24
  v_add_f32 v17, v17, v25
  v_add_f32 v18, v18, v26
  v_add_f32 v19, v19, v27
  v_cvt_pk_bf16_f32 v20, v16, v17
  v_cvt_pk_bf16_f32 v21, v18, v19
  s_add_u32 s25, s27, 95420416
  buffer_store_dwordx2 v[20:21], v8, s[4:7], s25 offen sc1
  s_lshl_b32 s24, s21, 7
  s_add_u32 s24, s24, 3686400
  s_waitcnt vmcnt(0)
  s_barrier
  v_cmp_eq_u32 vcc, 0, v0
  s_nop 0
  s_and_saveexec_b64 s[32:33], vcc
  s_cbranch_execz Lsig_32
  v_mov_b32 v3, 0
  v_mov_b32 v4, 1
  buffer_atomic_add v4, v3, s[4:7], s24 offen
Lsig_32:
  s_mov_b64 exec, s[32:33]
  s_cmp_lt_u32 s21, 8
  s_cselect_b32 s24, 1, 3
  s_add_u32 s21, s21, s24
  s_cmp_lt_u32 s21, 64
  s_cbranch_scc1 Lwotop_30
  s_branch mk_g2p0
mk_nwo0:
  s_cmp_lt_u32 s50, 68
  s_cbranch_scc0 mk_nln0
  s_sub_u32 s22, s50, 60
  s_lshr_b32 s21, s22, 2
  s_and_b32 s22, s22, 3
  v_lshrrev_b32 v7, 5, v0
  s_lshl_b32 s24, s22, 3
  v_add_u32 v7, s24, v7
  v_mul_u32_u24 v6, 0x500, v7
  v_and_b32 v7, 31, v0
  v_lshl_add_u32 v6, v7, 3, v6
Lln2_33:
  s_lshl_b32 s24, s21, 7
  s_add_u32 s24, s24, 3686400
  s_cmp_lg_u32 s17, 0
  s_cbranch_scc1 Lwf_34_ok
  v_mov_b32 v3, 0
Lwf_34:
  buffer_load_dword v4, v3, s[4:7], s24 offen sc1
  s_waitcnt vmcnt(0)
  v_readfirstlane_b32 s25, v4
  s_add_u32 s0, s0, 1
  s_cmp_ge_u32 s25, 20
  s_cbranch_scc1 Lwf_34_ok
  s_sleep 2
  s_cmp_lt_u32 s0, 1572864
  s_cbranch_scc1 Lwf_34
Lwf_34_ok:
  s_barrier
  s_mul_i32 s27, s21, 40960
  s_add_u32 s25, s27, 95420416
  buffer_load_dwordx2 v[10:11], v6, s[4:7], s25 offen offset:0 sc1
  buffer_load_dwordx2 v[12:13], v6, s[4:7], s25 offen offset:256 sc1
  buffer_load_dwordx2 v[14:15], v6, s[4:7], s25 offen offset:512 sc1
  buffer_load_dwordx2 v[16:17], v6, s[4:7], s25 offen offset:768 sc1
  buffer_load_dwordx2 v[18:19], v6, s[4:7], s25 offen offset:1024 sc1
  s_waitcnt vmcnt(0)
  v_lshlrev_b32 v20, 16, v10
  v_and_b32 v21, 0xffff0000, v10
  v_lshlrev_b32 v22, 16, v11
  v_and_b32 v23, 0xffff0000, v11
  v_lshlrev_b32 v24, 16, v12
  v_and_b32 v25, 0xffff0000, v12
  v_lshlrev_b32 v26, 16, v13
  v_and_b32 v27, 0xffff0000, v13
  v_lshlrev_b32 v28, 16, v14
  v_and_b32 v29, 0xffff0000, v14
  v_lshlrev_b32 v30, 16, v15
  v_and_b32 v31, 0xffff0000, v15
  v_lshlrev_b32 v32, 16, v16
  v_and_b32 v33, 0xffff0000, v16
  v_lshlrev_b32 v34, 16, v17
  v_and_b32 v35, 0xffff0000, v17
  v_lshlrev_b32 v36, 16, v18
  v_and_b32 v37, 0xffff0000, v18
  v_lshlrev_b32 v38, 16, v19
  v_and_b32 v39, 0xffff0000, v19
  v_add_f32 v7, v20, v21
  v_add_f32 v8, v22, v23
  v_add_f32 v7, v7, v24
  v_add_f32 v8, v8, v25
  v_add_f32 v7, v7, v26
  v_add_f32 v8, v8, v27
  v_add_f32 v7, v7, v28
  v_add_f32 v8, v8, v29
  v_add_f32 v7, v7, v30
  v_add_f32 v8, v8, v31
  v_add_f32 v7, v7, v32
  v_add_f32 v8, v8, v33
  v_add_f32 v7, v7, v34
  v_add_f32 v8, v8, v35
  v_add_f32 v7, v7, v36
  v_add_f32 v8, v8, v37
  v_add_f32 v7, v7, v38
  v_add_f32 v8, v8, v39
  v_add_f32 v7, v7, v8
  s_nop 1
  v_add_f32_dpp v7, v7, v7 row_ror:8 row_mask:0xf bank_mask:0xf
  s_nop 1
  v_add_f32_dpp v7, v7, v7 row_ror:4 row_mask:0xf bank_mask:0xf
  s_nop 1
  v_add_f32_dpp v7, v7, v7 row_ror:2 row_mask:0xf bank_mask:0xf
  s_nop 1
  v_add_f32_dpp v7, v7, v7 row_ror:1 row_mask:0xf bank_mask:0xf
  v_mov_b32 v8, v7
  s_nop 1
  v_permlane16_swap_b32 v7, v8
  v_add_f32 v7, v7, v8
  v_mul_f32 v7, 0x3acccccd, v7
  v_sub_f32 v8, v20, v7
  v_mul_f32 v9, v8, v8
  v_sub_f32 v8, v21, v7
  v_fmac_f32 v9, v8, v8
  v_sub_f32 v8, v22, v7
  v_fmac_f32 v9, v8, v8
  v_sub_f32 v8, v23, v7
  v_fmac_f32 v9, v8, v8
  v_sub_f32 v8, v24, v7
  v_fmac_f32 v9, v8, v8
  v_sub_f32 v8, v25, v7
  v_fmac_f32 v9, v8, v8
  v_sub_f32 v8, v26, v7
  v_fmac_f32 v9, v8, v8
  v_sub_f32 v8, v27, v7
  v_fmac_f32 v9, v8, v8
  v_sub_f32 v8, v28, v7
  v_fmac_f32 v9, v8, v8
  v_sub_f32 v8, v29, v7
  v_fmac_f32 v9, v8, v8
  v_sub_f32 v8, v30, v7
  v_fmac_f32 v9, v8, v8
  v_sub_f32 v8, v31, v7
  v_fmac_f32 v9, v8, v8
  v_sub_f32 v8, v32, v7
  v_fmac_f32 v9, v8, v8
  v_sub_f32 v8, v33, v7
  v_fmac_f32 v9, v8, v8
  v_sub_f32 v8, v34, v7
  v_fmac_f32 v9, v8, v8
  v_sub_f32 v8, v35, v7
  v_fmac_f32 v9, v8, v8
  v_sub_f32 v8, v36, v7
  v_fmac_f32 v9, v8, v8
  v_sub_f32 v8, v37, v7
  v_fmac_f32 v9, v8, v8
  v_sub_f32 v8, v38, v7
  v_fmac_f32 v9, v8, v8
  v_sub_f32 v8, v39, v7
  v_fmac_f32 v9, v8, v8
  s_nop 1
  v_add_f32_dpp v9, v9, v9 row_ror:8 row_mask:0xf bank_mask:0xf
  s_nop 1
  v_add_f32_dpp v9, v9, v9 row_ror:4 row_mask:0xf bank_mask:0xf
  s_nop 1
  v_add_f32_dpp v9, v9, v9 row_ror:2 row_mask:0xf bank_mask:0xf
  s_nop 1
  v_add_f32_dpp v9, v9, v9 row_ror:1 row_mask:0xf bank_mask:0xf
  v_mov_b32 v8, v9
  s_nop 1
  v_permlane16_swap_b32 v9, v8
  v_add_f32 v9, v9, v8
  v_mul_f32 v9, 0x3acccccd, v9
  v_cvt_pk_bf16_f32 v7, v7, v7
  v_and_b32 v7, 0xffff0000, v7
  v_cvt_pk_bf16_f32 v9, v9, v9
  v_and_b32 v9, 0xffff0000, v9
  v_add_f32 v9, 0x3727c5ac, v9
  v_cvt_pk_bf16_f32 v9, v9, v9
  v_and_b32 v9, 0xffff0000, v9
  v_sqrt_f32 v9, v9
  s_nop 0
  v_cvt_pk_bf16_f32 v9, v9, v9
  v_and_b32 v9, 0xffff0000, v9
  v_rcp_f32 v9, v9
  v_sub_f32 v20, v20, v7
  v_sub_f32 v21, v21, v7
  v_cvt_pk_bf16_f32 v10, v20, v21
  v_sub_f32 v22, v22, v7
  v_sub_f32 v23, v23, v7
  v_cvt_pk_bf16_f32 v11, v22, v23
  v_sub_f32 v24, v24, v7
  v_sub_f32 v25, v25, v7
  v_cvt_pk_bf16_f32 v12, v24, v25
  v_sub_f32 v26, v26, v7
  v_sub_f32 v27, v27, v7
  v_cvt_pk_bf16_f32 v13, v26, v27
  v_sub_f32 v28, v28, v7
  v_sub_f32 v29, v29, v7
  v_cvt_pk_bf16_f32 v14, v28, v29
  v_sub_f32 v30, v30, v7
  v_sub_f32 v31, v31, v7
  v_cvt_pk_bf16_f32 v15, v30, v31
  v_sub_f32 v32, v32, v7
  v_sub_f32 v33, v33, v7
  v_cvt_pk_bf16_f32 v16, v32, v33
  v_sub_f32 v34, v34, v7
  v_sub_f32 v35, v35, v7
  v_cvt_pk_bf16_f32 v17, v34, v35
  v_sub_f32 v36, v36, v7
  v_sub_f32 v37, v37, v7
  v_cvt_pk_bf16_f32 v18, v36, v37
  v_sub_f32 v38, v38, v7
  v_sub_f32 v39, v39, v7
  v_cvt_pk_bf16_f32 v19, v38, v39
  v_lshlrev_b32 v20, 16, v10
  v_and_b32 v21, 0xffff0000, v10
  v_mul_f32 v20, v20, v9
  v_mul_f32 v21, v21, v9
  v_cvt_pk_bf16_f32 v10, v20, v21
  v_lshlrev_b32 v22, 16, v11
  v_and_b32 v23, 0xffff0000, v11
  v_mul_f32 v22, v22, v9
  v_mul_f32 v23, v23, v9
  v_cvt_pk_bf16_f32 v11, v22, v23
  v_lshlrev_b32 v24, 16, v12
  v_and_b32 v25, 0xffff0000, v12
  v_mul_f32 v24, v24, v9
  v_mul_f32 v25, v25, v9
  v_cvt_pk_bf16_f32 v12, v24, v25
  v_lshlrev_b32 v26, 16, v13
  v_and_b32 v27, 0xffff0000, v13
  v_mul_f32 v26, v26, v9
  v_mul_f32 v27, v27, v9
  v_cvt_pk_bf16_f32 v13, v26, v27
  v_lshlrev_b32 v28, 16, v14
  v_and_b32 v29, 0xffff0000, v14
  v_mul_f32 v28, v28, v9
  v_mul_f32 v29, v29, v9
  v_cvt_pk_bf16_f32 v14, v28, v29
  v_lshlrev_b32 v30, 16, v15
  v_and_b32 v31, 0xffff0000, v15
  v_mul_f32 v30, v30, v9
  v_mul_f32 v31, v31, v9
  v_cvt_pk_bf16_f32 v15, v30, v31
  v_lshlrev_b32 v32, 16, v16
  v_and_b32 v33, 0xffff0000, v16
  v_mul_f32 v32, v32, v9
  v_mul_f32 v33, v33, v9
  v_cvt_pk_bf16_f32 v16, v32, v33
  v_lshlrev_b32 v34, 16, v17
  v_and_b32 v35, 0xffff0000, v17
  v_mul_f32 v34, v34, v9
  v_mul_f32 v35, v35, v9
  v_cvt_pk_bf16_f32 v17, v34, v35
  v_lshlrev_b32 v36, 16, v18
  v_and_b32 v37, 0xffff0000, v18
  v_mul_f32 v36, v36, v9
  v_mul_f32 v37, v37, v9
  v_cvt_pk_bf16_f32 v18, v36, v37
  v_lshlrev_b32 v38, 16, v19
  v_and_b32 v39, 0xffff0000, v19
  v_mul_f32 v38, v38, v9
  v_mul_f32 v39, v39, v9
  v_cvt_pk_bf16_f32 v19, v38, v39
  v_lshlrev_b32 v20, 16, v10
  v_and_b32 v21, 0xffff0000, v10
  v_lshlrev_b32 v22, 16, v11
  v_and_b32 v23, 0xffff0000, v11
  v_lshlrev_b32 v24, 16, v12
  v_and_b32 v25, 0xffff0000, v12
  v_lshlrev_b32 v26, 16, v13
  v_and_b32 v27, 0xffff0000, v13
  v_lshlrev_b32 v28, 16, v14
  v_and_b32 v29, 0xffff0000, v14
  v_lshlrev_b32 v30, 16, v15
  v_and_b32 v31, 0xffff0000, v15
  v_lshlrev_b32 v32, 16, v16
  v_and_b32 v33, 0xffff0000, v16
  v_lshlrev_b32 v34, 16, v17
  v_and_b32 v35, 0xffff0000, v17
  v_lshlrev_b32 v36, 16, v18
  v_and_b32 v37, 0xffff0000, v18
  v_lshlrev_b32 v38, 16, v19
  v_and_b32 v39, 0xffff0000, v19
  v_add_f32 v7, v20, v21
  v_add_f32 v8, v22, v23
  v_add_f32 v7, v7, v24
  v_add_f32 v8, v8, v25
  v_add_f32 v7, v7, v26
  v_add_f32 v8, v8, v27
  v_add_f32 v7, v7, v28
  v_add_f32 v8, v8, v29
  v_add_f32 v7, v7, v30
  v_add_f32 v8, v8, v31
  v_add_f32 v7, v7, v32
  v_add_f32 v8, v8, v33
  v_add_f32 v7, v7, v34
  v_add_f32 v8, v8, v35
  v_add_f32 v7, v7, v36
  v_add_f32 v8, v8, v37
  v_add_f32 v7, v7, v38
  v_add_f32 v8, v8, v39
  v_add_f32 v7, v7, v8
  s_nop 1
  v_add_f32_dpp v7, v7, v7 row_ror:8 row_mask:0xf bank_mask:0xf
  s_nop 1
  v_add_f32_dpp v7, v7, v7 row_ror:4 row_mask:0xf bank_mask:0xf
  s_nop 1
  v_add_f32_dpp v7, v7, v7 row_ror:2 row_mask:0xf bank_mask:0xf
  s_nop 1
  v_add_f32_dpp v7, v7, v7 row_ror:1 row_mask:0xf bank_mask:0xf
  v_mov_b32 v8, v7
  s_nop 1
  v_permlane16_swap_b32 v7, v8
  v_add_f32 v7, v7, v8
  v_mul_f32 v7, 0x3acccccd, v7
  v_sub_f32 v8, v20, v7
  v_mul_f32 v9, v8, v8
  v_sub_f32 v8, v21, v7
  v_fmac_f32 v9, v8, v8
  v_sub_f32 v8, v22, v7
  v_fmac_f32 v9, v8, v8
  v_sub_f32 v8, v23, v7
  v_fmac_f32 v9, v8, v8
  v_sub_f32 v8, v24, v7
  v_fmac_f32 v9, v8, v8
  v_sub_f32 v8, v25, v7
  v_fmac_f32 v9, v8, v8
  v_sub_f32 v8, v26, v7
  v_fmac_f32 v9, v8, v8
  v_sub_f32 v8, v27, v7
  v_fmac_f32 v9, v8, v8
  v_sub_f32 v8, v28, v7
  v_fmac_f32 v9, v8, v8
  v_sub_f32 v8, v29, v7
  v_fmac_f32 v9, v8, v8
  v_sub_f32 v8, v30, v7
  v_fmac_f32 v9, v8, v8
  v_sub_f32 v8, v31, v7
  v_fmac_f32 v9, v8, v8
  v_sub_f32 v8, v32, v7
  v_fmac_f32 v9, v8, v8
  v_sub_f32 v8, v33, v7
  v_fmac_f32 v9, v8, v8
  v_sub_f32 v8, v34, v7
  v_fmac_f32 v9, v8, v8
  v_sub_f32 v8, v35, v7
  v_fmac_f32 v9, v8, v8
  v_sub_f32 v8, v36, v7
  v_fmac_f32 v9, v8, v8
  v_sub_f32 v8, v37, v7
  v_fmac_f32 v9, v8, v8
  v_sub_f32 v8, v38, v7
  v_fmac_f32 v9, v8, v8
  v_sub_f32 v8, v39, v7
  v_fmac_f32 v9, v8, v8
  s_nop 1
  v_add_f32_dpp v9, v9, v9 row_ror:8 row_mask:0xf bank_mask:0xf
  s_nop 1
  v_add_f32_dpp v9, v9, v9 row_ror:4 row_mask:0xf bank_mask:0xf
  s_nop 1
  v_add_f32_dpp v9, v9, v9 row_ror:2 row_mask:0xf bank_mask:0xf
  s_nop 1
  v_add_f32_dpp v9, v9, v9 row_ror:1 row_mask:0xf bank_mask:0xf
  v_mov_b32 v8, v9
  s_nop 1
  v_permlane16_swap_b32 v9, v8
  v_add_f32 v9, v9, v8
  v_mul_f32 v9, 0x3acccccd, v9
  v_cvt_pk_bf16_f32 v7, v7, v7
  v_and_b32 v7, 0xffff0000, v7
  v_cvt_pk_bf16_f32 v9, v9, v9
  v_and_b32 v9, 0xffff0000, v9
  v_add_f32 v9, 0x3727c5ac, v9
  v_cvt_pk_bf16_f32 v9, v9, v9
  v_and_b32 v9, 0xffff0000, v9
  v_sqrt_f32 v9, v9
  s_nop 0
  v_cvt_pk_bf16_f32 v9, v9, v9
  v_and_b32 v9, 0xffff0000, v9
  v_rcp_f32 v9, v9
  v_sub_f32 v20, v20, v7
  v_sub_f32 v21, v21, v7
  v_cvt_pk_bf16_f32 v10, v20, v21
  v_sub_f32 v22, v22, v7
  v_sub_f32 v23, v23, v7
  v_cvt_pk_bf16_f32 v11, v22, v23
  v_sub_f32 v24, v24, v7
  v_sub_f32 v25, v25, v7
  v_cvt_pk_bf16_f32 v12, v24, v25
  v_sub_f32 v26, v26, v7
  v_sub_f32 v27, v27, v7
  v_cvt_pk_bf16_f32 v13, v26, v27
  v_sub_f32 v28, v28, v7
  v_sub_f32 v29, v29, v7
  v_cvt_pk_bf16_f32 v14, v28, v29
  v_sub_f32 v30, v30, v7
  v_sub_f32 v31, v31, v7
  v_cvt_pk_bf16_f32 v15, v30, v31
  v_sub_f32 v32, v32, v7
  v_sub_f32 v33, v33, v7
  v_cvt_pk_bf16_f32 v16, v32, v33
  v_sub_f32 v34, v34, v7
  v_sub_f32 v35, v35, v7
  v_cvt_pk_bf16_f32 v17, v34, v35
  v_sub_f32 v36, v36, v7
  v_sub_f32 v37, v37, v7
  v_cvt_pk_bf16_f32 v18, v36, v37
  v_sub_f32 v38, v38, v7
  v_sub_f32 v39, v39, v7
  v_cvt_pk_bf16_f32 v19, v38, v39
  v_lshlrev_b32 v20, 16, v10
  v_and_b32 v21, 0xffff0000, v10
  v_mul_f32 v20, v20, v9
  v_mul_f32 v21, v21, v9
  v_cvt_pk_bf16_f32 v10, v20, v21
  v_lshlrev_b32 v22, 16, v11
  v_and_b32 v23, 0xffff0000, v11
  v_mul_f32 v22, v22, v9
  v_mul_f32 v23, v23, v9
  v_cvt_pk_bf16_f32 v11, v22, v23
  v_lshlrev_b32 v24, 16, v12
  v_and_b32 v25, 0xffff0000, v12
  v_mul_f32 v24, v24, v9
  v_mul_f32 v25, v25, v9
  v_cvt_pk_bf16_f32 v12, v24, v25
  v_lshlrev_b32 v26, 16, v13
  v_and_b32 v27, 0xffff0000, v13
  v_mul_f32 v26, v26, v9
  v_mul_f32 v27, v27, v9
  v_cvt_pk_bf16_f32 v13, v26, v27
  v_lshlrev_b32 v28, 16, v14
  v_and_b32 v29, 0xffff0000, v14
  v_mul_f32 v28, v28, v9
  v_mul_f32 v29, v29, v9
  v_cvt_pk_bf16_f32 v14, v28, v29
  v_lshlrev_b32 v30, 16, v15
  v_and_b32 v31, 0xffff0000, v15
  v_mul_f32 v30, v30, v9
  v_mul_f32 v31, v31, v9
  v_cvt_pk_bf16_f32 v15, v30, v31
  v_lshlrev_b32 v32, 16, v16
  v_and_b32 v33, 0xffff0000, v16
  v_mul_f32 v32, v32, v9
  v_mul_f32 v33, v33, v9
  v_cvt_pk_bf16_f32 v16, v32, v33
  v_lshlrev_b32 v34, 16, v17
  v_and_b32 v35, 0xffff0000, v17
  v_mul_f32 v34, v34, v9
  v_mul_f32 v35, v35, v9
  v_cvt_pk_bf16_f32 v17, v34, v35
  v_lshlrev_b32 v36, 16, v18
  v_and_b32 v37, 0xffff0000, v18
  v_mul_f32 v36, v36, v9
  v_mul_f32 v37, v37, v9
  v_cvt_pk_bf16_f32 v18, v36, v37
  v_lshlrev_b32 v38, 16, v19
  v_and_b32 v39, 0xffff0000, v19
  v_mul_f32 v38, v38, v9
  v_mul_f32 v39, v39, v9
  v_cvt_pk_bf16_f32 v19, v38, v39
  s_add_u32 s25, s27, 98566144
  buffer_store_dwordx2 v[10:11], v6, s[4:7], s25 offen offset:0 sc1
  buffer_store_dwordx2 v[12:13], v6, s[4:7], s25 offen offset:256 sc1
  buffer_store_dwordx2 v[14:15], v6, s[4:7], s25 offen offset:512 sc1
  buffer_store_dwordx2 v[16:17], v6, s[4:7], s25 offen offset:768 sc1
  buffer_store_dwordx2 v[18:19], v6, s[4:7], s25 offen offset:1024 sc1
  s_lshl_b32 s24, s21, 7
  s_lshl_b32 s25, s22, 2
  s_add_u32 s24, s24, s25
  s_add_u32 s24, s24, 3678208
  s_waitcnt vmcnt(0)
  s_barrier
  s_cmp_eq_u32 s17, 0
  s_cbranch_scc0 Lsf_35
  v_mov_b32 v4, 1
  buffer_store_dword v4, off, s[4:7], s24 sc1
Lsf_35:
  s_add_u32 s21, s21, 2
  s_cmp_lt_u32 s21, 64
  s_cbranch_scc1 Lln2_33
  s_branch mk_g2p0
mk_nln0:
  s_cmp_lt_u32 s50, 158
  s_cbranch_scc0 mk_g2p0
  s_sub_u32 s22, s50, 68
  s_cmp_ge_u32 s22, 64
  s_cbranch_scc1 Lw2d_36
  s_mov_b32 s8, s44
  s_and_b32 s9, s45, 0xffff
  s_mov_b32 s10, 7077888
  s_mov_b32 s11, 0x00020000
  v_lshrrev_b32 v3, 2, v1
  v_lshlrev_b32 v3, 12, v3
  v_and_b32 v4, 3, v1
  v_lshl_add_u32 v6, v4, 4, v3
  v_lshrrev_b32 v3, 5, v1
  v_mul_u32_u24 v3, 8, v3
  v_bfe_u32 v4, v1, 2, 2
  v_add_u32 v3, v3, v4
  v_mul_u32_u24 v7, 64, v3
  v_bfe_u32 v4, v1, 1, 1
  v_lshl_add_u32 v7, v4, 3, v7
  v_bfe_u32 v4, v1, 4, 1
  v_lshl_add_u32 v7, v4, 4, v7
  v_bfe_u32 v4, v1, 0, 1
  v_lshl_add_u32 v7, v4, 5, v7
  s_lshl_b32 s26, s17, 15
  v_add_u32 v7, s26, v7
  s_mul_i32 s28, s17, 1769472
  s_lshl_b32 s25, s22, 6
  s_add_u32 s28, s28, s25
  s_barrier
  s_add_u32 m0, s26, 0
  s_nop 0
  buffer_load_dwordx4 v6, s[8:11], s28 offen lds
  s_add_u32 s28, s28, 65536
  s_add_u32 m0, s26, 1024
  s_nop 0
  buffer_load_dwordx4 v6, s[8:11], s28 offen lds
  s_add_u32 s28, s28, 65536
  s_add_u32 m0, s26, 2048
  s_nop 0
  buffer_load_dwordx4 v6, s[8:11], s28 offen lds
  s_add_u32 s28, s28, 65536
  s_add_u32 m0, s26, 3072
  s_nop 0
  buffer_load_dwordx4 v6, s[8:11], s28 offen lds
  s_add_u32 s28, s28, 65536
  s_add_u32 m0, s26, 4096
  s_nop 0
  buffer_load_dwordx4 v6, s[8:11], s28 offen lds
  s_add_u32 s28, s28, 65536
  s_add_u32 m0, s26, 5120
  s_nop 0
  buffer_load_dwordx4 v6, s[8:11], s28 offen lds
  s_add_u32 s28, s28, 65536
  s_add_u32 m0, s26, 6144
  s_nop 0
  buffer_load_dwordx4 v6, s[8:11], s28 offen lds
  s_add_u32 s28, s28, 65536
  s_add_u32 m0, s26, 7168
  s_nop 0
  buffer_load_dwordx4 v6, s[8:11], s28 offen lds
  s_add_u32 s28, s28, 65536
  s_add_u32 m0, s26, 8192
  s_nop 0
  buffer_load_dwordx4 v6, s[8:11], s28 offen lds
  s_add_u32 s28, s28, 65536
  s_add_u32 m0, s26, 9216
  s_nop 0
  buffer_load_dwordx4 v6, s[8:11], s28 offen lds
  s_add_u32 s28, s28, 65536
  s_add_u32 m0, s26, 10240
  s_nop 0
  buffer_load_dwordx4 v6, s[8:11], s28 offen lds
  s_add_u32 s28, s28, 65536
  s_add_u32 m0, s26, 11264
  s_nop 0
  buffer_load_dwordx4 v6, s[8:11], s28 offen lds
  s_add_u32 s28, s28, 65536
  s_add_u32 m0, s26, 12288
  s_nop 0
  buffer_load_dwordx4 v6, s[8:11], s28 offen lds
  s_add_u32 s28, s28, 65536
  s_add_u32 m0, s26, 13312
  s_nop 0
  buffer_load_dwordx4 v6, s[8:11], s28 offen lds
  s_add_u32 s28, s28, 65536
  s_add_u32 m0, s26, 14336
  s_nop 0
  buffer_load_dwordx4 v6, s[8:11], s28 offen lds
  s_add_u32 s28, s28, 65536
  s_add_u32 m0, s26, 15360
  s_nop 0
  buffer_load_dwordx4 v6, s[8:11], s28 offen lds
  s_add_u32 s28, s28, 65536
  s_add_u32 m0, s26, 16384
  s_nop 0
  buffer_load_dwordx4 v6, s[8:11], s28 offen lds
  s_add_u32 s28, s28, 65536
  s_add_u32 m0, s26, 17408
  s_nop 0
  buffer_load_dwordx4 v6, s[8:11], s28 offen lds
  s_add_u32 s28, s28, 65536
  s_add_u32 m0, s26, 18432
  s_nop 0
  buffer_load_dwordx4 v6, s[8:11], s28 offen lds
  s_add_u32 s28, s28, 65536
  s_add_u32 m0, s26, 19456
  s_nop 0
  buffer_load_dwordx4 v6, s[8:11], s28 offen lds
  s_add_u32 s28, s28, 65536
  s_add_u32 m0, s26, 20480
  s_nop 0
  buffer_load_dwordx4 v6, s[8:11], s28 offen lds
  s_add_u32 s28, s28, 65536
  s_add_u32 m0, s26, 21504
  s_nop 0
  buffer_load_dwordx4 v6, s[8:11], s28 offen lds
  s_add_u32 s28, s28, 65536
  s_add_u32 m0, s26, 22528
  s_nop 0
  buffer_load_dwordx4 v6, s[8:11], s28 offen lds
  s_add_u32 s28, s28, 65536
  s_add_u32 m0, s26, 23552
  s_nop 0
  buffer_load_dwordx4 v6, s[8:11], s28 offen lds
  s_add_u32 s28, s28, 65536
  s_add_u32 m0, s26, 24576
  s_nop 0
  buffer_load_dwordx4 v6, s[8:11], s28 offen lds
  s_add_u32 s28, s28, 65536
  s_add_u32 m0, s26, 25600
  s_nop 0
  buffer_load_dwordx4 v6, s[8:11], s28 offen lds
  s_add_u32 s28, s28, 65536
  s_add_u32 m0, s26, 26624
  s_nop 0
  buffer_load_dwordx4 v6, s[8:11], s28 offen lds
  s_add_u32 s28, s28, 65536
  s_mul_i32 s27, s22, 110592
  s_mul_i32 s25, s17, 27648
  s_add_u32 s27, s27, s25
  s_add_u32 s27, s27, 8388608
  s_waitcnt vmcnt(0)
  ds_read_b64_tr_b16 v[16:17], v7 offset:0
  ds_read_b64_tr_b16 v[18:19], v7 offset:256
  ds_read_b64_tr_b16 v[20:21], v7 offset:1024
  ds_read_b64_tr_b16 v[22:23], v7 offset:1280
  ds_read_b64_tr_b16 v[24:25], v7 offset:2048
  ds_read_b64_tr_b16 v[26:27], v7 offset:2304
  ds_read_b64_tr_b16 v[28:29], v7 offset:3072
  ds_read_b64_tr_b16 v[30:31], v7 offset:3328
  ds_read_b64_tr_b16 v[32:33], v7 offset:4096
  ds_read_b64_tr_b16 v[34:35], v7 offset:4352
  ds_read_b64_tr_b16 v[36:37], v7 offset:5120
  ds_read_b64_tr_b16 v[38:39], v7 offset:5376
  ds_read_b64_tr_b16 v[40:41], v7 offset:6144
  ds_read_b64_tr_b16 v[42:43], v7 offset:6400
  s_waitcnt lgkmcnt(0)
  ds_read_b64_tr_b16 v[44:45], v7 offset:7168
  ds_read_b64_tr_b16 v[46:47], v7 offset:7424
  ds_read_b64_tr_b16 v[48:49], v7 offset:8192
  ds_read_b64_tr_b16 v[50:51], v7 offset:8448
  ds_read_b64_tr_b16 v[52:53], v7 offset:9216
  ds_read_b64_tr_b16 v[54:55], v7 offset:9472
  ds_read_b64_tr_b16 v[56:57], v7 offset:10240
  ds_read_b64_tr_b16 v[58:59], v7 offset:10496
  ds_read_b64_tr_b16 v[60:61], v7 offset:11264
  ds_read_b64_tr_b16 v[62:63], v7 offset:11520
  ds_read_b64_tr_b16 v[64:65], v7 offset:12288
  ds_read_b64_tr_b16 v[66:67], v7 offset:12544
  ds_read_b64_tr_b16 v[68:69], v7 offset:13312
  ds_read_b64_tr_b16 v[70:71], v7 offset:13568
  s_waitcnt lgkmcnt(0)
  ds_read_b64_tr_b16 v[72:73], v7 offset:14336
  ds_read_b64_tr_b16 v[74:75], v7 offset:14592
  ds_read_b64_tr_b16 v[76:77], v7 offset:15360
  ds_read_b64_tr_b16 v[78:79], v7 offset:15616
  ds_read_b64_tr_b16 v[80:81], v7 offset:16384
  ds_read_b64_tr_b16 v[82:83], v7 offset:16640
  ds_read_b64_tr_b16 v[84:85], v7 offset:17408
  ds_read_b64_tr_b16 v[86:87], v7 offset:17664
  ds_read_b64_tr_b16 v[88:89], v7 offset:18432
  ds_read_b64_tr_b16 v[90:91], v7 offset:18688
  ds_read_b64_tr_b16 v[92:93], v7 offset:19456
  ds_read_b64_tr_b16 v[94:95], v7 offset:19712
  ds_read_b64_tr_b16 v[96:97], v7 offset:20480
  ds_read_b64_tr_b16 v[98:99], v7 offset:20736
  s_waitcnt lgkmcnt(0)
  ds_read_b64_tr_b16 v[100:101], v7 offset:21504
  ds_read_b64_tr_b16 v[102:103], v7 offset:21760
  ds_read_b64_tr_b16 v[104:105], v7 offset:22528
  ds_read_b64_tr_b16 v[106:107], v7 offset:22784
  ds_read_b64_tr_b16 v[108:109], v7 offset:23552
  ds_read_b64_tr_b16 v[110:111], v7 offset:23808
  ds_read_b64_tr_b16 v[112:113], v7 offset:24576
  ds_read_b64_tr_b16 v[114:115], v7 offset:24832
  ds_read_b64_tr_b16 v[116:117], v7 offset:25600
  ds_read_b64_tr_b16 v[118:119], v7 offset:25856
  ds_read_b64_tr_b16 v[120:121], v7 offset:26624
  ds_read_b64_tr_b16 v[122:123], v7 offset:26880
  s_waitcnt lgkmcnt(0)
  buffer_store_dwordx4 v[16:19], v2, s[4:7], s27 offen offset:0 sc1
  buffer_store_dwordx4 v[20:23], v2, s[4:7], s27 offen offset:1024 sc1
  buffer_store_dwordx4 v[24:27], v2, s[4:7], s27 offen offset:2048 sc1
  buffer_store_dwordx4 v[28:31], v2, s[4:7], s27 offen offset:3072 sc1
  s_add_u32 s27, s27, 4096
  buffer_store_dwordx4 v[32:35], v2, s[4:7], s27 offen offset:0 sc1
  buffer_store_dwordx4 v[36:39], v2, s[4:7], s27 offen offset:1024 sc1
  buffer_store_dwordx4 v[40:43], v2, s[4:7], s27 offen offset:2048 sc1
  buffer_store_dwordx4 v[44:47], v2, s[4:7], s27 offen offset:3072 sc1
  s_add_u32 s27, s27, 4096
  buffer_store_dwordx4 v[48:51], v2, s[4:7], s27 offen offset:0 sc1
  buffer_store_dwordx4 v[52:55], v2, s[4:7], s27 offen offset:1024 sc1
  buffer_store_dwordx4 v[56:59], v2, s[4:7], s27 offen offset:2048 sc1
  buffer_store_dwordx4 v[60:63], v2, s[4:7], s27 offen offset:3072 sc1
  s_add_u32 s27, s27, 4096
  buffer_store_dwordx4 v[64:67], v2, s[4:7], s27 offen offset:0 sc1
  buffer_store_dwordx4 v[68:71], v2, s[4:7], s27 offen offset:1024 sc1
  buffer_store_dwordx4 v[72:75], v2, s[4:7], s27 offen offset:2048 sc1
  buffer_store_dwordx4 v[76:79], v2, s[4:7], s27 offen offset:3072 sc1
  s_add_u32 s27, s27, 4096
  buffer_store_dwordx4 v[80:83], v2, s[4:7], s27 offen offset:0 sc1
  buffer_store_dwordx4 v[84:87], v2, s[4:7], s27 offen offset:1024 sc1
  buffer_store_dwordx4 v[88:91], v2, s[4:7], s27 offen offset:2048 sc1
  buffer_store_dwordx4 v[92:95], v2, s[4:7], s27 offen offset:3072 sc1
  s_add_u32 s27, s27, 4096
  buffer_store_dwordx4 v[96:99], v2, s[4:7], s27 offen offset:0 sc1
  buffer_store_dwordx4 v[100:103], v2, s[4:7], s27 offen offset:1024 sc1
  buffer_store_dwordx4 v[104:107], v2, s[4:7], s27 offen offset:2048 sc1
  buffer_store_dwordx4 v[108:111], v2, s[4:7], s27 offen offset:3072 sc1
  s_add_u32 s27, s27, 4096
  buffer_store_dwordx4 v[112:115], v2, s[4:7], s27 offen offset:0 sc1
  buffer_store_dwordx4 v[116:119], v2, s[4:7], s27 offen offset:1024 sc1
  buffer_store_dwordx4 v[120:123], v2, s[4:7], s27 offen offset:2048 sc1
  s_lshr_b32 s24, s22, 2
  s_lshl_b32 s24, s24, 7
  s_and_b32 s25, s22, 3
  s_lshl_b32 s25, s25, 2
  s_add_u32 s24, s24, s25
  s_add_u32 s24, s24, 3706880
  s_waitcnt vmcnt(0)
  s_barrier
  s_cmp_eq_u32 s17, 0
  s_cbranch_scc0 Lsf_37
  v_mov_b32 v4, 1
  buffer_store_dword v4, off, s[4:7], s24 sc1
Lsf_37:
Lw2d_36:
  s_mul_i32 s22, s35, 6554
  s_lshr_b32 s22, s22, 16
  s_mul_i32 s24, s22, 10
  s_sub_u32 s23, s35, s24
  v_lshlrev_b32 v5, 2, v1
  s_lshl_b32 s24, s22, 7
  s_add_u32 s24, s24, 3706880
  s_cmp_lg_u32 s17, 0
  s_cbranch_scc1 Lww_38_ok
Lww_38:
  buffer_load_dword v12, v5, s[4:7], s24 offen sc1
  s_waitcnt vmcnt(0)
  v_cmp_eq_u32 vcc, 0, v12
  s_add_u32 s0, s0, 1
  s_and_b32 s25, vcc_lo, 15
  s_cbranch_scc0 Lww_38_ok
  s_sleep 2
  s_cmp_lt_u32 s0, 1572864
  s_cbranch_scc1 Lww_38
Lww_38_ok:
  s_barrier
  s_mul_i32 s24, s22, 442368
  s_add_u32 s24, s24, s29
  s_add_u32 s72, s24, 8388608
  s_add_u32 s73, s24, 8499200
  s_add_u32 s74, s24, 8609792
  s_add_u32 s75, s24, 8720384
  s_mul_i32 s78, s22, 21846
  s_lshr_b32 s78, s78, 16
  s_mul_i32 s78, s78, 3
  s_sub_u32 s78, s22, s78
  s_mul_i32 s78, s78, 36864
  s_mov_b32 s79, s78
  s_lshl_b32 s25, s17, 15
  s_add_u32 s24, s72, s78
  buffer_load_dwordx4 v[96:99], v2, s[4:7], s24 offen sc1
  s_add_u32 s24, s73, s78
  buffer_load_dwordx4 v[100:103], v2, s[4:7], s24 offen sc1
  s_add_u32 s24, s74, s78
  buffer_load_dwordx4 v[104:107], v2, s[4:7], s24 offen sc1
  s_add_u32 s24, s75, s78
  buffer_load_dwordx4 v[108:111], v2, s[4:7], s24 offen sc1
  s_add_u32 s78, s78, 4096
  s_cmp_eq_u32 s78, 110592
  s_cselect_b32 s78, 0, s78
  s_add_u32 s24, s72, s78
  buffer_load_dwordx4 v[112:115], v2, s[4:7], s24 offen sc1
  s_add_u32 s24, s73, s78
  buffer_load_dwordx4 v[116:119], v2, s[4:7], s24 offen sc1
  s_add_u32 s24, s74, s78
  buffer_load_dwordx4 v[120:123], v2, s[4:7], s24 offen sc1
  s_add_u32 s24, s75, s78
  buffer_load_dwordx4 v[124:127], v2, s[4:7], s24 offen sc1
  s_add_u32 s78, s78, 4096
  s_cmp_eq_u32 s78, 110592
  s_cselect_b32 s78, 0, s78
  s_add_u32 s24, s72, s78
  buffer_load_dwordx4 v[128:131], v2, s[4:7], s24 offen sc1
  s_add_u32 s24, s73, s78
  buffer_load_dwordx4 v[132:135], v2, s[4:7], s24 offen sc1
  s_add_u32 s24, s74, s78
  buffer_load_dwordx4 v[136:139], v2, s[4:7], s24 offen sc1
  s_add_u32 s24, s75, s78
  buffer_load_dwordx4 v[140:143], v2, s[4:7], s24 offen sc1
  s_add_u32 s78, s78, 4096
  s_cmp_eq_u32 s78, 110592
  s_cselect_b32 s78, 0, s78
  s_add_u32 s24, s72, s78
  buffer_load_dwordx4 v[144:147], v2, s[4:7], s24 offen sc1
  s_add_u32 s24, s73, s78
  buffer_load_dwordx4 v[148:151], v2, s[4:7], s24 offen sc1
  s_add_u32 s24, s74, s78
  buffer_load_dwordx4 v[152:155], v2, s[4:7], s24 offen sc1
  s_add_u32 s24, s75, s78
  buffer_load_dwordx4 v[156:159], v2, s[4:7], s24 offen sc1
  s_add_u32 s78, s78, 4096
  s_cmp_eq_u32 s78, 110592
  s_cselect_b32 s78, 0, s78
  s_add_u32 s24, s72, s78
  buffer_load_dwordx4 v[160:163], v2, s[4:7], s24 offen sc1
  s_add_u32 s24, s73, s78
  buffer_load_dwordx4 v[164:167], v2, s[4:7], s24 offen sc1
  s_add_u32 s24, s74, s78
  buffer_load_dwordx4 v[168:171], v2, s[4:7], s24 offen sc1
  s_add_u32 s24, s75, s78
  buffer_load_dwordx4 v[172:175], v2, s[4:7], s24 offen sc1
  s_add_u32 s78, s78, 4096
  s_cmp_eq_u32 s78, 110592
  s_cselect_b32 s78, 0, s78
  s_add_u32 s24, s72, s78
  buffer_load_dwordx4 v[176:179], v2, s[4:7], s24 offen sc1
  s_add_u32 s24, s73, s78
  buffer_load_dwordx4 v[180:183], v2, s[4:7], s24 offen sc1
  s_add_u32 s24, s74, s78
  buffer_load_dwordx4 v[184:187], v2, s[4:7], s24 offen sc1
  s_add_u32 s24, s75, s78
  buffer_load_dwordx4 v[188:191], v2, s[4:7], s24 offen sc1
  s_add_u32 s78, s78, 4096
  s_cmp_eq_u32 s78, 110592
  s_cselect_b32 s78, 0, s78
  s_add_u32 s24, s72, s78
  buffer_load_dwordx4 v[192:195], v2, s[4:7], s24 offen sc1
  s_add_u32 s24, s73, s78
  buffer_load_dwordx4 v[196:199], v2, s[4:7], s24 offen sc1
  s_add_u32 s24, s74, s78
  buffer_load_dwordx4 v[200:203], v2, s[4:7], s24 offen sc1
  s_add_u32 s24, s75, s78
  buffer_load_dwordx4 v[204:207], v2, s[4:7], s24 offen sc1
  s_add_u32 s78, s78, 4096
  s_cmp_eq_u32 s78, 110592
  s_cselect_b32 s78, 0, s78
  s_add_u32 s24, s72, s78
  buffer_load_dwordx4 v[208:211], v2, s[4:7], s24 offen sc1
  s_add_u32 s24, s73, s78
  buffer_load_dwordx4 v[212:215], v2, s[4:7], s24 offen sc1
  s_add_u32 s24, s74, s78
  buffer_load_dwordx4 v[216:219], v2, s[4:7], s24 offen sc1
  s_add_u32 s24, s75, s78
  buffer_load_dwordx4 v[220:223], v2, s[4:7], s24 offen sc1
  s_add_u32 s78, s78, 4096
  s_cmp_eq_u32 s78, 110592
  s_cselect_b32 s78, 0, s78
  s_add_u32 s24, s72, s78
  buffer_load_dwordx4 v[224:227], v2, s[4:7], s24 offen sc1
  s_add_u32 s24, s73, s78
  buffer_load_dwordx4 v[228:231], v2, s[4:7], s24 offen sc1
  s_add_u32 s24, s74, s78
  buffer_load_dwordx4 v[232:235], v2, s[4:7], s24 offen sc1
  s_add_u32 s24, s75, s78
  buffer_load_dwordx4 v[236:239], v2, s[4:7], s24 offen sc1
  s_add_u32 s78, s78, 4096
  s_cmp_eq_u32 s78, 110592
  s_cselect_b32 s78, 0, s78
  s_add_u32 s24, s72, s78
  buffer_load_dwordx4 v[240:243], v2, s[4:7], s24 offen sc1
  s_add_u32 s24, s73, s78
  buffer_load_dwordx4 v[244:247], v2, s[4:7], s24 offen sc1
  s_add_u32 s24, s74, s78
  buffer_load_dwordx4 v[248:251], v2, s[4:7], s24 offen sc1
  s_add_u32 s24, s75, s78
  buffer_load_dwordx4 v[252:255], v2, s[4:7], s24 offen sc1
  s_add_u32 s78, s78, 4096
  s_cmp_eq_u32 s78, 110592
  s_cselect_b32 s78, 0, s78
  s_add_u32 s24, s72, s78
  buffer_load_dwordx4 a[128:131], v2, s[4:7], s24 offen sc1
  s_add_u32 s24, s73, s78
  buffer_load_dwordx4 a[132:135], v2, s[4:7], s24 offen sc1
  s_add_u32 s24, s74, s78
  buffer_load_dwordx4 a[136:139], v2, s[4:7], s24 offen sc1
  s_add_u32 s24, s75, s78
  buffer_load_dwordx4 a[140:143], v2, s[4:7], s24 offen sc1
  s_add_u32 s78, s78, 4096
  s_cmp_eq_u32 s78, 110592
  s_cselect_b32 s78, 0, s78
  s_add_u32 s24, s72, s78
  buffer_load_dwordx4 a[144:147], v2, s[4:7], s24 offen sc1
  s_add_u32 s24, s73, s78
  buffer_load_dwordx4 a[148:151], v2, s[4:7], s24 offen sc1
  s_add_u32 s24, s74, s78
  buffer_load_dwordx4 a[152:155], v2, s[4:7], s24 offen sc1
  s_add_u32 s24, s75, s78
  buffer_load_dwordx4 a[156:159], v2, s[4:7], s24 offen sc1
  s_add_u32 s78, s78, 4096
  s_cmp_eq_u32 s78, 110592
  s_cselect_b32 s78, 0, s78
  s_waitcnt vmcnt(24)
  s_add_u32 s24, s72, s78
  buffer_load_dwordx4 a[160:163], v2, s[4:7], s24 offen sc1
  s_add_u32 s24, s73, s78
  buffer_load_dwordx4 a[164:167], v2, s[4:7], s24 offen sc1
  s_add_u32 s24, s74, s78
  buffer_load_dwordx4 a[168:171], v2, s[4:7], s24 offen sc1
  s_add_u32 s24, s75, s78
  buffer_load_dwordx4 a[172:175], v2, s[4:7], s24 offen sc1
  s_add_u32 s78, s78, 4096
  s_cmp_eq_u32 s78, 110592
  s_cselect_b32 s78, 0, s78
  s_add_u32 s24, s72, s78
  buffer_load_dwordx4 a[176:179], v2, s[4:7], s24 offen sc1
  s_add_u32 s24, s73, s78
  buffer_load_dwordx4 a[180:183], v2, s[4:7], s24 offen sc1
  s_add_u32 s24, s74, s78
  buffer_load_dwordx4 a[184:187], v2, s[4:7], s24 offen sc1
  s_add_u32 s24, s75, s78
  buffer_load_dwordx4 a[188:191], v2, s[4:7], s24 offen sc1
  s_add_u32 s78, s78, 4096
  s_cmp_eq_u32 s78, 110592
  s_cselect_b32 s78, 0, s78
  s_add_u32 s24, s72, s78
  buffer_load_dwordx4 a[192:195], v2, s[4:7], s24 offen sc1
  s_add_u32 s24, s73, s78
  buffer_load_dwordx4 a[196:199], v2, s[4:7], s24 offen sc1
  s_add_u32 s24, s74, s78
  buffer_load_dwordx4 a[200:203], v2, s[4:7], s24 offen sc1
  s_add_u32 s24, s75, s78
  buffer_load_dwordx4 a[204:207], v2, s[4:7], s24 offen sc1
  s_add_u32 s78, s78, 4096
  s_cmp_eq_u32 s78, 110592
  s_cselect_b32 s78, 0, s78
  s_add_u32 s24, s72, s78
  buffer_load_dwordx4 a[208:211], v2, s[4:7], s24 offen sc1
  s_add_u32 s24, s73, s78
  buffer_load_dwordx4 a[212:215], v2, s[4:7], s24 offen sc1
  s_add_u32 s24, s74, s78
  buffer_load_dwordx4 a[216:219], v2, s[4:7], s24 offen sc1
  s_add_u32 s24, s75, s78
  buffer_load_dwordx4 a[220:223], v2, s[4:7], s24 offen sc1
  s_add_u32 s78, s78, 4096
  s_cmp_eq_u32 s78, 110592
  s_cselect_b32 s78, 0, s78
  s_add_u32 s24, s72, s78
  buffer_load_dwordx4 a[224:227], v2, s[4:7], s24 offen sc1
  s_add_u32 s24, s73, s78
  buffer_load_dwordx4 a[228:231], v2, s[4:7], s24 offen sc1
  s_add_u32 s24, s74, s78
  buffer_load_dwordx4 a[232:235], v2, s[4:7], s24 offen sc1
  s_add_u32 s24, s75, s78
  buffer_load_dwordx4 a[236:239], v2, s[4:7], s24 offen sc1
  s_add_u32 s78, s78, 4096
  s_cmp_eq_u32 s78, 110592
  s_cselect_b32 s78, 0, s78
  s_add_u32 s24, s72, s78
  buffer_load_dwordx4 a[240:243], v2, s[4:7], s24 offen sc1
  s_add_u32 s24, s73, s78
  buffer_load_dwordx4 a[244:247], v2, s[4:7], s24 offen sc1
  s_add_u32 s24, s74, s78
  buffer_load_dwordx4 a[248:251], v2, s[4:7], s24 offen sc1
  s_add_u32 s24, s75, s78
  buffer_load_dwordx4 a[252:255], v2, s[4:7], s24 offen sc1
  s_add_u32 s78, s78, 4096
  s_cmp_eq_u32 s78, 110592
  s_cselect_b32 s78, 0, s78
  s_add_u32 s24, s72, s78
  s_add_u32 m0, s25, 24576
  s_nop 0
  buffer_load_dwordx4 v2, s[4:7], s24 offen sc1 lds
  s_add_u32 s24, s73, s78
  s_add_u32 m0, s25, 25600
  s_nop 0
  buffer_load_dwordx4 v2, s[4:7], s24 offen sc1 lds
  s_add_u32 s24, s74, s78
  s_add_u32 m0, s25, 26624
  s_nop 0
  buffer_load_dwordx4 v2, s[4:7], s24 offen sc1 lds
  s_add_u32 s24, s75, s78
  s_add_u32 m0, s25, 27648
  s_nop 0
  buffer_load_dwordx4 v2, s[4:7], s24 offen sc1 lds
  s_add_u32 s78, s78, 4096
  s_cmp_eq_u32 s78, 110592
  s_cselect_b32 s78, 0, s78
  s_add_u32 s24, s72, s78
  s_add_u32 m0, s25, 28672
  s_nop 0
  buffer_load_dwordx4 v2, s[4:7], s24 offen sc1 lds
  s_add_u32 s24, s73, s78
  s_add_u32 m0, s25, 29696
  s_nop 0
  buffer_load_dwordx4 v2, s[4:7], s24 offen sc1 lds
  s_add_u32 s24, s74, s78
  s_add_u32 m0, s25, 30720
  s_nop 0
  buffer_load_dwordx4 v2, s[4:7], s24 offen sc1 lds
  s_add_u32 s24, s75, s78
  s_add_u32 m0, s25, 31744
  s_nop 0
  buffer_load_dwordx4 v2, s[4:7], s24 offen sc1 lds
  s_add_u32 s78, s78, 4096
  s_cmp_eq_u32 s78, 110592
  s_cselect_b32 s78, 0, s78
  s_waitcnt vmcnt(24)
  s_add_u32 s24, s72, s78
  s_add_u32 m0, s25, 32768
  s_nop 0
  buffer_load_dwordx4 v2, s[4:7], s24 offen sc1 lds
  s_add_u32 s24, s73, s78
  s_add_u32 m0, s25, 33792
  s_nop 0
  buffer_load_dwordx4 v2, s[4:7], s24 offen sc1 lds
  s_add_u32 s24, s74, s78
  s_add_u32 m0, s25, 34816
  s_nop 0
  buffer_load_dwordx4 v2, s[4:7], s24 offen sc1 lds
  s_add_u32 s24, s75, s78
  s_add_u32 m0, s25, 35840
  s_nop 0
  buffer_load_dwordx4 v2, s[4:7], s24 offen sc1 lds
  s_add_u32 s78, s78, 4096
  s_cmp_eq_u32 s78, 110592
  s_cselect_b32 s78, 0, s78
  s_add_u32 s24, s72, s78
  s_add_u32 m0, s25, 36864
  s_nop 0
  buffer_load_dwordx4 v2, s[4:7], s24 offen sc1 lds
  s_add_u32 s24, s73, s78
  s_add_u32 m0, s25, 37888
  s_nop 0
  buffer_load_dwordx4 v2, s[4:7], s24 offen sc1 lds
  s_add_u32 s24, s74, s78
  s_add_u32 m0, s25, 38912
  s_nop 0
  buffer_load_dwordx4 v2, s[4:7], s24 offen sc1 lds
  s_add_u32 s24, s75, s78
  s_add_u32 m0, s25, 39936
  s_nop 0
  buffer_load_dwordx4 v2, s[4:7], s24 offen sc1 lds
  s_add_u32 s78, s78, 4096
  s_cmp_eq_u32 s78, 110592
  s_cselect_b32 s78, 0, s78
  s_add_u32 s24, s72, s78
  s_add_u32 m0, s25, 40960
  s_nop 0
  buffer_load_dwordx4 v2, s[4:7], s24 offen sc1 lds
  s_add_u32 s24, s73, s78
  s_add_u32 m0, s25, 41984
  s_nop 0
  buffer_load_dwordx4 v2, s[4:7], s24 offen sc1 lds
  s_add_u32 s24, s74, s78
  s_add_u32 m0, s25, 43008
  s_nop 0
  buffer_load_dwordx4 v2, s[4:7], s24 offen sc1 lds
  s_add_u32 s24, s75, s78
  s_add_u32 m0, s25, 44032
  s_nop 0
  buffer_load_dwordx4 v2, s[4:7], s24 offen sc1 lds
  s_add_u32 s78, s78, 4096
  s_cmp_eq_u32 s78, 110592
  s_cselect_b32 s78, 0, s78
  s_add_u32 s24, s72, s78
  s_add_u32 m0, s25, 45056
  s_nop 0
  buffer_load_dwordx4 v2, s[4:7], s24 offen sc1 lds
  s_add_u32 s24, s73, s78
  s_add_u32 m0, s25, 46080
  s_nop 0
  buffer_load_dwordx4 v2, s[4:7], s24 offen sc1 lds
  s_add_u32 s24, s74, s78
  s_add_u32 m0, s25, 47104
  s_nop 0
  buffer_load_dwordx4 v2, s[4:7], s24 offen sc1 lds
  s_add_u32 s24, s75, s78
  s_add_u32 m0, s25, 48128
  s_nop 0
  buffer_load_dwordx4 v2, s[4:7], s24 offen sc1 lds
  s_add_u32 s78, s78, 4096
  s_cmp_eq_u32 s78, 110592
  s_cselect_b32 s78, 0, s78
  s_add_u32 s24, s72, s78
  s_add_u32 m0, s25, 49152
  s_nop 0
  buffer_load_dwordx4 v2, s[4:7], s24 offen sc1 lds
  s_add_u32 s24, s73, s78
  s_add_u32 m0, s25, 50176
  s_nop 0
  buffer_load_dwordx4 v2, s[4:7], s24 offen sc1 lds
  s_add_u32 s24, s74, s78
  s_add_u32 m0, s25, 51200
  s_nop 0
  buffer_load_dwordx4 v2, s[4:7], s24 offen sc1 lds
  s_add_u32 s24, s75, s78
  s_add_u32 m0, s25, 52224
  s_nop 0
  buffer_load_dwordx4 v2, s[4:7], s24 offen sc1 lds
  s_add_u32 s78, s78, 4096
  s_cmp_eq_u32 s78, 110592
  s_cselect_b32 s78, 0, s78
  s_add_u32 s24, s72, s78
  s_add_u32 m0, s25, 53248
  s_nop 0
  buffer_load_dwordx4 v2, s[4:7], s24 offen sc1 lds
  s_add_u32 s24, s73, s78
  s_add_u32 m0, s25, 54272
  s_nop 0
  buffer_load_dwordx4 v2, s[4:7], s24 offen sc1 lds
  s_add_u32 s24, s74, s78
  s_add_u32 m0, s25, 55296
  s_nop 0
  buffer_load_dwordx4 v2, s[4:7], s24 offen sc1 lds
  s_add_u32 s24, s75, s78
  s_add_u32 m0, s25, 56320
  s_nop 0
  buffer_load_dwordx4 v2, s[4:7], s24 offen sc1 lds
  s_add_u32 s78, s78, 4096
  s_cmp_eq_u32 s78, 110592
  s_cselect_b32 s78, 0, s78
  s_sub_u32 s24, s50, 68
  s_mul_i32 s22, s24, 13108
  s_lshr_b32 s22, s22, 16
  s_mul_i32 s25, s22, 5
  s_sub_u32 s23, s24, s25
  s_mov_b32 s8, s40
  s_and_b32 s9, s41, 0xffff
  s_mov_b32 s10, 7077888
  s_mov_b32 s11, 0x00020000
  s_mov_b32 s52, s42
  s_and_b32 s53, s43, 0xffff
  s_mov_b32 s54, 3456
  s_mov_b32 s55, 0x00020000
  s_mov_b32 s26, 5462
  s_movk_i32 s25, 3456
  s_mul_i32 s24, s22, 192
  v_add_u32 v3, 0, v0
  v_mul_lo_u32 v4, v3, s26
  v_lshrrev_b32 v4, 16, v4
  v_mul_u32_u24 v5, 12, v4
  v_sub_u32 v3, v3, v5
  v_mul_lo_u32 v4, v4, s25
  v_lshl_add_u32 v4, v3, 4, v4
  v_add_u32 v6, s24, v4
  v_add_u32 v3, 256, v0
  v_mul_lo_u32 v4, v3, s26
  v_lshrrev_b32 v4, 16, v4
  v_mul_u32_u24 v5, 12, v4
  v_sub_u32 v3, v3, v5
  v_mul_lo_u32 v4, v4, s25
  v_lshl_add_u32 v4, v3, 4, v4
  v_add_u32 v7, s24, v4
  s_lshl_b32 s24, s23, 8
  v_add_u32 v3, 0, v0
  v_lshrrev_b32 v4, 4, v3
  v_and_b32 v3, 15, v3
  v_and_b32 v5, 3, v4
  v_lshlrev_b32 v5, 2, v5
  v_xor_b32 v3, v3, v5
  v_mul_u32_u24 v4, 0x500, v4
  v_lshl_add_u32 v4, v3, 4, v4
  v_add_u32 v8, s24, v4
  v_add_u32 v3, 256, v0
  v_lshrrev_b32 v4, 4, v3
  v_and_b32 v3, 15, v3
  v_and_b32 v5, 3, v4
  v_lshlrev_b32 v5, 2, v5
  v_xor_b32 v3, v3, v5
  v_mul_u32_u24 v4, 0x500, v4
  v_lshl_add_u32 v4, v3, 4, v4
  v_add_u32 v9, s24, v4
  v_lshrrev_b32 v3, 5, v1
  v_mul_u32_u24 v3, 8, v3
  v_bfe_u32 v4, v1, 2, 2
  v_add_u32 v3, v3, v4
  v_mul_u32_u24 v10, 192, v3
  v_bfe_u32 v4, v1, 1, 1
  v_lshl_add_u32 v10, v4, 3, v10
  v_bfe_u32 v4, v1, 0, 1
  v_lshl_add_u32 v10, v4, 4, v10
  v_bfe_u32 v4, v1, 4, 1
  v_lshl_add_u32 v10, v4, 5, v10
  v_lshrrev_b32 v3, 5, v1
  v_mul_u32_u24 v3, 8, v3
  v_bfe_u32 v4, v1, 2, 2
  v_add_u32 v3, v3, v4
  v_mul_u32_u24 v11, 256, v3
  v_bfe_u32 v4, v1, 1, 1
  v_lshl_add_u32 v11, v4, 3, v11
  v_bfe_u32 v4, v1, 4, 1
  v_lshl_add_u32 v11, v4, 4, v11
  v_bfe_u32 v4, v1, 0, 1
  v_lshl_add_u32 v11, v4, 5, v11
  v_and_b32 v4, 3, v3
  v_lshlrev_b32 v4, 6, v4
  v_xor_b32 v11, v4, v11
  s_lshl_b32 s24, s17, 6
  v_xor_b32 v11, s24, v11
  v_lshlrev_b32 v5, 2, v1
  v_lshrrev_b32 v3, 5, v1
  v_lshlrev_b32 v3, 4, v3
  s_mul_i32 s24, s22, 192
  buffer_load_dwordx4 v[40:43], v3, s[52:55], s24 offen offset:0
  buffer_load_dwordx4 v[44:47], v3, s[52:55], s24 offen offset:32
  buffer_load_dwordx4 v[48:51], v3, s[52:55], s24 offen offset:64
  buffer_load_dwordx4 v[52:55], v3, s[52:55], s24 offen offset:96
  buffer_load_dwordx4 v[56:59], v3, s[52:55], s24 offen offset:128
  buffer_load_dwordx4 v[60:63], v3, s[52:55], s24 offen offset:160
  v_accvgpr_write_b32 a0, 0
  v_accvgpr_write_b32 a1, 0
  v_accvgpr_write_b32 a2, 0
  v_accvgpr_write_b32 a3, 0
  v_accvgpr_write_b32 a4, 0
  v_accvgpr_write_b32 a5, 0
  v_accvgpr_write_b32 a6, 0
  v_accvgpr_write_b32 a7, 0
  v_accvgpr_write_b32 a8, 0
  v_accvgpr_write_b32 a9, 0
  v_accvgpr_write_b32 a10, 0
  v_accvgpr_write_b32 a11, 0
  v_accvgpr_write_b32 a12, 0
  v_accvgpr_write_b32 a13, 0
  v_accvgpr_write_b32 a14, 0
  v_accvgpr_write_b32 a15, 0
  v_accvgpr_write_b32 a16, 0
  v_accvgpr_write_b32 a17, 0
  v_accvgpr_write_b32 a18, 0
  v_accvgpr_write_b32 a19, 0
  v_accvgpr_write_b32 a20, 0
  v_accvgpr_write_b32 a21, 0
  v_accvgpr_write_b32 a22, 0
  v_accvgpr_write_b32 a23, 0
  v_accvgpr_write_b32 a24, 0
  v_accvgpr_write_b32 a25, 0
  v_accvgpr_write_b32 a26, 0
  v_accvgpr_write_b32 a27, 0
  v_accvgpr_write_b32 a28, 0
  v_accvgpr_write_b32 a29, 0
  v_accvgpr_write_b32 a30, 0
  v_accvgpr_write_b32 a31, 0
  v_accvgpr_write_b32 a32, 0
  v_accvgpr_write_b32 a33, 0
  v_accvgpr_write_b32 a34, 0
  v_accvgpr_write_b32 a35, 0
  v_accvgpr_write_b32 a36, 0
  v_accvgpr_write_b32 a37, 0
  v_accvgpr_write_b32 a38, 0
  v_accvgpr_write_b32 a39, 0
  v_accvgpr_write_b32 a40, 0
  v_accvgpr_write_b32 a41, 0
  v_accvgpr_write_b32 a42, 0
  v_accvgpr_write_b32 a43, 0
  v_accvgpr_write_b32 a44, 0
  v_accvgpr_write_b32 a45, 0
  v_accvgpr_write_b32 a46, 0
  v_accvgpr_write_b32 a47, 0
  s_mov_b32 s27, 0
  s_mov_b32 s28, 98566144
  s_mov_b32 s31, 3678208
  s_mov_b32 s21, 0
  s_barrier
  s_add_u32 m0, s29, 0
  s_nop 0
  buffer_load_dwordx4 v6, s[8:11], s27 offen lds
  s_add_u32 m0, s29, 4096
  s_nop 0
  buffer_load_dwordx4 v7, s[8:11], s27 offen lds
  s_add_u32 s27, s27, 110592
Lg1p_39:
  s_cmp_lg_u32 s17, 0
  s_cbranch_scc1 Lww_40_ok
Lww_40:
  buffer_load_dword v12, v5, s[4:7], s31 offen sc1
  s_waitcnt vmcnt(0)
  v_cmp_eq_u32 vcc, 0, v12
  s_add_u32 s0, s0, 1
  s_and_b32 s25, vcc_lo, 15
  s_cbranch_scc0 Lww_40_ok
  s_sleep 2
  s_cmp_lt_u32 s0, 1572864
  s_cbranch_scc1 Lww_40
Lww_40_ok:
  s_barrier
  s_add_u32 m0, s29, 16384
  s_nop 0
  buffer_load_dwordx4 v8, s[4:7], s28 offen sc1 lds
  s_add_u32 m0, s29, 20480
  s_nop 0
  buffer_load_dwordx4 v9, s[4:7], s28 offen sc1 lds
  s_add_u32 m0, s29, 8192
  s_nop 0
  buffer_load_dwordx4 v6, s[8:11], s27 offen lds
  s_add_u32 m0, s29, 12288
  s_nop 0
  buffer_load_dwordx4 v7, s[8:11], s27 offen lds
  s_add_u32 s27, s27, 110592
  s_add_u32 s28, s28, 40960
  s_add_u32 s31, s31, 128
  s_waitcnt vmcnt(2)
  s_barrier
  ds_read_b64_tr_b16 v[28:29], v11 offset:16384
  ds_read_b64_tr_b16 v[30:31], v11 offset:17408
  ds_read_b64_tr_b16 v[16:17], v10 offset:0
  ds_read_b64_tr_b16 v[18:19], v10 offset:768
  ds_read_b64_tr_b16 v[20:21], v10 offset:64
  ds_read_b64_tr_b16 v[22:23], v10 offset:832
  ds_read_b64_tr_b16 v[24:25], v10 offset:128
  ds_read_b64_tr_b16 v[26:27], v10 offset:896
  ds_read_b64_tr_b16 v[76:77], v11 offset:20480
  ds_read_b64_tr_b16 v[78:79], v11 offset:21504
  ds_read_b64_tr_b16 v[64:65], v10 offset:3072
  ds_read_b64_tr_b16 v[66:67], v10 offset:3840
  ds_read_b64_tr_b16 v[68:69], v10 offset:3136
  ds_read_b64_tr_b16 v[70:71], v10 offset:3904
  ds_read_b64_tr_b16 v[72:73], v10 offset:3200
  ds_read_b64_tr_b16 v[74:75], v10 offset:3968
  s_waitcnt lgkmcnt(8)
  v_mfma_f32_32x32x16_bf16 a[0:15], v[16:19], v[28:31], a[0:15]
  v_mfma_f32_32x32x16_bf16 a[16:31], v[20:23], v[28:31], a[16:31]
  v_mfma_f32_32x32x16_bf16 a[32:47], v[24:27], v[28:31], a[32:47]
  s_waitcnt lgkmcnt(0)
  v_mfma_f32_32x32x16_bf16 a[0:15], v[64:67], v[76:79], a[0:15]
  v_mfma_f32_32x32x16_bf16 a[16:31], v[68:71], v[76:79], a[16:31]
  v_mfma_f32_32x32x16_bf16 a[32:47], v[72:75], v[76:79], a[32:47]
  s_barrier
  s_cmp_lg_u32 s17, 0
  s_cbranch_scc1 Lww_41_ok
Lww_41:
  buffer_load_dword v12, v5, s[4:7], s31 offen sc1
  s_waitcnt vmcnt(0)
  v_cmp_eq_u32 vcc, 0, v12
  s_add_u32 s0, s0, 1
  s_and_b32 s25, vcc_lo, 15
  s_cbranch_scc0 Lww_41_ok
  s_sleep 2
  s_cmp_lt_u32 s0, 1572864
  s_cbranch_scc1 Lww_41
Lww_41_ok:
  s_barrier
  s_add_u32 m0, s29, 16384
  s_nop 0
  buffer_load_dwordx4 v8, s[4:7], s28 offen sc1 lds
  s_add_u32 m0, s29, 20480
  s_nop 0
  buffer_load_dwordx4 v9, s[4:7], s28 offen sc1 lds
  s_add_u32 m0, s29, 0
  s_nop 0
  buffer_load_dwordx4 v6, s[8:11], s27 offen lds
  s_add_u32 m0, s29, 4096
  s_nop 0
  buffer_load_dwordx4 v7, s[8:11], s27 offen lds
  s_add_u32 s27, s27, 110592
  s_add_u32 s28, s28, 40960
  s_add_u32 s31, s31, 128
  s_waitcnt vmcnt(2)
  s_barrier
  ds_read_b64_tr_b16 v[28:29], v11 offset:16384
  ds_read_b64_tr_b16 v[30:31], v11 offset:17408
  ds_read_b64_tr_b16 v[16:17], v10 offset:8192
  ds_read_b64_tr_b16 v[18:19], v10 offset:8960
  ds_read_b64_tr_b16 v[20:21], v10 offset:8256
  ds_read_b64_tr_b16 v[22:23], v10 offset:9024
  ds_read_b64_tr_b16 v[24:25], v10 offset:8320
  ds_read_b64_tr_b16 v[26:27], v10 offset:9088
  ds_read_b64_tr_b16 v[76:77], v11 offset:20480
  ds_read_b64_tr_b16 v[78:79], v11 offset:21504
  ds_read_b64_tr_b16 v[64:65], v10 offset:11264
  ds_read_b64_tr_b16 v[66:67], v10 offset:12032
  ds_read_b64_tr_b16 v[68:69], v10 offset:11328
  ds_read_b64_tr_b16 v[70:71], v10 offset:12096
  ds_read_b64_tr_b16 v[72:73], v10 offset:11392
  ds_read_b64_tr_b16 v[74:75], v10 offset:12160
  s_waitcnt lgkmcnt(8)
  v_mfma_f32_32x32x16_bf16 a[0:15], v[16:19], v[28:31], a[0:15]
  v_mfma_f32_32x32x16_bf16 a[16:31], v[20:23], v[28:31], a[16:31]
  v_mfma_f32_32x32x16_bf16 a[32:47], v[24:27], v[28:31], a[32:47]
  s_waitcnt lgkmcnt(0)
  v_mfma_f32_32x32x16_bf16 a[0:15], v[64:67], v[76:79], a[0:15]
  v_mfma_f32_32x32x16_bf16 a[16:31], v[68:71], v[76:79], a[16:31]
  v_mfma_f32_32x32x16_bf16 a[32:47], v[72:75], v[76:79], a[32:47]
  s_barrier
  s_add_u32 s21, s21, 2
  s_cmp_lt_u32 s21, 64
  s_cbranch_scc1 Lg1p_39
  s_lshl_b32 s24, s23, 2
  s_add_u32 s24, s24, s17
  s_mul_i32 s26, s24, 110592
  s_mul_i32 s24, s22, 6144
  s_add_u32 s26, s26, s24
  s_add_u32 s26, s26, 101711872
  s_mov_b32 s24, 0xc0135761
  s_mov_b32 s27, 0xbdd2d3e8
  v_accvgpr_read_b32 v64, a0
  v_accvgpr_read_b32 v65, a1
  v_accvgpr_read_b32 v66, a2
  v_accvgpr_read_b32 v67, a3
  v_accvgpr_read_b32 v68, a4
  v_accvgpr_read_b32 v69, a5
  v_accvgpr_read_b32 v70, a6
  v_accvgpr_read_b32 v71, a7
  v_accvgpr_read_b32 v72, a8
  v_accvgpr_read_b32 v73, a9
  v_accvgpr_read_b32 v74, a10
  v_accvgpr_read_b32 v75, a11
  v_accvgpr_read_b32 v76, a12
  v_accvgpr_read_b32 v77, a13
  v_accvgpr_read_b32 v78, a14
  v_accvgpr_read_b32 v79, a15
  v_cvt_pk_bf16_f32 v16, v64, v65
  v_cvt_pk_bf16_f32 v17, v66, v67
  v_cvt_pk_bf16_f32 v18, v68, v69
  v_cvt_pk_bf16_f32 v19, v70, v71
  v_cvt_pk_bf16_f32 v20, v72, v73
  v_cvt_pk_bf16_f32 v21, v74, v75
  v_cvt_pk_bf16_f32 v22, v76, v77
  v_cvt_pk_bf16_f32 v23, v78, v79
  v_lshlrev_b32 v64, 16, v16
  v_and_b32 v65, 0xffff0000, v16
  v_lshlrev_b32 v66, 16, v17
  v_and_b32 v67, 0xffff0000, v17
  v_lshlrev_b32 v68, 16, v18
  v_and_b32 v69, 0xffff0000, v18
  v_lshlrev_b32 v70, 16, v19
  v_and_b32 v71, 0xffff0000, v19
  v_lshlrev_b32 v72, 16, v20
  v_and_b32 v73, 0xffff0000, v20
  v_lshlrev_b32 v74, 16, v21
  v_and_b32 v75, 0xffff0000, v21
  v_lshlrev_b32 v76, 16, v22
  v_and_b32 v77, 0xffff0000, v22
  v_lshlrev_b32 v78, 16, v23
  v_and_b32 v79, 0xffff0000, v23
  v_lshlrev_b32 v80, 16, v40
  v_and_b32 v81, 0xffff0000, v40
  v_lshlrev_b32 v82, 16, v41
  v_and_b32 v83, 0xffff0000, v41
  v_lshlrev_b32 v84, 16, v42
  v_and_b32 v85, 0xffff0000, v42
  v_lshlrev_b32 v86, 16, v43
  v_and_b32 v87, 0xffff0000, v43
  v_lshlrev_b32 v88, 16, v44
  v_and_b32 v89, 0xffff0000, v44
  v_lshlrev_b32 v90, 16, v45
  v_and_b32 v91, 0xffff0000, v45
  v_lshlrev_b32 v92, 16, v46
  v_and_b32 v93, 0xffff0000, v46
  v_lshlrev_b32 v94, 16, v47
  v_and_b32 v95, 0xffff0000, v47
  v_pk_add_f32 v[64:65], v[64:65], v[80:81]
  v_pk_add_f32 v[66:67], v[66:67], v[82:83]
  v_pk_add_f32 v[68:69], v[68:69], v[84:85]
  v_pk_add_f32 v[70:71], v[70:71], v[86:87]
  v_pk_add_f32 v[72:73], v[72:73], v[88:89]
  v_pk_add_f32 v[74:75], v[74:75], v[90:91]
  v_pk_add_f32 v[76:77], v[76:77], v[92:93]
  v_pk_add_f32 v[78:79], v[78:79], v[94:95]
  v_cvt_pk_bf16_f32 v16, v64, v65
  v_cvt_pk_bf16_f32 v17, v66, v67
  v_cvt_pk_bf16_f32 v18, v68, v69
  v_cvt_pk_bf16_f32 v19, v70, v71
  v_cvt_pk_bf16_f32 v20, v72, v73
  v_cvt_pk_bf16_f32 v21, v74, v75
  v_cvt_pk_bf16_f32 v22, v76, v77
  v_cvt_pk_bf16_f32 v23, v78, v79
  v_lshlrev_b32 v64, 16, v16
  v_and_b32 v65, 0xffff0000, v16
  v_lshlrev_b32 v66, 16, v17
  v_and_b32 v67, 0xffff0000, v17
  v_lshlrev_b32 v68, 16, v18
  v_and_b32 v69, 0xffff0000, v18
  v_lshlrev_b32 v70, 16, v19
  v_and_b32 v71, 0xffff0000, v19
  v_lshlrev_b32 v72, 16, v20
  v_and_b32 v73, 0xffff0000, v20
  v_lshlrev_b32 v74, 16, v21
  v_and_b32 v75, 0xffff0000, v21
  v_lshlrev_b32 v76, 16, v22
  v_and_b32 v77, 0xffff0000, v22
  v_lshlrev_b32 v78, 16, v23
  v_and_b32 v79, 0xffff0000, v23
  v_mul_f32 v80, v64, v64
  v_mul_f32 v81, v65, v65
  v_mul_f32 v82, v66, v66
  v_mul_f32 v83, v67, v67
  v_mul_f32 v84, v68, v68
  v_mul_f32 v85, v69, v69
  v_mul_f32 v86, v70, v70
  v_mul_f32 v87, v71, v71
  v_mov_b32 v40, s24
  v_fmac_f32 v40, s27, v80
  v_mov_b32 v41, s24
  v_fmac_f32 v41, s27, v81
  v_mov_b32 v42, s24
  v_fmac_f32 v42, s27, v82
  v_mov_b32 v43, s24
  v_fmac_f32 v43, s27, v83
  v_mov_b32 v44, s24
  v_fmac_f32 v44, s27, v84
  v_mov_b32 v45, s24
  v_fmac_f32 v45, s27, v85
  v_mov_b32 v46, s24
  v_fmac_f32 v46, s27, v86
  v_mov_b32 v47, s24
  v_fmac_f32 v47, s27, v87
  v_mul_f32 v80, v40, v64
  v_mul_f32 v81, v41, v65
  v_mul_f32 v82, v42, v66
  v_mul_f32 v83, v43, v67
  v_mul_f32 v84, v44, v68
  v_mul_f32 v85, v45, v69
  v_mul_f32 v86, v46, v70
  v_mul_f32 v87, v47, v71
  v_exp_f32 v80, v80
  v_exp_f32 v81, v81
  v_exp_f32 v82, v82
  v_exp_f32 v83, v83
  v_exp_f32 v84, v84
  v_exp_f32 v85, v85
  v_exp_f32 v86, v86
  v_exp_f32 v87, v87
  v_add_f32 v80, 1.0, v80
  v_add_f32 v81, 1.0, v81
  v_add_f32 v82, 1.0, v82
  v_add_f32 v83, 1.0, v83
  v_add_f32 v84, 1.0, v84
  v_add_f32 v85, 1.0, v85
  v_add_f32 v86, 1.0, v86
  v_add_f32 v87, 1.0, v87
  v_rcp_f32 v80, v80
  v_rcp_f32 v81, v81
  v_rcp_f32 v82, v82
  v_rcp_f32 v83, v83
  v_rcp_f32 v84, v84
  v_rcp_f32 v85, v85
  v_rcp_f32 v86, v86
  v_rcp_f32 v87, v87
  v_mul_f32 v64, v64, v80
  v_mul_f32 v65, v65, v81
  v_mul_f32 v66, v66, v82
  v_mul_f32 v67, v67, v83
  v_mul_f32 v68, v68, v84
  v_mul_f32 v69, v69, v85
  v_mul_f32 v70, v70, v86
  v_mul_f32 v71, v71, v87
  v_mul_f32 v88, v72, v72
  v_mul_f32 v89, v73, v73
  v_mul_f32 v90, v74, v74
  v_mul_f32 v91, v75, v75
  v_mul_f32 v92, v76, v76
  v_mul_f32 v93, v77, v77
  v_mul_f32 v94, v78, v78
  v_mul_f32 v95, v79, v79
  v_mov_b32 v40, s24
  v_fmac_f32 v40, s27, v88
  v_mov_b32 v41, s24
  v_fmac_f32 v41, s27, v89
  v_mov_b32 v42, s24
  v_fmac_f32 v42, s27, v90
  v_mov_b32 v43, s24
  v_fmac_f32 v43, s27, v91
  v_mov_b32 v44, s24
  v_fmac_f32 v44, s27, v92
  v_mov_b32 v45, s24
  v_fmac_f32 v45, s27, v93
  v_mov_b32 v46, s24
  v_fmac_f32 v46, s27, v94
  v_mov_b32 v47, s24
  v_fmac_f32 v47, s27, v95
  v_mul_f32 v88, v40, v72
  v_mul_f32 v89, v41, v73
  v_mul_f32 v90, v42, v74
  v_mul_f32 v91, v43, v75
  v_mul_f32 v92, v44, v76
  v_mul_f32 v93, v45, v77
  v_mul_f32 v94, v46, v78
  v_mul_f32 v95, v47, v79
  v_exp_f32 v88, v88
  v_exp_f32 v89, v89
  v_exp_f32 v90, v90
  v_exp_f32 v91, v91
  v_exp_f32 v92, v92
  v_exp_f32 v93, v93
  v_exp_f32 v94, v94
  v_exp_f32 v95, v95
  v_add_f32 v88, 1.0, v88
  v_add_f32 v89, 1.0, v89
  v_add_f32 v90, 1.0, v90
  v_add_f32 v91, 1.0, v91
  v_add_f32 v92, 1.0, v92
  v_add_f32 v93, 1.0, v93
  v_add_f32 v94, 1.0, v94
  v_add_f32 v95, 1.0, v95
  v_rcp_f32 v88, v88
  v_rcp_f32 v89, v89
  v_rcp_f32 v90, v90
  v_rcp_f32 v91, v91
  v_rcp_f32 v92, v92
  v_rcp_f32 v93, v93
  v_rcp_f32 v94, v94
  v_rcp_f32 v95, v95
  v_mul_f32 v72, v72, v88
  v_mul_f32 v73, v73, v89
  v_mul_f32 v74, v74, v90
  v_mul_f32 v75, v75, v91
  v_mul_f32 v76, v76, v92
  v_mul_f32 v77, v77, v93
  v_mul_f32 v78, v78, v94
  v_mul_f32 v79, v79, v95
  v_cvt_pk_bf16_f32 v16, v64, v65
  v_cvt_pk_bf16_f32 v17, v66, v67
  v_cvt_pk_bf16_f32 v18, v68, v69
  v_cvt_pk_bf16_f32 v19, v70, v71
  v_cvt_pk_bf16_f32 v20, v72, v73
  v_cvt_pk_bf16_f32 v21, v74, v75
  v_cvt_pk_bf16_f32 v22, v76, v77
  v_cvt_pk_bf16_f32 v23, v78, v79
  buffer_store_dwordx4 v[16:19], v2, s[4:7], s26 offen offset:0 sc1
  buffer_store_dwordx4 v[20:23], v2, s[4:7], s26 offen offset:1024 sc1
  v_accvgpr_read_b32 v64, a16
  v_accvgpr_read_b32 v65, a17
  v_accvgpr_read_b32 v66, a18
  v_accvgpr_read_b32 v67, a19
  v_accvgpr_read_b32 v68, a20
  v_accvgpr_read_b32 v69, a21
  v_accvgpr_read_b32 v70, a22
  v_accvgpr_read_b32 v71, a23
  v_accvgpr_read_b32 v72, a24
  v_accvgpr_read_b32 v73, a25
  v_accvgpr_read_b32 v74, a26
  v_accvgpr_read_b32 v75, a27
  v_accvgpr_read_b32 v76, a28
  v_accvgpr_read_b32 v77, a29
  v_accvgpr_read_b32 v78, a30
  v_accvgpr_read_b32 v79, a31
  v_cvt_pk_bf16_f32 v24, v64, v65
  v_cvt_pk_bf16_f32 v25, v66, v67
  v_cvt_pk_bf16_f32 v26, v68, v69
  v_cvt_pk_bf16_f32 v27, v70, v71
  v_cvt_pk_bf16_f32 v28, v72, v73
  v_cvt_pk_bf16_f32 v29, v74, v75
  v_cvt_pk_bf16_f32 v30, v76, v77
  v_cvt_pk_bf16_f32 v31, v78, v79
  v_lshlrev_b32 v64, 16, v24
  v_and_b32 v65, 0xffff0000, v24
  v_lshlrev_b32 v66, 16, v25
  v_and_b32 v67, 0xffff0000, v25
  v_lshlrev_b32 v68, 16, v26
  v_and_b32 v69, 0xffff0000, v26
  v_lshlrev_b32 v70, 16, v27
  v_and_b32 v71, 0xffff0000, v27
  v_lshlrev_b32 v72, 16, v28
  v_and_b32 v73, 0xffff0000, v28
  v_lshlrev_b32 v74, 16, v29
  v_and_b32 v75, 0xffff0000, v29
  v_lshlrev_b32 v76, 16, v30
  v_and_b32 v77, 0xffff0000, v30
  v_lshlrev_b32 v78, 16, v31
  v_and_b32 v79, 0xffff0000, v31
  v_lshlrev_b32 v80, 16, v48
  v_and_b32 v81, 0xffff0000, v48
  v_lshlrev_b32 v82, 16, v49
  v_and_b32 v83, 0xffff0000, v49
  v_lshlrev_b32 v84, 16, v50
  v_and_b32 v85, 0xffff0000, v50
  v_lshlrev_b32 v86, 16, v51
  v_and_b32 v87, 0xffff0000, v51
  v_lshlrev_b32 v88, 16, v52
  v_and_b32 v89, 0xffff0000, v52
  v_lshlrev_b32 v90, 16, v53
  v_and_b32 v91, 0xffff0000, v53
  v_lshlrev_b32 v92, 16, v54
  v_and_b32 v93, 0xffff0000, v54
  v_lshlrev_b32 v94, 16, v55
  v_and_b32 v95, 0xffff0000, v55
  v_pk_add_f32 v[64:65], v[64:65], v[80:81]
  v_pk_add_f32 v[66:67], v[66:67], v[82:83]
  v_pk_add_f32 v[68:69], v[68:69], v[84:85]
  v_pk_add_f32 v[70:71], v[70:71], v[86:87]
  v_pk_add_f32 v[72:73], v[72:73], v[88:89]
  v_pk_add_f32 v[74:75], v[74:75], v[90:91]
  v_pk_add_f32 v[76:77], v[76:77], v[92:93]
  v_pk_add_f32 v[78:79], v[78:79], v[94:95]
  v_cvt_pk_bf16_f32 v24, v64, v65
  v_cvt_pk_bf16_f32 v25, v66, v67
  v_cvt_pk_bf16_f32 v26, v68, v69
  v_cvt_pk_bf16_f32 v27, v70, v71
  v_cvt_pk_bf16_f32 v28, v72, v73
  v_cvt_pk_bf16_f32 v29, v74, v75
  v_cvt_pk_bf16_f32 v30, v76, v77
  v_cvt_pk_bf16_f32 v31, v78, v79
  v_lshlrev_b32 v64, 16, v24
  v_and_b32 v65, 0xffff0000, v24
  v_lshlrev_b32 v66, 16, v25
  v_and_b32 v67, 0xffff0000, v25
  v_lshlrev_b32 v68, 16, v26
  v_and_b32 v69, 0xffff0000, v26
  v_lshlrev_b32 v70, 16, v27
  v_and_b32 v71, 0xffff0000, v27
  v_lshlrev_b32 v72, 16, v28
  v_and_b32 v73, 0xffff0000, v28
  v_lshlrev_b32 v74, 16, v29
  v_and_b32 v75, 0xffff0000, v29
  v_lshlrev_b32 v76, 16, v30
  v_and_b32 v77, 0xffff0000, v30
  v_lshlrev_b32 v78, 16, v31
  v_and_b32 v79, 0xffff0000, v31
  v_mul_f32 v80, v64, v64
  v_mul_f32 v81, v65, v65
  v_mul_f32 v82, v66, v66
  v_mul_f32 v83, v67, v67
  v_mul_f32 v84, v68, v68
  v_mul_f32 v85, v69, v69
  v_mul_f32 v86, v70, v70
  v_mul_f32 v87, v71, v71
  v_mov_b32 v48, s24
  v_fmac_f32 v48, s27, v80
  v_mov_b32 v49, s24
  v_fmac_f32 v49, s27, v81
  v_mov_b32 v50, s24
  v_fmac_f32 v50, s27, v82
  v_mov_b32 v51, s24
  v_fmac_f32 v51, s27, v83
  v_mov_b32 v52, s24
  v_fmac_f32 v52, s27, v84
  v_mov_b32 v53, s24
  v_fmac_f32 v53, s27, v85
  v_mov_b32 v54, s24
  v_fmac_f32 v54, s27, v86
  v_mov_b32 v55, s24
  v_fmac_f32 v55, s27, v87
  v_mul_f32 v80, v48, v64
  v_mul_f32 v81, v49, v65
  v_mul_f32 v82, v50, v66
  v_mul_f32 v83, v51, v67
  v_mul_f32 v84, v52, v68
  v_mul_f32 v85, v53, v69
  v_mul_f32 v86, v54, v70
  v_mul_f32 v87, v55, v71
  v_exp_f32 v80, v80
  v_exp_f32 v81, v81
  v_exp_f32 v82, v82
  v_exp_f32 v83, v83
  v_exp_f32 v84, v84
  v_exp_f32 v85, v85
  v_exp_f32 v86, v86
  v_exp_f32 v87, v87
  v_add_f32 v80, 1.0, v80
  v_add_f32 v81, 1.0, v81
  v_add_f32 v82, 1.0, v82
  v_add_f32 v83, 1.0, v83
  v_add_f32 v84, 1.0, v84
  v_add_f32 v85, 1.0, v85
  v_add_f32 v86, 1.0, v86
  v_add_f32 v87, 1.0, v87
  v_rcp_f32 v80, v80
  v_rcp_f32 v81, v81
  v_rcp_f32 v82, v82
  v_rcp_f32 v83, v83
  v_rcp_f32 v84, v84
  v_rcp_f32 v85, v85
  v_rcp_f32 v86, v86
  v_rcp_f32 v87, v87
  v_mul_f32 v64, v64, v80
  v_mul_f32 v65, v65, v81
  v_mul_f32 v66, v66, v82
  v_mul_f32 v67, v67, v83
  v_mul_f32 v68, v68, v84
  v_mul_f32 v69, v69, v85
  v_mul_f32 v70, v70, v86
  v_mul_f32 v71, v71, v87
  v_mul_f32 v88, v72, v72
  v_mul_f32 v89, v73, v73
  v_mul_f32 v90, v74, v74
  v_mul_f32 v91, v75, v75
  v_mul_f32 v92, v76, v76
  v_mul_f32 v93, v77, v77
  v_mul_f32 v94, v78, v78
  v_mul_f32 v95, v79, v79
  v_mov_b32 v48, s24
  v_fmac_f32 v48, s27, v88
  v_mov_b32 v49, s24
  v_fmac_f32 v49, s27, v89
  v_mov_b32 v50, s24
  v_fmac_f32 v50, s27, v90
  v_mov_b32 v51, s24
  v_fmac_f32 v51, s27, v91
  v_mov_b32 v52, s24
  v_fmac_f32 v52, s27, v92
  v_mov_b32 v53, s24
  v_fmac_f32 v53, s27, v93
  v_mov_b32 v54, s24
  v_fmac_f32 v54, s27, v94
  v_mov_b32 v55, s24
  v_fmac_f32 v55, s27, v95
  v_mul_f32 v88, v48, v72
  v_mul_f32 v89, v49, v73
  v_mul_f32 v90, v50, v74
  v_mul_f32 v91, v51, v75
  v_mul_f32 v92, v52, v76
  v_mul_f32 v93, v53, v77
  v_mul_f32 v94, v54, v78
  v_mul_f32 v95, v55, v79
  v_exp_f32 v88, v88
  v_exp_f32 v89, v89
  v_exp_f32 v90, v90
  v_exp_f32 v91, v91
  v_exp_f32 v92, v92
  v_exp_f32 v93, v93
  v_exp_f32 v94, v94
  v_exp_f32 v95, v95
  v_add_f32 v88, 1.0, v88
  v_add_f32 v89, 1.0, v89
  v_add_f32 v90, 1.0, v90
  v_add_f32 v91, 1.0, v91
  v_add_f32 v92, 1.0, v92
  v_add_f32 v93, 1.0, v93
  v_add_f32 v94, 1.0, v94
  v_add_f32 v95, 1.0, v95
  v_rcp_f32 v88, v88
  v_rcp_f32 v89, v89
  v_rcp_f32 v90, v90
  v_rcp_f32 v91, v91
  v_rcp_f32 v92, v92
  v_rcp_f32 v93, v93
  v_rcp_f32 v94, v94
  v_rcp_f32 v95, v95
  v_mul_f32 v72, v72, v88
  v_mul_f32 v73, v73, v89
  v_mul_f32 v74, v74, v90
  v_mul_f32 v75, v75, v91
  v_mul_f32 v76, v76, v92
  v_mul_f32 v77, v77, v93
  v_mul_f32 v78, v78, v94
  v_mul_f32 v79, v79, v95
  v_cvt_pk_bf16_f32 v24, v64, v65
  v_cvt_pk_bf16_f32 v25, v66, v67
  v_cvt_pk_bf16_f32 v26, v68, v69
  v_cvt_pk_bf16_f32 v27, v70, v71
  v_cvt_pk_bf16_f32 v28, v72, v73
  v_cvt_pk_bf16_f32 v29, v74, v75
  v_cvt_pk_bf16_f32 v30, v76, v77
  v_cvt_pk_bf16_f32 v31, v78, v79
  buffer_store_dwordx4 v[24:27], v2, s[4:7], s26 offen offset:2048 sc1
  buffer_store_dwordx4 v[28:31], v2, s[4:7], s26 offen offset:3072 sc1
  v_accvgpr_read_b32 v64, a32
  v_accvgpr_read_b32 v65, a33
  v_accvgpr_read_b32 v66, a34
  v_accvgpr_read_b32 v67, a35
  v_accvgpr_read_b32 v68, a36
  v_accvgpr_read_b32 v69, a37
  v_accvgpr_read_b32 v70, a38
  v_accvgpr_read_b32 v71, a39
  v_accvgpr_read_b32 v72, a40
  v_accvgpr_read_b32 v73, a41
  v_accvgpr_read_b32 v74, a42
  v_accvgpr_read_b32 v75, a43
  v_accvgpr_read_b32 v76, a44
  v_accvgpr_read_b32 v77, a45
  v_accvgpr_read_b32 v78, a46
  v_accvgpr_read_b32 v79, a47
  v_cvt_pk_bf16_f32 v32, v64, v65
  v_cvt_pk_bf16_f32 v33, v66, v67
  v_cvt_pk_bf16_f32 v34, v68, v69
  v_cvt_pk_bf16_f32 v35, v70, v71
  v_cvt_pk_bf16_f32 v36, v72, v73
  v_cvt_pk_bf16_f32 v37, v74, v75
  v_cvt_pk_bf16_f32 v38, v76, v77
  v_cvt_pk_bf16_f32 v39, v78, v79
  v_lshlrev_b32 v64, 16, v32
  v_and_b32 v65, 0xffff0000, v32
  v_lshlrev_b32 v66, 16, v33
  v_and_b32 v67, 0xffff0000, v33
  v_lshlrev_b32 v68, 16, v34
  v_and_b32 v69, 0xffff0000, v34
  v_lshlrev_b32 v70, 16, v35
  v_and_b32 v71, 0xffff0000, v35
  v_lshlrev_b32 v72, 16, v36
  v_and_b32 v73, 0xffff0000, v36
  v_lshlrev_b32 v74, 16, v37
  v_and_b32 v75, 0xffff0000, v37
  v_lshlrev_b32 v76, 16, v38
  v_and_b32 v77, 0xffff0000, v38
  v_lshlrev_b32 v78, 16, v39
  v_and_b32 v79, 0xffff0000, v39
  v_lshlrev_b32 v80, 16, v56
  v_and_b32 v81, 0xffff0000, v56
  v_lshlrev_b32 v82, 16, v57
  v_and_b32 v83, 0xffff0000, v57
  v_lshlrev_b32 v84, 16, v58
  v_and_b32 v85, 0xffff0000, v58
  v_lshlrev_b32 v86, 16, v59
  v_and_b32 v87, 0xffff0000, v59
  v_lshlrev_b32 v88, 16, v60
  v_and_b32 v89, 0xffff0000, v60
  v_lshlrev_b32 v90, 16, v61
  v_and_b32 v91, 0xffff0000, v61
  v_lshlrev_b32 v92, 16, v62
  v_and_b32 v93, 0xffff0000, v62
  v_lshlrev_b32 v94, 16, v63
  v_and_b32 v95, 0xffff0000, v63
  v_pk_add_f32 v[64:65], v[64:65], v[80:81]
  v_pk_add_f32 v[66:67], v[66:67], v[82:83]
  v_pk_add_f32 v[68:69], v[68:69], v[84:85]
  v_pk_add_f32 v[70:71], v[70:71], v[86:87]
  v_pk_add_f32 v[72:73], v[72:73], v[88:89]
  v_pk_add_f32 v[74:75], v[74:75], v[90:91]
  v_pk_add_f32 v[76:77], v[76:77], v[92:93]
  v_pk_add_f32 v[78:79], v[78:79], v[94:95]
  v_cvt_pk_bf16_f32 v32, v64, v65
  v_cvt_pk_bf16_f32 v33, v66, v67
  v_cvt_pk_bf16_f32 v34, v68, v69
  v_cvt_pk_bf16_f32 v35, v70, v71
  v_cvt_pk_bf16_f32 v36, v72, v73
  v_cvt_pk_bf16_f32 v37, v74, v75
  v_cvt_pk_bf16_f32 v38, v76, v77
  v_cvt_pk_bf16_f32 v39, v78, v79
  v_lshlrev_b32 v64, 16, v32
  v_and_b32 v65, 0xffff0000, v32
  v_lshlrev_b32 v66, 16, v33
  v_and_b32 v67, 0xffff0000, v33
  v_lshlrev_b32 v68, 16, v34
  v_and_b32 v69, 0xffff0000, v34
  v_lshlrev_b32 v70, 16, v35
  v_and_b32 v71, 0xffff0000, v35
  v_lshlrev_b32 v72, 16, v36
  v_and_b32 v73, 0xffff0000, v36
  v_lshlrev_b32 v74, 16, v37
  v_and_b32 v75, 0xffff0000, v37
  v_lshlrev_b32 v76, 16, v38
  v_and_b32 v77, 0xffff0000, v38
  v_lshlrev_b32 v78, 16, v39
  v_and_b32 v79, 0xffff0000, v39
  v_mul_f32 v80, v64, v64
  v_mul_f32 v81, v65, v65
  v_mul_f32 v82, v66, v66
  v_mul_f32 v83, v67, v67
  v_mul_f32 v84, v68, v68
  v_mul_f32 v85, v69, v69
  v_mul_f32 v86, v70, v70
  v_mul_f32 v87, v71, v71
  v_mov_b32 v56, s24
  v_fmac_f32 v56, s27, v80
  v_mov_b32 v57, s24
  v_fmac_f32 v57, s27, v81
  v_mov_b32 v58, s24
  v_fmac_f32 v58, s27, v82
  v_mov_b32 v59, s24
  v_fmac_f32 v59, s27, v83
  v_mov_b32 v60, s24
  v_fmac_f32 v60, s27, v84
  v_mov_b32 v61, s24
  v_fmac_f32 v61, s27, v85
  v_mov_b32 v62, s24
  v_fmac_f32 v62, s27, v86
  v_mov_b32 v63, s24
  v_fmac_f32 v63, s27, v87
  v_mul_f32 v80, v56, v64
  v_mul_f32 v81, v57, v65
  v_mul_f32 v82, v58, v66
  v_mul_f32 v83, v59, v67
  v_mul_f32 v84, v60, v68
  v_mul_f32 v85, v61, v69
  v_mul_f32 v86, v62, v70
  v_mul_f32 v87, v63, v71
  v_exp_f32 v80, v80
  v_exp_f32 v81, v81
  v_exp_f32 v82, v82
  v_exp_f32 v83, v83
  v_exp_f32 v84, v84
  v_exp_f32 v85, v85
  v_exp_f32 v86, v86
  v_exp_f32 v87, v87
  v_add_f32 v80, 1.0, v80
  v_add_f32 v81, 1.0, v81
  v_add_f32 v82, 1.0, v82
  v_add_f32 v83, 1.0, v83
  v_add_f32 v84, 1.0, v84
  v_add_f32 v85, 1.0, v85
  v_add_f32 v86, 1.0, v86
  v_add_f32 v87, 1.0, v87
  v_rcp_f32 v80, v80
  v_rcp_f32 v81, v81
  v_rcp_f32 v82, v82
  v_rcp_f32 v83, v83
  v_rcp_f32 v84, v84
  v_rcp_f32 v85, v85
  v_rcp_f32 v86, v86
  v_rcp_f32 v87, v87
  v_mul_f32 v64, v64, v80
  v_mul_f32 v65, v65, v81
  v_mul_f32 v66, v66, v82
  v_mul_f32 v67, v67, v83
  v_mul_f32 v68, v68, v84
  v_mul_f32 v69, v69, v85
  v_mul_f32 v70, v70, v86
  v_mul_f32 v71, v71, v87
  v_mul_f32 v88, v72, v72
  v_mul_f32 v89, v73, v73
  v_mul_f32 v90, v74, v74
  v_mul_f32 v91, v75, v75
  v_mul_f32 v92, v76, v76
  v_mul_f32 v93, v77, v77
  v_mul_f32 v94, v78, v78
  v_mul_f32 v95, v79, v79
  v_mov_b32 v56, s24
  v_fmac_f32 v56, s27, v88
  v_mov_b32 v57, s24
  v_fmac_f32 v57, s27, v89
  v_mov_b32 v58, s24
  v_fmac_f32 v58, s27, v90
  v_mov_b32 v59, s24
  v_fmac_f32 v59, s27, v91
  v_mov_b32 v60, s24
  v_fmac_f32 v60, s27, v92
  v_mov_b32 v61, s24
  v_fmac_f32 v61, s27, v93
  v_mov_b32 v62, s24
  v_fmac_f32 v62, s27, v94
  v_mov_b32 v63, s24
  v_fmac_f32 v63, s27, v95
  v_mul_f32 v88, v56, v72
  v_mul_f32 v89, v57, v73
  v_mul_f32 v90, v58, v74
  v_mul_f32 v91, v59, v75
  v_mul_f32 v92, v60, v76
  v_mul_f32 v93, v61, v77
  v_mul_f32 v94, v62, v78
  v_mul_f32 v95, v63, v79
  v_exp_f32 v88, v88
  v_exp_f32 v89, v89
  v_exp_f32 v90, v90
  v_exp_f32 v91, v91
  v_exp_f32 v92, v92
  v_exp_f32 v93, v93
  v_exp_f32 v94, v94
  v_exp_f32 v95, v95
  v_add_f32 v88, 1.0, v88
  v_add_f32 v89, 1.0, v89
  v_add_f32 v90, 1.0, v90
  v_add_f32 v91, 1.0, v91
  v_add_f32 v92, 1.0, v92
  v_add_f32 v93, 1.0, v93
  v_add_f32 v94, 1.0, v94
  v_add_f32 v95, 1.0, v95
  v_rcp_f32 v88, v88
  v_rcp_f32 v89, v89
  v_rcp_f32 v90, v90
  v_rcp_f32 v91, v91
  v_rcp_f32 v92, v92
  v_rcp_f32 v93, v93
  v_rcp_f32 v94, v94
  v_rcp_f32 v95, v95
  v_mul_f32 v72, v72, v88
  v_mul_f32 v73, v73, v89
  v_mul_f32 v74, v74, v90
  v_mul_f32 v75, v75, v91
  v_mul_f32 v76, v76, v92
  v_mul_f32 v77, v77, v93
  v_mul_f32 v78, v78, v94
  v_mul_f32 v79, v79, v95
  v_cvt_pk_bf16_f32 v32, v64, v65
  v_cvt_pk_bf16_f32 v33, v66, v67
  v_cvt_pk_bf16_f32 v34, v68, v69
  v_cvt_pk_bf16_f32 v35, v70, v71
  v_cvt_pk_bf16_f32 v36, v72, v73
  v_cvt_pk_bf16_f32 v37, v74, v75
  v_cvt_pk_bf16_f32 v38, v76, v77
  v_cvt_pk_bf16_f32 v39, v78, v79
  s_add_u32 s26, s26, 4096
  buffer_store_dwordx4 v[32:35], v2, s[4:7], s26 offen offset:0 sc1
  buffer_store_dwordx4 v[36:39], v2, s[4:7], s26 offen offset:1024 sc1
  s_mul_i32 s24, s23, 18
  s_add_u32 s24, s24, s22
  s_lshl_b32 s24, s24, 7
  s_add_u32 s24, s24, 3694592
  s_waitcnt vmcnt(0)
  s_barrier
  s_cmp_eq_u32 s17, 0
  s_cbranch_scc0 Lsf_42
  v_mov_b32 v4, 1
  buffer_store_dword v4, off, s[4:7], s24 sc1
Lsf_42:
  s_branch mk_g20
mk_g2p0:
  s_mul_i32 s22, s35, 6554
  s_lshr_b32 s22, s22, 16
  s_mul_i32 s24, s22, 10
  s_sub_u32 s23, s35, s24
  v_lshlrev_b32 v5, 2, v1
  s_lshl_b32 s24, s22, 7
  s_add_u32 s24, s24, 3706880
  s_cmp_lg_u32 s17, 0
  s_cbranch_scc1 Lww_43_ok
Lww_43:
  buffer_load_dword v12, v5, s[4:7], s24 offen sc1
  s_waitcnt vmcnt(0)
  v_cmp_eq_u32 vcc, 0, v12
  s_add_u32 s0, s0, 1
  s_and_b32 s25, vcc_lo, 15
  s_cbranch_scc0 Lww_43_ok
  s_sleep 2
  s_cmp_lt_u32 s0, 1572864
  s_cbranch_scc1 Lww_43
Lww_43_ok:
  s_barrier
  s_mul_i32 s24, s22, 442368
  s_add_u32 s24, s24, s29
  s_add_u32 s72, s24, 8388608
  s_add_u32 s73, s24, 8499200
  s_add_u32 s74, s24, 8609792
  s_add_u32 s75, s24, 8720384
  s_mul_i32 s78, s22, 21846
  s_lshr_b32 s78, s78, 16
  s_mul_i32 s78, s78, 3
  s_sub_u32 s78, s22, s78
  s_mul_i32 s78, s78, 36864
  s_mov_b32 s79, s78
  s_lshl_b32 s25, s17, 15
  s_add_u32 s24, s72, s78
  buffer_load_dwordx4 v[96:99], v2, s[4:7], s24 offen sc1
  s_add_u32 s24, s73, s78
  buffer_load_dwordx4 v[100:103], v2, s[4:7], s24 offen sc1
  s_add_u32 s24, s74, s78
  buffer_load_dwordx4 v[104:107], v2, s[4:7], s24 offen sc1
  s_add_u32 s24, s75, s78
  buffer_load_dwordx4 v[108:111], v2, s[4:7], s24 offen sc1
  s_add_u32 s78, s78, 4096
  s_cmp_eq_u32 s78, 110592
  s_cselect_b32 s78, 0, s78
  s_add_u32 s24, s72, s78
  buffer_load_dwordx4 v[112:115], v2, s[4:7], s24 offen sc1
  s_add_u32 s24, s73, s78
  buffer_load_dwordx4 v[116:119], v2, s[4:7], s24 offen sc1
  s_add_u32 s24, s74, s78
  buffer_load_dwordx4 v[120:123], v2, s[4:7], s24 offen sc1
  s_add_u32 s24, s75, s78
  buffer_load_dwordx4 v[124:127], v2, s[4:7], s24 offen sc1
  s_add_u32 s78, s78, 4096
  s_cmp_eq_u32 s78, 110592
  s_cselect_b32 s78, 0, s78
  s_add_u32 s24, s72, s78
  buffer_load_dwordx4 v[128:131], v2, s[4:7], s24 offen sc1
  s_add_u32 s24, s73, s78
  buffer_load_dwordx4 v[132:135], v2, s[4:7], s24 offen sc1
  s_add_u32 s24, s74, s78
  buffer_load_dwordx4 v[136:139], v2, s[4:7], s24 offen sc1
  s_add_u32 s24, s75, s78
  buffer_load_dwordx4 v[140:143], v2, s[4:7], s24 offen sc1
  s_add_u32 s78, s78, 4096
  s_cmp_eq_u32 s78, 110592
  s_cselect_b32 s78, 0, s78
  s_add_u32 s24, s72, s78
  buffer_load_dwordx4 v[144:147], v2, s[4:7], s24 offen sc1
  s_add_u32 s24, s73, s78
  buffer_load_dwordx4 v[148:151], v2, s[4:7], s24 offen sc1
  s_add_u32 s24, s74, s78
  buffer_load_dwordx4 v[152:155], v2, s[4:7], s24 offen sc1
  s_add_u32 s24, s75, s78
  buffer_load_dwordx4 v[156:159], v2, s[4:7], s24 offen sc1
  s_add_u32 s78, s78, 4096
  s_cmp_eq_u32 s78, 110592
  s_cselect_b32 s78, 0, s78
  s_add_u32 s24, s72, s78
  buffer_load_dwordx4 v[160:163], v2, s[4:7], s24 offen sc1
  s_add_u32 s24, s73, s78
  buffer_load_dwordx4 v[164:167], v2, s[4:7], s24 offen sc1
  s_add_u32 s24, s74, s78
  buffer_load_dwordx4 v[168:171], v2, s[4:7], s24 offen sc1
  s_add_u32 s24, s75, s78
  buffer_load_dwordx4 v[172:175], v2, s[4:7], s24 offen sc1
  s_add_u32 s78, s78, 4096
  s_cmp_eq_u32 s78, 110592
  s_cselect_b32 s78, 0, s78
  s_add_u32 s24, s72, s78
  buffer_load_dwordx4 v[176:179], v2, s[4:7], s24 offen sc1
  s_add_u32 s24, s73, s78
  buffer_load_dwordx4 v[180:183], v2, s[4:7], s24 offen sc1
  s_add_u32 s24, s74, s78
  buffer_load_dwordx4 v[184:187], v2, s[4:7], s24 offen sc1
  s_add_u32 s24, s75, s78
  buffer_load_dwordx4 v[188:191], v2, s[4:7], s24 offen sc1
  s_add_u32 s78, s78, 4096
  s_cmp_eq_u32 s78, 110592
  s_cselect_b32 s78, 0, s78
  s_add_u32 s24, s72, s78
  buffer_load_dwordx4 v[192:195], v2, s[4:7], s24 offen sc1
  s_add_u32 s24, s73, s78
  buffer_load_dwordx4 v[196:199], v2, s[4:7], s24 offen sc1
  s_add_u32 s24, s74, s78
  buffer_load_dwordx4 v[200:203], v2, s[4:7], s24 offen sc1
  s_add_u32 s24, s75, s78
  buffer_load_dwordx4 v[204:207], v2, s[4:7], s24 offen sc1
  s_add_u32 s78, s78, 4096
  s_cmp_eq_u32 s78, 110592
  s_cselect_b32 s78, 0, s78
  s_add_u32 s24, s72, s78
  buffer_load_dwordx4 v[208:211], v2, s[4:7], s24 offen sc1
  s_add_u32 s24, s73, s78
  buffer_load_dwordx4 v[212:215], v2, s[4:7], s24 offen sc1
  s_add_u32 s24, s74, s78
  buffer_load_dwordx4 v[216:219], v2, s[4:7], s24 offen sc1
  s_add_u32 s24, s75, s78
  buffer_load_dwordx4 v[220:223], v2, s[4:7], s24 offen sc1
  s_add_u32 s78, s78, 4096
  s_cmp_eq_u32 s78, 110592
  s_cselect_b32 s78, 0, s78
  s_add_u32 s24, s72, s78
  buffer_load_dwordx4 v[224:227], v2, s[4:7], s24 offen sc1
  s_add_u32 s24, s73, s78
  buffer_load_dwordx4 v[228:231], v2, s[4:7], s24 offen sc1
  s_add_u32 s24, s74, s78
  buffer_load_dwordx4 v[232:235], v2, s[4:7], s24 offen sc1
  s_add_u32 s24, s75, s78
  buffer_load_dwordx4 v[236:239], v2, s[4:7], s24 offen sc1
  s_add_u32 s78, s78, 4096
  s_cmp_eq_u32 s78, 110592
  s_cselect_b32 s78, 0, s78
  s_add_u32 s24, s72, s78
  buffer_load_dwordx4 v[240:243], v2, s[4:7], s24 offen sc1
  s_add_u32 s24, s73, s78
  buffer_load_dwordx4 v[244:247], v2, s[4:7], s24 offen sc1
  s_add_u32 s24, s74, s78
  buffer_load_dwordx4 v[248:251], v2, s[4:7], s24 offen sc1
  s_add_u32 s24, s75, s78
  buffer_load_dwordx4 v[252:255], v2, s[4:7], s24 offen sc1
  s_add_u32 s78, s78, 4096
  s_cmp_eq_u32 s78, 110592
  s_cselect_b32 s78, 0, s78
  s_add_u32 s24, s72, s78
  buffer_load_dwordx4 a[128:131], v2, s[4:7], s24 offen sc1
  s_add_u32 s24, s73, s78
  buffer_load_dwordx4 a[132:135], v2, s[4:7], s24 offen sc1
  s_add_u32 s24, s74, s78
  buffer_load_dwordx4 a[136:139], v2, s[4:7], s24 offen sc1
  s_add_u32 s24, s75, s78
  buffer_load_dwordx4 a[140:143], v2, s[4:7], s24 offen sc1
  s_add_u32 s78, s78, 4096
  s_cmp_eq_u32 s78, 110592
  s_cselect_b32 s78, 0, s78
  s_add_u32 s24, s72, s78
  buffer_load_dwordx4 a[144:147], v2, s[4:7], s24 offen sc1
  s_add_u32 s24, s73, s78
  buffer_load_dwordx4 a[148:151], v2, s[4:7], s24 offen sc1
  s_add_u32 s24, s74, s78
  buffer_load_dwordx4 a[152:155], v2, s[4:7], s24 offen sc1
  s_add_u32 s24, s75, s78
  buffer_load_dwordx4 a[156:159], v2, s[4:7], s24 offen sc1
  s_add_u32 s78, s78, 4096
  s_cmp_eq_u32 s78, 110592
  s_cselect_b32 s78, 0, s78
  s_waitcnt vmcnt(24)
  s_add_u32 s24, s72, s78
  buffer_load_dwordx4 a[160:163], v2, s[4:7], s24 offen sc1
  s_add_u32 s24, s73, s78
  buffer_load_dwordx4 a[164:167], v2, s[4:7], s24 offen sc1
  s_add_u32 s24, s74, s78
  buffer_load_dwordx4 a[168:171], v2, s[4:7], s24 offen sc1
  s_add_u32 s24, s75, s78
  buffer_load_dwordx4 a[172:175], v2, s[4:7], s24 offen sc1
  s_add_u32 s78, s78, 4096
  s_cmp_eq_u32 s78, 110592
  s_cselect_b32 s78, 0, s78
  s_add_u32 s24, s72, s78
  buffer_load_dwordx4 a[176:179], v2, s[4:7], s24 offen sc1
  s_add_u32 s24, s73, s78
  buffer_load_dwordx4 a[180:183], v2, s[4:7], s24 offen sc1
  s_add_u32 s24, s74, s78
  buffer_load_dwordx4 a[184:187], v2, s[4:7], s24 offen sc1
  s_add_u32 s24, s75, s78
  buffer_load_dwordx4 a[188:191], v2, s[4:7], s24 offen sc1
  s_add_u32 s78, s78, 4096
  s_cmp_eq_u32 s78, 110592
  s_cselect_b32 s78, 0, s78
  s_add_u32 s24, s72, s78
  buffer_load_dwordx4 a[192:195], v2, s[4:7], s24 offen sc1
  s_add_u32 s24, s73, s78
  buffer_load_dwordx4 a[196:199], v2, s[4:7], s24 offen sc1
  s_add_u32 s24, s74, s78
  buffer_load_dwordx4 a[200:203], v2, s[4:7], s24 offen sc1
  s_add_u32 s24, s75, s78
  buffer_load_dwordx4 a[204:207], v2, s[4:7], s24 offen sc1
  s_add_u32 s78, s78, 4096
  s_cmp_eq_u32 s78, 110592
  s_cselect_b32 s78, 0, s78
  s_add_u32 s24, s72, s78
  buffer_load_dwordx4 a[208:211], v2, s[4:7], s24 offen sc1
  s_add_u32 s24, s73, s78
  buffer_load_dwordx4 a[212:215], v2, s[4:7], s24 offen sc1
  s_add_u32 s24, s74, s78
  buffer_load_dwordx4 a[216:219], v2, s[4:7], s24 offen sc1
  s_add_u32 s24, s75, s78
  buffer_load_dwordx4 a[220:223], v2, s[4:7], s24 offen sc1
  s_add_u32 s78, s78, 4096
  s_cmp_eq_u32 s78, 110592
  s_cselect_b32 s78, 0, s78
  s_add_u32 s24, s72, s78
  buffer_load_dwordx4 a[224:227], v2, s[4:7], s24 offen sc1
  s_add_u32 s24, s73, s78
  buffer_load_dwordx4 a[228:231], v2, s[4:7], s24 offen sc1
  s_add_u32 s24, s74, s78
  buffer_load_dwordx4 a[232:235], v2, s[4:7], s24 offen sc1
  s_add_u32 s24, s75, s78
  buffer_load_dwordx4 a[236:239], v2, s[4:7], s24 offen sc1
  s_add_u32 s78, s78, 4096
  s_cmp_eq_u32 s78, 110592
  s_cselect_b32 s78, 0, s78
  s_add_u32 s24, s72, s78
  buffer_load_dwordx4 a[240:243], v2, s[4:7], s24 offen sc1
  s_add_u32 s24, s73, s78
  buffer_load_dwordx4 a[244:247], v2, s[4:7], s24 offen sc1
  s_add_u32 s24, s74, s78
  buffer_load_dwordx4 a[248:251], v2, s[4:7], s24 offen sc1
  s_add_u32 s24, s75, s78
  buffer_load_dwordx4 a[252:255], v2, s[4:7], s24 offen sc1
  s_add_u32 s78, s78, 4096
  s_cmp_eq_u32 s78, 110592
  s_cselect_b32 s78, 0, s78
  s_add_u32 s24, s72, s78
  s_add_u32 m0, s25, 24576
  s_nop 0
  buffer_load_dwordx4 v2, s[4:7], s24 offen sc1 lds
  s_add_u32 s24, s73, s78
  s_add_u32 m0, s25, 25600
  s_nop 0
  buffer_load_dwordx4 v2, s[4:7], s24 offen sc1 lds
  s_add_u32 s24, s74, s78
  s_add_u32 m0, s25, 26624
  s_nop 0
  buffer_load_dwordx4 v2, s[4:7], s24 offen sc1 lds
  s_add_u32 s24, s75, s78
  s_add_u32 m0, s25, 27648
  s_nop 0
  buffer_load_dwordx4 v2, s[4:7], s24 offen sc1 lds
  s_add_u32 s78, s78, 4096
  s_cmp_eq_u32 s78, 110592
  s_cselect_b32 s78, 0, s78
  s_add_u32 s24, s72, s78
  s_add_u32 m0, s25, 28672
  s_nop 0
  buffer_load_dwordx4 v2, s[4:7], s24 offen sc1 lds
  s_add_u32 s24, s73, s78
  s_add_u32 m0, s25, 29696
  s_nop 0
  buffer_load_dwordx4 v2, s[4:7], s24 offen sc1 lds
  s_add_u32 s24, s74, s78
  s_add_u32 m0, s25, 30720
  s_nop 0
  buffer_load_dwordx4 v2, s[4:7], s24 offen sc1 lds
  s_add_u32 s24, s75, s78
  s_add_u32 m0, s25, 31744
  s_nop 0
  buffer_load_dwordx4 v2, s[4:7], s24 offen sc1 lds
  s_add_u32 s78, s78, 4096
  s_cmp_eq_u32 s78, 110592
  s_cselect_b32 s78, 0, s78
  s_waitcnt vmcnt(24)
  s_add_u32 s24, s72, s78
  s_add_u32 m0, s25, 32768
  s_nop 0
  buffer_load_dwordx4 v2, s[4:7], s24 offen sc1 lds
  s_add_u32 s24, s73, s78
  s_add_u32 m0, s25, 33792
  s_nop 0
  buffer_load_dwordx4 v2, s[4:7], s24 offen sc1 lds
  s_add_u32 s24, s74, s78
  s_add_u32 m0, s25, 34816
  s_nop 0
  buffer_load_dwordx4 v2, s[4:7], s24 offen sc1 lds
  s_add_u32 s24, s75, s78
  s_add_u32 m0, s25, 35840
  s_nop 0
  buffer_load_dwordx4 v2, s[4:7], s24 offen sc1 lds
  s_add_u32 s78, s78, 4096
  s_cmp_eq_u32 s78, 110592
  s_cselect_b32 s78, 0, s78
  s_add_u32 s24, s72, s78
  s_add_u32 m0, s25, 36864
  s_nop 0
  buffer_load_dwordx4 v2, s[4:7], s24 offen sc1 lds
  s_add_u32 s24, s73, s78
  s_add_u32 m0, s25, 37888
  s_nop 0
  buffer_load_dwordx4 v2, s[4:7], s24 offen sc1 lds
  s_add_u32 s24, s74, s78
  s_add_u32 m0, s25, 38912
  s_nop 0
  buffer_load_dwordx4 v2, s[4:7], s24 offen sc1 lds
  s_add_u32 s24, s75, s78
  s_add_u32 m0, s25, 39936
  s_nop 0
  buffer_load_dwordx4 v2, s[4:7], s24 offen sc1 lds
  s_add_u32 s78, s78, 4096
  s_cmp_eq_u32 s78, 110592
  s_cselect_b32 s78, 0, s78
  s_add_u32 s24, s72, s78
  s_add_u32 m0, s25, 40960
  s_nop 0
  buffer_load_dwordx4 v2, s[4:7], s24 offen sc1 lds
  s_add_u32 s24, s73, s78
  s_add_u32 m0, s25, 41984
  s_nop 0
  buffer_load_dwordx4 v2, s[4:7], s24 offen sc1 lds
  s_add_u32 s24, s74, s78
  s_add_u32 m0, s25, 43008
  s_nop 0
  buffer_load_dwordx4 v2, s[4:7], s24 offen sc1 lds
  s_add_u32 s24, s75, s78
  s_add_u32 m0, s25, 44032
  s_nop 0
  buffer_load_dwordx4 v2, s[4:7], s24 offen sc1 lds
  s_add_u32 s78, s78, 4096
  s_cmp_eq_u32 s78, 110592
  s_cselect_b32 s78, 0, s78
  s_add_u32 s24, s72, s78
  s_add_u32 m0, s25, 45056
  s_nop 0
  buffer_load_dwordx4 v2, s[4:7], s24 offen sc1 lds
  s_add_u32 s24, s73, s78
  s_add_u32 m0, s25, 46080
  s_nop 0
  buffer_load_dwordx4 v2, s[4:7], s24 offen sc1 lds
  s_add_u32 s24, s74, s78
  s_add_u32 m0, s25, 47104
  s_nop 0
  buffer_load_dwordx4 v2, s[4:7], s24 offen sc1 lds
  s_add_u32 s24, s75, s78
  s_add_u32 m0, s25, 48128
  s_nop 0
  buffer_load_dwordx4 v2, s[4:7], s24 offen sc1 lds
  s_add_u32 s78, s78, 4096
  s_cmp_eq_u32 s78, 110592
  s_cselect_b32 s78, 0, s78
  s_add_u32 s24, s72, s78
  s_add_u32 m0, s25, 49152
  s_nop 0
  buffer_load_dwordx4 v2, s[4:7], s24 offen sc1 lds
  s_add_u32 s24, s73, s78
  s_add_u32 m0, s25, 50176
  s_nop 0
  buffer_load_dwordx4 v2, s[4:7], s24 offen sc1 lds
  s_add_u32 s24, s74, s78
  s_add_u32 m0, s25, 51200
  s_nop 0
  buffer_load_dwordx4 v2, s[4:7], s24 offen sc1 lds
  s_add_u32 s24, s75, s78
  s_add_u32 m0, s25, 52224
  s_nop 0
  buffer_load_dwordx4 v2, s[4:7], s24 offen sc1 lds
  s_add_u32 s78, s78, 4096
  s_cmp_eq_u32 s78, 110592
  s_cselect_b32 s78, 0, s78
  s_add_u32 s24, s72, s78
  s_add_u32 m0, s25, 53248
  s_nop 0
  buffer_load_dwordx4 v2, s[4:7], s24 offen sc1 lds
  s_add_u32 s24, s73, s78
  s_add_u32 m0, s25, 54272
  s_nop 0
  buffer_load_dwordx4 v2, s[4:7], s24 offen sc1 lds
  s_add_u32 s24, s74, s78
  s_add_u32 m0, s25, 55296
  s_nop 0
  buffer_load_dwordx4 v2, s[4:7], s24 offen sc1 lds
  s_add_u32 s24, s75, s78
  s_add_u32 m0, s25, 56320
  s_nop 0
  buffer_load_dwordx4 v2, s[4:7], s24 offen sc1 lds
  s_add_u32 s78, s78, 4096
  s_cmp_eq_u32 s78, 110592
  s_cselect_b32 s78, 0, s78
mk_g20:
  s_mul_i32 s22, s35, 6554
  s_lshr_b32 s22, s22, 16
  s_mul_i32 s24, s22, 10
  s_sub_u32 s23, s35, s24
  s_mov_b32 s52, s46
  s_and_b32 s53, s47, 0xffff
  s_mov_b32 s54, 4096
  s_mov_b32 s55, 0x00020000
  s_mul_i32 s24, s23, 221184
  s_add_u32 s24, s24, s29
  s_add_u32 s76, s24, 101711872
  s_add_u32 s77, s24, 101822464
  v_and_b32 v3, 31, v1
  v_lshrrev_b32 v4, 5, v1
  v_and_b32 v6, 3, v1
  v_bfe_u32 v10, v1, 3, 2
  v_lshl_add_u32 v6, v10, 2, v6
  v_bfe_u32 v10, v1, 2, 1
  v_lshl_add_u32 v6, v10, 4, v6
  s_lshl_b32 s24, s22, 2
  s_add_u32 s24, s24, s17
  s_lshl_b32 s25, s24, 5
  v_add_u32 v6, s25, v6
  s_movk_i32 s25, 1280
  v_mul_lo_u32 v7, v6, s25
  v_lshl_add_u32 v7, v4, 5, v7
  s_lshl_b32 s25, s23, 7
  v_add_u32 v7, s25, v7
  v_lshlrev_b32 v9, 10, v4
  v_lshl_add_u32 v9, v3, 4, v9
  s_mul_i32 s26, s24, 40960
  s_lshl_b32 s25, s23, 12
  s_add_u32 s26, s26, s25
  s_add_u32 s26, s26, 104857600
  v_lshlrev_b32 v3, 1, v6
  v_accvgpr_write_b32 a0, 0
  v_accvgpr_write_b32 a1, 0
  v_accvgpr_write_b32 a2, 0
  v_accvgpr_write_b32 a3, 0
  v_accvgpr_write_b32 a4, 0
  v_accvgpr_write_b32 a5, 0
  v_accvgpr_write_b32 a6, 0
  v_accvgpr_write_b32 a7, 0
  v_accvgpr_write_b32 a8, 0
  v_accvgpr_write_b32 a9, 0
  v_accvgpr_write_b32 a10, 0
  v_accvgpr_write_b32 a11, 0
  v_accvgpr_write_b32 a12, 0
  v_accvgpr_write_b32 a13, 0
  v_accvgpr_write_b32 a14, 0
  v_accvgpr_write_b32 a15, 0
  v_accvgpr_write_b32 a16, 0
  v_accvgpr_write_b32 a17, 0
  v_accvgpr_write_b32 a18, 0
  v_accvgpr_write_b32 a19, 0
  v_accvgpr_write_b32 a20, 0
  v_accvgpr_write_b32 a21, 0
  v_accvgpr_write_b32 a22, 0
  v_accvgpr_write_b32 a23, 0
  v_accvgpr_write_b32 a24, 0
  v_accvgpr_write_b32 a25, 0
  v_accvgpr_write_b32 a26, 0
  v_accvgpr_write_b32 a27, 0
  v_accvgpr_write_b32 a28, 0
  v_accvgpr_write_b32 a29, 0
  v_accvgpr_write_b32 a30, 0
  v_accvgpr_write_b32 a31, 0
  v_accvgpr_write_b32 a32, 0
  v_accvgpr_write_b32 a33, 0
  v_accvgpr_write_b32 a34, 0
  v_accvgpr_write_b32 a35, 0
  v_accvgpr_write_b32 a36, 0
  v_accvgpr_write_b32 a37, 0
  v_accvgpr_write_b32 a38, 0
  v_accvgpr_write_b32 a39, 0
  v_accvgpr_write_b32 a40, 0
  v_accvgpr_write_b32 a41, 0
  v_accvgpr_write_b32 a42, 0
  v_accvgpr_write_b32 a43, 0
  v_accvgpr_write_b32 a44, 0
  v_accvgpr_write_b32 a45, 0
  v_accvgpr_write_b32 a46, 0
  v_accvgpr_write_b32 a47, 0
  v_accvgpr_write_b32 a48, 0
  v_accvgpr_write_b32 a49, 0
  v_accvgpr_write_b32 a50, 0
  v_accvgpr_write_b32 a51, 0
  v_accvgpr_write_b32 a52, 0
  v_accvgpr_write_b32 a53, 0
  v_accvgpr_write_b32 a54, 0
  v_accvgpr_write_b32 a55, 0
  v_accvgpr_write_b32 a56, 0
  v_accvgpr_write_b32 a57, 0
  v_accvgpr_write_b32 a58, 0
  v_accvgpr_write_b32 a59, 0
  v_accvgpr_write_b32 a60, 0
  v_accvgpr_write_b32 a61, 0
  v_accvgpr_write_b32 a62, 0
  v_accvgpr_write_b32 a63, 0
  v_accvgpr_write_b32 a64, 0
  v_accvgpr_write_b32 a65, 0
  v_accvgpr_write_b32 a66, 0
  v_accvgpr_write_b32 a67, 0
  v_accvgpr_write_b32 a68, 0
  v_accvgpr_write_b32 a69, 0
  v_accvgpr_write_b32 a70, 0
  v_accvgpr_write_b32 a71, 0
  v_accvgpr_write_b32 a72, 0
  v_accvgpr_write_b32 a73, 0
  v_accvgpr_write_b32 a74, 0
  v_accvgpr_write_b32 a75, 0
  v_accvgpr_write_b32 a76, 0
  v_accvgpr_write_b32 a77, 0
  v_accvgpr_write_b32 a78, 0
  v_accvgpr_write_b32 a79, 0
  v_accvgpr_write_b32 a80, 0
  v_accvgpr_write_b32 a81, 0
  v_accvgpr_write_b32 a82, 0
  v_accvgpr_write_b32 a83, 0
  v_accvgpr_write_b32 a84, 0
  v_accvgpr_write_b32 a85, 0
  v_accvgpr_write_b32 a86, 0
  v_accvgpr_write_b32 a87, 0
  v_accvgpr_write_b32 a88, 0
  v_accvgpr_write_b32 a89, 0
  v_accvgpr_write_b32 a90, 0
  v_accvgpr_write_b32 a91, 0
  v_accvgpr_write_b32 a92, 0
  v_accvgpr_write_b32 a93, 0
  v_accvgpr_write_b32 a94, 0
  v_accvgpr_write_b32 a95, 0
  v_accvgpr_write_b32 a96, 0
  v_accvgpr_write_b32 a97, 0
  v_accvgpr_write_b32 a98, 0
  v_accvgpr_write_b32 a99, 0
  v_accvgpr_write_b32 a100, 0
  v_accvgpr_write_b32 a101, 0
  v_accvgpr_write_b32 a102, 0
  v_accvgpr_write_b32 a103, 0
  v_accvgpr_write_b32 a104, 0
  v_accvgpr_write_b32 a105, 0
  v_accvgpr_write_b32 a106, 0
  v_accvgpr_write_b32 a107, 0
  v_accvgpr_write_b32 a108, 0
  v_accvgpr_write_b32 a109, 0
  v_accvgpr_write_b32 a110, 0
  v_accvgpr_write_b32 a111, 0
  v_accvgpr_write_b32 a112, 0
  v_accvgpr_write_b32 a113, 0
  v_accvgpr_write_b32 a114, 0
  v_accvgpr_write_b32 a115, 0
  v_accvgpr_write_b32 a116, 0
  v_accvgpr_write_b32 a117, 0
  v_accvgpr_write_b32 a118, 0
  v_accvgpr_write_b32 a119, 0
  v_accvgpr_write_b32 a120, 0
  v_accvgpr_write_b32 a121, 0
  v_accvgpr_write_b32 a122, 0
  v_accvgpr_write_b32 a123, 0
  v_accvgpr_write_b32 a124, 0
  v_accvgpr_write_b32 a125, 0
  v_accvgpr_write_b32 a126, 0
  v_accvgpr_write_b32 a127, 0
  buffer_load_ushort v8, v3, s[52:55], 0 offen
  s_lshr_b32 s31, s23, 1
  s_mul_i32 s31, s31, 2304
  s_add_u32 s31, s31, 3694592
  v_lshlrev_b32 v5, 7, v1
  s_cmp_lg_u32 s17, 0
  s_cbranch_scc1 Lww_44_ok
Lww_44:
  buffer_load_dword v12, v5, s[4:7], s31 offen sc1
  s_waitcnt vmcnt(0)
  v_cmp_eq_u32 vcc, 0, v12
  s_add_u32 s0, s0, 1
  s_and_b32 s25, vcc_lo, 262143
  s_cbranch_scc0 Lww_44_ok
  s_sleep 2
  s_cmp_lt_u32 s0, 1572864
  s_cbranch_scc1 Lww_44
Lww_44_ok:
  s_barrier
  s_waitcnt vmcnt(0)
  s_add_u32 s24, s76, s79
  buffer_load_dwordx4 v[24:27], v2, s[4:7], s24 offen sc1
  s_add_u32 s24, s77, s79
  buffer_load_dwordx4 v[28:31], v2, s[4:7], s24 offen sc1
  s_add_u32 s79, s79, 4096
  s_cmp_eq_u32 s79, 110592
  s_cselect_b32 s79, 0, s79
  s_add_u32 s24, s76, s79
  buffer_load_dwordx4 v[32:35], v2, s[4:7], s24 offen sc1
  s_add_u32 s24, s77, s79
  buffer_load_dwordx4 v[36:39], v2, s[4:7], s24 offen sc1
  s_add_u32 s79, s79, 4096
  s_cmp_eq_u32 s79, 110592
  s_cselect_b32 s79, 0, s79
  s_add_u32 s24, s76, s79
  buffer_load_dwordx4 v[40:43], v2, s[4:7], s24 offen sc1
  s_add_u32 s24, s77, s79
  buffer_load_dwordx4 v[44:47], v2, s[4:7], s24 offen sc1
  s_add_u32 s79, s79, 4096
  s_cmp_eq_u32 s79, 110592
  s_cselect_b32 s79, 0, s79
  s_add_u32 s24, s76, s79
  buffer_load_dwordx4 v[48:51], v2, s[4:7], s24 offen sc1
  s_add_u32 s24, s77, s79
  buffer_load_dwordx4 v[52:55], v2, s[4:7], s24 offen sc1
  s_add_u32 s79, s79, 4096
  s_cmp_eq_u32 s79, 110592
  s_cselect_b32 s79, 0, s79
  s_add_u32 s24, s76, s79
  buffer_load_dwordx4 v[56:59], v2, s[4:7], s24 offen sc1
  s_add_u32 s24, s77, s79
  buffer_load_dwordx4 v[60:63], v2, s[4:7], s24 offen sc1
  s_add_u32 s79, s79, 4096
  s_cmp_eq_u32 s79, 110592
  s_cselect_b32 s79, 0, s79
  s_add_u32 s24, s76, s79
  buffer_load_dwordx4 v[64:67], v2, s[4:7], s24 offen sc1
  s_add_u32 s24, s77, s79
  buffer_load_dwordx4 v[68:71], v2, s[4:7], s24 offen sc1
  s_add_u32 s79, s79, 4096
  s_cmp_eq_u32 s79, 110592
  s_cselect_b32 s79, 0, s79
  s_add_u32 s24, s76, s79
  buffer_load_dwordx4 v[72:75], v2, s[4:7], s24 offen sc1
  s_add_u32 s24, s77, s79
  buffer_load_dwordx4 v[76:79], v2, s[4:7], s24 offen sc1
  s_add_u32 s79, s79, 4096
  s_cmp_eq_u32 s79, 110592
  s_cselect_b32 s79, 0, s79
  s_add_u32 s24, s76, s79
  buffer_load_dwordx4 v[80:83], v2, s[4:7], s24 offen sc1
  s_add_u32 s24, s77, s79
  buffer_load_dwordx4 v[84:87], v2, s[4:7], s24 offen sc1
  s_add_u32 s79, s79, 4096
  s_cmp_eq_u32 s79, 110592
  s_cselect_b32 s79, 0, s79
  s_add_u32 s24, s76, s79
  buffer_load_dwordx4 v[88:91], v2, s[4:7], s24 offen sc1
  s_add_u32 s24, s77, s79
  buffer_load_dwordx4 v[92:95], v2, s[4:7], s24 offen sc1
  s_add_u32 s79, s79, 4096
  s_cmp_eq_u32 s79, 110592
  s_cselect_b32 s79, 0, s79
  s_lshl_b32 s25, s17, 15
  s_add_u32 s25, s25, 24576
  v_add_u32 v10, s25, v2
  s_waitcnt vmcnt(16)
  v_mfma_f32_32x32x16_bf16 a[0:15], v[24:27], v[96:99], a[0:15]
  v_mfma_f32_32x32x16_bf16 a[16:31], v[28:31], v[96:99], a[16:31]
  v_mfma_f32_32x32x16_bf16 a[32:47], v[24:27], v[100:103], a[32:47]
  v_mfma_f32_32x32x16_bf16 a[48:63], v[28:31], v[100:103], a[48:63]
  v_mfma_f32_32x32x16_bf16 a[64:79], v[24:27], v[104:107], a[64:79]
  v_mfma_f32_32x32x16_bf16 a[80:95], v[28:31], v[104:107], a[80:95]
  v_mfma_f32_32x32x16_bf16 a[96:111], v[24:27], v[108:111], a[96:111]
  v_mfma_f32_32x32x16_bf16 a[112:127], v[28:31], v[108:111], a[112:127]
  s_add_u32 s24, s76, s79
  buffer_load_dwordx4 v[96:99], v2, s[4:7], s24 offen sc1
  s_add_u32 s24, s77, s79
  buffer_load_dwordx4 v[100:103], v2, s[4:7], s24 offen sc1
  s_add_u32 s79, s79, 4096
  s_cmp_eq_u32 s79, 110592
  s_cselect_b32 s79, 0, s79
  s_add_u32 s24, s76, s79
  buffer_load_dwordx4 v[104:107], v2, s[4:7], s24 offen sc1
  s_add_u32 s24, s77, s79
  buffer_load_dwordx4 v[108:111], v2, s[4:7], s24 offen sc1
  s_add_u32 s79, s79, 4096
  s_cmp_eq_u32 s79, 110592
  s_cselect_b32 s79, 0, s79
  s_add_u32 s24, s76, s79
  buffer_load_dwordx4 v[24:27], v2, s[4:7], s24 offen sc1
  s_add_u32 s24, s77, s79
  buffer_load_dwordx4 v[28:31], v2, s[4:7], s24 offen sc1
  s_add_u32 s79, s79, 4096
  s_cmp_eq_u32 s79, 110592
  s_cselect_b32 s79, 0, s79
  s_waitcnt vmcnt(20)
  v_mfma_f32_32x32x16_bf16 a[0:15], v[32:35], v[112:115], a[0:15]
  v_mfma_f32_32x32x16_bf16 a[16:31], v[36:39], v[112:115], a[16:31]
  v_mfma_f32_32x32x16_bf16 a[32:47], v[32:35], v[116:119], a[32:47]
  v_mfma_f32_32x32x16_bf16 a[48:63], v[36:39], v[116:119], a[48:63]
  v_mfma_f32_32x32x16_bf16 a[64:79], v[32:35], v[120:123], a[64:79]
  v_mfma_f32_32x32x16_bf16 a[80:95], v[36:39], v[120:123], a[80:95]
  v_mfma_f32_32x32x16_bf16 a[96:111], v[32:35], v[124:127], a[96:111]
  v_mfma_f32_32x32x16_bf16 a[112:127], v[36:39], v[124:127], a[112:127]
  s_add_u32 s24, s76, s79
  buffer_load_dwordx4 v[112:115], v2, s[4:7], s24 offen sc1
  s_add_u32 s24, s77, s79
  buffer_load_dwordx4 v[116:119], v2, s[4:7], s24 offen sc1
  s_add_u32 s79, s79, 4096
  s_cmp_eq_u32 s79, 110592
  s_cselect_b32 s79, 0, s79
  s_add_u32 s24, s76, s79
  buffer_load_dwordx4 v[120:123], v2, s[4:7], s24 offen sc1
  s_add_u32 s24, s77, s79
  buffer_load_dwordx4 v[124:127], v2, s[4:7], s24 offen sc1
  s_add_u32 s79, s79, 4096
  s_cmp_eq_u32 s79, 110592
  s_cselect_b32 s79, 0, s79
  s_add_u32 s24, s76, s79
  buffer_load_dwordx4 v[32:35], v2, s[4:7], s24 offen sc1
  s_add_u32 s24, s77, s79
  buffer_load_dwordx4 v[36:39], v2, s[4:7], s24 offen sc1
  s_add_u32 s79, s79, 4096
  s_cmp_eq_u32 s79, 110592
  s_cselect_b32 s79, 0, s79
  s_waitcnt vmcnt(24)
  v_mfma_f32_32x32x16_bf16 a[0:15], v[40:43], v[128:131], a[0:15]
  v_mfma_f32_32x32x16_bf16 a[16:31], v[44:47], v[128:131], a[16:31]
  v_mfma_f32_32x32x16_bf16 a[32:47], v[40:43], v[132:135], a[32:47]
  v_mfma_f32_32x32x16_bf16 a[48:63], v[44:47], v[132:135], a[48:63]
  v_mfma_f32_32x32x16_bf16 a[64:79], v[40:43], v[136:139], a[64:79]
  v_mfma_f32_32x32x16_bf16 a[80:95], v[44:47], v[136:139], a[80:95]
  v_mfma_f32_32x32x16_bf16 a[96:111], v[40:43], v[140:143], a[96:111]
  v_mfma_f32_32x32x16_bf16 a[112:127], v[44:47], v[140:143], a[112:127]
  s_add_u32 s24, s76, s79
  buffer_load_dwordx4 v[128:131], v2, s[4:7], s24 offen sc1
  s_add_u32 s24, s77, s79
  buffer_load_dwordx4 v[132:135], v2, s[4:7], s24 offen sc1
  s_add_u32 s79, s79, 4096
  s_cmp_eq_u32 s79, 110592
  s_cselect_b32 s79, 0, s79
  s_add_u32 s24, s76, s79
  buffer_load_dwordx4 v[136:139], v2, s[4:7], s24 offen sc1
  s_add_u32 s24, s77, s79
  buffer_load_dwordx4 v[140:143], v2, s[4:7], s24 offen sc1
  s_add_u32 s79, s79, 4096
  s_cmp_eq_u32 s79, 110592
  s_cselect_b32 s79, 0, s79
  s_add_u32 s24, s76, s79
  buffer_load_dwordx4 v[40:43], v2, s[4:7], s24 offen sc1
  s_add_u32 s24, s77, s79
  buffer_load_dwordx4 v[44:47], v2, s[4:7], s24 offen sc1
  s_add_u32 s79, s79, 4096
  s_cmp_eq_u32 s79, 110592
  s_cselect_b32 s79, 0, s79
  s_waitcnt vmcnt(28)
  v_mfma_f32_32x32x16_bf16 a[0:15], v[48:51], v[144:147], a[0:15]
  v_mfma_f32_32x32x16_bf16 a[16:31], v[52:55], v[144:147], a[16:31]
  v_mfma_f32_32x32x16_bf16 a[32:47], v[48:51], v[148:151], a[32:47]
  v_mfma_f32_32x32x16_bf16 a[48:63], v[52:55], v[148:151], a[48:63]
  v_mfma_f32_32x32x16_bf16 a[64:79], v[48:51], v[152:155], a[64:79]
  v_mfma_f32_32x32x16_bf16 a[80:95], v[52:55], v[152:155], a[80:95]
  v_mfma_f32_32x32x16_bf16 a[96:111], v[48:51], v[156:159], a[96:111]
  v_mfma_f32_32x32x16_bf16 a[112:127], v[52:55], v[156:159], a[112:127]
  s_add_u32 s24, s76, s79
  buffer_load_dwordx4 v[144:147], v2, s[4:7], s24 offen sc1
  s_add_u32 s24, s77, s79
  buffer_load_dwordx4 v[148:151], v2, s[4:7], s24 offen sc1
  s_add_u32 s79, s79, 4096
  s_cmp_eq_u32 s79, 110592
  s_cselect_b32 s79, 0, s79
  s_add_u32 s24, s76, s79
  buffer_load_dwordx4 v[152:155], v2, s[4:7], s24 offen sc1
  s_add_u32 s24, s77, s79
  buffer_load_dwordx4 v[156:159], v2, s[4:7], s24 offen sc1
  s_add_u32 s79, s79, 4096
  s_cmp_eq_u32 s79, 110592
  s_cselect_b32 s79, 0, s79
  s_add_u32 s24, s76, s79
  buffer_load_dwordx4 v[48:51], v2, s[4:7], s24 offen sc1
  s_add_u32 s24, s77, s79
  buffer_load_dwordx4 v[52:55], v2, s[4:7], s24 offen sc1
  s_add_u32 s79, s79, 4096
  s_cmp_eq_u32 s79, 110592
  s_cselect_b32 s79, 0, s79
  s_waitcnt vmcnt(32)
  v_mfma_f32_32x32x16_bf16 a[0:15], v[56:59], v[160:163], a[0:15]
  v_mfma_f32_32x32x16_bf16 a[16:31], v[60:63], v[160:163], a[16:31]
  v_mfma_f32_32x32x16_bf16 a[32:47], v[56:59], v[164:167], a[32:47]
  v_mfma_f32_32x32x16_bf16 a[48:63], v[60:63], v[164:167], a[48:63]
  v_mfma_f32_32x32x16_bf16 a[64:79], v[56:59], v[168:171], a[64:79]
  v_mfma_f32_32x32x16_bf16 a[80:95], v[60:63], v[168:171], a[80:95]
  v_mfma_f32_32x32x16_bf16 a[96:111], v[56:59], v[172:175], a[96:111]
  v_mfma_f32_32x32x16_bf16 a[112:127], v[60:63], v[172:175], a[112:127]
  s_add_u32 s24, s76, s79
  buffer_load_dwordx4 v[160:163], v2, s[4:7], s24 offen sc1
  s_add_u32 s24, s77, s79
  buffer_load_dwordx4 v[164:167], v2, s[4:7], s24 offen sc1
  s_add_u32 s79, s79, 4096
  s_cmp_eq_u32 s79, 110592
  s_cselect_b32 s79, 0, s79
  s_add_u32 s24, s76, s79
  buffer_load_dwordx4 v[168:171], v2, s[4:7], s24 offen sc1
  s_add_u32 s24, s77, s79
  buffer_load_dwordx4 v[172:175], v2, s[4:7], s24 offen sc1
  s_add_u32 s79, s79, 4096
  s_cmp_eq_u32 s79, 110592
  s_cselect_b32 s79, 0, s79
  s_add_u32 s24, s76, s79
  buffer_load_dwordx4 v[56:59], v2, s[4:7], s24 offen sc1
  s_add_u32 s24, s77, s79
  buffer_load_dwordx4 v[60:63], v2, s[4:7], s24 offen sc1
  s_add_u32 s79, s79, 4096
  s_cmp_eq_u32 s79, 110592
  s_cselect_b32 s79, 0, s79
  s_waitcnt vmcnt(36)
  v_mfma_f32_32x32x16_bf16 a[0:15], v[64:67], v[176:179], a[0:15]
  v_mfma_f32_32x32x16_bf16 a[16:31], v[68:71], v[176:179], a[16:31]
  v_mfma_f32_32x32x16_bf16 a[32:47], v[64:67], v[180:183], a[32:47]
  v_mfma_f32_32x32x16_bf16 a[48:63], v[68:71], v[180:183], a[48:63]
  v_mfma_f32_32x32x16_bf16 a[64:79], v[64:67], v[184:187], a[64:79]
  v_mfma_f32_32x32x16_bf16 a[80:95], v[68:71], v[184:187], a[80:95]
  v_mfma_f32_32x32x16_bf16 a[96:111], v[64:67], v[188:191], a[96:111]
  v_mfma_f32_32x32x16_bf16 a[112:127], v[68:71], v[188:191], a[112:127]
  s_add_u32 s24, s76, s79
  buffer_load_dwordx4 v[176:179], v2, s[4:7], s24 offen sc1
  s_add_u32 s24, s77, s79
  buffer_load_dwordx4 v[180:183], v2, s[4:7], s24 offen sc1
  s_add_u32 s79, s79, 4096
  s_cmp_eq_u32 s79, 110592
  s_cselect_b32 s79, 0, s79
  s_add_u32 s24, s76, s79
  buffer_load_dwordx4 v[184:187], v2, s[4:7], s24 offen sc1
  s_add_u32 s24, s77, s79
  buffer_load_dwordx4 v[188:191], v2, s[4:7], s24 offen sc1
  s_add_u32 s79, s79, 4096
  s_cmp_eq_u32 s79, 110592
  s_cselect_b32 s79, 0, s79
  s_add_u32 s24, s76, s79
  buffer_load_dwordx4 v[64:67], v2, s[4:7], s24 offen sc1
  s_add_u32 s24, s77, s79
  buffer_load_dwordx4 v[68:71], v2, s[4:7], s24 offen sc1
  s_add_u32 s79, s79, 4096
  s_cmp_eq_u32 s79, 110592
  s_cselect_b32 s79, 0, s79
  s_waitcnt vmcnt(40)
  v_mfma_f32_32x32x16_bf16 a[0:15], v[72:75], v[192:195], a[0:15]
  v_mfma_f32_32x32x16_bf16 a[16:31], v[76:79], v[192:195], a[16:31]
  v_mfma_f32_32x32x16_bf16 a[32:47], v[72:75], v[196:199], a[32:47]
  v_mfma_f32_32x32x16_bf16 a[48:63], v[76:79], v[196:199], a[48:63]
  v_mfma_f32_32x32x16_bf16 a[64:79], v[72:75], v[200:203], a[64:79]
  v_mfma_f32_32x32x16_bf16 a[80:95], v[76:79], v[200:203], a[80:95]
  v_mfma_f32_32x32x16_bf16 a[96:111], v[72:75], v[204:207], a[96:111]
  v_mfma_f32_32x32x16_bf16 a[112:127], v[76:79], v[204:207], a[112:127]
  s_waitcnt vmcnt(38)
  v_mfma_f32_32x32x16_bf16 a[0:15], v[80:83], v[208:211], a[0:15]
  v_mfma_f32_32x32x16_bf16 a[16:31], v[84:87], v[208:211], a[16:31]
  v_mfma_f32_32x32x16_bf16 a[32:47], v[80:83], v[212:215], a[32:47]
  v_mfma_f32_32x32x16_bf16 a[48:63], v[84:87], v[212:215], a[48:63]
  v_mfma_f32_32x32x16_bf16 a[64:79], v[80:83], v[216:219], a[64:79]
  v_mfma_f32_32x32x16_bf16 a[80:95], v[84:87], v[216:219], a[80:95]
  v_mfma_f32_32x32x16_bf16 a[96:111], v[80:83], v[220:223], a[96:111]
  v_mfma_f32_32x32x16_bf16 a[112:127], v[84:87], v[220:223], a[112:127]
  s_waitcnt vmcnt(36)
  v_mfma_f32_32x32x16_bf16 a[0:15], v[88:91], v[224:227], a[0:15]
  v_mfma_f32_32x32x16_bf16 a[16:31], v[92:95], v[224:227], a[16:31]
  v_mfma_f32_32x32x16_bf16 a[32:47], v[88:91], v[228:231], a[32:47]
  v_mfma_f32_32x32x16_bf16 a[48:63], v[92:95], v[228:231], a[48:63]
  v_mfma_f32_32x32x16_bf16 a[64:79], v[88:91], v[232:235], a[64:79]
  v_mfma_f32_32x32x16_bf16 a[80:95], v[92:95], v[232:235], a[80:95]
  v_mfma_f32_32x32x16_bf16 a[96:111], v[88:91], v[236:239], a[96:111]
  v_mfma_f32_32x32x16_bf16 a[112:127], v[92:95], v[236:239], a[112:127]
  s_add_u32 s24, s72, s78
  buffer_load_dwordx4 v[224:227], v2, s[4:7], s24 offen sc1
  s_add_u32 s24, s73, s78
  buffer_load_dwordx4 v[228:231], v2, s[4:7], s24 offen sc1
  s_add_u32 s24, s74, s78
  buffer_load_dwordx4 v[232:235], v2, s[4:7], s24 offen sc1
  s_add_u32 s24, s75, s78
  buffer_load_dwordx4 v[236:239], v2, s[4:7], s24 offen sc1
  s_add_u32 s78, s78, 4096
  s_cmp_eq_u32 s78, 110592
  s_cselect_b32 s78, 0, s78
  s_waitcnt vmcnt(38)
  v_mfma_f32_32x32x16_bf16 a[0:15], v[96:99], v[240:243], a[0:15]
  v_mfma_f32_32x32x16_bf16 a[16:31], v[100:103], v[240:243], a[16:31]
  v_mfma_f32_32x32x16_bf16 a[32:47], v[96:99], v[244:247], a[32:47]
  v_mfma_f32_32x32x16_bf16 a[48:63], v[100:103], v[244:247], a[48:63]
  v_mfma_f32_32x32x16_bf16 a[64:79], v[96:99], v[248:251], a[64:79]
  v_mfma_f32_32x32x16_bf16 a[80:95], v[100:103], v[248:251], a[80:95]
  v_mfma_f32_32x32x16_bf16 a[96:111], v[96:99], v[252:255], a[96:111]
  v_mfma_f32_32x32x16_bf16 a[112:127], v[100:103], v[252:255], a[112:127]
  s_mov_b32 s25, 95420416
  buffer_load_dwordx4 v[240:243], v7, s[4:7], s25 offen offset:0 sc1
  buffer_load_dwordx4 v[244:247], v7, s[4:7], s25 offen offset:16 sc1
  buffer_load_dwordx4 v[248:251], v7, s[4:7], s25 offen offset:64 sc1
  buffer_load_dwordx4 v[252:255], v7, s[4:7], s25 offen offset:80 sc1
  s_waitcnt vmcnt(40)
  v_mfma_f32_32x32x16_bf16 a[0:15], v[104:107], a[128:131], a[0:15]
  v_mfma_f32_32x32x16_bf16 a[16:31], v[108:111], a[128:131], a[16:31]
  v_mfma_f32_32x32x16_bf16 a[32:47], v[104:107], a[132:135], a[32:47]
  v_mfma_f32_32x32x16_bf16 a[48:63], v[108:111], a[132:135], a[48:63]
  v_mfma_f32_32x32x16_bf16 a[64:79], v[104:107], a[136:139], a[64:79]
  v_mfma_f32_32x32x16_bf16 a[80:95], v[108:111], a[136:139], a[80:95]
  v_mfma_f32_32x32x16_bf16 a[96:111], v[104:107], a[140:143], a[96:111]
  v_mfma_f32_32x32x16_bf16 a[112:127], v[108:111], a[140:143], a[112:127]
  s_waitcnt vmcnt(38)
  v_mfma_f32_32x32x16_bf16 a[0:15], v[24:27], a[144:147], a[0:15]
  v_mfma_f32_32x32x16_bf16 a[16:31], v[28:31], a[144:147], a[16:31]
  v_mfma_f32_32x32x16_bf16 a[32:47], v[24:27], a[148:151], a[32:47]
  v_mfma_f32_32x32x16_bf16 a[48:63], v[28:31], a[148:151], a[48:63]
  v_mfma_f32_32x32x16_bf16 a[64:79], v[24:27], a[152:155], a[64:79]
  v_mfma_f32_32x32x16_bf16 a[80:95], v[28:31], a[152:155], a[80:95]
  v_mfma_f32_32x32x16_bf16 a[96:111], v[24:27], a[156:159], a[96:111]
  v_mfma_f32_32x32x16_bf16 a[112:127], v[28:31], a[156:159], a[112:127]
  s_waitcnt vmcnt(36)
  v_mfma_f32_32x32x16_bf16 a[0:15], v[112:115], a[160:163], a[0:15]
  v_mfma_f32_32x32x16_bf16 a[16:31], v[116:119], a[160:163], a[16:31]
  v_mfma_f32_32x32x16_bf16 a[32:47], v[112:115], a[164:167], a[32:47]
  v_mfma_f32_32x32x16_bf16 a[48:63], v[116:119], a[164:167], a[48:63]
  v_mfma_f32_32x32x16_bf16 a[64:79], v[112:115], a[168:171], a[64:79]
  v_mfma_f32_32x32x16_bf16 a[80:95], v[116:119], a[168:171], a[80:95]
  v_mfma_f32_32x32x16_bf16 a[96:111], v[112:115], a[172:175], a[96:111]
  v_mfma_f32_32x32x16_bf16 a[112:127], v[116:119], a[172:175], a[112:127]
  s_waitcnt vmcnt(34)
  v_mfma_f32_32x32x16_bf16 a[0:15], v[120:123], a[176:179], a[0:15]
  v_mfma_f32_32x32x16_bf16 a[16:31], v[124:127], a[176:179], a[16:31]
  v_mfma_f32_32x32x16_bf16 a[32:47], v[120:123], a[180:183], a[32:47]
  v_mfma_f32_32x32x16_bf16 a[48:63], v[124:127], a[180:183], a[48:63]
  v_mfma_f32_32x32x16_bf16 a[64:79], v[120:123], a[184:187], a[64:79]
  v_mfma_f32_32x32x16_bf16 a[80:95], v[124:127], a[184:187], a[80:95]
  v_mfma_f32_32x32x16_bf16 a[96:111], v[120:123], a[188:191], a[96:111]
  v_mfma_f32_32x32x16_bf16 a[112:127], v[124:127], a[188:191], a[112:127]
  s_waitcnt vmcnt(32)
  v_mfma_f32_32x32x16_bf16 a[0:15], v[32:35], a[192:195], a[0:15]
  v_mfma_f32_32x32x16_bf16 a[16:31], v[36:39], a[192:195], a[16:31]
  v_mfma_f32_32x32x16_bf16 a[32:47], v[32:35], a[196:199], a[32:47]
  v_mfma_f32_32x32x16_bf16 a[48:63], v[36:39], a[196:199], a[48:63]
  v_mfma_f32_32x32x16_bf16 a[64:79], v[32:35], a[200:203], a[64:79]
  v_mfma_f32_32x32x16_bf16 a[80:95], v[36:39], a[200:203], a[80:95]
  v_mfma_f32_32x32x16_bf16 a[96:111], v[32:35], a[204:207], a[96:111]
  v_mfma_f32_32x32x16_bf16 a[112:127], v[36:39], a[204:207], a[112:127]
  s_waitcnt vmcnt(30)
  v_mfma_f32_32x32x16_bf16 a[0:15], v[128:131], a[208:211], a[0:15]
  v_mfma_f32_32x32x16_bf16 a[16:31], v[132:135], a[208:211], a[16:31]
  v_mfma_f32_32x32x16_bf16 a[32:47], v[128:131], a[212:215], a[32:47]
  v_mfma_f32_32x32x16_bf16 a[48:63], v[132:135], a[212:215], a[48:63]
  v_mfma_f32_32x32x16_bf16 a[64:79], v[128:131], a[216:219], a[64:79]
  v_mfma_f32_32x32x16_bf16 a[80:95], v[132:135], a[216:219], a[80:95]
  v_mfma_f32_32x32x16_bf16 a[96:111], v[128:131], a[220:223], a[96:111]
  v_mfma_f32_32x32x16_bf16 a[112:127], v[132:135], a[220:223], a[112:127]
  ds_read_b128 v[192:195], v10 offset:0
  ds_read_b128 v[196:199], v10 offset:1024
  ds_read_b128 v[200:203], v10 offset:2048
  ds_read_b128 v[204:207], v10 offset:3072
  ds_read_b128 v[208:211], v10 offset:4096
  ds_read_b128 v[212:215], v10 offset:5120
  ds_read_b128 v[216:219], v10 offset:6144
  ds_read_b128 v[220:223], v10 offset:7168
  s_waitcnt vmcnt(28)
  v_mfma_f32_32x32x16_bf16 a[0:15], v[136:139], a[224:227], a[0:15]
  v_mfma_f32_32x32x16_bf16 a[16:31], v[140:143], a[224:227], a[16:31]
  v_mfma_f32_32x32x16_bf16 a[32:47], v[136:139], a[228:231], a[32:47]
  v_mfma_f32_32x32x16_bf16 a[48:63], v[140:143], a[228:231], a[48:63]
  v_mfma_f32_32x32x16_bf16 a[64:79], v[136:139], a[232:235], a[64:79]
  v_mfma_f32_32x32x16_bf16 a[80:95], v[140:143], a[232:235], a[80:95]
  v_mfma_f32_32x32x16_bf16 a[96:111], v[136:139], a[236:239], a[96:111]
  v_mfma_f32_32x32x16_bf16 a[112:127], v[140:143], a[236:239], a[112:127]
  s_waitcnt vmcnt(26)
  v_mfma_f32_32x32x16_bf16 a[0:15], v[40:43], a[240:243], a[0:15]
  v_mfma_f32_32x32x16_bf16 a[16:31], v[44:47], a[240:243], a[16:31]
  v_mfma_f32_32x32x16_bf16 a[32:47], v[40:43], a[244:247], a[32:47]
  v_mfma_f32_32x32x16_bf16 a[48:63], v[44:47], a[244:247], a[48:63]
  v_mfma_f32_32x32x16_bf16 a[64:79], v[40:43], a[248:251], a[64:79]
  v_mfma_f32_32x32x16_bf16 a[80:95], v[44:47], a[248:251], a[80:95]
  v_mfma_f32_32x32x16_bf16 a[96:111], v[40:43], a[252:255], a[96:111]
  v_mfma_f32_32x32x16_bf16 a[112:127], v[44:47], a[252:255], a[112:127]
  s_waitcnt vmcnt(24)
  s_waitcnt lgkmcnt(4)
  v_mfma_f32_32x32x16_bf16 a[0:15], v[144:147], v[192:195], a[0:15]
  v_mfma_f32_32x32x16_bf16 a[16:31], v[148:151], v[192:195], a[16:31]
  v_mfma_f32_32x32x16_bf16 a[32:47], v[144:147], v[196:199], a[32:47]
  v_mfma_f32_32x32x16_bf16 a[48:63], v[148:151], v[196:199], a[48:63]
  v_mfma_f32_32x32x16_bf16 a[64:79], v[144:147], v[200:203], a[64:79]
  v_mfma_f32_32x32x16_bf16 a[80:95], v[148:151], v[200:203], a[80:95]
  v_mfma_f32_32x32x16_bf16 a[96:111], v[144:147], v[204:207], a[96:111]
  v_mfma_f32_32x32x16_bf16 a[112:127], v[148:151], v[204:207], a[112:127]
  ds_read_b128 v[192:195], v10 offset:8192
  ds_read_b128 v[196:199], v10 offset:9216
  ds_read_b128 v[200:203], v10 offset:10240
  ds_read_b128 v[204:207], v10 offset:11264
  s_waitcnt vmcnt(22)
  s_waitcnt lgkmcnt(4)
  v_mfma_f32_32x32x16_bf16 a[0:15], v[152:155], v[208:211], a[0:15]
  v_mfma_f32_32x32x16_bf16 a[16:31], v[156:159], v[208:211], a[16:31]
  v_mfma_f32_32x32x16_bf16 a[32:47], v[152:155], v[212:215], a[32:47]
  v_mfma_f32_32x32x16_bf16 a[48:63], v[156:159], v[212:215], a[48:63]
  v_mfma_f32_32x32x16_bf16 a[64:79], v[152:155], v[216:219], a[64:79]
  v_mfma_f32_32x32x16_bf16 a[80:95], v[156:159], v[216:219], a[80:95]
  v_mfma_f32_32x32x16_bf16 a[96:111], v[152:155], v[220:223], a[96:111]
  v_mfma_f32_32x32x16_bf16 a[112:127], v[156:159], v[220:223], a[112:127]
  ds_read_b128 v[208:211], v10 offset:12288
  ds_read_b128 v[212:215], v10 offset:13312
  ds_read_b128 v[216:219], v10 offset:14336
  ds_read_b128 v[220:223], v10 offset:15360
  s_waitcnt vmcnt(20)
  s_waitcnt lgkmcnt(4)
  v_mfma_f32_32x32x16_bf16 a[0:15], v[48:51], v[192:195], a[0:15]
  v_mfma_f32_32x32x16_bf16 a[16:31], v[52:55], v[192:195], a[16:31]
  v_mfma_f32_32x32x16_bf16 a[32:47], v[48:51], v[196:199], a[32:47]
  v_mfma_f32_32x32x16_bf16 a[48:63], v[52:55], v[196:199], a[48:63]
  v_mfma_f32_32x32x16_bf16 a[64:79], v[48:51], v[200:203], a[64:79]
  v_mfma_f32_32x32x16_bf16 a[80:95], v[52:55], v[200:203], a[80:95]
  v_mfma_f32_32x32x16_bf16 a[96:111], v[48:51], v[204:207], a[96:111]
  v_mfma_f32_32x32x16_bf16 a[112:127], v[52:55], v[204:207], a[112:127]
  ds_read_b128 v[192:195], v10 offset:16384
  ds_read_b128 v[196:199], v10 offset:17408
  ds_read_b128 v[200:203], v10 offset:18432
  ds_read_b128 v[204:207], v10 offset:19456
  s_waitcnt vmcnt(18)
  s_waitcnt lgkmcnt(4)
  v_mfma_f32_32x32x16_bf16 a[0:15], v[160:163], v[208:211], a[0:15]
  v_mfma_f32_32x32x16_bf16 a[16:31], v[164:167], v[208:211], a[16:31]
  v_mfma_f32_32x32x16_bf16 a[32:47], v[160:163], v[212:215], a[32:47]
  v_mfma_f32_32x32x16_bf16 a[48:63], v[164:167], v[212:215], a[48:63]
  v_mfma_f32_32x32x16_bf16 a[64:79], v[160:163], v[216:219], a[64:79]
  v_mfma_f32_32x32x16_bf16 a[80:95], v[164:167], v[216:219], a[80:95]
  v_mfma_f32_32x32x16_bf16 a[96:111], v[160:163], v[220:223], a[96:111]
  v_mfma_f32_32x32x16_bf16 a[112:127], v[164:167], v[220:223], a[112:127]
  ds_read_b128 v[208:211], v10 offset:20480
  ds_read_b128 v[212:215], v10 offset:21504
  ds_read_b128 v[216:219], v10 offset:22528
  ds_read_b128 v[220:223], v10 offset:23552
  s_waitcnt vmcnt(16)
  s_waitcnt lgkmcnt(4)
  v_mfma_f32_32x32x16_bf16 a[0:15], v[168:171], v[192:195], a[0:15]
  v_mfma_f32_32x32x16_bf16 a[16:31], v[172:175], v[192:195], a[16:31]
  v_mfma_f32_32x32x16_bf16 a[32:47], v[168:171], v[196:199], a[32:47]
  v_mfma_f32_32x32x16_bf16 a[48:63], v[172:175], v[196:199], a[48:63]
  v_mfma_f32_32x32x16_bf16 a[64:79], v[168:171], v[200:203], a[64:79]
  v_mfma_f32_32x32x16_bf16 a[80:95], v[172:175], v[200:203], a[80:95]
  v_mfma_f32_32x32x16_bf16 a[96:111], v[168:171], v[204:207], a[96:111]
  v_mfma_f32_32x32x16_bf16 a[112:127], v[172:175], v[204:207], a[112:127]
  ds_read_b128 v[192:195], v10 offset:24576
  ds_read_b128 v[196:199], v10 offset:25600
  ds_read_b128 v[200:203], v10 offset:26624
  ds_read_b128 v[204:207], v10 offset:27648
  s_waitcnt vmcnt(14)
  s_waitcnt lgkmcnt(4)
  v_mfma_f32_32x32x16_bf16 a[0:15], v[56:59], v[208:211], a[0:15]
  v_mfma_f32_32x32x16_bf16 a[16:31], v[60:63], v[208:211], a[16:31]
  v_mfma_f32_32x32x16_bf16 a[32:47], v[56:59], v[212:215], a[32:47]
  v_mfma_f32_32x32x16_bf16 a[48:63], v[60:63], v[212:215], a[48:63]
  v_mfma_f32_32x32x16_bf16 a[64:79], v[56:59], v[216:219], a[64:79]
  v_mfma_f32_32x32x16_bf16 a[80:95], v[60:63], v[216:219], a[80:95]
  v_mfma_f32_32x32x16_bf16 a[96:111], v[56:59], v[220:223], a[96:111]
  v_mfma_f32_32x32x16_bf16 a[112:127], v[60:63], v[220:223], a[112:127]
  ds_read_b128 v[208:211], v10 offset:28672
  ds_read_b128 v[212:215], v10 offset:29696
  ds_read_b128 v[216:219], v10 offset:30720
  ds_read_b128 v[220:223], v10 offset:31744
  s_waitcnt vmcnt(12)
  s_waitcnt lgkmcnt(4)
  v_mfma_f32_32x32x16_bf16 a[0:15], v[176:179], v[192:195], a[0:15]
  v_mfma_f32_32x32x16_bf16 a[16:31], v[180:183], v[192:195], a[16:31]
  v_mfma_f32_32x32x16_bf16 a[32:47], v[176:179], v[196:199], a[32:47]
  v_mfma_f32_32x32x16_bf16 a[48:63], v[180:183], v[196:199], a[48:63]
  v_mfma_f32_32x32x16_bf16 a[64:79], v[176:179], v[200:203], a[64:79]
  v_mfma_f32_32x32x16_bf16 a[80:95], v[180:183], v[200:203], a[80:95]
  v_mfma_f32_32x32x16_bf16 a[96:111], v[176:179], v[204:207], a[96:111]
  v_mfma_f32_32x32x16_bf16 a[112:127], v[180:183], v[204:207], a[112:127]
  s_waitcnt vmcnt(10)
  s_waitcnt lgkmcnt(0)
  v_mfma_f32_32x32x16_bf16 a[0:15], v[184:187], v[208:211], a[0:15]
  v_mfma_f32_32x32x16_bf16 a[16:31], v[188:191], v[208:211], a[16:31]
  v_mfma_f32_32x32x16_bf16 a[32:47], v[184:187], v[212:215], a[32:47]
  v_mfma_f32_32x32x16_bf16 a[48:63], v[188:191], v[212:215], a[48:63]
  v_mfma_f32_32x32x16_bf16 a[64:79], v[184:187], v[216:219], a[64:79]
  v_mfma_f32_32x32x16_bf16 a[80:95], v[188:191], v[216:219], a[80:95]
  v_mfma_f32_32x32x16_bf16 a[96:111], v[184:187], v[220:223], a[96:111]
  v_mfma_f32_32x32x16_bf16 a[112:127], v[188:191], v[220:223], a[112:127]
  s_waitcnt vmcnt(4)
  v_mfma_f32_32x32x16_bf16 a[0:15], v[64:67], v[224:227], a[0:15]
  v_mfma_f32_32x32x16_bf16 a[16:31], v[68:71], v[224:227], a[16:31]
  v_mfma_f32_32x32x16_bf16 a[32:47], v[64:67], v[228:231], a[32:47]
  v_mfma_f32_32x32x16_bf16 a[48:63], v[68:71], v[228:231], a[48:63]
  v_mfma_f32_32x32x16_bf16 a[64:79], v[64:67], v[232:235], a[64:79]
  v_mfma_f32_32x32x16_bf16 a[80:95], v[68:71], v[232:235], a[80:95]
  v_mfma_f32_32x32x16_bf16 a[96:111], v[64:67], v[236:239], a[96:111]
  v_mfma_f32_32x32x16_bf16 a[112:127], v[68:71], v[236:239], a[112:127]
  s_waitcnt vmcnt(0)
  s_barrier
  s_lshl_b32 s24, s17, 12
  v_add_u32 v12, s24, v2
  v_add_u32 v13, 0x10000, v12
  s_lshl_b32 s24, s17, 15
  v_add_u32 v14, s24, v2
  s_nop 7
  ds_write_b128 v12, a[0:3] offset:0
  ds_write_b128 v12, a[4:7] offset:1024
  ds_write_b128 v12, a[8:11] offset:2048
  ds_write_b128 v12, a[12:15] offset:3072
  ds_write_b128 v12, a[16:19] offset:16384
  ds_write_b128 v12, a[20:23] offset:17408
  ds_write_b128 v12, a[24:27] offset:18432
  ds_write_b128 v12, a[28:31] offset:19456
  ds_write_b128 v12, a[32:35] offset:32768
  ds_write_b128 v12, a[36:39] offset:33792
  ds_write_b128 v12, a[40:43] offset:34816
  ds_write_b128 v12, a[44:47] offset:35840
  ds_write_b128 v12, a[48:51] offset:49152
  ds_write_b128 v12, a[52:55] offset:50176
  ds_write_b128 v12, a[56:59] offset:51200
  ds_write_b128 v12, a[60:63] offset:52224
  ds_write_b128 v13, a[64:67] offset:0
  ds_write_b128 v13, a[68:71] offset:1024
  ds_write_b128 v13, a[72:75] offset:2048
  ds_write_b128 v13, a[76:79] offset:3072
  ds_write_b128 v13, a[80:83] offset:16384
  ds_write_b128 v13, a[84:87] offset:17408
  ds_write_b128 v13, a[88:91] offset:18432
  ds_write_b128 v13, a[92:95] offset:19456
  ds_write_b128 v13, a[96:99] offset:32768
  ds_write_b128 v13, a[100:103] offset:33792
  ds_write_b128 v13, a[104:107] offset:34816
  ds_write_b128 v13, a[108:111] offset:35840
  ds_write_b128 v13, a[112:115] offset:49152
  ds_write_b128 v13, a[116:119] offset:50176
  ds_write_b128 v13, a[120:123] offset:51200
  ds_write_b128 v13, a[124:127] offset:52224
  s_waitcnt lgkmcnt(0)
  s_barrier
  ds_read_b128 v[100:103], v14 offset:0
  ds_read_b128 v[104:107], v14 offset:1024
  ds_read_b128 v[108:111], v14 offset:2048
  ds_read_b128 v[112:115], v14 offset:3072
  ds_read_b128 v[116:119], v14 offset:4096
  ds_read_b128 v[120:123], v14 offset:5120
  ds_read_b128 v[124:127], v14 offset:6144
  ds_read_b128 v[128:131], v14 offset:7168
  ds_read_b128 v[132:135], v14 offset:8192
  ds_read_b128 v[136:139], v14 offset:9216
  ds_read_b128 v[140:143], v14 offset:10240
  ds_read_b128 v[144:147], v14 offset:11264
  ds_read_b128 v[148:151], v14 offset:12288
  ds_read_b128 v[152:155], v14 offset:13312
  ds_read_b128 v[156:159], v14 offset:14336
  ds_read_b128 v[160:163], v14 offset:15360
  ds_read_b128 v[164:167], v14 offset:16384
  ds_read_b128 v[168:171], v14 offset:17408
  ds_read_b128 v[172:175], v14 offset:18432
  ds_read_b128 v[176:179], v14 offset:19456
  ds_read_b128 v[180:183], v14 offset:20480
  ds_read_b128 v[184:187], v14 offset:21504
  ds_read_b128 v[188:191], v14 offset:22528
  ds_read_b128 v[192:195], v14 offset:23552
  ds_read_b128 v[196:199], v14 offset:24576
  ds_read_b128 v[200:203], v14 offset:25600
  ds_read_b128 v[204:207], v14 offset:26624
  ds_read_b128 v[208:211], v14 offset:27648
  ds_read_b128 v[212:215], v14 offset:28672
  ds_read_b128 v[216:219], v14 offset:29696
  ds_read_b128 v[220:223], v14 offset:30720
  ds_read_b128 v[224:227], v14 offset:31744
  v_lshlrev_b32 v8, 16, v8
  s_waitcnt lgkmcnt(15)
  v_pk_add_f32 v[100:101], v[100:101], v[116:117]
  v_pk_add_f32 v[102:103], v[102:103], v[118:119]
  v_pk_add_f32 v[104:105], v[104:105], v[120:121]
  v_pk_add_f32 v[106:107], v[106:107], v[122:123]
  v_pk_add_f32 v[108:109], v[108:109], v[124:125]
  v_pk_add_f32 v[110:111], v[110:111], v[126:127]
  v_pk_add_f32 v[112:113], v[112:113], v[128:129]
  v_pk_add_f32 v[114:115], v[114:115], v[130:131]
  v_pk_add_f32 v[132:133], v[132:133], v[148:149]
  v_pk_add_f32 v[134:135], v[134:135], v[150:151]
  v_pk_add_f32 v[136:137], v[136:137], v[152:153]
  v_pk_add_f32 v[138:139], v[138:139], v[154:155]
  v_pk_add_f32 v[140:141], v[140:141], v[156:157]
  v_pk_add_f32 v[142:143], v[142:143], v[158:159]
  v_pk_add_f32 v[144:145], v[144:145], v[160:161]
  v_pk_add_f32 v[146:147], v[146:147], v[162:163]
  v_pk_add_f32 v[100:101], v[100:101], v[132:133]
  v_pk_add_f32 v[102:103], v[102:103], v[134:135]
  v_pk_add_f32 v[104:105], v[104:105], v[136:137]
  v_pk_add_f32 v[106:107], v[106:107], v[138:139]
  v_pk_add_f32 v[108:109], v[108:109], v[140:141]
  v_pk_add_f32 v[110:111], v[110:111], v[142:143]
  v_pk_add_f32 v[112:113], v[112:113], v[144:145]
  v_pk_add_f32 v[114:115], v[114:115], v[146:147]
  v_cvt_pk_bf16_f32 v116, v100, v101
  v_cvt_pk_bf16_f32 v117, v102, v103
  v_cvt_pk_bf16_f32 v118, v104, v105
  v_cvt_pk_bf16_f32 v119, v106, v107
  v_cvt_pk_bf16_f32 v120, v108, v109
  v_cvt_pk_bf16_f32 v121, v110, v111
  v_cvt_pk_bf16_f32 v122, v112, v113
  v_cvt_pk_bf16_f32 v123, v114, v115
  v_lshlrev_b32 v100, 16, v116
  v_and_b32 v101, 0xffff0000, v116
  v_lshlrev_b32 v102, 16, v117
  v_and_b32 v103, 0xffff0000, v117
  v_lshlrev_b32 v104, 16, v118
  v_and_b32 v105, 0xffff0000, v118
  v_lshlrev_b32 v106, 16, v119
  v_and_b32 v107, 0xffff0000, v119
  v_lshlrev_b32 v108, 16, v120
  v_and_b32 v109, 0xffff0000, v120
  v_lshlrev_b32 v110, 16, v121
  v_and_b32 v111, 0xffff0000, v121
  v_lshlrev_b32 v112, 16, v122
  v_and_b32 v113, 0xffff0000, v122
  v_lshlrev_b32 v114, 16, v123
  v_and_b32 v115, 0xffff0000, v123
  v_add_f32 v100, v100, v8
  v_add_f32 v101, v101, v8
  v_add_f32 v102, v102, v8
  v_add_f32 v103, v103, v8
  v_add_f32 v104, v104, v8
  v_add_f32 v105, v105, v8
  v_add_f32 v106, v106, v8
  v_add_f32 v107, v107, v8
  v_add_f32 v108, v108, v8
  v_add_f32 v109, v109, v8
  v_add_f32 v110, v110, v8
  v_add_f32 v111, v111, v8
  v_add_f32 v112, v112, v8
  v_add_f32 v113, v113, v8
  v_add_f32 v114, v114, v8
  v_add_f32 v115, v115, v8
  v_cvt_pk_bf16_f32 v116, v100, v101
  v_cvt_pk_bf16_f32 v117, v102, v103
  v_cvt_pk_bf16_f32 v118, v104, v105
  v_cvt_pk_bf16_f32 v119, v106, v107
  v_cvt_pk_bf16_f32 v120, v108, v109
  v_cvt_pk_bf16_f32 v121, v110, v111
  v_cvt_pk_bf16_f32 v122, v112, v113
  v_cvt_pk_bf16_f32 v123, v114, v115
  v_lshlrev_b32 v100, 16, v116
  v_and_b32 v101, 0xffff0000, v116
  v_lshlrev_b32 v102, 16, v117
  v_and_b32 v103, 0xffff0000, v117
  v_lshlrev_b32 v104, 16, v118
  v_and_b32 v105, 0xffff0000, v118
  v_lshlrev_b32 v106, 16, v119
  v_and_b32 v107, 0xffff0000, v119
  v_lshlrev_b32 v108, 16, v120
  v_and_b32 v109, 0xffff0000, v120
  v_lshlrev_b32 v110, 16, v121
  v_and_b32 v111, 0xffff0000, v121
  v_lshlrev_b32 v112, 16, v122
  v_and_b32 v113, 0xffff0000, v122
  v_lshlrev_b32 v114, 16, v123
  v_and_b32 v115, 0xffff0000, v123
  v_lshlrev_b32 v132, 16, v240
  v_and_b32 v133, 0xffff0000, v240
  v_lshlrev_b32 v134, 16, v241
  v_and_b32 v135, 0xffff0000, v241
  v_lshlrev_b32 v136, 16, v242
  v_and_b32 v137, 0xffff0000, v242
  v_lshlrev_b32 v138, 16, v243
  v_and_b32 v139, 0xffff0000, v243
  v_lshlrev_b32 v140, 16, v244
  v_and_b32 v141, 0xffff0000, v244
  v_lshlrev_b32 v142, 16, v245
  v_and_b32 v143, 0xffff0000, v245
  v_lshlrev_b32 v144, 16, v246
  v_and_b32 v145, 0xffff0000, v246
  v_lshlrev_b32 v146, 16, v247
  v_and_b32 v147, 0xffff0000, v247
  v_pk_add_f32 v[100:101], v[100:101], v[132:133]
  v_pk_add_f32 v[102:103], v[102:103], v[134:135]
  v_pk_add_f32 v[104:105], v[104:105], v[136:137]
  v_pk_add_f32 v[106:107], v[106:107], v[138:139]
  v_pk_add_f32 v[108:109], v[108:109], v[140:141]
  v_pk_add_f32 v[110:111], v[110:111], v[142:143]
  v_pk_add_f32 v[112:113], v[112:113], v[144:145]
  v_pk_add_f32 v[114:115], v[114:115], v[146:147]
  v_cvt_pk_bf16_f32 v116, v100, v101
  v_cvt_pk_bf16_f32 v117, v102, v103
  v_cvt_pk_bf16_f32 v118, v104, v105
  v_cvt_pk_bf16_f32 v119, v106, v107
  v_cvt_pk_bf16_f32 v120, v108, v109
  v_cvt_pk_bf16_f32 v121, v110, v111
  v_cvt_pk_bf16_f32 v122, v112, v113
  v_cvt_pk_bf16_f32 v123, v114, v115
  s_cmp_eq_u32 s22, 0
  s_cbranch_scc1 Lg2p_45
  s_mov_b32 s24, 3676160
  s_cmp_lg_u32 s17, 0
  s_cbranch_scc1 Lwf_46_ok
  v_mov_b32 v3, 0
Lwf_46:
  buffer_load_dword v4, v3, s[4:7], s24 offen sc1
  s_waitcnt vmcnt(0)
  v_readfirstlane_b32 s25, v4
  s_add_u32 s0, s0, 1
  s_cmp_ge_u32 s25, 10
  s_cbranch_scc1 Lwf_46_ok
  s_sleep 16
  s_cmp_lt_u32 s0, 1572864
  s_cbranch_scc1 Lwf_46
Lwf_46_ok:
  s_barrier
Lg2p_45:
  buffer_store_dwordx4 v[116:119], v9, s[4:7], s26 offen offset:0 sc1
  buffer_store_dwordx4 v[120:123], v9, s[4:7], s26 offen offset:512 sc1
  s_waitcnt lgkmcnt(8)
  v_pk_add_f32 v[164:165], v[164:165], v[180:181]
  v_pk_add_f32 v[166:167], v[166:167], v[182:183]
  v_pk_add_f32 v[168:169], v[168:169], v[184:185]
  v_pk_add_f32 v[170:171], v[170:171], v[186:187]
  v_pk_add_f32 v[172:173], v[172:173], v[188:189]
  v_pk_add_f32 v[174:175], v[174:175], v[190:191]
  v_pk_add_f32 v[176:177], v[176:177], v[192:193]
  v_pk_add_f32 v[178:179], v[178:179], v[194:195]
  s_waitcnt lgkmcnt(0)
  v_pk_add_f32 v[196:197], v[196:197], v[212:213]
  v_pk_add_f32 v[198:199], v[198:199], v[214:215]
  v_pk_add_f32 v[200:201], v[200:201], v[216:217]
  v_pk_add_f32 v[202:203], v[202:203], v[218:219]
  v_pk_add_f32 v[204:205], v[204:205], v[220:221]
  v_pk_add_f32 v[206:207], v[206:207], v[222:223]
  v_pk_add_f32 v[208:209], v[208:209], v[224:225]
  v_pk_add_f32 v[210:211], v[210:211], v[226:227]
  v_pk_add_f32 v[164:165], v[164:165], v[196:197]
  v_pk_add_f32 v[166:167], v[166:167], v[198:199]
  v_pk_add_f32 v[168:169], v[168:169], v[200:201]
  v_pk_add_f32 v[170:171], v[170:171], v[202:203]
  v_pk_add_f32 v[172:173], v[172:173], v[204:205]
  v_pk_add_f32 v[174:175], v[174:175], v[206:207]
  v_pk_add_f32 v[176:177], v[176:177], v[208:209]
  v_pk_add_f32 v[178:179], v[178:179], v[210:211]
  v_cvt_pk_bf16_f32 v180, v164, v165
  v_cvt_pk_bf16_f32 v181, v166, v167
  v_cvt_pk_bf16_f32 v182, v168, v169
  v_cvt_pk_bf16_f32 v183, v170, v171
  v_cvt_pk_bf16_f32 v184, v172, v173
  v_cvt_pk_bf16_f32 v185, v174, v175
  v_cvt_pk_bf16_f32 v186, v176, v177
  v_cvt_pk_bf16_f32 v187, v178, v179
  v_lshlrev_b32 v164, 16, v180
  v_and_b32 v165, 0xffff0000, v180
  v_lshlrev_b32 v166, 16, v181
  v_and_b32 v167, 0xffff0000, v181
  v_lshlrev_b32 v168, 16, v182
  v_and_b32 v169, 0xffff0000, v182
  v_lshlrev_b32 v170, 16, v183
  v_and_b32 v171, 0xffff0000, v183
  v_lshlrev_b32 v172, 16, v184
  v_and_b32 v173, 0xffff0000, v184
  v_lshlrev_b32 v174, 16, v185
  v_and_b32 v175, 0xffff0000, v185
  v_lshlrev_b32 v176, 16, v186
  v_and_b32 v177, 0xffff0000, v186
  v_lshlrev_b32 v178, 16, v187
  v_and_b32 v179, 0xffff0000, v187
  v_add_f32 v164, v164, v8
  v_add_f32 v165, v165, v8
  v_add_f32 v166, v166, v8
  v_add_f32 v167, v167, v8
  v_add_f32 v168, v168, v8
  v_add_f32 v169, v169, v8
  v_add_f32 v170, v170, v8
  v_add_f32 v171, v171, v8
  v_add_f32 v172, v172, v8
  v_add_f32 v173, v173, v8
  v_add_f32 v174, v174, v8
  v_add_f32 v175, v175, v8
  v_add_f32 v176, v176, v8
  v_add_f32 v177, v177, v8
  v_add_f32 v178, v178, v8
  v_add_f32 v179, v179, v8
  v_cvt_pk_bf16_f32 v180, v164, v165
  v_cvt_pk_bf16_f32 v181, v166, v167
  v_cvt_pk_bf16_f32 v182, v168, v169
  v_cvt_pk_bf16_f32 v183, v170, v171
  v_cvt_pk_bf16_f32 v184, v172, v173
  v_cvt_pk_bf16_f32 v185, v174, v175
  v_cvt_pk_bf16_f32 v186, v176, v177
  v_cvt_pk_bf16_f32 v187, v178, v179
  v_lshlrev_b32 v164, 16, v180
  v_and_b32 v165, 0xffff0000, v180
  v_lshlrev_b32 v166, 16, v181
  v_and_b32 v167, 0xffff0000, v181
  v_lshlrev_b32 v168, 16, v182
  v_and_b32 v169, 0xffff0000, v182
  v_lshlrev_b32 v170, 16, v183
  v_and_b32 v171, 0xffff0000, v183
  v_lshlrev_b32 v172, 16, v184
  v_and_b32 v173, 0xffff0000, v184
  v_lshlrev_b32 v174, 16, v185
  v_and_b32 v175, 0xffff0000, v185
  v_lshlrev_b32 v176, 16, v186
  v_and_b32 v177, 0xffff0000, v186
  v_lshlrev_b32 v178, 16, v187
  v_and_b32 v179, 0xffff0000, v187
  v_lshlrev_b32 v196, 16, v248
  v_and_b32 v197, 0xffff0000, v248
  v_lshlrev_b32 v198, 16, v249
  v_and_b32 v199, 0xffff0000, v249
  v_lshlrev_b32 v200, 16, v250
  v_and_b32 v201, 0xffff0000, v250
  v_lshlrev_b32 v202, 16, v251
  v_and_b32 v203, 0xffff0000, v251
  v_lshlrev_b32 v204, 16, v252
  v_and_b32 v205, 0xffff0000, v252
  v_lshlrev_b32 v206, 16, v253
  v_and_b32 v207, 0xffff0000, v253
  v_lshlrev_b32 v208, 16, v254
  v_and_b32 v209, 0xffff0000, v254
  v_lshlrev_b32 v210, 16, v255
  v_and_b32 v211, 0xffff0000, v255
  v_pk_add_f32 v[164:165], v[164:165], v[196:197]
  v_pk_add_f32 v[166:167], v[166:167], v[198:199]
  v_pk_add_f32 v[168:169], v[168:169], v[200:201]
  v_pk_add_f32 v[170:171], v[170:171], v[202:203]
  v_pk_add_f32 v[172:173], v[172:173], v[204:205]
  v_pk_add_f32 v[174:175], v[174:175], v[206:207]
  v_pk_add_f32 v[176:177], v[176:177], v[208:209]
  v_pk_add_f32 v[178:179], v[178:179], v[210:211]
  v_cvt_pk_bf16_f32 v180, v164, v165
  v_cvt_pk_bf16_f32 v181, v166, v167
  v_cvt_pk_bf16_f32 v182, v168, v169
  v_cvt_pk_bf16_f32 v183, v170, v171
  v_cvt_pk_bf16_f32 v184, v172, v173
  v_cvt_pk_bf16_f32 v185, v174, v175
  v_cvt_pk_bf16_f32 v186, v176, v177
  v_cvt_pk_bf16_f32 v187, v178, v179
  buffer_store_dwordx4 v[180:183], v9, s[4:7], s26 offen offset:2048 sc1
  buffer_store_dwordx4 v[184:187], v9, s[4:7], s26 offen offset:2560 sc1
  s_lshl_b32 s24, s22, 7
  s_add_u32 s24, s24, 3676160
  s_waitcnt vmcnt(0)
  s_barrier
  v_cmp_eq_u32 vcc, 0, v0
  s_nop 0
  s_and_saveexec_b64 s[32:33], vcc
  s_cbranch_execz Lsig_47
  v_mov_b32 v3, 0
  v_mov_b32 v4, 1
  buffer_atomic_add v4, v3, s[4:7], s24 offen
Lsig_47:
  s_mov_b64 exec, s[32:33]
  s_lshl_b32 s24, s20, 2
  s_cmp_ge_u32 s19, s24
  s_cbranch_scc1 mk_nq1
  s_lshr_b32 s23, s19, 2
  s_mul_i32 s23, s23, 7
  s_add_u32 s23, s23, s18
  s_and_b32 s26, s19, 3
  s_mul_i32 s30, s19, 13108
  s_lshr_b32 s30, s30, 16
  s_mul_i32 s30, s30, 5
  s_sub_u32 s30, s19, s30
  s_lshl_b32 s30, s30, 1
  s_mov_b32 s8, s58
  s_and_b32 s9, s59, 0xffff
  s_mov_b32 s10, 5242880
  s_mov_b32 s11, 0x00020000
  s_mov_b32 s12, s60
  s_and_b32 s13, s61, 0xffff
  s_mov_b32 s14, 5242880
  s_mov_b32 s15, 0x00020000
  s_mov_b32 s36, s56
  s_and_b32 s37, s57, 0xffff
  s_mov_b32 s38, 5242880
  s_mov_b32 s39, 0x00020000
  v_lshrrev_b32 v3, 2, v1
  v_lshlrev_b32 v3, 13, v3
  v_and_b32 v4, 3, v1
  v_lshl_add_u32 v6, v4, 4, v3
  s_lshl_b32 s28, s23, 8
  s_lshl_b32 s25, s26, 6
  s_add_u32 s28, s28, s25
  s_lshl_b32 s25, s17, 17
  s_add_u32 s28, s28, s25
  s_lshl_b32 s25, s30, 19
  s_add_u32 s25, s25, s28
  s_add_u32 m0, s29, 0
  s_nop 0
  buffer_load_dwordx4 v6, s[8:11], s25 offen lds
  s_add_u32 m0, s29, 40960
  s_nop 0
  buffer_load_dwordx4 v6, s[12:15], s25 offen lds
  s_add_u32 m0, s29, 81920
  s_nop 0
  buffer_load_dwordx4 v6, s[36:39], s25 offen lds
  s_add_u32 s30, s30, 1
  s_cmp_eq_u32 s30, 10
  s_cselect_b32 s30, 0, s30
  s_lshl_b32 s25, s30, 19
  s_add_u32 s25, s25, s28
  s_add_u32 m0, s29, 4096
  s_nop 0
  buffer_load_dwordx4 v6, s[8:11], s25 offen lds
  s_add_u32 m0, s29, 45056
  s_nop 0
  buffer_load_dwordx4 v6, s[12:15], s25 offen lds
  s_add_u32 m0, s29, 86016
  s_nop 0
  buffer_load_dwordx4 v6, s[36:39], s25 offen lds
  s_add_u32 s30, s30, 1
  s_cmp_eq_u32 s30, 10
  s_cselect_b32 s30, 0, s30
  s_lshl_b32 s25, s30, 19
  s_add_u32 s25, s25, s28
  s_add_u32 m0, s29, 8192
  s_nop 0
  buffer_load_dwordx4 v6, s[8:11], s25 offen lds
  s_add_u32 m0, s29, 49152
  s_nop 0
  buffer_load_dwordx4 v6, s[12:15], s25 offen lds
  s_add_u32 m0, s29, 90112
  s_nop 0
  buffer_load_dwordx4 v6, s[36:39], s25 offen lds
  s_add_u32 s30, s30, 1
  s_cmp_eq_u32 s30, 10
  s_cselect_b32 s30, 0, s30
  s_lshl_b32 s25, s30, 19
  s_add_u32 s25, s25, s28
  s_add_u32 m0, s29, 12288
  s_nop 0
  buffer_load_dwordx4 v6, s[8:11], s25 offen lds
  s_add_u32 m0, s29, 53248
  s_nop 0
  buffer_load_dwordx4 v6, s[12:15], s25 offen lds
  s_add_u32 m0, s29, 94208
  s_nop 0
  buffer_load_dwordx4 v6, s[36:39], s25 offen lds
  s_add_u32 s30, s30, 1
  s_cmp_eq_u32 s30, 10
  s_cselect_b32 s30, 0, s30
  s_lshl_b32 s25, s30, 19
  s_add_u32 s25, s25, s28
  s_add_u32 m0, s29, 16384
  s_nop 0
  buffer_load_dwordx4 v6, s[8:11], s25 offen lds
  s_add_u32 m0, s29, 57344
  s_nop 0
  buffer_load_dwordx4 v6, s[12:15], s25 offen lds
  s_add_u32 m0, s29, 98304
  s_nop 0
  buffer_load_dwordx4 v6, s[36:39], s25 offen lds
  s_add_u32 s30, s30, 1
  s_cmp_eq_u32 s30, 10
  s_cselect_b32 s30, 0, s30
  s_lshl_b32 s25, s30, 19
  s_add_u32 s25, s25, s28
  s_add_u32 m0, s29, 20480
  s_nop 0
  buffer_load_dwordx4 v6, s[8:11], s25 offen lds
  s_add_u32 m0, s29, 61440
  s_nop 0
  buffer_load_dwordx4 v6, s[12:15], s25 offen lds
  s_add_u32 m0, s29, 102400
  s_nop 0
  buffer_load_dwordx4 v6, s[36:39], s25 offen lds
  s_add_u32 s30, s30, 1
  s_cmp_eq_u32 s30, 10
  s_cselect_b32 s30, 0, s30
  s_lshl_b32 s25, s30, 19
  s_add_u32 s25, s25, s28
  s_add_u32 m0, s29, 24576
  s_nop 0
  buffer_load_dwordx4 v6, s[8:11], s25 offen lds
  s_add_u32 m0, s29, 65536
  s_nop 0
  buffer_load_dwordx4 v6, s[12:15], s25 offen lds
  s_add_u32 m0, s29, 106496
  s_nop 0
  buffer_load_dwordx4 v6, s[36:39], s25 offen lds
  s_add_u32 s30, s30, 1
  s_cmp_eq_u32 s30, 10
  s_cselect_b32 s30, 0, s30
  s_lshl_b32 s25, s30, 19
  s_add_u32 s25, s25, s28
  s_add_u32 m0, s29, 28672
  s_nop 0
  buffer_load_dwordx4 v6, s[8:11], s25 offen lds
  s_add_u32 m0, s29, 69632
  s_nop 0
  buffer_load_dwordx4 v6, s[12:15], s25 offen lds
  s_add_u32 m0, s29, 110592
  s_nop 0
  buffer_load_dwordx4 v6, s[36:39], s25 offen lds
  s_add_u32 s30, s30, 1
  s_cmp_eq_u32 s30, 10
  s_cselect_b32 s30, 0, s30
  s_lshl_b32 s25, s30, 19
  s_add_u32 s25, s25, s28
  s_add_u32 m0, s29, 32768
  s_nop 0
  buffer_load_dwordx4 v6, s[8:11], s25 offen lds
  s_add_u32 m0, s29, 73728
  s_nop 0
  buffer_load_dwordx4 v6, s[12:15], s25 offen lds
  s_add_u32 m0, s29, 114688
  s_nop 0
  buffer_load_dwordx4 v6, s[36:39], s25 offen lds
  s_add_u32 s30, s30, 1
  s_cmp_eq_u32 s30, 10
  s_cselect_b32 s30, 0, s30
  s_lshl_b32 s25, s30, 19
  s_add_u32 s25, s25, s28
  s_add_u32 m0, s29, 36864
  s_nop 0
  buffer_load_dwordx4 v6, s[8:11], s25 offen lds
  s_add_u32 m0, s29, 77824
  s_nop 0
  buffer_load_dwordx4 v6, s[12:15], s25 offen lds
  s_add_u32 m0, s29, 118784
  s_nop 0
  buffer_load_dwordx4 v6, s[36:39], s25 offen lds
  s_add_u32 s30, s30, 1
  s_cmp_eq_u32 s30, 10
  s_cselect_b32 s30, 0, s30
  s_lshr_b32 s23, s19, 2
  s_mul_i32 s23, s23, 7
  s_add_u32 s23, s23, s18
  s_and_b32 s26, s19, 3
  s_mul_i32 s30, s19, 13108
  s_lshr_b32 s30, s30, 16
  s_mul_i32 s30, s30, 5
  s_sub_u32 s30, s19, s30
  s_lshl_b32 s30, s30, 1
  v_lshrrev_b32 v3, 5, v1
  v_mul_u32_u24 v3, 8, v3
  v_bfe_u32 v4, v1, 2, 2
  v_add_u32 v3, v3, v4
  v_mul_u32_u24 v8, 64, v3
  v_bfe_u32 v4, v1, 1, 1
  v_lshl_add_u32 v8, v4, 3, v8
  v_bfe_u32 v4, v1, 4, 1
  v_lshl_add_u32 v8, v4, 4, v8
  v_bfe_u32 v4, v1, 0, 1
  v_lshl_add_u32 v8, v4, 5, v8
  v_add_u32 v8, 0, v8
  v_lshrrev_b32 v3, 5, v1
  v_mul_u32_u24 v3, 8, v3
  v_bfe_u32 v4, v1, 2, 2
  v_add_u32 v3, v3, v4
  v_mul_u32_u24 v10, 64, v3
  v_bfe_u32 v4, v1, 0, 1
  v_lshl_add_u32 v10, v4, 3, v10
  v_bfe_u32 v4, v1, 1, 1
  v_lshl_add_u32 v10, v4, 4, v10
  v_bfe_u32 v4, v1, 4, 1
  v_lshl_add_u32 v10, v4, 5, v10
  v_add_u32 v10, 40960, v10
  v_lshrrev_b32 v3, 5, v1
  v_mul_u32_u24 v3, 8, v3
  v_bfe_u32 v4, v1, 2, 2
  v_add_u32 v3, v3, v4
  v_mul_u32_u24 v12, 64, v3
  v_bfe_u32 v4, v1, 1, 1
  v_lshl_add_u32 v12, v4, 3, v12
  v_bfe_u32 v4, v1, 0, 1
  v_lshl_add_u32 v12, v4, 4, v12
  v_bfe_u32 v4, v1, 4, 1
  v_lshl_add_u32 v12, v4, 5, v12
  v_add_u32 v12, 81920, v12
  v_lshrrev_b32 v3, 5, v1
  v_lshlrev_b32 v7, 9, v3
  v_bfe_u32 v3, v1, 1, 4
  v_lshl_add_u32 v7, v3, 4, v7
  v_and_b32 v3, 1, v1
  v_lshl_add_u32 v7, v3, 8, v7
  s_mul_i32 s27, s17, 40960
  s_add_u32 s27, s27, 117440512
  s_lshl_b32 s28, s17, 5
  s_add_u32 s28, s28, s23
  s_lshl_b32 s28, s28, 13
  s_lshl_b32 s25, s26, 11
  s_add_u32 s28, s28, s25
  s_lshl_b32 s31, s23, 7
  s_add_u32 s31, s31, 3801088
  s_mov_b32 s34, 3805184
  s_mov_b32 s74, 0
  s_mov_b32 s22, 0
Lwqf_48:
  s_add_u32 s24, s22, 0
  s_min_u32 s24, s24, 15
  s_cmp_lt_u32 s24, s74
  s_cbranch_scc1 Lxr_49_ok
  s_cmp_lg_u32 s17, 0
  s_cbranch_scc1 Lxr_49_w
  v_lshlrev_b32 v5, 7, v1
Lxr_49_sp:
  buffer_load_dword v3, v5, s[4:7], s34 offen sc1
  s_waitcnt vmcnt(0)
  v_cmp_le_u32 vcc, 16, v3
  s_add_u32 s0, s0, 1
  s_and_b32 s74, vcc_lo, 0xffff
  s_ff0_i32_b32 s74, s74
  s_cmp_lt_u32 s24, s74
  s_cbranch_scc1 Lxr_49_got
  s_sleep 2
  s_cmp_lt_u32 s0, 1572864
  s_cbranch_scc1 Lxr_49_sp
Lxr_49_got:
  v_mov_b32 v3, s74
  v_mov_b32 v5, 123392
  ds_write_b32 v5, v3
  s_waitcnt lgkmcnt(0)
Lxr_49_w:
  s_barrier
  v_mov_b32 v5, 123392
  ds_read_b32 v3, v5
  s_waitcnt lgkmcnt(0)
  v_readfirstlane_b32 s74, v3
  s_barrier
Lxr_49_ok:
  s_lshl_b32 s75, s30, 12
  s_add_u32 s75, s75, s27
  s_add_u32 s30, s30, 1
  s_cmp_eq_u32 s30, 10
  s_cselect_b32 s30, 0, s30
  buffer_load_dwordx4 v[96:99], v2, s[4:7], s75 offen offset:0 sc1
  buffer_load_dwordx4 v[100:103], v2, s[4:7], s75 offen offset:1024 sc1
  buffer_load_dwordx4 v[104:107], v2, s[4:7], s75 offen offset:2048 sc1
  buffer_load_dwordx4 v[108:111], v2, s[4:7], s75 offen offset:3072 sc1
  s_lshl_b32 s75, s30, 12
  s_add_u32 s75, s75, s27
  s_add_u32 s30, s30, 1
  s_cmp_eq_u32 s30, 10
  s_cselect_b32 s30, 0, s30
  buffer_load_dwordx4 v[112:115], v2, s[4:7], s75 offen offset:0 sc1
  buffer_load_dwordx4 v[116:119], v2, s[4:7], s75 offen offset:1024 sc1
  buffer_load_dwordx4 v[120:123], v2, s[4:7], s75 offen offset:2048 sc1
  buffer_load_dwordx4 v[124:127], v2, s[4:7], s75 offen offset:3072 sc1
  s_lshl_b32 s75, s30, 12
  s_add_u32 s75, s75, s27
  s_add_u32 s30, s30, 1
  s_cmp_eq_u32 s30, 10
  s_cselect_b32 s30, 0, s30
  buffer_load_dwordx4 v[128:131], v2, s[4:7], s75 offen offset:0 sc1
  buffer_load_dwordx4 v[132:135], v2, s[4:7], s75 offen offset:1024 sc1
  buffer_load_dwordx4 v[136:139], v2, s[4:7], s75 offen offset:2048 sc1
  buffer_load_dwordx4 v[140:143], v2, s[4:7], s75 offen offset:3072 sc1
  s_lshl_b32 s75, s30, 12
  s_add_u32 s75, s75, s27
  s_add_u32 s30, s30, 1
  s_cmp_eq_u32 s30, 10
  s_cselect_b32 s30, 0, s30
  buffer_load_dwordx4 v[144:147], v2, s[4:7], s75 offen offset:0 sc1
  buffer_load_dwordx4 v[148:151], v2, s[4:7], s75 offen offset:1024 sc1
  buffer_load_dwordx4 v[152:155], v2, s[4:7], s75 offen offset:2048 sc1
  buffer_load_dwordx4 v[156:159], v2, s[4:7], s75 offen offset:3072 sc1
  s_lshl_b32 s75, s30, 12
  s_add_u32 s75, s75, s27
  s_add_u32 s30, s30, 1
  s_cmp_eq_u32 s30, 10
  s_cselect_b32 s30, 0, s30
  buffer_load_dwordx4 v[160:163], v2, s[4:7], s75 offen offset:0 sc1
  buffer_load_dwordx4 v[164:167], v2, s[4:7], s75 offen offset:1024 sc1
  buffer_load_dwordx4 v[168:171], v2, s[4:7], s75 offen offset:2048 sc1
  buffer_load_dwordx4 v[172:175], v2, s[4:7], s75 offen offset:3072 sc1
  s_lshl_b32 s75, s30, 12
  s_add_u32 s75, s75, s27
  s_add_u32 s30, s30, 1
  s_cmp_eq_u32 s30, 10
  s_cselect_b32 s30, 0, s30
  buffer_load_dwordx4 v[176:179], v2, s[4:7], s75 offen offset:0 sc1
  buffer_load_dwordx4 v[180:183], v2, s[4:7], s75 offen offset:1024 sc1
  buffer_load_dwordx4 v[184:187], v2, s[4:7], s75 offen offset:2048 sc1
  buffer_load_dwordx4 v[188:191], v2, s[4:7], s75 offen offset:3072 sc1
  s_lshl_b32 s75, s30, 12
  s_add_u32 s75, s75, s27
  s_add_u32 s30, s30, 1
  s_cmp_eq_u32 s30, 10
  s_cselect_b32 s30, 0, s30
  buffer_load_dwordx4 v[192:195], v2, s[4:7], s75 offen offset:0 sc1
  buffer_load_dwordx4 v[196:199], v2, s[4:7], s75 offen offset:1024 sc1
  buffer_load_dwordx4 v[200:203], v2, s[4:7], s75 offen offset:2048 sc1
  buffer_load_dwordx4 v[204:207], v2, s[4:7], s75 offen offset:3072 sc1
  s_lshl_b32 s75, s30, 12
  s_add_u32 s75, s75, s27
  s_add_u32 s30, s30, 1
  s_cmp_eq_u32 s30, 10
  s_cselect_b32 s30, 0, s30
  buffer_load_dwordx4 v[208:211], v2, s[4:7], s75 offen offset:0 sc1
  buffer_load_dwordx4 v[212:215], v2, s[4:7], s75 offen offset:1024 sc1
  buffer_load_dwordx4 v[216:219], v2, s[4:7], s75 offen offset:2048 sc1
  buffer_load_dwordx4 v[220:223], v2, s[4:7], s75 offen offset:3072 sc1
  s_lshl_b32 s75, s30, 12
  s_add_u32 s75, s75, s27
  s_add_u32 s30, s30, 1
  s_cmp_eq_u32 s30, 10
  s_cselect_b32 s30, 0, s30
  buffer_load_dwordx4 v[224:227], v2, s[4:7], s75 offen offset:0 sc1
  buffer_load_dwordx4 v[228:231], v2, s[4:7], s75 offen offset:1024 sc1
  buffer_load_dwordx4 v[232:235], v2, s[4:7], s75 offen offset:2048 sc1
  buffer_load_dwordx4 v[236:239], v2, s[4:7], s75 offen offset:3072 sc1
  s_lshl_b32 s75, s30, 12
  s_add_u32 s75, s75, s27
  s_add_u32 s30, s30, 1
  s_cmp_eq_u32 s30, 10
  s_cselect_b32 s30, 0, s30
  buffer_load_dwordx4 v[240:243], v2, s[4:7], s75 offen offset:0 sc1
  buffer_load_dwordx4 v[244:247], v2, s[4:7], s75 offen offset:1024 sc1
  buffer_load_dwordx4 v[248:251], v2, s[4:7], s75 offen offset:2048 sc1
  buffer_load_dwordx4 v[252:255], v2, s[4:7], s75 offen offset:3072 sc1
  s_add_u32 s27, s27, 163840
  s_waitcnt vmcnt(40)
  s_barrier
  ds_read_b64_tr_b16 v[16:17], v8 offset:0
  ds_read_b64_tr_b16 v[18:19], v8 offset:256
  ds_read_b64_tr_b16 v[20:21], v10 offset:0
  ds_read_b64_tr_b16 v[22:23], v10 offset:256
  ds_read_b64_tr_b16 v[24:25], v12 offset:0
  ds_read_b64_tr_b16 v[26:27], v12 offset:256
  ds_read_b64_tr_b16 v[28:29], v8 offset:1024
  ds_read_b64_tr_b16 v[30:31], v8 offset:1280
  ds_read_b64_tr_b16 v[32:33], v10 offset:1024
  ds_read_b64_tr_b16 v[34:35], v10 offset:1280
  ds_read_b64_tr_b16 v[36:37], v12 offset:1024
  ds_read_b64_tr_b16 v[38:39], v12 offset:1280
  s_waitcnt vmcnt(39) lgkmcnt(6)
  v_mfma_f32_32x32x16_bf16 a[0:15], v[16:19], v[96:99], 0
  v_mfma_f32_32x32x16_bf16 a[16:31], v[96:99], v[20:23], 0
  v_mfma_f32_32x32x16_bf16 a[32:47], v[24:27], v[96:99], 0
  ds_read_b64_tr_b16 v[16:17], v8 offset:2048
  ds_read_b64_tr_b16 v[18:19], v8 offset:2304
  ds_read_b64_tr_b16 v[20:21], v10 offset:2048
  ds_read_b64_tr_b16 v[22:23], v10 offset:2304
  ds_read_b64_tr_b16 v[24:25], v12 offset:2048
  ds_read_b64_tr_b16 v[26:27], v12 offset:2304
  s_waitcnt vmcnt(38) lgkmcnt(6)
  v_mfma_f32_32x32x16_bf16 a[0:15], v[28:31], v[100:103], a[0:15]
  v_mfma_f32_32x32x16_bf16 a[16:31], v[100:103], v[32:35], a[16:31]
  v_mfma_f32_32x32x16_bf16 a[32:47], v[36:39], v[100:103], a[32:47]
  ds_read_b64_tr_b16 v[28:29], v8 offset:3072
  ds_read_b64_tr_b16 v[30:31], v8 offset:3328
  ds_read_b64_tr_b16 v[32:33], v10 offset:3072
  ds_read_b64_tr_b16 v[34:35], v10 offset:3328
  ds_read_b64_tr_b16 v[36:37], v12 offset:3072
  ds_read_b64_tr_b16 v[38:39], v12 offset:3328
  s_waitcnt vmcnt(37) lgkmcnt(6)
  v_mfma_f32_32x32x16_bf16 a[0:15], v[16:19], v[104:107], a[0:15]
  v_mfma_f32_32x32x16_bf16 a[16:31], v[104:107], v[20:23], a[16:31]
  v_mfma_f32_32x32x16_bf16 a[32:47], v[24:27], v[104:107], a[32:47]
  ds_read_b64_tr_b16 v[16:17], v8 offset:4096
  ds_read_b64_tr_b16 v[18:19], v8 offset:4352
  ds_read_b64_tr_b16 v[20:21], v10 offset:4096
  ds_read_b64_tr_b16 v[22:23], v10 offset:4352
  ds_read_b64_tr_b16 v[24:25], v12 offset:4096
  ds_read_b64_tr_b16 v[26:27], v12 offset:4352
  s_waitcnt vmcnt(36) lgkmcnt(6)
  v_mfma_f32_32x32x16_bf16 a[0:15], v[28:31], v[108:111], a[0:15]
  v_mfma_f32_32x32x16_bf16 a[16:31], v[108:111], v[32:35], a[16:31]
  v_mfma_f32_32x32x16_bf16 a[32:47], v[36:39], v[108:111], a[32:47]
  ds_read_b64_tr_b16 v[28:29], v8 offset:5120
  ds_read_b64_tr_b16 v[30:31], v8 offset:5376
  ds_read_b64_tr_b16 v[32:33], v10 offset:5120
  ds_read_b64_tr_b16 v[34:35], v10 offset:5376
  ds_read_b64_tr_b16 v[36:37], v12 offset:5120
  ds_read_b64_tr_b16 v[38:39], v12 offset:5376
  s_waitcnt vmcnt(35) lgkmcnt(6)
  v_mfma_f32_32x32x16_bf16 a[0:15], v[16:19], v[112:115], a[0:15]
  v_mfma_f32_32x32x16_bf16 a[16:31], v[112:115], v[20:23], a[16:31]
  v_mfma_f32_32x32x16_bf16 a[32:47], v[24:27], v[112:115], a[32:47]
  ds_read_b64_tr_b16 v[16:17], v8 offset:6144
  ds_read_b64_tr_b16 v[18:19], v8 offset:6400
  ds_read_b64_tr_b16 v[20:21], v10 offset:6144
  ds_read_b64_tr_b16 v[22:23], v10 offset:6400
  ds_read_b64_tr_b16 v[24:25], v12 offset:6144
  ds_read_b64_tr_b16 v[26:27], v12 offset:6400
  s_waitcnt vmcnt(34) lgkmcnt(6)
  v_mfma_f32_32x32x16_bf16 a[0:15], v[28:31], v[116:119], a[0:15]
  v_mfma_f32_32x32x16_bf16 a[16:31], v[116:119], v[32:35], a[16:31]
  v_mfma_f32_32x32x16_bf16 a[32:47], v[36:39], v[116:119], a[32:47]
  ds_read_b64_tr_b16 v[28:29], v8 offset:7168
  ds_read_b64_tr_b16 v[30:31], v8 offset:7424
  ds_read_b64_tr_b16 v[32:33], v10 offset:7168
  ds_read_b64_tr_b16 v[34:35], v10 offset:7424
  ds_read_b64_tr_b16 v[36:37], v12 offset:7168
  ds_read_b64_tr_b16 v[38:39], v12 offset:7424
  s_waitcnt vmcnt(33) lgkmcnt(6)
  v_mfma_f32_32x32x16_bf16 a[0:15], v[16:19], v[120:123], a[0:15]
  v_mfma_f32_32x32x16_bf16 a[16:31], v[120:123], v[20:23], a[16:31]
  v_mfma_f32_32x32x16_bf16 a[32:47], v[24:27], v[120:123], a[32:47]
  ds_read_b64_tr_b16 v[16:17], v8 offset:8192
  ds_read_b64_tr_b16 v[18:19], v8 offset:8448
  ds_read_b64_tr_b16 v[20:21], v10 offset:8192
  ds_read_b64_tr_b16 v[22:23], v10 offset:8448
  ds_read_b64_tr_b16 v[24:25], v12 offset:8192
  ds_read_b64_tr_b16 v[26:27], v12 offset:8448
  s_waitcnt vmcnt(32) lgkmcnt(6)
  v_mfma_f32_32x32x16_bf16 a[0:15], v[28:31], v[124:127], a[0:15]
  v_mfma_f32_32x32x16_bf16 a[16:31], v[124:127], v[32:35], a[16:31]
  v_mfma_f32_32x32x16_bf16 a[32:47], v[36:39], v[124:127], a[32:47]
  ds_read_b64_tr_b16 v[28:29], v8 offset:9216
  ds_read_b64_tr_b16 v[30:31], v8 offset:9472
  ds_read_b64_tr_b16 v[32:33], v10 offset:9216
  ds_read_b64_tr_b16 v[34:35], v10 offset:9472
  ds_read_b64_tr_b16 v[36:37], v12 offset:9216
  ds_read_b64_tr_b16 v[38:39], v12 offset:9472
  s_waitcnt vmcnt(31) lgkmcnt(6)
  v_mfma_f32_32x32x16_bf16 a[0:15], v[16:19], v[128:131], a[0:15]
  v_mfma_f32_32x32x16_bf16 a[16:31], v[128:131], v[20:23], a[16:31]
  v_mfma_f32_32x32x16_bf16 a[32:47], v[24:27], v[128:131], a[32:47]
  ds_read_b64_tr_b16 v[16:17], v8 offset:10240
  ds_read_b64_tr_b16 v[18:19], v8 offset:10496
  ds_read_b64_tr_b16 v[20:21], v10 offset:10240
  ds_read_b64_tr_b16 v[22:23], v10 offset:10496
  ds_read_b64_tr_b16 v[24:25], v12 offset:10240
  ds_read_b64_tr_b16 v[26:27], v12 offset:10496
  s_waitcnt vmcnt(30) lgkmcnt(6)
  v_mfma_f32_32x32x16_bf16 a[0:15], v[28:31], v[132:135], a[0:15]
  v_mfma_f32_32x32x16_bf16 a[16:31], v[132:135], v[32:35], a[16:31]
  v_mfma_f32_32x32x16_bf16 a[32:47], v[36:39], v[132:135], a[32:47]
  ds_read_b64_tr_b16 v[28:29], v8 offset:11264
  ds_read_b64_tr_b16 v[30:31], v8 offset:11520
  ds_read_b64_tr_b16 v[32:33], v10 offset:11264
  ds_read_b64_tr_b16 v[34:35], v10 offset:11520
  ds_read_b64_tr_b16 v[36:37], v12 offset:11264
  ds_read_b64_tr_b16 v[38:39], v12 offset:11520
  s_waitcnt vmcnt(29) lgkmcnt(6)
  v_mfma_f32_32x32x16_bf16 a[0:15], v[16:19], v[136:139], a[0:15]
  v_mfma_f32_32x32x16_bf16 a[16:31], v[136:139], v[20:23], a[16:31]
  v_mfma_f32_32x32x16_bf16 a[32:47], v[24:27], v[136:139], a[32:47]
  ds_read_b64_tr_b16 v[16:17], v8 offset:12288
  ds_read_b64_tr_b16 v[18:19], v8 offset:12544
  ds_read_b64_tr_b16 v[20:21], v10 offset:12288
  ds_read_b64_tr_b16 v[22:23], v10 offset:12544
  ds_read_b64_tr_b16 v[24:25], v12 offset:12288
  ds_read_b64_tr_b16 v[26:27], v12 offset:12544
  s_waitcnt vmcnt(28) lgkmcnt(6)
  v_mfma_f32_32x32x16_bf16 a[0:15], v[28:31], v[140:143], a[0:15]
  v_mfma_f32_32x32x16_bf16 a[16:31], v[140:143], v[32:35], a[16:31]
  v_mfma_f32_32x32x16_bf16 a[32:47], v[36:39], v[140:143], a[32:47]
  ds_read_b64_tr_b16 v[28:29], v8 offset:13312
  ds_read_b64_tr_b16 v[30:31], v8 offset:13568
  ds_read_b64_tr_b16 v[32:33], v10 offset:13312
  ds_read_b64_tr_b16 v[34:35], v10 offset:13568
  ds_read_b64_tr_b16 v[36:37], v12 offset:13312
  ds_read_b64_tr_b16 v[38:39], v12 offset:13568
  s_waitcnt vmcnt(27) lgkmcnt(6)
  v_mfma_f32_32x32x16_bf16 a[0:15], v[16:19], v[144:147], a[0:15]
  v_mfma_f32_32x32x16_bf16 a[16:31], v[144:147], v[20:23], a[16:31]
  v_mfma_f32_32x32x16_bf16 a[32:47], v[24:27], v[144:147], a[32:47]
  ds_read_b64_tr_b16 v[16:17], v8 offset:14336
  ds_read_b64_tr_b16 v[18:19], v8 offset:14592
  ds_read_b64_tr_b16 v[20:21], v10 offset:14336
  ds_read_b64_tr_b16 v[22:23], v10 offset:14592
  ds_read_b64_tr_b16 v[24:25], v12 offset:14336
  ds_read_b64_tr_b16 v[26:27], v12 offset:14592
  s_waitcnt vmcnt(26) lgkmcnt(6)
  v_mfma_f32_32x32x16_bf16 a[0:15], v[28:31], v[148:151], a[0:15]
  v_mfma_f32_32x32x16_bf16 a[16:31], v[148:151], v[32:35], a[16:31]
  v_mfma_f32_32x32x16_bf16 a[32:47], v[36:39], v[148:151], a[32:47]
  ds_read_b64_tr_b16 v[28:29], v8 offset:15360
  ds_read_b64_tr_b16 v[30:31], v8 offset:15616
  ds_read_b64_tr_b16 v[32:33], v10 offset:15360
  ds_read_b64_tr_b16 v[34:35], v10 offset:15616
  ds_read_b64_tr_b16 v[36:37], v12 offset:15360
  ds_read_b64_tr_b16 v[38:39], v12 offset:15616
  s_waitcnt vmcnt(25) lgkmcnt(6)
  v_mfma_f32_32x32x16_bf16 a[0:15], v[16:19], v[152:155], a[0:15]
  v_mfma_f32_32x32x16_bf16 a[16:31], v[152:155], v[20:23], a[16:31]
  v_mfma_f32_32x32x16_bf16 a[32:47], v[24:27], v[152:155], a[32:47]
  ds_read_b64_tr_b16 v[16:17], v8 offset:16384
  ds_read_b64_tr_b16 v[18:19], v8 offset:16640
  ds_read_b64_tr_b16 v[20:21], v10 offset:16384
  ds_read_b64_tr_b16 v[22:23], v10 offset:16640
  ds_read_b64_tr_b16 v[24:25], v12 offset:16384
  ds_read_b64_tr_b16 v[26:27], v12 offset:16640
  s_waitcnt vmcnt(24) lgkmcnt(6)
  v_mfma_f32_32x32x16_bf16 a[0:15], v[28:31], v[156:159], a[0:15]
  v_mfma_f32_32x32x16_bf16 a[16:31], v[156:159], v[32:35], a[16:31]
  v_mfma_f32_32x32x16_bf16 a[32:47], v[36:39], v[156:159], a[32:47]
  ds_read_b64_tr_b16 v[28:29], v8 offset:17408
  ds_read_b64_tr_b16 v[30:31], v8 offset:17664
  ds_read_b64_tr_b16 v[32:33], v10 offset:17408
  ds_read_b64_tr_b16 v[34:35], v10 offset:17664
  ds_read_b64_tr_b16 v[36:37], v12 offset:17408
  ds_read_b64_tr_b16 v[38:39], v12 offset:17664
  s_waitcnt vmcnt(23) lgkmcnt(6)
  v_mfma_f32_32x32x16_bf16 a[0:15], v[16:19], v[160:163], a[0:15]
  v_mfma_f32_32x32x16_bf16 a[16:31], v[160:163], v[20:23], a[16:31]
  v_mfma_f32_32x32x16_bf16 a[32:47], v[24:27], v[160:163], a[32:47]
  ds_read_b64_tr_b16 v[16:17], v8 offset:18432
  ds_read_b64_tr_b16 v[18:19], v8 offset:18688
  ds_read_b64_tr_b16 v[20:21], v10 offset:18432
  ds_read_b64_tr_b16 v[22:23], v10 offset:18688
  ds_read_b64_tr_b16 v[24:25], v12 offset:18432
  ds_read_b64_tr_b16 v[26:27], v12 offset:18688
  s_waitcnt vmcnt(22) lgkmcnt(6)
  v_mfma_f32_32x32x16_bf16 a[0:15], v[28:31], v[164:167], a[0:15]
  v_mfma_f32_32x32x16_bf16 a[16:31], v[164:167], v[32:35], a[16:31]
  v_mfma_f32_32x32x16_bf16 a[32:47], v[36:39], v[164:167], a[32:47]
  ds_read_b64_tr_b16 v[28:29], v8 offset:19456
  ds_read_b64_tr_b16 v[30:31], v8 offset:19712
  ds_read_b64_tr_b16 v[32:33], v10 offset:19456
  ds_read_b64_tr_b16 v[34:35], v10 offset:19712
  ds_read_b64_tr_b16 v[36:37], v12 offset:19456
  ds_read_b64_tr_b16 v[38:39], v12 offset:19712
  s_waitcnt vmcnt(21) lgkmcnt(6)
  v_mfma_f32_32x32x16_bf16 a[0:15], v[16:19], v[168:171], a[0:15]
  v_mfma_f32_32x32x16_bf16 a[16:31], v[168:171], v[20:23], a[16:31]
  v_mfma_f32_32x32x16_bf16 a[32:47], v[24:27], v[168:171], a[32:47]
  ds_read_b64_tr_b16 v[16:17], v8 offset:20480
  ds_read_b64_tr_b16 v[18:19], v8 offset:20736
  ds_read_b64_tr_b16 v[20:21], v10 offset:20480
  ds_read_b64_tr_b16 v[22:23], v10 offset:20736
  ds_read_b64_tr_b16 v[24:25], v12 offset:20480
  ds_read_b64_tr_b16 v[26:27], v12 offset:20736
  s_waitcnt vmcnt(20) lgkmcnt(6)
  v_mfma_f32_32x32x16_bf16 a[0:15], v[28:31], v[172:175], a[0:15]
  v_mfma_f32_32x32x16_bf16 a[16:31], v[172:175], v[32:35], a[16:31]
  v_mfma_f32_32x32x16_bf16 a[32:47], v[36:39], v[172:175], a[32:47]
  ds_read_b64_tr_b16 v[28:29], v8 offset:21504
  ds_read_b64_tr_b16 v[30:31], v8 offset:21760
  ds_read_b64_tr_b16 v[32:33], v10 offset:21504
  ds_read_b64_tr_b16 v[34:35], v10 offset:21760
  ds_read_b64_tr_b16 v[36:37], v12 offset:21504
  ds_read_b64_tr_b16 v[38:39], v12 offset:21760
  s_waitcnt vmcnt(19) lgkmcnt(6)
  v_mfma_f32_32x32x16_bf16 a[0:15], v[16:19], v[176:179], a[0:15]
  v_mfma_f32_32x32x16_bf16 a[16:31], v[176:179], v[20:23], a[16:31]
  v_mfma_f32_32x32x16_bf16 a[32:47], v[24:27], v[176:179], a[32:47]
  ds_read_b64_tr_b16 v[16:17], v8 offset:22528
  ds_read_b64_tr_b16 v[18:19], v8 offset:22784
  ds_read_b64_tr_b16 v[20:21], v10 offset:22528
  ds_read_b64_tr_b16 v[22:23], v10 offset:22784
  ds_read_b64_tr_b16 v[24:25], v12 offset:22528
  ds_read_b64_tr_b16 v[26:27], v12 offset:22784
  s_waitcnt vmcnt(18) lgkmcnt(6)
  v_mfma_f32_32x32x16_bf16 a[0:15], v[28:31], v[180:183], a[0:15]
  v_mfma_f32_32x32x16_bf16 a[16:31], v[180:183], v[32:35], a[16:31]
  v_mfma_f32_32x32x16_bf16 a[32:47], v[36:39], v[180:183], a[32:47]
  ds_read_b64_tr_b16 v[28:29], v8 offset:23552
  ds_read_b64_tr_b16 v[30:31], v8 offset:23808
  ds_read_b64_tr_b16 v[32:33], v10 offset:23552
  ds_read_b64_tr_b16 v[34:35], v10 offset:23808
  ds_read_b64_tr_b16 v[36:37], v12 offset:23552
  ds_read_b64_tr_b16 v[38:39], v12 offset:23808
  s_waitcnt vmcnt(17) lgkmcnt(6)
  v_mfma_f32_32x32x16_bf16 a[0:15], v[16:19], v[184:187], a[0:15]
  v_mfma_f32_32x32x16_bf16 a[16:31], v[184:187], v[20:23], a[16:31]
  v_mfma_f32_32x32x16_bf16 a[32:47], v[24:27], v[184:187], a[32:47]
  ds_read_b64_tr_b16 v[16:17], v8 offset:24576
  ds_read_b64_tr_b16 v[18:19], v8 offset:24832
  ds_read_b64_tr_b16 v[20:21], v10 offset:24576
  ds_read_b64_tr_b16 v[22:23], v10 offset:24832
  ds_read_b64_tr_b16 v[24:25], v12 offset:24576
  ds_read_b64_tr_b16 v[26:27], v12 offset:24832
  s_waitcnt vmcnt(16) lgkmcnt(6)
  v_mfma_f32_32x32x16_bf16 a[0:15], v[28:31], v[188:191], a[0:15]
  v_mfma_f32_32x32x16_bf16 a[16:31], v[188:191], v[32:35], a[16:31]
  v_mfma_f32_32x32x16_bf16 a[32:47], v[36:39], v[188:191], a[32:47]
  ds_read_b64_tr_b16 v[28:29], v8 offset:25600
  ds_read_b64_tr_b16 v[30:31], v8 offset:25856
  ds_read_b64_tr_b16 v[32:33], v10 offset:25600
  ds_read_b64_tr_b16 v[34:35], v10 offset:25856
  ds_read_b64_tr_b16 v[36:37], v12 offset:25600
  ds_read_b64_tr_b16 v[38:39], v12 offset:25856
  s_waitcnt vmcnt(15) lgkmcnt(6)
  v_mfma_f32_32x32x16_bf16 a[0:15], v[16:19], v[192:195], a[0:15]
  v_mfma_f32_32x32x16_bf16 a[16:31], v[192:195], v[20:23], a[16:31]
  v_mfma_f32_32x32x16_bf16 a[32:47], v[24:27], v[192:195], a[32:47]
  ds_read_b64_tr_b16 v[16:17], v8 offset:26624
  ds_read_b64_tr_b16 v[18:19], v8 offset:26880
  ds_read_b64_tr_b16 v[20:21], v10 offset:26624
  ds_read_b64_tr_b16 v[22:23], v10 offset:26880
  ds_read_b64_tr_b16 v[24:25], v12 offset:26624
  ds_read_b64_tr_b16 v[26:27], v12 offset:26880
  s_waitcnt vmcnt(14) lgkmcnt(6)
  v_mfma_f32_32x32x16_bf16 a[0:15], v[28:31], v[196:199], a[0:15]
  v_mfma_f32_32x32x16_bf16 a[16:31], v[196:199], v[32:35], a[16:31]
  v_mfma_f32_32x32x16_bf16 a[32:47], v[36:39], v[196:199], a[32:47]
  ds_read_b64_tr_b16 v[28:29], v8 offset:27648
  ds_read_b64_tr_b16 v[30:31], v8 offset:27904
  ds_read_b64_tr_b16 v[32:33], v10 offset:27648
  ds_read_b64_tr_b16 v[34:35], v10 offset:27904
  ds_read_b64_tr_b16 v[36:37], v12 offset:27648
  ds_read_b64_tr_b16 v[38:39], v12 offset:27904
  s_waitcnt vmcnt(13) lgkmcnt(6)
  v_mfma_f32_32x32x16_bf16 a[0:15], v[16:19], v[200:203], a[0:15]
  v_mfma_f32_32x32x16_bf16 a[16:31], v[200:203], v[20:23], a[16:31]
  v_mfma_f32_32x32x16_bf16 a[32:47], v[24:27], v[200:203], a[32:47]
  ds_read_b64_tr_b16 v[16:17], v8 offset:28672
  ds_read_b64_tr_b16 v[18:19], v8 offset:28928
  ds_read_b64_tr_b16 v[20:21], v10 offset:28672
  ds_read_b64_tr_b16 v[22:23], v10 offset:28928
  ds_read_b64_tr_b16 v[24:25], v12 offset:28672
  ds_read_b64_tr_b16 v[26:27], v12 offset:28928
  s_waitcnt vmcnt(12) lgkmcnt(6)
  v_mfma_f32_32x32x16_bf16 a[0:15], v[28:31], v[204:207], a[0:15]
  v_mfma_f32_32x32x16_bf16 a[16:31], v[204:207], v[32:35], a[16:31]
  v_mfma_f32_32x32x16_bf16 a[32:47], v[36:39], v[204:207], a[32:47]
  ds_read_b64_tr_b16 v[28:29], v8 offset:29696
  ds_read_b64_tr_b16 v[30:31], v8 offset:29952
  ds_read_b64_tr_b16 v[32:33], v10 offset:29696
  ds_read_b64_tr_b16 v[34:35], v10 offset:29952
  ds_read_b64_tr_b16 v[36:37], v12 offset:29696
  ds_read_b64_tr_b16 v[38:39], v12 offset:29952
  s_waitcnt vmcnt(11) lgkmcnt(6)
  v_mfma_f32_32x32x16_bf16 a[0:15], v[16:19], v[208:211], a[0:15]
  v_mfma_f32_32x32x16_bf16 a[16:31], v[208:211], v[20:23], a[16:31]
  v_mfma_f32_32x32x16_bf16 a[32:47], v[24:27], v[208:211], a[32:47]
  ds_read_b64_tr_b16 v[16:17], v8 offset:30720
  ds_read_b64_tr_b16 v[18:19], v8 offset:30976
  ds_read_b64_tr_b16 v[20:21], v10 offset:30720
  ds_read_b64_tr_b16 v[22:23], v10 offset:30976
  ds_read_b64_tr_b16 v[24:25], v12 offset:30720
  ds_read_b64_tr_b16 v[26:27], v12 offset:30976
  s_waitcnt vmcnt(10) lgkmcnt(6)
  v_mfma_f32_32x32x16_bf16 a[0:15], v[28:31], v[212:215], a[0:15]
  v_mfma_f32_32x32x16_bf16 a[16:31], v[212:215], v[32:35], a[16:31]
  v_mfma_f32_32x32x16_bf16 a[32:47], v[36:39], v[212:215], a[32:47]
  ds_read_b64_tr_b16 v[28:29], v8 offset:31744
  ds_read_b64_tr_b16 v[30:31], v8 offset:32000
  ds_read_b64_tr_b16 v[32:33], v10 offset:31744
  ds_read_b64_tr_b16 v[34:35], v10 offset:32000
  ds_read_b64_tr_b16 v[36:37], v12 offset:31744
  ds_read_b64_tr_b16 v[38:39], v12 offset:32000
  s_waitcnt vmcnt(9) lgkmcnt(6)
  v_mfma_f32_32x32x16_bf16 a[0:15], v[16:19], v[216:219], a[0:15]
  v_mfma_f32_32x32x16_bf16 a[16:31], v[216:219], v[20:23], a[16:31]
  v_mfma_f32_32x32x16_bf16 a[32:47], v[24:27], v[216:219], a[32:47]
  ds_read_b64_tr_b16 v[16:17], v8 offset:32768
  ds_read_b64_tr_b16 v[18:19], v8 offset:33024
  ds_read_b64_tr_b16 v[20:21], v10 offset:32768
  ds_read_b64_tr_b16 v[22:23], v10 offset:33024
  ds_read_b64_tr_b16 v[24:25], v12 offset:32768
  ds_read_b64_tr_b16 v[26:27], v12 offset:33024
  s_waitcnt vmcnt(8) lgkmcnt(6)
  v_mfma_f32_32x32x16_bf16 a[0:15], v[28:31], v[220:223], a[0:15]
  v_mfma_f32_32x32x16_bf16 a[16:31], v[220:223], v[32:35], a[16:31]
  v_mfma_f32_32x32x16_bf16 a[32:47], v[36:39], v[220:223], a[32:47]
  ds_read_b64_tr_b16 v[28:29], v8 offset:33792
  ds_read_b64_tr_b16 v[30:31], v8 offset:34048
  ds_read_b64_tr_b16 v[32:33], v10 offset:33792
  ds_read_b64_tr_b16 v[34:35], v10 offset:34048
  ds_read_b64_tr_b16 v[36:37], v12 offset:33792
  ds_read_b64_tr_b16 v[38:39], v12 offset:34048
  s_waitcnt vmcnt(7) lgkmcnt(6)
  v_mfma_f32_32x32x16_bf16 a[0:15], v[16:19], v[224:227], a[0:15]
  v_mfma_f32_32x32x16_bf16 a[16:31], v[224:227], v[20:23], a[16:31]
  v_mfma_f32_32x32x16_bf16 a[32:47], v[24:27], v[224:227], a[32:47]
  ds_read_b64_tr_b16 v[16:17], v8 offset:34816
  ds_read_b64_tr_b16 v[18:19], v8 offset:35072
  ds_read_b64_tr_b16 v[20:21], v10 offset:34816
  ds_read_b64_tr_b16 v[22:23], v10 offset:35072
  ds_read_b64_tr_b16 v[24:25], v12 offset:34816
  ds_read_b64_tr_b16 v[26:27], v12 offset:35072
  s_waitcnt vmcnt(6) lgkmcnt(6)
  v_mfma_f32_32x32x16_bf16 a[0:15], v[28:31], v[228:231], a[0:15]
  v_mfma_f32_32x32x16_bf16 a[16:31], v[228:231], v[32:35], a[16:31]
  v_mfma_f32_32x32x16_bf16 a[32:47], v[36:39], v[228:231], a[32:47]
  ds_read_b64_tr_b16 v[28:29], v8 offset:35840
  ds_read_b64_tr_b16 v[30:31], v8 offset:36096
  ds_read_b64_tr_b16 v[32:33], v10 offset:35840
  ds_read_b64_tr_b16 v[34:35], v10 offset:36096
  ds_read_b64_tr_b16 v[36:37], v12 offset:35840
  ds_read_b64_tr_b16 v[38:39], v12 offset:36096
  s_waitcnt vmcnt(5) lgkmcnt(6)
  v_mfma_f32_32x32x16_bf16 a[0:15], v[16:19], v[232:235], a[0:15]
  v_mfma_f32_32x32x16_bf16 a[16:31], v[232:235], v[20:23], a[16:31]
  v_mfma_f32_32x32x16_bf16 a[32:47], v[24:27], v[232:235], a[32:47]
  ds_read_b64_tr_b16 v[16:17], v8 offset:36864
  ds_read_b64_tr_b16 v[18:19], v8 offset:37120
  ds_read_b64_tr_b16 v[20:21], v10 offset:36864
  ds_read_b64_tr_b16 v[22:23], v10 offset:37120
  ds_read_b64_tr_b16 v[24:25], v12 offset:36864
  ds_read_b64_tr_b16 v[26:27], v12 offset:37120
  s_waitcnt vmcnt(4) lgkmcnt(6)
  v_mfma_f32_32x32x16_bf16 a[0:15], v[28:31], v[236:239], a[0:15]
  v_mfma_f32_32x32x16_bf16 a[16:31], v[236:239], v[32:35], a[16:31]
  v_mfma_f32_32x32x16_bf16 a[32:47], v[36:39], v[236:239], a[32:47]
  ds_read_b64_tr_b16 v[28:29], v8 offset:37888
  ds_read_b64_tr_b16 v[30:31], v8 offset:38144
  ds_read_b64_tr_b16 v[32:33], v10 offset:37888
  ds_read_b64_tr_b16 v[34:35], v10 offset:38144
  ds_read_b64_tr_b16 v[36:37], v12 offset:37888
  ds_read_b64_tr_b16 v[38:39], v12 offset:38144
  s_waitcnt vmcnt(3) lgkmcnt(6)
  v_mfma_f32_32x32x16_bf16 a[0:15], v[16:19], v[240:243], a[0:15]
  v_mfma_f32_32x32x16_bf16 a[16:31], v[240:243], v[20:23], a[16:31]
  v_mfma_f32_32x32x16_bf16 a[32:47], v[24:27], v[240:243], a[32:47]
  ds_read_b64_tr_b16 v[16:17], v8 offset:38912
  ds_read_b64_tr_b16 v[18:19], v8 offset:39168
  ds_read_b64_tr_b16 v[20:21], v10 offset:38912
  ds_read_b64_tr_b16 v[22:23], v10 offset:39168
  ds_read_b64_tr_b16 v[24:25], v12 offset:38912
  ds_read_b64_tr_b16 v[26:27], v12 offset:39168
  s_waitcnt vmcnt(2) lgkmcnt(6)
  v_mfma_f32_32x32x16_bf16 a[0:15], v[28:31], v[244:247], a[0:15]
  v_mfma_f32_32x32x16_bf16 a[16:31], v[244:247], v[32:35], a[16:31]
  v_mfma_f32_32x32x16_bf16 a[32:47], v[36:39], v[244:247], a[32:47]
  ds_read_b64_tr_b16 v[28:29], v8 offset:39936
  ds_read_b64_tr_b16 v[30:31], v8 offset:40192
  ds_read_b64_tr_b16 v[32:33], v10 offset:39936
  ds_read_b64_tr_b16 v[34:35], v10 offset:40192
  ds_read_b64_tr_b16 v[36:37], v12 offset:39936
  ds_read_b64_tr_b16 v[38:39], v12 offset:40192
  s_waitcnt vmcnt(1) lgkmcnt(6)
  v_mfma_f32_32x32x16_bf16 a[0:15], v[16:19], v[248:251], a[0:15]
  v_mfma_f32_32x32x16_bf16 a[16:31], v[248:251], v[20:23], a[16:31]
  v_mfma_f32_32x32x16_bf16 a[32:47], v[24:27], v[248:251], a[32:47]
  s_waitcnt vmcnt(0) lgkmcnt(0)
  v_mfma_f32_32x32x16_bf16 a[0:15], v[28:31], v[252:255], a[0:15]
  v_mfma_f32_32x32x16_bf16 a[16:31], v[252:255], v[32:35], a[16:31]
  v_mfma_f32_32x32x16_bf16 a[32:47], v[36:39], v[252:255], a[32:47]
  v_accvgpr_read_b32 v40, a0
  v_accvgpr_read_b32 v41, a1
  v_accvgpr_read_b32 v42, a2
  v_accvgpr_read_b32 v43, a3
  v_accvgpr_read_b32 v44, a4
  v_accvgpr_read_b32 v45, a5
  v_accvgpr_read_b32 v46, a6
  v_accvgpr_read_b32 v47, a7
  v_accvgpr_read_b32 v48, a8
  v_accvgpr_read_b32 v49, a9
  v_accvgpr_read_b32 v50, a10
  v_accvgpr_read_b32 v51, a11
  v_accvgpr_read_b32 v52, a12
  v_accvgpr_read_b32 v53, a13
  v_accvgpr_read_b32 v54, a14
  v_accvgpr_read_b32 v55, a15
  v_cvt_pk_bf16_f32 v56, v40, v41
  v_cvt_pk_bf16_f32 v57, v42, v43
  v_cvt_pk_bf16_f32 v58, v44, v45
  v_cvt_pk_bf16_f32 v59, v46, v47
  v_cvt_pk_bf16_f32 v60, v48, v49
  v_cvt_pk_bf16_f32 v61, v50, v51
  v_cvt_pk_bf16_f32 v62, v52, v53
  v_cvt_pk_bf16_f32 v63, v54, v55
  s_add_u32 s25, s28, 120586240
  buffer_store_dwordx4 v[56:59], v2, s[4:7], s25 offen sc1
  buffer_store_dwordx4 v[60:63], v2, s[4:7], s25 offen offset:1024 sc1
  v_accvgpr_read_b32 v40, a16
  v_accvgpr_read_b32 v41, a17
  v_accvgpr_read_b32 v42, a18
  v_accvgpr_read_b32 v43, a19
  v_accvgpr_read_b32 v44, a20
  v_accvgpr_read_b32 v45, a21
  v_accvgpr_read_b32 v46, a22
  v_accvgpr_read_b32 v47, a23
  v_accvgpr_read_b32 v48, a24
  v_accvgpr_read_b32 v49, a25
  v_accvgpr_read_b32 v50, a26
  v_accvgpr_read_b32 v51, a27
  v_accvgpr_read_b32 v52, a28
  v_accvgpr_read_b32 v53, a29
  v_accvgpr_read_b32 v54, a30
  v_accvgpr_read_b32 v55, a31
  v_cvt_pk_bf16_f32 v64, v40, v41
  v_cvt_pk_bf16_f32 v65, v42, v43
  v_cvt_pk_bf16_f32 v66, v44, v45
  v_cvt_pk_bf16_f32 v67, v46, v47
  v_cvt_pk_bf16_f32 v68, v48, v49
  v_cvt_pk_bf16_f32 v69, v50, v51
  v_cvt_pk_bf16_f32 v70, v52, v53
  v_cvt_pk_bf16_f32 v71, v54, v55
  s_add_u32 s25, s28, 137363456
  buffer_store_dwordx4 v[64:67], v7, s[4:7], s25 offen sc1
  buffer_store_dwordx4 v[68:71], v7, s[4:7], s25 offen offset:1024 sc1
  v_accvgpr_read_b32 v40, a32
  v_accvgpr_read_b32 v41, a33
  v_accvgpr_read_b32 v42, a34
  v_accvgpr_read_b32 v43, a35
  v_accvgpr_read_b32 v44, a36
  v_accvgpr_read_b32 v45, a37
  v_accvgpr_read_b32 v46, a38
  v_accvgpr_read_b32 v47, a39
  v_accvgpr_read_b32 v48, a40
  v_accvgpr_read_b32 v49, a41
  v_accvgpr_read_b32 v50, a42
  v_accvgpr_read_b32 v51, a43
  v_accvgpr_read_b32 v52, a44
  v_accvgpr_read_b32 v53, a45
  v_accvgpr_read_b32 v54, a46
  v_accvgpr_read_b32 v55, a47
  v_cvt_pk_bf16_f32 v72, v40, v41
  v_cvt_pk_bf16_f32 v73, v42, v43
  v_cvt_pk_bf16_f32 v74, v44, v45
  v_cvt_pk_bf16_f32 v75, v46, v47
  v_cvt_pk_bf16_f32 v76, v48, v49
  v_cvt_pk_bf16_f32 v77, v50, v51
  v_cvt_pk_bf16_f32 v78, v52, v53
  v_cvt_pk_bf16_f32 v79, v54, v55
  s_add_u32 s25, s28, 154140672
  buffer_store_dwordx4 v[72:75], v2, s[4:7], s25 offen sc1
  buffer_store_dwordx4 v[76:79], v2, s[4:7], s25 offen offset:1024 sc1
  s_add_u32 s28, s28, 1048576
  s_waitcnt vmcnt(0)
  s_barrier
  s_cmp_eq_u32 s17, 0
  s_cselect_b32 s25, s31, 2147479552
  s_mov_b64 exec, 1
  v_mov_b32 v4, 1
  buffer_atomic_add v4, off, s[4:7], s25
  s_mov_b64 exec, -1
  s_add_u32 s31, s31, 4
  s_add_u32 s22, s22, 1
  s_cmp_lt_u32 s22, 2
  s_cbranch_scc1 Lwqf_48
  s_mov_b32 s81, s27
  s_mov_b32 s82, s28
  s_mov_b32 s72, s31
  s_mov_b32 s73, s34
  v_lshrrev_b32 v3, 3, v0
  v_lshlrev_b32 v6, 9, v3
  v_and_b32 v3, 7, v0
  v_lshl_add_u32 v6, v3, 4, v6
  v_lshlrev_b32 v8, 4, v3
  v_add_u32 v8, 122880, v8
  s_lshl_b32 s24, s17, 2
  v_add_u32 v7, s24, v8
  s_cmp_lt_u32 s17, 2
  s_cselect_b32 s34, 1.0, 0
  s_mov_b32 s26, 0x60000000
  s_cselect_b32 s26, 32768, s26
  s_add_u32 s21, s51, 32
Llnf_50:
  s_lshr_b32 s24, s21, 4
  s_lshl_b32 s22, s24, 7
  s_add_u32 s24, s22, 3676160
  s_cmp_lg_u32 s17, 0
  s_cbranch_scc1 Lwf_51_ok
  v_mov_b32 v3, 0
Lwf_51:
  buffer_load_dword v4, v3, s[4:7], s24 offen sc1
  s_waitcnt vmcnt(0)
  v_readfirstlane_b32 s25, v4
  s_add_u32 s0, s0, 1
  s_cmp_ge_u32 s25, 10
  s_cbranch_scc1 Lwf_51_ok
  s_sleep 2
  s_cmp_lt_u32 s0, 1572864
  s_cbranch_scc1 Lwf_51
Lwf_51_ok:
  s_barrier
  s_lshr_b32 s27, s21, 2
  s_mul_i32 s27, s27, 40960
  s_and_b32 s24, s21, 3
  s_lshl_b32 s24, s24, 7
  s_add_u32 s27, s27, s24
  s_add_u32 s25, s27, 104857600
  buffer_load_dwordx4 v[12:15], v6, s[4:7], s25 offen sc1
  s_add_u32 s25, s27, 104873984
  buffer_load_dwordx4 v[16:19], v6, s[4:7], s25 offen sc1
  s_add_u32 s25, s27, s26
  s_add_u32 s25, s25, 104857600
  buffer_load_dwordx4 v[20:23], v6, s[4:7], s25 offen sc1
  s_waitcnt vmcnt(0)
  v_lshlrev_b32 v24, 16, v12
  v_and_b32 v25, 0xffff0000, v12
  v_lshlrev_b32 v26, 16, v13
  v_and_b32 v27, 0xffff0000, v13
  v_lshlrev_b32 v28, 16, v14
  v_and_b32 v29, 0xffff0000, v14
  v_lshlrev_b32 v30, 16, v15
  v_and_b32 v31, 0xffff0000, v15
  v_lshlrev_b32 v32, 16, v16
  v_and_b32 v33, 0xffff0000, v16
  v_lshlrev_b32 v34, 16, v17
  v_and_b32 v35, 0xffff0000, v17
  v_lshlrev_b32 v36, 16, v18
  v_and_b32 v37, 0xffff0000, v18
  v_lshlrev_b32 v38, 16, v19
  v_and_b32 v39, 0xffff0000, v19
  v_lshlrev_b32 v40, 16, v20
  v_and_b32 v41, 0xffff0000, v20
  v_lshlrev_b32 v42, 16, v21
  v_and_b32 v43, 0xffff0000, v21
  v_lshlrev_b32 v44, 16, v22
  v_and_b32 v45, 0xffff0000, v22
  v_lshlrev_b32 v46, 16, v23
  v_and_b32 v47, 0xffff0000, v23
  v_add_f32 v9, v24, v25
  v_add_f32 v10, v26, v27
  v_add_f32 v9, v9, v28
  v_add_f32 v10, v10, v29
  v_add_f32 v9, v9, v30
  v_add_f32 v10, v10, v31
  v_add_f32 v9, v9, v32
  v_add_f32 v10, v10, v33
  v_add_f32 v9, v9, v34
  v_add_f32 v10, v10, v35
  v_add_f32 v9, v9, v36
  v_add_f32 v10, v10, v37
  v_add_f32 v9, v9, v38
  v_add_f32 v10, v10, v39
  v_add_f32 v9, v9, v40
  v_add_f32 v10, v10, v41
  v_add_f32 v9, v9, v42
  v_add_f32 v10, v10, v43
  v_add_f32 v9, v9, v44
  v_add_f32 v10, v10, v45
  v_add_f32 v9, v9, v46
  v_add_f32 v10, v10, v47
  v_add_f32 v9, v9, v10
  s_nop 1
  v_add_f32_dpp v9, v9, v9 row_ror:8 row_mask:0xf bank_mask:0xf
  v_mov_b32 v10, v9
  s_nop 1
  v_permlane16_swap_b32 v9, v10
  v_add_f32 v9, v9, v10
  v_mov_b32 v10, v9
  s_nop 1
  v_permlane32_swap_b32 v9, v10
  v_add_f32 v9, v9, v10
  ds_write_b32 v7, v9 offset:0
  s_waitcnt lgkmcnt(0)
  s_barrier
  ds_read_b128 v[48:51], v8 offset:0
  s_waitcnt lgkmcnt(0)
  v_add_f32 v48, v48, v49
  v_add_f32 v50, v50, v51
  v_add_f32 v9, v48, v50
  v_mul_f32 v9, 0x3acccccd, v9
  v_mov_b32 v11, 0
  v_mov_b32 v52, 0
  v_sub_f32 v10, v24, v9
  v_fmac_f32 v11, v10, v10
  v_sub_f32 v10, v25, v9
  v_fmac_f32 v11, v10, v10
  v_sub_f32 v10, v26, v9
  v_fmac_f32 v11, v10, v10
  v_sub_f32 v10, v27, v9
  v_fmac_f32 v11, v10, v10
  v_sub_f32 v10, v28, v9
  v_fmac_f32 v11, v10, v10
  v_sub_f32 v10, v29, v9
  v_fmac_f32 v11, v10, v10
  v_sub_f32 v10, v30, v9
  v_fmac_f32 v11, v10, v10
  v_sub_f32 v10, v31, v9
  v_fmac_f32 v11, v10, v10
  v_sub_f32 v10, v32, v9
  v_fmac_f32 v11, v10, v10
  v_sub_f32 v10, v33, v9
  v_fmac_f32 v11, v10, v10
  v_sub_f32 v10, v34, v9
  v_fmac_f32 v11, v10, v10
  v_sub_f32 v10, v35, v9
  v_fmac_f32 v11, v10, v10
  v_sub_f32 v10, v36, v9
  v_fmac_f32 v11, v10, v10
  v_sub_f32 v10, v37, v9
  v_fmac_f32 v11, v10, v10
  v_sub_f32 v10, v38, v9
  v_fmac_f32 v11, v10, v10
  v_sub_f32 v10, v39, v9
  v_fmac_f32 v11, v10, v10
  v_sub_f32 v10, v40, v9
  v_fmac_f32 v52, v10, v10
  v_sub_f32 v10, v41, v9
  v_fmac_f32 v52, v10, v10
  v_sub_f32 v10, v42, v9
  v_fmac_f32 v52, v10, v10
  v_sub_f32 v10, v43, v9
  v_fmac_f32 v52, v10, v10
  v_sub_f32 v10, v44, v9
  v_fmac_f32 v52, v10, v10
  v_sub_f32 v10, v45, v9
  v_fmac_f32 v52, v10, v10
  v_sub_f32 v10, v46, v9
  v_fmac_f32 v52, v10, v10
  v_sub_f32 v10, v47, v9
  v_fmac_f32 v52, v10, v10
  v_fmac_f32 v11, s34, v52
  s_nop 1
  v_add_f32_dpp v11, v11, v11 row_ror:8 row_mask:0xf bank_mask:0xf
  v_mov_b32 v10, v11
  s_nop 1
  v_permlane16_swap_b32 v11, v10
  v_add_f32 v11, v11, v10
  v_mov_b32 v10, v11
  s_nop 1
  v_permlane32_swap_b32 v11, v10
  v_add_f32 v11, v11, v10
  ds_write_b32 v7, v11 offset:128
  s_waitcnt lgkmcnt(0)
  s_barrier
  ds_read_b128 v[48:51], v8 offset:128
  s_waitcnt lgkmcnt(0)
  v_add_f32 v48, v48, v49
  v_add_f32 v50, v50, v51
  v_add_f32 v11, v48, v50
  v_mul_f32 v11, 0x3acccccd, v11
  v_cvt_pk_bf16_f32 v9, v9, v9
  v_and_b32 v9, 0xffff0000, v9
  v_cvt_pk_bf16_f32 v11, v11, v11
  v_and_b32 v11, 0xffff0000, v11
  v_add_f32 v11, 0x3727c5ac, v11
  v_cvt_pk_bf16_f32 v11, v11, v11
  v_and_b32 v11, 0xffff0000, v11
  v_sqrt_f32 v11, v11
  s_nop 0
  v_cvt_pk_bf16_f32 v11, v11, v11
  v_and_b32 v11, 0xffff0000, v11
  v_rcp_f32 v11, v11
  v_sub_f32 v24, v24, v9
  v_sub_f32 v25, v25, v9
  v_cvt_pk_bf16_f32 v12, v24, v25
  v_sub_f32 v26, v26, v9
  v_sub_f32 v27, v27, v9
  v_cvt_pk_bf16_f32 v13, v26, v27
  v_sub_f32 v28, v28, v9
  v_sub_f32 v29, v29, v9
  v_cvt_pk_bf16_f32 v14, v28, v29
  v_sub_f32 v30, v30, v9
  v_sub_f32 v31, v31, v9
  v_cvt_pk_bf16_f32 v15, v30, v31
  v_sub_f32 v32, v32, v9
  v_sub_f32 v33, v33, v9
  v_cvt_pk_bf16_f32 v16, v32, v33
  v_sub_f32 v34, v34, v9
  v_sub_f32 v35, v35, v9
  v_cvt_pk_bf16_f32 v17, v34, v35
  v_sub_f32 v36, v36, v9
  v_sub_f32 v37, v37, v9
  v_cvt_pk_bf16_f32 v18, v36, v37
  v_sub_f32 v38, v38, v9
  v_sub_f32 v39, v39, v9
  v_cvt_pk_bf16_f32 v19, v38, v39
  v_sub_f32 v40, v40, v9
  v_sub_f32 v41, v41, v9
  v_cvt_pk_bf16_f32 v20, v40, v41
  v_sub_f32 v42, v42, v9
  v_sub_f32 v43, v43, v9
  v_cvt_pk_bf16_f32 v21, v42, v43
  v_sub_f32 v44, v44, v9
  v_sub_f32 v45, v45, v9
  v_cvt_pk_bf16_f32 v22, v44, v45
  v_sub_f32 v46, v46, v9
  v_sub_f32 v47, v47, v9
  v_cvt_pk_bf16_f32 v23, v46, v47
  v_lshlrev_b32 v24, 16, v12
  v_and_b32 v25, 0xffff0000, v12
  v_mul_f32 v24, v24, v11
  v_mul_f32 v25, v25, v11
  v_cvt_pk_bf16_f32 v12, v24, v25
  v_lshlrev_b32 v26, 16, v13
  v_and_b32 v27, 0xffff0000, v13
  v_mul_f32 v26, v26, v11
  v_mul_f32 v27, v27, v11
  v_cvt_pk_bf16_f32 v13, v26, v27
  v_lshlrev_b32 v28, 16, v14
  v_and_b32 v29, 0xffff0000, v14
  v_mul_f32 v28, v28, v11
  v_mul_f32 v29, v29, v11
  v_cvt_pk_bf16_f32 v14, v28, v29
  v_lshlrev_b32 v30, 16, v15
  v_and_b32 v31, 0xffff0000, v15
  v_mul_f32 v30, v30, v11
  v_mul_f32 v31, v31, v11
  v_cvt_pk_bf16_f32 v15, v30, v31
  v_lshlrev_b32 v32, 16, v16
  v_and_b32 v33, 0xffff0000, v16
  v_mul_f32 v32, v32, v11
  v_mul_f32 v33, v33, v11
  v_cvt_pk_bf16_f32 v16, v32, v33
  v_lshlrev_b32 v34, 16, v17
  v_and_b32 v35, 0xffff0000, v17
  v_mul_f32 v34, v34, v11
  v_mul_f32 v35, v35, v11
  v_cvt_pk_bf16_f32 v17, v34, v35
  v_lshlrev_b32 v36, 16, v18
  v_and_b32 v37, 0xffff0000, v18
  v_mul_f32 v36, v36, v11
  v_mul_f32 v37, v37, v11
  v_cvt_pk_bf16_f32 v18, v36, v37
  v_lshlrev_b32 v38, 16, v19
  v_and_b32 v39, 0xffff0000, v19
  v_mul_f32 v38, v38, v11
  v_mul_f32 v39, v39, v11
  v_cvt_pk_bf16_f32 v19, v38, v39
  v_lshlrev_b32 v40, 16, v20
  v_and_b32 v41, 0xffff0000, v20
  v_mul_f32 v40, v40, v11
  v_mul_f32 v41, v41, v11
  v_cvt_pk_bf16_f32 v20, v40, v41
  v_lshlrev_b32 v42, 16, v21
  v_and_b32 v43, 0xffff0000, v21
  v_mul_f32 v42, v42, v11
  v_mul_f32 v43, v43, v11
  v_cvt_pk_bf16_f32 v21, v42, v43
  v_lshlrev_b32 v44, 16, v22
  v_and_b32 v45, 0xffff0000, v22
  v_mul_f32 v44, v44, v11
  v_mul_f32 v45, v45, v11
  v_cvt_pk_bf16_f32 v22, v44, v45
  v_lshlrev_b32 v46, 16, v23
  v_and_b32 v47, 0xffff0000, v23
  v_mul_f32 v46, v46, v11
  v_mul_f32 v47, v47, v11
  v_cvt_pk_bf16_f32 v23, v46, v47
  s_add_u32 s25, s27, 117440512
  buffer_store_dwordx4 v[12:15], v6, s[4:7], s25 offen sc1
  s_add_u32 s25, s27, 117456896
  buffer_store_dwordx4 v[16:19], v6, s[4:7], s25 offen sc1
  s_add_u32 s25, s27, s26
  s_add_u32 s25, s25, 117440512
  buffer_store_dwordx4 v[20:23], v6, s[4:7], s25 offen sc1
  s_add_u32 s24, s22, 3805184
  s_waitcnt vmcnt(0)
  s_barrier
  v_cmp_eq_u32 vcc, 0, v0
  s_nop 0
  s_and_saveexec_b64 s[32:33], vcc
  s_cbranch_execz Lsig_52
  v_mov_b32 v3, 0
  v_mov_b32 v4, 1
  buffer_atomic_add v4, v3, s[4:7], s24 offen
Lsig_52:
  s_mov_b64 exec, s[32:33]
  s_mov_b32 s27, s81
  s_mov_b32 s28, s82
  s_mov_b32 s31, s72
  s_mov_b32 s34, s73
  v_lshrrev_b32 v3, 5, v1
  v_mul_u32_u24 v3, 8, v3
  v_bfe_u32 v4, v1, 2, 2
  v_add_u32 v3, v3, v4
  v_mul_u32_u24 v8, 64, v3
  v_bfe_u32 v4, v1, 1, 1
  v_lshl_add_u32 v8, v4, 3, v8
  v_bfe_u32 v4, v1, 4, 1
  v_lshl_add_u32 v8, v4, 4, v8
  v_bfe_u32 v4, v1, 0, 1
  v_lshl_add_u32 v8, v4, 5, v8
  v_add_u32 v8, 0, v8
  v_lshrrev_b32 v3, 5, v1
  v_mul_u32_u24 v3, 8, v3
  v_bfe_u32 v4, v1, 2, 2
  v_add_u32 v3, v3, v4
  v_mul_u32_u24 v10, 64, v3
  v_bfe_u32 v4, v1, 0, 1
  v_lshl_add_u32 v10, v4, 3, v10
  v_bfe_u32 v4, v1, 1, 1
  v_lshl_add_u32 v10, v4, 4, v10
  v_bfe_u32 v4, v1, 4, 1
  v_lshl_add_u32 v10, v4, 5, v10
  v_add_u32 v10, 40960, v10
  v_lshrrev_b32 v3, 5, v1
  v_mul_u32_u24 v3, 8, v3
  v_bfe_u32 v4, v1, 2, 2
  v_add_u32 v3, v3, v4
  v_mul_u32_u24 v12, 64, v3
  v_bfe_u32 v4, v1, 1, 1
  v_lshl_add_u32 v12, v4, 3, v12
  v_bfe_u32 v4, v1, 0, 1
  v_lshl_add_u32 v12, v4, 4, v12
  v_bfe_u32 v4, v1, 4, 1
  v_lshl_add_u32 v12, v4, 5, v12
  v_add_u32 v12, 81920, v12
  v_lshrrev_b32 v3, 5, v1
  v_lshlrev_b32 v7, 9, v3
  v_bfe_u32 v3, v1, 1, 4
  v_lshl_add_u32 v7, v3, 4, v7
  v_and_b32 v3, 1, v1
  v_lshl_add_u32 v7, v3, 8, v7
  s_mov_b32 s22, 2
  s_add_u32 s24, s22, 0
  s_min_u32 s24, s24, 15
  s_cmp_lt_u32 s24, s74
  s_cbranch_scc1 Lxr_53_ok
  s_cmp_lg_u32 s17, 0
  s_cbranch_scc1 Lxr_53_w
  v_lshlrev_b32 v5, 7, v1
Lxr_53_sp:
  buffer_load_dword v3, v5, s[4:7], s34 offen sc1
  s_waitcnt vmcnt(0)
  v_cmp_le_u32 vcc, 16, v3
  s_add_u32 s0, s0, 1
  s_and_b32 s74, vcc_lo, 0xffff
  s_ff0_i32_b32 s74, s74
  s_cmp_lt_u32 s24, s74
  s_cbranch_scc1 Lxr_53_got
  s_sleep 2
  s_cmp_lt_u32 s0, 1572864
  s_cbranch_scc1 Lxr_53_sp
Lxr_53_got:
  v_mov_b32 v3, s74
  v_mov_b32 v5, 123392
  ds_write_b32 v5, v3
  s_waitcnt lgkmcnt(0)
Lxr_53_w:
  s_barrier
  v_mov_b32 v5, 123392
  ds_read_b32 v3, v5
  s_waitcnt lgkmcnt(0)
  v_readfirstlane_b32 s74, v3
  s_barrier
Lxr_53_ok:
  s_lshl_b32 s75, s30, 12
  s_add_u32 s75, s75, s27
  s_add_u32 s30, s30, 1
  s_cmp_eq_u32 s30, 10
  s_cselect_b32 s30, 0, s30
  buffer_load_dwordx4 v[96:99], v2, s[4:7], s75 offen offset:0 sc1
  buffer_load_dwordx4 v[100:103], v2, s[4:7], s75 offen offset:1024 sc1
  buffer_load_dwordx4 v[104:107], v2, s[4:7], s75 offen offset:2048 sc1
  buffer_load_dwordx4 v[108:111], v2, s[4:7], s75 offen offset:3072 sc1
  s_lshl_b32 s75, s30, 12
  s_add_u32 s75, s75, s27
  s_add_u32 s30, s30, 1
  s_cmp_eq_u32 s30, 10
  s_cselect_b32 s30, 0, s30
  buffer_load_dwordx4 v[112:115], v2, s[4:7], s75 offen offset:0 sc1
  buffer_load_dwordx4 v[116:119], v2, s[4:7], s75 offen offset:1024 sc1
  buffer_load_dwordx4 v[120:123], v2, s[4:7], s75 offen offset:2048 sc1
  buffer_load_dwordx4 v[124:127], v2, s[4:7], s75 offen offset:3072 sc1
  s_lshl_b32 s75, s30, 12
  s_add_u32 s75, s75, s27
  s_add_u32 s30, s30, 1
  s_cmp_eq_u32 s30, 10
  s_cselect_b32 s30, 0, s30
  buffer_load_dwordx4 v[128:131], v2, s[4:7], s75 offen offset:0 sc1
  buffer_load_dwordx4 v[132:135], v2, s[4:7], s75 offen offset:1024 sc1
  buffer_load_dwordx4 v[136:139], v2, s[4:7], s75 offen offset:2048 sc1
  buffer_load_dwordx4 v[140:143], v2, s[4:7], s75 offen offset:3072 sc1
  s_lshl_b32 s75, s30, 12
  s_add_u32 s75, s75, s27
  s_add_u32 s30, s30, 1
  s_cmp_eq_u32 s30, 10
  s_cselect_b32 s30, 0, s30
  buffer_load_dwordx4 v[144:147], v2, s[4:7], s75 offen offset:0 sc1
  buffer_load_dwordx4 v[148:151], v2, s[4:7], s75 offen offset:1024 sc1
  buffer_load_dwordx4 v[152:155], v2, s[4:7], s75 offen offset:2048 sc1
  buffer_load_dwordx4 v[156:159], v2, s[4:7], s75 offen offset:3072 sc1
  s_lshl_b32 s75, s30, 12
  s_add_u32 s75, s75, s27
  s_add_u32 s30, s30, 1
  s_cmp_eq_u32 s30, 10
  s_cselect_b32 s30, 0, s30
  buffer_load_dwordx4 v[160:163], v2, s[4:7], s75 offen offset:0 sc1
  buffer_load_dwordx4 v[164:167], v2, s[4:7], s75 offen offset:1024 sc1
  buffer_load_dwordx4 v[168:171], v2, s[4:7], s75 offen offset:2048 sc1
  buffer_load_dwordx4 v[172:175], v2, s[4:7], s75 offen offset:3072 sc1
  s_lshl_b32 s75, s30, 12
  s_add_u32 s75, s75, s27
  s_add_u32 s30, s30, 1
  s_cmp_eq_u32 s30, 10
  s_cselect_b32 s30, 0, s30
  buffer_load_dwordx4 v[176:179], v2, s[4:7], s75 offen offset:0 sc1
  buffer_load_dwordx4 v[180:183], v2, s[4:7], s75 offen offset:1024 sc1
  buffer_load_dwordx4 v[184:187], v2, s[4:7], s75 offen offset:2048 sc1
  buffer_load_dwordx4 v[188:191], v2, s[4:7], s75 offen offset:3072 sc1
  s_lshl_b32 s75, s30, 12
  s_add_u32 s75, s75, s27
  s_add_u32 s30, s30, 1
  s_cmp_eq_u32 s30, 10
  s_cselect_b32 s30, 0, s30
  buffer_load_dwordx4 v[192:195], v2, s[4:7], s75 offen offset:0 sc1
  buffer_load_dwordx4 v[196:199], v2, s[4:7], s75 offen offset:1024 sc1
  buffer_load_dwordx4 v[200:203], v2, s[4:7], s75 offen offset:2048 sc1
  buffer_load_dwordx4 v[204:207], v2, s[4:7], s75 offen offset:3072 sc1
  s_lshl_b32 s75, s30, 12
  s_add_u32 s75, s75, s27
  s_add_u32 s30, s30, 1
  s_cmp_eq_u32 s30, 10
  s_cselect_b32 s30, 0, s30
  buffer_load_dwordx4 v[208:211], v2, s[4:7], s75 offen offset:0 sc1
  buffer_load_dwordx4 v[212:215], v2, s[4:7], s75 offen offset:1024 sc1
  buffer_load_dwordx4 v[216:219], v2, s[4:7], s75 offen offset:2048 sc1
  buffer_load_dwordx4 v[220:223], v2, s[4:7], s75 offen offset:3072 sc1
  s_lshl_b32 s75, s30, 12
  s_add_u32 s75, s75, s27
  s_add_u32 s30, s30, 1
  s_cmp_eq_u32 s30, 10
  s_cselect_b32 s30, 0, s30
  buffer_load_dwordx4 v[224:227], v2, s[4:7], s75 offen offset:0 sc1
  buffer_load_dwordx4 v[228:231], v2, s[4:7], s75 offen offset:1024 sc1
  buffer_load_dwordx4 v[232:235], v2, s[4:7], s75 offen offset:2048 sc1
  buffer_load_dwordx4 v[236:239], v2, s[4:7], s75 offen offset:3072 sc1
  s_lshl_b32 s75, s30, 12
  s_add_u32 s75, s75, s27
  s_add_u32 s30, s30, 1
  s_cmp_eq_u32 s30, 10
  s_cselect_b32 s30, 0, s30
  buffer_load_dwordx4 v[240:243], v2, s[4:7], s75 offen offset:0 sc1
  buffer_load_dwordx4 v[244:247], v2, s[4:7], s75 offen offset:1024 sc1
  buffer_load_dwordx4 v[248:251], v2, s[4:7], s75 offen offset:2048 sc1
  buffer_load_dwordx4 v[252:255], v2, s[4:7], s75 offen offset:3072 sc1
  s_add_u32 s27, s27, 163840
  s_mov_b32 s25, 2147479552
  buffer_store_dword v3, off, s[4:7], s25
  buffer_store_dword v3, off, s[4:7], s25
  buffer_store_dword v3, off, s[4:7], s25
  buffer_store_dword v3, off, s[4:7], s25
  buffer_store_dword v3, off, s[4:7], s25
  buffer_store_dword v3, off, s[4:7], s25
Lwq_54:
  s_add_u32 s24, s22, 1
  s_min_u32 s24, s24, 15
  s_cmp_lt_u32 s24, s74
  s_cbranch_scc1 Lxr_55_ok
  s_cmp_lg_u32 s17, 0
  s_cbranch_scc1 Lxr_55_w
  v_lshlrev_b32 v5, 7, v1
Lxr_55_sp:
  buffer_load_dword v3, v5, s[4:7], s34 offen sc1
  s_waitcnt vmcnt(0)
  v_cmp_le_u32 vcc, 16, v3
  s_add_u32 s0, s0, 1
  s_and_b32 s74, vcc_lo, 0xffff
  s_ff0_i32_b32 s74, s74
  s_cmp_lt_u32 s24, s74
  s_cbranch_scc1 Lxr_55_got
  s_sleep 2
  s_cmp_lt_u32 s0, 1572864
  s_cbranch_scc1 Lxr_55_sp
Lxr_55_got:
  v_mov_b32 v3, s74
  v_mov_b32 v5, 123392
  ds_write_b32 v5, v3
  s_waitcnt lgkmcnt(0)
Lxr_55_w:
  s_barrier
  v_mov_b32 v5, 123392
  ds_read_b32 v3, v5
  s_waitcnt lgkmcnt(0)
  v_readfirstlane_b32 s74, v3
  s_barrier
Lxr_55_ok:
  s_cmp_eq_u32 s22, 15
  s_cselect_b32 s27, 2146430976, s27
  ds_read_b64_tr_b16 v[16:17], v8 offset:0
  ds_read_b64_tr_b16 v[18:19], v8 offset:256
  ds_read_b64_tr_b16 v[20:21], v10 offset:0
  ds_read_b64_tr_b16 v[22:23], v10 offset:256
  ds_read_b64_tr_b16 v[24:25], v12 offset:0
  ds_read_b64_tr_b16 v[26:27], v12 offset:256
  ds_read_b64_tr_b16 v[28:29], v8 offset:1024
  ds_read_b64_tr_b16 v[30:31], v8 offset:1280
  ds_read_b64_tr_b16 v[32:33], v10 offset:1024
  ds_read_b64_tr_b16 v[34:35], v10 offset:1280
  ds_read_b64_tr_b16 v[36:37], v12 offset:1024
  ds_read_b64_tr_b16 v[38:39], v12 offset:1280
  s_waitcnt vmcnt(45) lgkmcnt(6)
  v_mfma_f32_32x32x16_bf16 a[0:15], v[16:19], v[96:99], 0
  v_mfma_f32_32x32x16_bf16 a[16:31], v[96:99], v[20:23], 0
  v_mfma_f32_32x32x16_bf16 a[32:47], v[24:27], v[96:99], 0
  s_lshl_b32 s75, s30, 12
  s_add_u32 s75, s75, s27
  s_add_u32 s30, s30, 1
  s_cmp_eq_u32 s30, 10
  s_cselect_b32 s30, 0, s30
  buffer_load_dwordx4 v[96:99], v2, s[4:7], s75 offen offset:0 sc1
  ds_read_b64_tr_b16 v[16:17], v8 offset:2048
  ds_read_b64_tr_b16 v[18:19], v8 offset:2304
  ds_read_b64_tr_b16 v[20:21], v10 offset:2048
  ds_read_b64_tr_b16 v[22:23], v10 offset:2304
  ds_read_b64_tr_b16 v[24:25], v12 offset:2048
  ds_read_b64_tr_b16 v[26:27], v12 offset:2304
  s_waitcnt vmcnt(45) lgkmcnt(6)
  v_mfma_f32_32x32x16_bf16 a[0:15], v[28:31], v[100:103], a[0:15]
  v_mfma_f32_32x32x16_bf16 a[16:31], v[100:103], v[32:35], a[16:31]
  v_mfma_f32_32x32x16_bf16 a[32:47], v[36:39], v[100:103], a[32:47]
  buffer_load_dwordx4 v[100:103], v2, s[4:7], s75 offen offset:1024 sc1
  ds_read_b64_tr_b16 v[28:29], v8 offset:3072
  ds_read_b64_tr_b16 v[30:31], v8 offset:3328
  ds_read_b64_tr_b16 v[32:33], v10 offset:3072
  ds_read_b64_tr_b16 v[34:35], v10 offset:3328
  ds_read_b64_tr_b16 v[36:37], v12 offset:3072
  ds_read_b64_tr_b16 v[38:39], v12 offset:3328
  s_waitcnt vmcnt(45) lgkmcnt(6)
  v_mfma_f32_32x32x16_bf16 a[0:15], v[16:19], v[104:107], a[0:15]
  v_mfma_f32_32x32x16_bf16 a[16:31], v[104:107], v[20:23], a[16:31]
  v_mfma_f32_32x32x16_bf16 a[32:47], v[24:27], v[104:107], a[32:47]
  buffer_load_dwordx4 v[104:107], v2, s[4:7], s75 offen offset:2048 sc1
  ds_read_b64_tr_b16 v[16:17], v8 offset:4096
  ds_read_b64_tr_b16 v[18:19], v8 offset:4352
  ds_read_b64_tr_b16 v[20:21], v10 offset:4096
  ds_read_b64_tr_b16 v[22:23], v10 offset:4352
  ds_read_b64_tr_b16 v[24:25], v12 offset:4096
  ds_read_b64_tr_b16 v[26:27], v12 offset:4352
  s_waitcnt vmcnt(45) lgkmcnt(6)
  v_mfma_f32_32x32x16_bf16 a[0:15], v[28:31], v[108:111], a[0:15]
  v_mfma_f32_32x32x16_bf16 a[16:31], v[108:111], v[32:35], a[16:31]
  v_mfma_f32_32x32x16_bf16 a[32:47], v[36:39], v[108:111], a[32:47]
  buffer_load_dwordx4 v[108:111], v2, s[4:7], s75 offen offset:3072 sc1
  ds_read_b64_tr_b16 v[28:29], v8 offset:5120
  ds_read_b64_tr_b16 v[30:31], v8 offset:5376
  ds_read_b64_tr_b16 v[32:33], v10 offset:5120
  ds_read_b64_tr_b16 v[34:35], v10 offset:5376
  ds_read_b64_tr_b16 v[36:37], v12 offset:5120
  ds_read_b64_tr_b16 v[38:39], v12 offset:5376
  s_waitcnt vmcnt(45) lgkmcnt(6)
  v_mfma_f32_32x32x16_bf16 a[0:15], v[16:19], v[112:115], a[0:15]
  v_mfma_f32_32x32x16_bf16 a[16:31], v[112:115], v[20:23], a[16:31]
  v_mfma_f32_32x32x16_bf16 a[32:47], v[24:27], v[112:115], a[32:47]
  s_lshl_b32 s75, s30, 12
  s_add_u32 s75, s75, s27
  s_add_u32 s30, s30, 1
  s_cmp_eq_u32 s30, 10
  s_cselect_b32 s30, 0, s30
  buffer_load_dwordx4 v[112:115], v2, s[4:7], s75 offen offset:0 sc1
  ds_read_b64_tr_b16 v[16:17], v8 offset:6144
  ds_read_b64_tr_b16 v[18:19], v8 offset:6400
  ds_read_b64_tr_b16 v[20:21], v10 offset:6144
  ds_read_b64_tr_b16 v[22:23], v10 offset:6400
  ds_read_b64_tr_b16 v[24:25], v12 offset:6144
  ds_read_b64_tr_b16 v[26:27], v12 offset:6400
  s_waitcnt vmcnt(45) lgkmcnt(6)
  v_mfma_f32_32x32x16_bf16 a[0:15], v[28:31], v[116:119], a[0:15]
  v_mfma_f32_32x32x16_bf16 a[16:31], v[116:119], v[32:35], a[16:31]
  v_mfma_f32_32x32x16_bf16 a[32:47], v[36:39], v[116:119], a[32:47]
  buffer_load_dwordx4 v[116:119], v2, s[4:7], s75 offen offset:1024 sc1
  ds_read_b64_tr_b16 v[28:29], v8 offset:7168
  ds_read_b64_tr_b16 v[30:31], v8 offset:7424
  ds_read_b64_tr_b16 v[32:33], v10 offset:7168
  ds_read_b64_tr_b16 v[34:35], v10 offset:7424
  ds_read_b64_tr_b16 v[36:37], v12 offset:7168
  ds_read_b64_tr_b16 v[38:39], v12 offset:7424
  s_waitcnt vmcnt(45) lgkmcnt(6)
  v_mfma_f32_32x32x16_bf16 a[0:15], v[16:19], v[120:123], a[0:15]
  v_mfma_f32_32x32x16_bf16 a[16:31], v[120:123], v[20:23], a[16:31]
  v_mfma_f32_32x32x16_bf16 a[32:47], v[24:27], v[120:123], a[32:47]
  buffer_load_dwordx4 v[120:123], v2, s[4:7], s75 offen offset:2048 sc1
  ds_read_b64_tr_b16 v[16:17], v8 offset:8192
  ds_read_b64_tr_b16 v[18:19], v8 offset:8448
  ds_read_b64_tr_b16 v[20:21], v10 offset:8192
  ds_read_b64_tr_b16 v[22:23], v10 offset:8448
  ds_read_b64_tr_b16 v[24:25], v12 offset:8192
  ds_read_b64_tr_b16 v[26:27], v12 offset:8448
  s_waitcnt vmcnt(45) lgkmcnt(6)
  v_mfma_f32_32x32x16_bf16 a[0:15], v[28:31], v[124:127], a[0:15]
  v_mfma_f32_32x32x16_bf16 a[16:31], v[124:127], v[32:35], a[16:31]
  v_mfma_f32_32x32x16_bf16 a[32:47], v[36:39], v[124:127], a[32:47]
  buffer_load_dwordx4 v[124:127], v2, s[4:7], s75 offen offset:3072 sc1
  ds_read_b64_tr_b16 v[28:29], v8 offset:9216
  ds_read_b64_tr_b16 v[30:31], v8 offset:9472
  ds_read_b64_tr_b16 v[32:33], v10 offset:9216
  ds_read_b64_tr_b16 v[34:35], v10 offset:9472
  ds_read_b64_tr_b16 v[36:37], v12 offset:9216
  ds_read_b64_tr_b16 v[38:39], v12 offset:9472
  s_waitcnt vmcnt(45) lgkmcnt(6)
  v_mfma_f32_32x32x16_bf16 a[0:15], v[16:19], v[128:131], a[0:15]
  v_mfma_f32_32x32x16_bf16 a[16:31], v[128:131], v[20:23], a[16:31]
  v_mfma_f32_32x32x16_bf16 a[32:47], v[24:27], v[128:131], a[32:47]
  s_lshl_b32 s75, s30, 12
  s_add_u32 s75, s75, s27
  s_add_u32 s30, s30, 1
  s_cmp_eq_u32 s30, 10
  s_cselect_b32 s30, 0, s30
  buffer_load_dwordx4 v[128:131], v2, s[4:7], s75 offen offset:0 sc1
  ds_read_b64_tr_b16 v[16:17], v8 offset:10240
  ds_read_b64_tr_b16 v[18:19], v8 offset:10496
  ds_read_b64_tr_b16 v[20:21], v10 offset:10240
  ds_read_b64_tr_b16 v[22:23], v10 offset:10496
  ds_read_b64_tr_b16 v[24:25], v12 offset:10240
  ds_read_b64_tr_b16 v[26:27], v12 offset:10496
  s_waitcnt vmcnt(45) lgkmcnt(6)
  v_mfma_f32_32x32x16_bf16 a[0:15], v[28:31], v[132:135], a[0:15]
  v_mfma_f32_32x32x16_bf16 a[16:31], v[132:135], v[32:35], a[16:31]
  v_mfma_f32_32x32x16_bf16 a[32:47], v[36:39], v[132:135], a[32:47]
  buffer_load_dwordx4 v[132:135], v2, s[4:7], s75 offen offset:1024 sc1
  ds_read_b64_tr_b16 v[28:29], v8 offset:11264
  ds_read_b64_tr_b16 v[30:31], v8 offset:11520
  ds_read_b64_tr_b16 v[32:33], v10 offset:11264
  ds_read_b64_tr_b16 v[34:35], v10 offset:11520
  ds_read_b64_tr_b16 v[36:37], v12 offset:11264
  ds_read_b64_tr_b16 v[38:39], v12 offset:11520
  s_waitcnt vmcnt(45) lgkmcnt(6)
  v_mfma_f32_32x32x16_bf16 a[0:15], v[16:19], v[136:139], a[0:15]
  v_mfma_f32_32x32x16_bf16 a[16:31], v[136:139], v[20:23], a[16:31]
  v_mfma_f32_32x32x16_bf16 a[32:47], v[24:27], v[136:139], a[32:47]
  buffer_load_dwordx4 v[136:139], v2, s[4:7], s75 offen offset:2048 sc1
  ds_read_b64_tr_b16 v[16:17], v8 offset:12288
  ds_read_b64_tr_b16 v[18:19], v8 offset:12544
  ds_read_b64_tr_b16 v[20:21], v10 offset:12288
  ds_read_b64_tr_b16 v[22:23], v10 offset:12544
  ds_read_b64_tr_b16 v[24:25], v12 offset:12288
  ds_read_b64_tr_b16 v[26:27], v12 offset:12544
  s_waitcnt vmcnt(45) lgkmcnt(6)
  v_mfma_f32_32x32x16_bf16 a[0:15], v[28:31], v[140:143], a[0:15]
  v_mfma_f32_32x32x16_bf16 a[16:31], v[140:143], v[32:35], a[16:31]
  v_mfma_f32_32x32x16_bf16 a[32:47], v[36:39], v[140:143], a[32:47]
  buffer_load_dwordx4 v[140:143], v2, s[4:7], s75 offen offset:3072 sc1
  ds_read_b64_tr_b16 v[28:29], v8 offset:13312
  ds_read_b64_tr_b16 v[30:31], v8 offset:13568
  ds_read_b64_tr_b16 v[32:33], v10 offset:13312
  ds_read_b64_tr_b16 v[34:35], v10 offset:13568
  ds_read_b64_tr_b16 v[36:37], v12 offset:13312
  ds_read_b64_tr_b16 v[38:39], v12 offset:13568
  s_waitcnt vmcnt(45) lgkmcnt(6)
  v_mfma_f32_32x32x16_bf16 a[0:15], v[16:19], v[144:147], a[0:15]
  v_mfma_f32_32x32x16_bf16 a[16:31], v[144:147], v[20:23], a[16:31]
  v_mfma_f32_32x32x16_bf16 a[32:47], v[24:27], v[144:147], a[32:47]
  s_lshl_b32 s75, s30, 12
  s_add_u32 s75, s75, s27
  s_add_u32 s30, s30, 1
  s_cmp_eq_u32 s30, 10
  s_cselect_b32 s30, 0, s30
  buffer_load_dwordx4 v[144:147], v2, s[4:7], s75 offen offset:0 sc1
  ds_read_b64_tr_b16 v[16:17], v8 offset:14336
  ds_read_b64_tr_b16 v[18:19], v8 offset:14592
  ds_read_b64_tr_b16 v[20:21], v10 offset:14336
  ds_read_b64_tr_b16 v[22:23], v10 offset:14592
  ds_read_b64_tr_b16 v[24:25], v12 offset:14336
  ds_read_b64_tr_b16 v[26:27], v12 offset:14592
  s_waitcnt vmcnt(45) lgkmcnt(6)
  v_mfma_f32_32x32x16_bf16 a[0:15], v[28:31], v[148:151], a[0:15]
  v_mfma_f32_32x32x16_bf16 a[16:31], v[148:151], v[32:35], a[16:31]
  v_mfma_f32_32x32x16_bf16 a[32:47], v[36:39], v[148:151], a[32:47]
  buffer_load_dwordx4 v[148:151], v2, s[4:7], s75 offen offset:1024 sc1
  ds_read_b64_tr_b16 v[28:29], v8 offset:15360
  ds_read_b64_tr_b16 v[30:31], v8 offset:15616
  ds_read_b64_tr_b16 v[32:33], v10 offset:15360
  ds_read_b64_tr_b16 v[34:35], v10 offset:15616
  ds_read_b64_tr_b16 v[36:37], v12 offset:15360
  ds_read_b64_tr_b16 v[38:39], v12 offset:15616
  s_waitcnt vmcnt(45) lgkmcnt(6)
  v_mfma_f32_32x32x16_bf16 a[0:15], v[16:19], v[152:155], a[0:15]
  v_mfma_f32_32x32x16_bf16 a[16:31], v[152:155], v[20:23], a[16:31]
  v_mfma_f32_32x32x16_bf16 a[32:47], v[24:27], v[152:155], a[32:47]
  buffer_load_dwordx4 v[152:155], v2, s[4:7], s75 offen offset:2048 sc1
  ds_read_b64_tr_b16 v[16:17], v8 offset:16384
  ds_read_b64_tr_b16 v[18:19], v8 offset:16640
  ds_read_b64_tr_b16 v[20:21], v10 offset:16384
  ds_read_b64_tr_b16 v[22:23], v10 offset:16640
  ds_read_b64_tr_b16 v[24:25], v12 offset:16384
  ds_read_b64_tr_b16 v[26:27], v12 offset:16640
  s_waitcnt vmcnt(45) lgkmcnt(6)
  v_mfma_f32_32x32x16_bf16 a[0:15], v[28:31], v[156:159], a[0:15]
  v_mfma_f32_32x32x16_bf16 a[16:31], v[156:159], v[32:35], a[16:31]
  v_mfma_f32_32x32x16_bf16 a[32:47], v[36:39], v[156:159], a[32:47]
  buffer_load_dwordx4 v[156:159], v2, s[4:7], s75 offen offset:3072 sc1
  ds_read_b64_tr_b16 v[28:29], v8 offset:17408
  ds_read_b64_tr_b16 v[30:31], v8 offset:17664
  ds_read_b64_tr_b16 v[32:33], v10 offset:17408
  ds_read_b64_tr_b16 v[34:35], v10 offset:17664
  ds_read_b64_tr_b16 v[36:37], v12 offset:17408
  ds_read_b64_tr_b16 v[38:39], v12 offset:17664
  s_waitcnt vmcnt(45) lgkmcnt(6)
  v_mfma_f32_32x32x16_bf16 a[0:15], v[16:19], v[160:163], a[0:15]
  v_mfma_f32_32x32x16_bf16 a[16:31], v[160:163], v[20:23], a[16:31]
  v_mfma_f32_32x32x16_bf16 a[32:47], v[24:27], v[160:163], a[32:47]
  s_lshl_b32 s75, s30, 12
  s_add_u32 s75, s75, s27
  s_add_u32 s30, s30, 1
  s_cmp_eq_u32 s30, 10
  s_cselect_b32 s30, 0, s30
  buffer_load_dwordx4 v[160:163], v2, s[4:7], s75 offen offset:0 sc1
  ds_read_b64_tr_b16 v[16:17], v8 offset:18432
  ds_read_b64_tr_b16 v[18:19], v8 offset:18688
  ds_read_b64_tr_b16 v[20:21], v10 offset:18432
  ds_read_b64_tr_b16 v[22:23], v10 offset:18688
  ds_read_b64_tr_b16 v[24:25], v12 offset:18432
  ds_read_b64_tr_b16 v[26:27], v12 offset:18688
  s_waitcnt vmcnt(45) lgkmcnt(6)
  v_mfma_f32_32x32x16_bf16 a[0:15], v[28:31], v[164:167], a[0:15]
  v_mfma_f32_32x32x16_bf16 a[16:31], v[164:167], v[32:35], a[16:31]
  v_mfma_f32_32x32x16_bf16 a[32:47], v[36:39], v[164:167], a[32:47]
  buffer_load_dwordx4 v[164:167], v2, s[4:7], s75 offen offset:1024 sc1
  ds_read_b64_tr_b16 v[28:29], v8 offset:19456
  ds_read_b64_tr_b16 v[30:31], v8 offset:19712
  ds_read_b64_tr_b16 v[32:33], v10 offset:19456
  ds_read_b64_tr_b16 v[34:35], v10 offset:19712
  ds_read_b64_tr_b16 v[36:37], v12 offset:19456
  ds_read_b64_tr_b16 v[38:39], v12 offset:19712
  s_waitcnt vmcnt(45) lgkmcnt(6)
  v_mfma_f32_32x32x16_bf16 a[0:15], v[16:19], v[168:171], a[0:15]
  v_mfma_f32_32x32x16_bf16 a[16:31], v[168:171], v[20:23], a[16:31]
  v_mfma_f32_32x32x16_bf16 a[32:47], v[24:27], v[168:171], a[32:47]
  buffer_load_dwordx4 v[168:171], v2, s[4:7], s75 offen offset:2048 sc1
  ds_read_b64_tr_b16 v[16:17], v8 offset:20480
  ds_read_b64_tr_b16 v[18:19], v8 offset:20736
  ds_read_b64_tr_b16 v[20:21], v10 offset:20480
  ds_read_b64_tr_b16 v[22:23], v10 offset:20736
  ds_read_b64_tr_b16 v[24:25], v12 offset:20480
  ds_read_b64_tr_b16 v[26:27], v12 offset:20736
  s_waitcnt vmcnt(45) lgkmcnt(6)
  v_mfma_f32_32x32x16_bf16 a[0:15], v[28:31], v[172:175], a[0:15]
  v_mfma_f32_32x32x16_bf16 a[16:31], v[172:175], v[32:35], a[16:31]
  v_mfma_f32_32x32x16_bf16 a[32:47], v[36:39], v[172:175], a[32:47]
  buffer_load_dwordx4 v[172:175], v2, s[4:7], s75 offen offset:3072 sc1
  ds_read_b64_tr_b16 v[28:29], v8 offset:21504
  ds_read_b64_tr_b16 v[30:31], v8 offset:21760
  ds_read_b64_tr_b16 v[32:33], v10 offset:21504
  ds_read_b64_tr_b16 v[34:35], v10 offset:21760
  ds_read_b64_tr_b16 v[36:37], v12 offset:21504
  ds_read_b64_tr_b16 v[38:39], v12 offset:21760
  s_waitcnt vmcnt(45) lgkmcnt(6)
  v_mfma_f32_32x32x16_bf16 a[0:15], v[16:19], v[176:179], a[0:15]
  v_mfma_f32_32x32x16_bf16 a[16:31], v[176:179], v[20:23], a[16:31]
  v_mfma_f32_32x32x16_bf16 a[32:47], v[24:27], v[176:179], a[32:47]
  s_lshl_b32 s75, s30, 12
  s_add_u32 s75, s75, s27
  s_add_u32 s30, s30, 1
  s_cmp_eq_u32 s30, 10
  s_cselect_b32 s30, 0, s30
  buffer_load_dwordx4 v[176:179], v2, s[4:7], s75 offen offset:0 sc1
  ds_read_b64_tr_b16 v[16:17], v8 offset:22528
  ds_read_b64_tr_b16 v[18:19], v8 offset:22784
  ds_read_b64_tr_b16 v[20:21], v10 offset:22528
  ds_read_b64_tr_b16 v[22:23], v10 offset:22784
  ds_read_b64_tr_b16 v[24:25], v12 offset:22528
  ds_read_b64_tr_b16 v[26:27], v12 offset:22784
  s_waitcnt vmcnt(45) lgkmcnt(6)
  v_mfma_f32_32x32x16_bf16 a[0:15], v[28:31], v[180:183], a[0:15]
  v_mfma_f32_32x32x16_bf16 a[16:31], v[180:183], v[32:35], a[16:31]
  v_mfma_f32_32x32x16_bf16 a[32:47], v[36:39], v[180:183], a[32:47]
  buffer_load_dwordx4 v[180:183], v2, s[4:7], s75 offen offset:1024 sc1
  ds_read_b64_tr_b16 v[28:29], v8 offset:23552
  ds_read_b64_tr_b16 v[30:31], v8 offset:23808
  ds_read_b64_tr_b16 v[32:33], v10 offset:23552
  ds_read_b64_tr_b16 v[34:35], v10 offset:23808
  ds_read_b64_tr_b16 v[36:37], v12 offset:23552
  ds_read_b64_tr_b16 v[38:39], v12 offset:23808
  s_waitcnt vmcnt(45) lgkmcnt(6)
  v_mfma_f32_32x32x16_bf16 a[0:15], v[16:19], v[184:187], a[0:15]
  v_mfma_f32_32x32x16_bf16 a[16:31], v[184:187], v[20:23], a[16:31]
  v_mfma_f32_32x32x16_bf16 a[32:47], v[24:27], v[184:187], a[32:47]
  buffer_load_dwordx4 v[184:187], v2, s[4:7], s75 offen offset:2048 sc1
  ds_read_b64_tr_b16 v[16:17], v8 offset:24576
  ds_read_b64_tr_b16 v[18:19], v8 offset:24832
  ds_read_b64_tr_b16 v[20:21], v10 offset:24576
  ds_read_b64_tr_b16 v[22:23], v10 offset:24832
  ds_read_b64_tr_b16 v[24:25], v12 offset:24576
  ds_read_b64_tr_b16 v[26:27], v12 offset:24832
  s_waitcnt vmcnt(45) lgkmcnt(6)
  v_mfma_f32_32x32x16_bf16 a[0:15], v[28:31], v[188:191], a[0:15]
  v_mfma_f32_32x32x16_bf16 a[16:31], v[188:191], v[32:35], a[16:31]
  v_mfma_f32_32x32x16_bf16 a[32:47], v[36:39], v[188:191], a[32:47]
  buffer_load_dwordx4 v[188:191], v2, s[4:7], s75 offen offset:3072 sc1
  ds_read_b64_tr_b16 v[28:29], v8 offset:25600
  ds_read_b64_tr_b16 v[30:31], v8 offset:25856
  ds_read_b64_tr_b16 v[32:33], v10 offset:25600
  ds_read_b64_tr_b16 v[34:35], v10 offset:25856
  ds_read_b64_tr_b16 v[36:37], v12 offset:25600
  ds_read_b64_tr_b16 v[38:39], v12 offset:25856
  s_waitcnt vmcnt(45) lgkmcnt(6)
  v_mfma_f32_32x32x16_bf16 a[0:15], v[16:19], v[192:195], a[0:15]
  v_mfma_f32_32x32x16_bf16 a[16:31], v[192:195], v[20:23], a[16:31]
  v_mfma_f32_32x32x16_bf16 a[32:47], v[24:27], v[192:195], a[32:47]
  s_lshl_b32 s75, s30, 12
  s_add_u32 s75, s75, s27
  s_add_u32 s30, s30, 1
  s_cmp_eq_u32 s30, 10
  s_cselect_b32 s30, 0, s30
  buffer_load_dwordx4 v[192:195], v2, s[4:7], s75 offen offset:0 sc1
  ds_read_b64_tr_b16 v[16:17], v8 offset:26624
  ds_read_b64_tr_b16 v[18:19], v8 offset:26880
  ds_read_b64_tr_b16 v[20:21], v10 offset:26624
  ds_read_b64_tr_b16 v[22:23], v10 offset:26880
  ds_read_b64_tr_b16 v[24:25], v12 offset:26624
  ds_read_b64_tr_b16 v[26:27], v12 offset:26880
  s_waitcnt vmcnt(45) lgkmcnt(6)
  v_mfma_f32_32x32x16_bf16 a[0:15], v[28:31], v[196:199], a[0:15]
  v_mfma_f32_32x32x16_bf16 a[16:31], v[196:199], v[32:35], a[16:31]
  v_mfma_f32_32x32x16_bf16 a[32:47], v[36:39], v[196:199], a[32:47]
  buffer_load_dwordx4 v[196:199], v2, s[4:7], s75 offen offset:1024 sc1
  ds_read_b64_tr_b16 v[28:29], v8 offset:27648
  ds_read_b64_tr_b16 v[30:31], v8 offset:27904
  ds_read_b64_tr_b16 v[32:33], v10 offset:27648
  ds_read_b64_tr_b16 v[34:35], v10 offset:27904
  ds_read_b64_tr_b16 v[36:37], v12 offset:27648
  ds_read_b64_tr_b16 v[38:39], v12 offset:27904
  s_waitcnt vmcnt(45) lgkmcnt(6)
  v_mfma_f32_32x32x16_bf16 a[0:15], v[16:19], v[200:203], a[0:15]
  v_mfma_f32_32x32x16_bf16 a[16:31], v[200:203], v[20:23], a[16:31]
  v_mfma_f32_32x32x16_bf16 a[32:47], v[24:27], v[200:203], a[32:47]
  buffer_load_dwordx4 v[200:203], v2, s[4:7], s75 offen offset:2048 sc1
  ds_read_b64_tr_b16 v[16:17], v8 offset:28672
  ds_read_b64_tr_b16 v[18:19], v8 offset:28928
  ds_read_b64_tr_b16 v[20:21], v10 offset:28672
  ds_read_b64_tr_b16 v[22:23], v10 offset:28928
  ds_read_b64_tr_b16 v[24:25], v12 offset:28672
  ds_read_b64_tr_b16 v[26:27], v12 offset:28928
  s_waitcnt vmcnt(45) lgkmcnt(6)
  v_mfma_f32_32x32x16_bf16 a[0:15], v[28:31], v[204:207], a[0:15]
  v_mfma_f32_32x32x16_bf16 a[16:31], v[204:207], v[32:35], a[16:31]
  v_mfma_f32_32x32x16_bf16 a[32:47], v[36:39], v[204:207], a[32:47]
  buffer_load_dwordx4 v[204:207], v2, s[4:7], s75 offen offset:3072 sc1
  ds_read_b64_tr_b16 v[28:29], v8 offset:29696
  ds_read_b64_tr_b16 v[30:31], v8 offset:29952
  ds_read_b64_tr_b16 v[32:33], v10 offset:29696
  ds_read_b64_tr_b16 v[34:35], v10 offset:29952
  ds_read_b64_tr_b16 v[36:37], v12 offset:29696
  ds_read_b64_tr_b16 v[38:39], v12 offset:29952
  s_waitcnt vmcnt(45) lgkmcnt(6)
  v_mfma_f32_32x32x16_bf16 a[0:15], v[16:19], v[208:211], a[0:15]
  v_mfma_f32_32x32x16_bf16 a[16:31], v[208:211], v[20:23], a[16:31]
  v_mfma_f32_32x32x16_bf16 a[32:47], v[24:27], v[208:211], a[32:47]
  s_lshl_b32 s75, s30, 12
  s_add_u32 s75, s75, s27
  s_add_u32 s30, s30, 1
  s_cmp_eq_u32 s30, 10
  s_cselect_b32 s30, 0, s30
  buffer_load_dwordx4 v[208:211], v2, s[4:7], s75 offen offset:0 sc1
  ds_read_b64_tr_b16 v[16:17], v8 offset:30720
  ds_read_b64_tr_b16 v[18:19], v8 offset:30976
  ds_read_b64_tr_b16 v[20:21], v10 offset:30720
  ds_read_b64_tr_b16 v[22:23], v10 offset:30976
  ds_read_b64_tr_b16 v[24:25], v12 offset:30720
  ds_read_b64_tr_b16 v[26:27], v12 offset:30976
  s_waitcnt vmcnt(45) lgkmcnt(6)
  v_mfma_f32_32x32x16_bf16 a[0:15], v[28:31], v[212:215], a[0:15]
  v_mfma_f32_32x32x16_bf16 a[16:31], v[212:215], v[32:35], a[16:31]
  v_mfma_f32_32x32x16_bf16 a[32:47], v[36:39], v[212:215], a[32:47]
  buffer_load_dwordx4 v[212:215], v2, s[4:7], s75 offen offset:1024 sc1
  ds_read_b64_tr_b16 v[28:29], v8 offset:31744
  ds_read_b64_tr_b16 v[30:31], v8 offset:32000
  ds_read_b64_tr_b16 v[32:33], v10 offset:31744
  ds_read_b64_tr_b16 v[34:35], v10 offset:32000
  ds_read_b64_tr_b16 v[36:37], v12 offset:31744
  ds_read_b64_tr_b16 v[38:39], v12 offset:32000
  s_waitcnt vmcnt(45) lgkmcnt(6)
  v_mfma_f32_32x32x16_bf16 a[0:15], v[16:19], v[216:219], a[0:15]
  v_mfma_f32_32x32x16_bf16 a[16:31], v[216:219], v[20:23], a[16:31]
  v_mfma_f32_32x32x16_bf16 a[32:47], v[24:27], v[216:219], a[32:47]
  buffer_load_dwordx4 v[216:219], v2, s[4:7], s75 offen offset:2048 sc1
  ds_read_b64_tr_b16 v[16:17], v8 offset:32768
  ds_read_b64_tr_b16 v[18:19], v8 offset:33024
  ds_read_b64_tr_b16 v[20:21], v10 offset:32768
  ds_read_b64_tr_b16 v[22:23], v10 offset:33024
  ds_read_b64_tr_b16 v[24:25], v12 offset:32768
  ds_read_b64_tr_b16 v[26:27], v12 offset:33024
  s_waitcnt vmcnt(45) lgkmcnt(6)
  v_mfma_f32_32x32x16_bf16 a[0:15], v[28:31], v[220:223], a[0:15]
  v_mfma_f32_32x32x16_bf16 a[16:31], v[220:223], v[32:35], a[16:31]
  v_mfma_f32_32x32x16_bf16 a[32:47], v[36:39], v[220:223], a[32:47]
  buffer_load_dwordx4 v[220:223], v2, s[4:7], s75 offen offset:3072 sc1
  ds_read_b64_tr_b16 v[28:29], v8 offset:33792
  ds_read_b64_tr_b16 v[30:31], v8 offset:34048
  ds_read_b64_tr_b16 v[32:33], v10 offset:33792
  ds_read_b64_tr_b16 v[34:35], v10 offset:34048
  ds_read_b64_tr_b16 v[36:37], v12 offset:33792
  ds_read_b64_tr_b16 v[38:39], v12 offset:34048
  s_waitcnt vmcnt(45) lgkmcnt(6)
  v_mfma_f32_32x32x16_bf16 a[0:15], v[16:19], v[224:227], a[0:15]
  v_mfma_f32_32x32x16_bf16 a[16:31], v[224:227], v[20:23], a[16:31]
  v_mfma_f32_32x32x16_bf16 a[32:47], v[24:27], v[224:227], a[32:47]
  s_lshl_b32 s75, s30, 12
  s_add_u32 s75, s75, s27
  s_add_u32 s30, s30, 1
  s_cmp_eq_u32 s30, 10
  s_cselect_b32 s30, 0, s30
  buffer_load_dwordx4 v[224:227], v2, s[4:7], s75 offen offset:0 sc1
  ds_read_b64_tr_b16 v[16:17], v8 offset:34816
  ds_read_b64_tr_b16 v[18:19], v8 offset:35072
  ds_read_b64_tr_b16 v[20:21], v10 offset:34816
  ds_read_b64_tr_b16 v[22:23], v10 offset:35072
  ds_read_b64_tr_b16 v[24:25], v12 offset:34816
  ds_read_b64_tr_b16 v[26:27], v12 offset:35072
  s_waitcnt vmcnt(45) lgkmcnt(6)
  v_mfma_f32_32x32x16_bf16 a[0:15], v[28:31], v[228:231], a[0:15]
  v_mfma_f32_32x32x16_bf16 a[16:31], v[228:231], v[32:35], a[16:31]
  v_mfma_f32_32x32x16_bf16 a[32:47], v[36:39], v[228:231], a[32:47]
  buffer_load_dwordx4 v[228:231], v2, s[4:7], s75 offen offset:1024 sc1
  ds_read_b64_tr_b16 v[28:29], v8 offset:35840
  ds_read_b64_tr_b16 v[30:31], v8 offset:36096
  ds_read_b64_tr_b16 v[32:33], v10 offset:35840
  ds_read_b64_tr_b16 v[34:35], v10 offset:36096
  ds_read_b64_tr_b16 v[36:37], v12 offset:35840
  ds_read_b64_tr_b16 v[38:39], v12 offset:36096
  s_waitcnt vmcnt(45) lgkmcnt(6)
  v_mfma_f32_32x32x16_bf16 a[0:15], v[16:19], v[232:235], a[0:15]
  v_mfma_f32_32x32x16_bf16 a[16:31], v[232:235], v[20:23], a[16:31]
  v_mfma_f32_32x32x16_bf16 a[32:47], v[24:27], v[232:235], a[32:47]
  buffer_load_dwordx4 v[232:235], v2, s[4:7], s75 offen offset:2048 sc1
  ds_read_b64_tr_b16 v[16:17], v8 offset:36864
  ds_read_b64_tr_b16 v[18:19], v8 offset:37120
  ds_read_b64_tr_b16 v[20:21], v10 offset:36864
  ds_read_b64_tr_b16 v[22:23], v10 offset:37120
  ds_read_b64_tr_b16 v[24:25], v12 offset:36864
  ds_read_b64_tr_b16 v[26:27], v12 offset:37120
  s_waitcnt vmcnt(45) lgkmcnt(6)
  v_mfma_f32_32x32x16_bf16 a[0:15], v[28:31], v[236:239], a[0:15]
  v_mfma_f32_32x32x16_bf16 a[16:31], v[236:239], v[32:35], a[16:31]
  v_mfma_f32_32x32x16_bf16 a[32:47], v[36:39], v[236:239], a[32:47]
  buffer_load_dwordx4 v[236:239], v2, s[4:7], s75 offen offset:3072 sc1
  ds_read_b64_tr_b16 v[28:29], v8 offset:37888
  ds_read_b64_tr_b16 v[30:31], v8 offset:38144
  ds_read_b64_tr_b16 v[32:33], v10 offset:37888
  ds_read_b64_tr_b16 v[34:35], v10 offset:38144
  ds_read_b64_tr_b16 v[36:37], v12 offset:37888
  ds_read_b64_tr_b16 v[38:39], v12 offset:38144
  s_waitcnt vmcnt(45) lgkmcnt(6)
  v_mfma_f32_32x32x16_bf16 a[0:15], v[16:19], v[240:243], a[0:15]
  v_mfma_f32_32x32x16_bf16 a[16:31], v[240:243], v[20:23], a[16:31]
  v_mfma_f32_32x32x16_bf16 a[32:47], v[24:27], v[240:243], a[32:47]
  s_lshl_b32 s75, s30, 12
  s_add_u32 s75, s75, s27
  s_add_u32 s30, s30, 1
  s_cmp_eq_u32 s30, 10
  s_cselect_b32 s30, 0, s30
  buffer_load_dwordx4 v[240:243], v2, s[4:7], s75 offen offset:0 sc1
  ds_read_b64_tr_b16 v[16:17], v8 offset:38912
  ds_read_b64_tr_b16 v[18:19], v8 offset:39168
  ds_read_b64_tr_b16 v[20:21], v10 offset:38912
  ds_read_b64_tr_b16 v[22:23], v10 offset:39168
  ds_read_b64_tr_b16 v[24:25], v12 offset:38912
  ds_read_b64_tr_b16 v[26:27], v12 offset:39168
  s_waitcnt vmcnt(45) lgkmcnt(6)
  v_mfma_f32_32x32x16_bf16 a[0:15], v[28:31], v[244:247], a[0:15]
  v_mfma_f32_32x32x16_bf16 a[16:31], v[244:247], v[32:35], a[16:31]
  v_mfma_f32_32x32x16_bf16 a[32:47], v[36:39], v[244:247], a[32:47]
  buffer_load_dwordx4 v[244:247], v2, s[4:7], s75 offen offset:1024 sc1
  ds_read_b64_tr_b16 v[28:29], v8 offset:39936
  ds_read_b64_tr_b16 v[30:31], v8 offset:40192
  ds_read_b64_tr_b16 v[32:33], v10 offset:39936
  ds_read_b64_tr_b16 v[34:35], v10 offset:40192
  ds_read_b64_tr_b16 v[36:37], v12 offset:39936
  ds_read_b64_tr_b16 v[38:39], v12 offset:40192
  s_waitcnt vmcnt(45) lgkmcnt(6)
  v_mfma_f32_32x32x16_bf16 a[0:15], v[16:19], v[248:251], a[0:15]
  v_mfma_f32_32x32x16_bf16 a[16:31], v[248:251], v[20:23], a[16:31]
  v_mfma_f32_32x32x16_bf16 a[32:47], v[24:27], v[248:251], a[32:47]
  buffer_load_dwordx4 v[248:251], v2, s[4:7], s75 offen offset:2048 sc1
  s_cmp_eq_u32 s22, 2
  s_cbranch_scc1 Lwqs_56
  s_waitcnt vmcnt(39)
  s_barrier
  s_cmp_eq_u32 s17, 0
  s_cselect_b32 s25, s31, 2147479552
  s_mov_b64 exec, 1
  v_mov_b32 v4, 1
  buffer_atomic_add v4, off, s[4:7], s25
  s_mov_b64 exec, -1
  s_add_u32 s31, s31, 4
Lwqs_56:
  s_waitcnt vmcnt(45) lgkmcnt(0)
  v_mfma_f32_32x32x16_bf16 a[0:15], v[28:31], v[252:255], a[0:15]
  v_mfma_f32_32x32x16_bf16 a[16:31], v[252:255], v[32:35], a[16:31]
  v_mfma_f32_32x32x16_bf16 a[32:47], v[36:39], v[252:255], a[32:47]
  buffer_load_dwordx4 v[252:255], v2, s[4:7], s75 offen offset:3072 sc1
  s_add_u32 s27, s27, 163840
  v_accvgpr_read_b32 v40, a0
  v_accvgpr_read_b32 v41, a1
  v_accvgpr_read_b32 v42, a2
  v_accvgpr_read_b32 v43, a3
  v_accvgpr_read_b32 v44, a4
  v_accvgpr_read_b32 v45, a5
  v_accvgpr_read_b32 v46, a6
  v_accvgpr_read_b32 v47, a7
  v_accvgpr_read_b32 v48, a8
  v_accvgpr_read_b32 v49, a9
  v_accvgpr_read_b32 v50, a10
  v_accvgpr_read_b32 v51, a11
  v_accvgpr_read_b32 v52, a12
  v_accvgpr_read_b32 v53, a13
  v_accvgpr_read_b32 v54, a14
  v_accvgpr_read_b32 v55, a15
  v_cvt_pk_bf16_f32 v56, v40, v41
  v_cvt_pk_bf16_f32 v57, v42, v43
  v_cvt_pk_bf16_f32 v58, v44, v45
  v_cvt_pk_bf16_f32 v59, v46, v47
  v_cvt_pk_bf16_f32 v60, v48, v49
  v_cvt_pk_bf16_f32 v61, v50, v51
  v_cvt_pk_bf16_f32 v62, v52, v53
  v_cvt_pk_bf16_f32 v63, v54, v55
  s_add_u32 s25, s28, 120586240
  buffer_store_dwordx4 v[56:59], v2, s[4:7], s25 offen sc1
  buffer_store_dwordx4 v[60:63], v2, s[4:7], s25 offen offset:1024 sc1
  v_accvgpr_read_b32 v40, a16
  v_accvgpr_read_b32 v41, a17
  v_accvgpr_read_b32 v42, a18
  v_accvgpr_read_b32 v43, a19
  v_accvgpr_read_b32 v44, a20
  v_accvgpr_read_b32 v45, a21
  v_accvgpr_read_b32 v46, a22
  v_accvgpr_read_b32 v47, a23
  v_accvgpr_read_b32 v48, a24
  v_accvgpr_read_b32 v49, a25
  v_accvgpr_read_b32 v50, a26
  v_accvgpr_read_b32 v51, a27
  v_accvgpr_read_b32 v52, a28
  v_accvgpr_read_b32 v53, a29
  v_accvgpr_read_b32 v54, a30
  v_accvgpr_read_b32 v55, a31
  v_cvt_pk_bf16_f32 v64, v40, v41
  v_cvt_pk_bf16_f32 v65, v42, v43
  v_cvt_pk_bf16_f32 v66, v44, v45
  v_cvt_pk_bf16_f32 v67, v46, v47
  v_cvt_pk_bf16_f32 v68, v48, v49
  v_cvt_pk_bf16_f32 v69, v50, v51
  v_cvt_pk_bf16_f32 v70, v52, v53
  v_cvt_pk_bf16_f32 v71, v54, v55
  s_add_u32 s25, s28, 137363456
  buffer_store_dwordx4 v[64:67], v7, s[4:7], s25 offen sc1
  buffer_store_dwordx4 v[68:71], v7, s[4:7], s25 offen offset:1024 sc1
  v_accvgpr_read_b32 v40, a32
  v_accvgpr_read_b32 v41, a33
  v_accvgpr_read_b32 v42, a34
  v_accvgpr_read_b32 v43, a35
  v_accvgpr_read_b32 v44, a36
  v_accvgpr_read_b32 v45, a37
  v_accvgpr_read_b32 v46, a38
  v_accvgpr_read_b32 v47, a39
  v_accvgpr_read_b32 v48, a40
  v_accvgpr_read_b32 v49, a41
  v_accvgpr_read_b32 v50, a42
  v_accvgpr_read_b32 v51, a43
  v_accvgpr_read_b32 v52, a44
  v_accvgpr_read_b32 v53, a45
  v_accvgpr_read_b32 v54, a46
  v_accvgpr_read_b32 v55, a47
  v_cvt_pk_bf16_f32 v72, v40, v41
  v_cvt_pk_bf16_f32 v73, v42, v43
  v_cvt_pk_bf16_f32 v74, v44, v45
  v_cvt_pk_bf16_f32 v75, v46, v47
  v_cvt_pk_bf16_f32 v76, v48, v49
  v_cvt_pk_bf16_f32 v77, v50, v51
  v_cvt_pk_bf16_f32 v78, v52, v53
  v_cvt_pk_bf16_f32 v79, v54, v55
  s_add_u32 s25, s28, 154140672
  buffer_store_dwordx4 v[72:75], v2, s[4:7], s25 offen sc1
  buffer_store_dwordx4 v[76:79], v2, s[4:7], s25 offen offset:1024 sc1
  s_add_u32 s28, s28, 1048576
  s_add_u32 s22, s22, 1
  s_cmp_lt_u32 s22, 16
  s_cbranch_scc1 Lwq_54
  s_waitcnt vmcnt(0)
  s_barrier
  s_cmp_eq_u32 s17, 0
  s_cselect_b32 s25, s31, 2147479552
  s_mov_b64 exec, 1
  v_mov_b32 v4, 1
  buffer_atomic_add v4, off, s[4:7], s25
  s_mov_b64 exec, -1
  s_add_u32 s31, s31, 4
  s_branch mk_dq1
mk_nq1:
  v_lshrrev_b32 v3, 3, v0
  v_lshlrev_b32 v6, 9, v3
  v_and_b32 v3, 7, v0
  v_lshl_add_u32 v6, v3, 4, v6
  v_lshlrev_b32 v8, 4, v3
  v_add_u32 v8, 122880, v8
  s_lshl_b32 s24, s17, 2
  v_add_u32 v7, s24, v8
  s_cmp_lt_u32 s17, 2
  s_cselect_b32 s34, 1.0, 0
  s_mov_b32 s26, 0x60000000
  s_cselect_b32 s26, 32768, s26
  s_add_u32 s21, s51, 0
Llnf_57:
  s_lshr_b32 s24, s21, 4
  s_lshl_b32 s22, s24, 7
  s_add_u32 s24, s22, 3676160
  s_cmp_lg_u32 s17, 0
  s_cbranch_scc1 Lwf_58_ok
  v_mov_b32 v3, 0
Lwf_58:
  buffer_load_dword v4, v3, s[4:7], s24 offen sc1
  s_waitcnt vmcnt(0)
  v_readfirstlane_b32 s25, v4
  s_add_u32 s0, s0, 1
  s_cmp_ge_u32 s25, 10
  s_cbranch_scc1 Lwf_58_ok
  s_sleep 2
  s_cmp_lt_u32 s0, 1572864
  s_cbranch_scc1 Lwf_58
Lwf_58_ok:
  s_barrier
  s_lshr_b32 s27, s21, 2
  s_mul_i32 s27, s27, 40960
  s_and_b32 s24, s21, 3
  s_lshl_b32 s24, s24, 7
  s_add_u32 s27, s27, s24
  s_add_u32 s25, s27, 104857600
  buffer_load_dwordx4 v[12:15], v6, s[4:7], s25 offen sc1
  s_add_u32 s25, s27, 104873984
  buffer_load_dwordx4 v[16:19], v6, s[4:7], s25 offen sc1
  s_add_u32 s25, s27, s26
  s_add_u32 s25, s25, 104857600
  buffer_load_dwordx4 v[20:23], v6, s[4:7], s25 offen sc1
  s_waitcnt vmcnt(0)
  v_lshlrev_b32 v24, 16, v12
  v_and_b32 v25, 0xffff0000, v12
  v_lshlrev_b32 v26, 16, v13
  v_and_b32 v27, 0xffff0000, v13
  v_lshlrev_b32 v28, 16, v14
  v_and_b32 v29, 0xffff0000, v14
  v_lshlrev_b32 v30, 16, v15
  v_and_b32 v31, 0xffff0000, v15
  v_lshlrev_b32 v32, 16, v16
  v_and_b32 v33, 0xffff0000, v16
  v_lshlrev_b32 v34, 16, v17
  v_and_b32 v35, 0xffff0000, v17
  v_lshlrev_b32 v36, 16, v18
  v_and_b32 v37, 0xffff0000, v18
  v_lshlrev_b32 v38, 16, v19
  v_and_b32 v39, 0xffff0000, v19
  v_lshlrev_b32 v40, 16, v20
  v_and_b32 v41, 0xffff0000, v20
  v_lshlrev_b32 v42, 16, v21
  v_and_b32 v43, 0xffff0000, v21
  v_lshlrev_b32 v44, 16, v22
  v_and_b32 v45, 0xffff0000, v22
  v_lshlrev_b32 v46, 16, v23
  v_and_b32 v47, 0xffff0000, v23
  v_add_f32 v9, v24, v25
  v_add_f32 v10, v26, v27
  v_add_f32 v9, v9, v28
  v_add_f32 v10, v10, v29
  v_add_f32 v9, v9, v30
  v_add_f32 v10, v10, v31
  v_add_f32 v9, v9, v32
  v_add_f32 v10, v10, v33
  v_add_f32 v9, v9, v34
  v_add_f32 v10, v10, v35
  v_add_f32 v9, v9, v36
  v_add_f32 v10, v10, v37
  v_add_f32 v9, v9, v38
  v_add_f32 v10, v10, v39
  v_add_f32 v9, v9, v40
  v_add_f32 v10, v10, v41
  v_add_f32 v9, v9, v42
  v_add_f32 v10, v10, v43
  v_add_f32 v9, v9, v44
  v_add_f32 v10, v10, v45
  v_add_f32 v9, v9, v46
  v_add_f32 v10, v10, v47
  v_add_f32 v9, v9, v10
  s_nop 1
  v_add_f32_dpp v9, v9, v9 row_ror:8 row_mask:0xf bank_mask:0xf
  v_mov_b32 v10, v9
  s_nop 1
  v_permlane16_swap_b32 v9, v10
  v_add_f32 v9, v9, v10
  v_mov_b32 v10, v9
  s_nop 1
  v_permlane32_swap_b32 v9, v10
  v_add_f32 v9, v9, v10
  ds_write_b32 v7, v9 offset:0
  s_waitcnt lgkmcnt(0)
  s_barrier
  ds_read_b128 v[48:51], v8 offset:0
  s_waitcnt lgkmcnt(0)
  v_add_f32 v48, v48, v49
  v_add_f32 v50, v50, v51
  v_add_f32 v9, v48, v50
  v_mul_f32 v9, 0x3acccccd, v9
  v_mov_b32 v11, 0
  v_mov_b32 v52, 0
  v_sub_f32 v10, v24, v9
  v_fmac_f32 v11, v10, v10
  v_sub_f32 v10, v25, v9
  v_fmac_f32 v11, v10, v10
  v_sub_f32 v10, v26, v9
  v_fmac_f32 v11, v10, v10
  v_sub_f32 v10, v27, v9
  v_fmac_f32 v11, v10, v10
  v_sub_f32 v10, v28, v9
  v_fmac_f32 v11, v10, v10
  v_sub_f32 v10, v29, v9
  v_fmac_f32 v11, v10, v10
  v_sub_f32 v10, v30, v9
  v_fmac_f32 v11, v10, v10
  v_sub_f32 v10, v31, v9
  v_fmac_f32 v11, v10, v10
  v_sub_f32 v10, v32, v9
  v_fmac_f32 v11, v10, v10
  v_sub_f32 v10, v33, v9
  v_fmac_f32 v11, v10, v10
  v_sub_f32 v10, v34, v9
  v_fmac_f32 v11, v10, v10
  v_sub_f32 v10, v35, v9
  v_fmac_f32 v11, v10, v10
  v_sub_f32 v10, v36, v9
  v_fmac_f32 v11, v10, v10
  v_sub_f32 v10, v37, v9
  v_fmac_f32 v11, v10, v10
  v_sub_f32 v10, v38, v9
  v_fmac_f32 v11, v10, v10
  v_sub_f32 v10, v39, v9
  v_fmac_f32 v11, v10, v10
  v_sub_f32 v10, v40, v9
  v_fmac_f32 v52, v10, v10
  v_sub_f32 v10, v41, v9
  v_fmac_f32 v52, v10, v10
  v_sub_f32 v10, v42, v9
  v_fmac_f32 v52, v10, v10
  v_sub_f32 v10, v43, v9
  v_fmac_f32 v52, v10, v10
  v_sub_f32 v10, v44, v9
  v_fmac_f32 v52, v10, v10
  v_sub_f32 v10, v45, v9
  v_fmac_f32 v52, v10, v10
  v_sub_f32 v10, v46, v9
  v_fmac_f32 v52, v10, v10
  v_sub_f32 v10, v47, v9
  v_fmac_f32 v52, v10, v10
  v_fmac_f32 v11, s34, v52
  s_nop 1
  v_add_f32_dpp v11, v11, v11 row_ror:8 row_mask:0xf bank_mask:0xf
  v_mov_b32 v10, v11
  s_nop 1
  v_permlane16_swap_b32 v11, v10
  v_add_f32 v11, v11, v10
  v_mov_b32 v10, v11
  s_nop 1
  v_permlane32_swap_b32 v11, v10
  v_add_f32 v11, v11, v10
  ds_write_b32 v7, v11 offset:128
  s_waitcnt lgkmcnt(0)
  s_barrier
  ds_read_b128 v[48:51], v8 offset:128
  s_waitcnt lgkmcnt(0)
  v_add_f32 v48, v48, v49
  v_add_f32 v50, v50, v51
  v_add_f32 v11, v48, v50
  v_mul_f32 v11, 0x3acccccd, v11
  v_cvt_pk_bf16_f32 v9, v9, v9
  v_and_b32 v9, 0xffff0000, v9
  v_cvt_pk_bf16_f32 v11, v11, v11
  v_and_b32 v11, 0xffff0000, v11
  v_add_f32 v11, 0x3727c5ac, v11
  v_cvt_pk_bf16_f32 v11, v11, v11
  v_and_b32 v11, 0xffff0000, v11
  v_sqrt_f32 v11, v11
  s_nop 0
  v_cvt_pk_bf16_f32 v11, v11, v11
  v_and_b32 v11, 0xffff0000, v11
  v_rcp_f32 v11, v11
  v_sub_f32 v24, v24, v9
  v_sub_f32 v25, v25, v9
  v_cvt_pk_bf16_f32 v12, v24, v25
  v_sub_f32 v26, v26, v9
  v_sub_f32 v27, v27, v9
  v_cvt_pk_bf16_f32 v13, v26, v27
  v_sub_f32 v28, v28, v9
  v_sub_f32 v29, v29, v9
  v_cvt_pk_bf16_f32 v14, v28, v29
  v_sub_f32 v30, v30, v9
  v_sub_f32 v31, v31, v9
  v_cvt_pk_bf16_f32 v15, v30, v31
  v_sub_f32 v32, v32, v9
  v_sub_f32 v33, v33, v9
  v_cvt_pk_bf16_f32 v16, v32, v33
  v_sub_f32 v34, v34, v9
  v_sub_f32 v35, v35, v9
  v_cvt_pk_bf16_f32 v17, v34, v35
  v_sub_f32 v36, v36, v9
  v_sub_f32 v37, v37, v9
  v_cvt_pk_bf16_f32 v18, v36, v37
  v_sub_f32 v38, v38, v9
  v_sub_f32 v39, v39, v9
  v_cvt_pk_bf16_f32 v19, v38, v39
  v_sub_f32 v40, v40, v9
  v_sub_f32 v41, v41, v9
  v_cvt_pk_bf16_f32 v20, v40, v41
  v_sub_f32 v42, v42, v9
  v_sub_f32 v43, v43, v9
  v_cvt_pk_bf16_f32 v21, v42, v43
  v_sub_f32 v44, v44, v9
  v_sub_f32 v45, v45, v9
  v_cvt_pk_bf16_f32 v22, v44, v45
  v_sub_f32 v46, v46, v9
  v_sub_f32 v47, v47, v9
  v_cvt_pk_bf16_f32 v23, v46, v47
  v_lshlrev_b32 v24, 16, v12
  v_and_b32 v25, 0xffff0000, v12
  v_mul_f32 v24, v24, v11
  v_mul_f32 v25, v25, v11
  v_cvt_pk_bf16_f32 v12, v24, v25
  v_lshlrev_b32 v26, 16, v13
  v_and_b32 v27, 0xffff0000, v13
  v_mul_f32 v26, v26, v11
  v_mul_f32 v27, v27, v11
  v_cvt_pk_bf16_f32 v13, v26, v27
  v_lshlrev_b32 v28, 16, v14
  v_and_b32 v29, 0xffff0000, v14
  v_mul_f32 v28, v28, v11
  v_mul_f32 v29, v29, v11
  v_cvt_pk_bf16_f32 v14, v28, v29
  v_lshlrev_b32 v30, 16, v15
  v_and_b32 v31, 0xffff0000, v15
  v_mul_f32 v30, v30, v11
  v_mul_f32 v31, v31, v11
  v_cvt_pk_bf16_f32 v15, v30, v31
  v_lshlrev_b32 v32, 16, v16
  v_and_b32 v33, 0xffff0000, v16
  v_mul_f32 v32, v32, v11
  v_mul_f32 v33, v33, v11
  v_cvt_pk_bf16_f32 v16, v32, v33
  v_lshlrev_b32 v34, 16, v17
  v_and_b32 v35, 0xffff0000, v17
  v_mul_f32 v34, v34, v11
  v_mul_f32 v35, v35, v11
  v_cvt_pk_bf16_f32 v17, v34, v35
  v_lshlrev_b32 v36, 16, v18
  v_and_b32 v37, 0xffff0000, v18
  v_mul_f32 v36, v36, v11
  v_mul_f32 v37, v37, v11
  v_cvt_pk_bf16_f32 v18, v36, v37
  v_lshlrev_b32 v38, 16, v19
  v_and_b32 v39, 0xffff0000, v19
  v_mul_f32 v38, v38, v11
  v_mul_f32 v39, v39, v11
  v_cvt_pk_bf16_f32 v19, v38, v39
  v_lshlrev_b32 v40, 16, v20
  v_and_b32 v41, 0xffff0000, v20
  v_mul_f32 v40, v40, v11
  v_mul_f32 v41, v41, v11
  v_cvt_pk_bf16_f32 v20, v40, v41
  v_lshlrev_b32 v42, 16, v21
  v_and_b32 v43, 0xffff0000, v21
  v_mul_f32 v42, v42, v11
  v_mul_f32 v43, v43, v11
  v_cvt_pk_bf16_f32 v21, v42, v43
  v_lshlrev_b32 v44, 16, v22
  v_and_b32 v45, 0xffff0000, v22
  v_mul_f32 v44, v44, v11
  v_mul_f32 v45, v45, v11
  v_cvt_pk_bf16_f32 v22, v44, v45
  v_lshlrev_b32 v46, 16, v23
  v_and_b32 v47, 0xffff0000, v23
  v_mul_f32 v46, v46, v11
  v_mul_f32 v47, v47, v11
  v_cvt_pk_bf16_f32 v23, v46, v47
  s_add_u32 s25, s27, 117440512
  buffer_store_dwordx4 v[12:15], v6, s[4:7], s25 offen sc1
  s_add_u32 s25, s27, 117456896
  buffer_store_dwordx4 v[16:19], v6, s[4:7], s25 offen sc1
  s_add_u32 s25, s27, s26
  s_add_u32 s25, s25, 117440512
  buffer_store_dwordx4 v[20:23], v6, s[4:7], s25 offen sc1
  s_add_u32 s24, s22, 3805184
  s_waitcnt vmcnt(0)
  s_barrier
  v_cmp_eq_u32 vcc, 0, v0
  s_nop 0
  s_and_saveexec_b64 s[32:33], vcc
  s_cbranch_execz Lsig_59
  v_mov_b32 v3, 0
  v_mov_b32 v4, 1
  buffer_atomic_add v4, v3, s[4:7], s24 offen
Lsig_59:
  s_mov_b64 exec, s[32:33]
  s_cmp_lt_u32 s21, 32
  s_cselect_b32 s24, 160, 32
  s_add_u32 s21, s21, s24
  s_cmp_lt_u32 s21, 256
  s_cbranch_scc1 Llnf_57
mk_dq1:
  s_cmp_lt_u32 s50, 60
  s_cbranch_scc0 mk_nwo1
  s_mov_b32 s24, s50
  s_mul_i32 s22, s24, 3277
  s_lshr_b32 s22, s22, 16
  s_mul_i32 s25, s22, 20
  s_sub_u32 s23, s24, s25
  s_mov_b32 s8, s62
  s_and_b32 s9, s63, 0xffff
  s_mov_b32 s10, 5242880
  s_mov_b32 s11, 0x00020000
  v_lshrrev_b32 v3, 2, v1
  v_mul_u32_u24 v3, 0x500, v3
  v_and_b32 v4, 3, v1
  v_lshl_add_u32 v6, v4, 4, v3
  v_lshrrev_b32 v3, 5, v1
  v_mul_u32_u24 v3, 4, v3
  v_bfe_u32 v4, v1, 2, 2
  v_add_u32 v3, v3, v4
  v_mul_u32_u24 v7, 64, v3
  v_bfe_u32 v4, v1, 1, 1
  v_lshl_add_u32 v7, v4, 3, v7
  v_bfe_u32 v4, v1, 4, 1
  v_lshl_add_u32 v7, v4, 4, v7
  v_bfe_u32 v4, v1, 0, 1
  v_lshl_add_u32 v7, v4, 5, v7
  s_lshl_b32 s26, s17, 15
  v_add_u32 v7, s26, v7
  s_mul_i32 s28, s17, 1310720
  s_lshl_b32 s25, s23, 6
  s_add_u32 s28, s28, s25
  s_add_u32 m0, s26, 0
  s_nop 0
  buffer_load_dwordx4 v6, s[8:11], s28 offen lds
  s_add_u32 s28, s28, 20480
  s_add_u32 m0, s26, 1024
  s_nop 0
  buffer_load_dwordx4 v6, s[8:11], s28 offen lds
  s_add_u32 s28, s28, 20480
  s_add_u32 m0, s26, 2048
  s_nop 0
  buffer_load_dwordx4 v6, s[8:11], s28 offen lds
  s_add_u32 s28, s28, 20480
  s_add_u32 m0, s26, 3072
  s_nop 0
  buffer_load_dwordx4 v6, s[8:11], s28 offen lds
  s_add_u32 s28, s28, 20480
  s_add_u32 m0, s26, 4096
  s_nop 0
  buffer_load_dwordx4 v6, s[8:11], s28 offen lds
  s_add_u32 s28, s28, 20480
  s_add_u32 m0, s26, 5120
  s_nop 0
  buffer_load_dwordx4 v6, s[8:11], s28 offen lds
  s_add_u32 s28, s28, 20480
  s_add_u32 m0, s26, 6144
  s_nop 0
  buffer_load_dwordx4 v6, s[8:11], s28 offen lds
  s_add_u32 s28, s28, 20480
  s_add_u32 m0, s26, 7168
  s_nop 0
  buffer_load_dwordx4 v6, s[8:11], s28 offen lds
  s_add_u32 s28, s28, 20480
  s_add_u32 m0, s26, 8192
  s_nop 0
  buffer_load_dwordx4 v6, s[8:11], s28 offen lds
  s_add_u32 s28, s28, 20480
  s_add_u32 m0, s26, 9216
  s_nop 0
  buffer_load_dwordx4 v6, s[8:11], s28 offen lds
  s_add_u32 s28, s28, 20480
  s_add_u32 m0, s26, 10240
  s_nop 0
  buffer_load_dwordx4 v6, s[8:11], s28 offen lds
  s_add_u32 s28, s28, 20480
  s_add_u32 m0, s26, 11264
  s_nop 0
  buffer_load_dwordx4 v6, s[8:11], s28 offen lds
  s_add_u32 s28, s28, 20480
  s_add_u32 m0, s26, 12288
  s_nop 0
  buffer_load_dwordx4 v6, s[8:11], s28 offen lds
  s_add_u32 s28, s28, 20480
  s_add_u32 m0, s26, 13312
  s_nop 0
  buffer_load_dwordx4 v6, s[8:11], s28 offen lds
  s_add_u32 s28, s28, 20480
  s_add_u32 m0, s26, 14336
  s_nop 0
  buffer_load_dwordx4 v6, s[8:11], s28 offen lds
  s_add_u32 s28, s28, 20480
  s_add_u32 m0, s26, 15360
  s_nop 0
  buffer_load_dwordx4 v6, s[8:11], s28 offen lds
  s_add_u32 s28, s28, 20480
  s_add_u32 m0, s26, 16384
  s_nop 0
  buffer_load_dwordx4 v6, s[8:11], s28 offen lds
  s_add_u32 s28, s28, 20480
  s_add_u32 m0, s26, 17408
  s_nop 0
  buffer_load_dwordx4 v6, s[8:11], s28 offen lds
  s_add_u32 s28, s28, 20480
  s_add_u32 m0, s26, 18432
  s_nop 0
  buffer_load_dwordx4 v6, s[8:11], s28 offen lds
  s_add_u32 s28, s28, 20480
  s_add_u32 m0, s26, 19456
  s_nop 0
  buffer_load_dwordx4 v6, s[8:11], s28 offen lds
  s_add_u32 s28, s28, 20480
  s_add_u32 m0, s26, 20480
  s_nop 0
  buffer_load_dwordx4 v6, s[8:11], s28 offen lds
  s_add_u32 s28, s28, 20480
  s_add_u32 m0, s26, 21504
  s_nop 0
  buffer_load_dwordx4 v6, s[8:11], s28 offen lds
  s_add_u32 s28, s28, 20480
  s_add_u32 m0, s26, 22528
  s_nop 0
  buffer_load_dwordx4 v6, s[8:11], s28 offen lds
  s_add_u32 s28, s28, 20480
  s_add_u32 m0, s26, 23552
  s_nop 0
  buffer_load_dwordx4 v6, s[8:11], s28 offen lds
  s_add_u32 s28, s28, 20480
  s_add_u32 m0, s26, 24576
  s_nop 0
  buffer_load_dwordx4 v6, s[8:11], s28 offen lds
  s_add_u32 s28, s28, 20480
  s_add_u32 m0, s26, 25600
  s_nop 0
  buffer_load_dwordx4 v6, s[8:11], s28 offen lds
  s_add_u32 s28, s28, 20480
  s_add_u32 m0, s26, 26624
  s_nop 0
  buffer_load_dwordx4 v6, s[8:11], s28 offen lds
  s_add_u32 s28, s28, 20480
  s_add_u32 m0, s26, 27648
  s_nop 0
  buffer_load_dwordx4 v6, s[8:11], s28 offen lds
  s_add_u32 s28, s28, 20480
  s_add_u32 m0, s26, 28672
  s_nop 0
  buffer_load_dwordx4 v6, s[8:11], s28 offen lds
  s_add_u32 s28, s28, 20480
  s_add_u32 m0, s26, 29696
  s_nop 0
  buffer_load_dwordx4 v6, s[8:11], s28 offen lds
  s_add_u32 s28, s28, 20480
  s_add_u32 m0, s26, 30720
  s_nop 0
  buffer_load_dwordx4 v6, s[8:11], s28 offen lds
  s_add_u32 s28, s28, 20480
  s_add_u32 m0, s26, 31744
  s_nop 0
  buffer_load_dwordx4 v6, s[8:11], s28 offen lds
  s_add_u32 s28, s28, 20480
  s_waitcnt vmcnt(24)
  ds_read_b64_tr_b16 a[0:1], v7 offset:0
  ds_read_b64_tr_b16 a[2:3], v7 offset:512
  ds_read_b64_tr_b16 a[4:5], v7 offset:1024
  ds_read_b64_tr_b16 a[6:7], v7 offset:1536
  ds_read_b64_tr_b16 a[8:9], v7 offset:2048
  ds_read_b64_tr_b16 a[10:11], v7 offset:2560
  ds_read_b64_tr_b16 a[12:13], v7 offset:3072
  ds_read_b64_tr_b16 a[14:15], v7 offset:3584
  s_waitcnt lgkmcnt(0)
  ds_read_b64_tr_b16 a[16:17], v7 offset:4096
  ds_read_b64_tr_b16 a[18:19], v7 offset:4608
  ds_read_b64_tr_b16 a[20:21], v7 offset:5120
  ds_read_b64_tr_b16 a[22:23], v7 offset:5632
  ds_read_b64_tr_b16 a[24:25], v7 offset:6144
  ds_read_b64_tr_b16 a[26:27], v7 offset:6656
  ds_read_b64_tr_b16 a[28:29], v7 offset:7168
  ds_read_b64_tr_b16 a[30:31], v7 offset:7680
  s_waitcnt lgkmcnt(0)
  s_waitcnt vmcnt(16)
  ds_read_b64_tr_b16 a[32:33], v7 offset:8192
  ds_read_b64_tr_b16 a[34:35], v7 offset:8704
  ds_read_b64_tr_b16 a[36:37], v7 offset:9216
  ds_read_b64_tr_b16 a[38:39], v7 offset:9728
  ds_read_b64_tr_b16 a[40:41], v7 offset:10240
  ds_read_b64_tr_b16 a[42:43], v7 offset:10752
  ds_read_b64_tr_b16 a[44:45], v7 offset:11264
  ds_read_b64_tr_b16 a[46:47], v7 offset:11776
  s_waitcnt lgkmcnt(0)
  ds_read_b64_tr_b16 a[48:49], v7 offset:12288
  ds_read_b64_tr_b16 a[50:51], v7 offset:12800
  ds_read_b64_tr_b16 a[52:53], v7 offset:13312
  ds_read_b64_tr_b16 a[54:55], v7 offset:13824
  ds_read_b64_tr_b16 a[56:57], v7 offset:14336
  ds_read_b64_tr_b16 a[58:59], v7 offset:14848
  ds_read_b64_tr_b16 a[60:61], v7 offset:15360
  ds_read_b64_tr_b16 a[62:63], v7 offset:15872
  s_waitcnt lgkmcnt(0)
  s_waitcnt vmcnt(8)
  ds_read_b64_tr_b16 a[64:65], v7 offset:16384
  ds_read_b64_tr_b16 a[66:67], v7 offset:16896
  ds_read_b64_tr_b16 a[68:69], v7 offset:17408
  ds_read_b64_tr_b16 a[70:71], v7 offset:17920
  ds_read_b64_tr_b16 a[72:73], v7 offset:18432
  ds_read_b64_tr_b16 a[74:75], v7 offset:18944
  ds_read_b64_tr_b16 a[76:77], v7 offset:19456
  ds_read_b64_tr_b16 a[78:79], v7 offset:19968
  s_waitcnt lgkmcnt(0)
  ds_read_b64_tr_b16 a[80:81], v7 offset:20480
  ds_read_b64_tr_b16 a[82:83], v7 offset:20992
  ds_read_b64_tr_b16 a[84:85], v7 offset:21504
  ds_read_b64_tr_b16 a[86:87], v7 offset:22016
  ds_read_b64_tr_b16 a[88:89], v7 offset:22528
  ds_read_b64_tr_b16 a[90:91], v7 offset:23040
  ds_read_b64_tr_b16 a[92:93], v7 offset:23552
  ds_read_b64_tr_b16 a[94:95], v7 offset:24064
  s_waitcnt lgkmcnt(0)
  s_waitcnt vmcnt(0)
  ds_read_b64_tr_b16 a[96:97], v7 offset:24576
  ds_read_b64_tr_b16 a[98:99], v7 offset:25088
  ds_read_b64_tr_b16 a[100:101], v7 offset:25600
  ds_read_b64_tr_b16 a[102:103], v7 offset:26112
  ds_read_b64_tr_b16 a[104:105], v7 offset:26624
  ds_read_b64_tr_b16 a[106:107], v7 offset:27136
  ds_read_b64_tr_b16 a[108:109], v7 offset:27648
  ds_read_b64_tr_b16 a[110:111], v7 offset:28160
  s_waitcnt lgkmcnt(0)
  ds_read_b64_tr_b16 a[112:113], v7 offset:28672
  ds_read_b64_tr_b16 a[114:115], v7 offset:29184
  ds_read_b64_tr_b16 a[116:117], v7 offset:29696
  ds_read_b64_tr_b16 a[118:119], v7 offset:30208
  ds_read_b64_tr_b16 a[120:121], v7 offset:30720
  ds_read_b64_tr_b16 a[122:123], v7 offset:31232
  ds_read_b64_tr_b16 a[124:125], v7 offset:31744
  ds_read_b64_tr_b16 a[126:127], v7 offset:32256
  s_waitcnt lgkmcnt(0)
  s_add_u32 m0, s26, 0
  s_nop 0
  buffer_load_dwordx4 v6, s[8:11], s28 offen lds
  s_add_u32 s28, s28, 20480
  s_add_u32 m0, s26, 1024
  s_nop 0
  buffer_load_dwordx4 v6, s[8:11], s28 offen lds
  s_add_u32 s28, s28, 20480
  s_add_u32 m0, s26, 2048
  s_nop 0
  buffer_load_dwordx4 v6, s[8:11], s28 offen lds
  s_add_u32 s28, s28, 20480
  s_add_u32 m0, s26, 3072
  s_nop 0
  buffer_load_dwordx4 v6, s[8:11], s28 offen lds
  s_add_u32 s28, s28, 20480
  s_add_u32 m0, s26, 4096
  s_nop 0
  buffer_load_dwordx4 v6, s[8:11], s28 offen lds
  s_add_u32 s28, s28, 20480
  s_add_u32 m0, s26, 5120
  s_nop 0
  buffer_load_dwordx4 v6, s[8:11], s28 offen lds
  s_add_u32 s28, s28, 20480
  s_add_u32 m0, s26, 6144
  s_nop 0
  buffer_load_dwordx4 v6, s[8:11], s28 offen lds
  s_add_u32 s28, s28, 20480
  s_add_u32 m0, s26, 7168
  s_nop 0
  buffer_load_dwordx4 v6, s[8:11], s28 offen lds
  s_add_u32 s28, s28, 20480
  s_add_u32 m0, s26, 8192
  s_nop 0
  buffer_load_dwordx4 v6, s[8:11], s28 offen lds
  s_add_u32 s28, s28, 20480
  s_add_u32 m0, s26, 9216
  s_nop 0
  buffer_load_dwordx4 v6, s[8:11], s28 offen lds
  s_add_u32 s28, s28, 20480
  s_add_u32 m0, s26, 10240
  s_nop 0
  buffer_load_dwordx4 v6, s[8:11], s28 offen lds
  s_add_u32 s28, s28, 20480
  s_add_u32 m0, s26, 11264
  s_nop 0
  buffer_load_dwordx4 v6, s[8:11], s28 offen lds
  s_add_u32 s28, s28, 20480
  s_add_u32 m0, s26, 12288
  s_nop 0
  buffer_load_dwordx4 v6, s[8:11], s28 offen lds
  s_add_u32 s28, s28, 20480
  s_add_u32 m0, s26, 13312
  s_nop 0
  buffer_load_dwordx4 v6, s[8:11], s28 offen lds
  s_add_u32 s28, s28, 20480
  s_add_u32 m0, s26, 14336
  s_nop 0
  buffer_load_dwordx4 v6, s[8:11], s28 offen lds
  s_add_u32 s28, s28, 20480
  s_add_u32 m0, s26, 15360
  s_nop 0
  buffer_load_dwordx4 v6, s[8:11], s28 offen lds
  s_add_u32 s28, s28, 20480
  s_add_u32 m0, s26, 16384
  s_nop 0
  buffer_load_dwordx4 v6, s[8:11], s28 offen lds
  s_add_u32 s28, s28, 20480
  s_add_u32 m0, s26, 17408
  s_nop 0
  buffer_load_dwordx4 v6, s[8:11], s28 offen lds
  s_add_u32 s28, s28, 20480
  s_add_u32 m0, s26, 18432
  s_nop 0
  buffer_load_dwordx4 v6, s[8:11], s28 offen lds
  s_add_u32 s28, s28, 20480
  s_add_u32 m0, s26, 19456
  s_nop 0
  buffer_load_dwordx4 v6, s[8:11], s28 offen lds
  s_add_u32 s28, s28, 20480
  s_add_u32 m0, s26, 20480
  s_nop 0
  buffer_load_dwordx4 v6, s[8:11], s28 offen lds
  s_add_u32 s28, s28, 20480
  s_add_u32 m0, s26, 21504
  s_nop 0
  buffer_load_dwordx4 v6, s[8:11], s28 offen lds
  s_add_u32 s28, s28, 20480
  s_add_u32 m0, s26, 22528
  s_nop 0
  buffer_load_dwordx4 v6, s[8:11], s28 offen lds
  s_add_u32 s28, s28, 20480
  s_add_u32 m0, s26, 23552
  s_nop 0
  buffer_load_dwordx4 v6, s[8:11], s28 offen lds
  s_add_u32 s28, s28, 20480
  s_add_u32 m0, s26, 24576
  s_nop 0
  buffer_load_dwordx4 v6, s[8:11], s28 offen lds
  s_add_u32 s28, s28, 20480
  s_add_u32 m0, s26, 25600
  s_nop 0
  buffer_load_dwordx4 v6, s[8:11], s28 offen lds
  s_add_u32 s28, s28, 20480
  s_add_u32 m0, s26, 26624
  s_nop 0
  buffer_load_dwordx4 v6, s[8:11], s28 offen lds
  s_add_u32 s28, s28, 20480
  s_add_u32 m0, s26, 27648
  s_nop 0
  buffer_load_dwordx4 v6, s[8:11], s28 offen lds
  s_add_u32 s28, s28, 20480
  s_add_u32 m0, s26, 28672
  s_nop 0
  buffer_load_dwordx4 v6, s[8:11], s28 offen lds
  s_add_u32 s28, s28, 20480
  s_add_u32 m0, s26, 29696
  s_nop 0
  buffer_load_dwordx4 v6, s[8:11], s28 offen lds
  s_add_u32 s28, s28, 20480
  s_add_u32 m0, s26, 30720
  s_nop 0
  buffer_load_dwordx4 v6, s[8:11], s28 offen lds
  s_add_u32 s28, s28, 20480
  s_add_u32 m0, s26, 31744
  s_nop 0
  buffer_load_dwordx4 v6, s[8:11], s28 offen lds
  s_add_u32 s28, s28, 20480
  s_waitcnt vmcnt(24)
  ds_read_b64_tr_b16 a[128:129], v7 offset:0
  ds_read_b64_tr_b16 a[130:131], v7 offset:512
  ds_read_b64_tr_b16 a[132:133], v7 offset:1024
  ds_read_b64_tr_b16 a[134:135], v7 offset:1536
  ds_read_b64_tr_b16 a[136:137], v7 offset:2048
  ds_read_b64_tr_b16 a[138:139], v7 offset:2560
  ds_read_b64_tr_b16 a[140:141], v7 offset:3072
  ds_read_b64_tr_b16 a[142:143], v7 offset:3584
  s_waitcnt lgkmcnt(0)
  ds_read_b64_tr_b16 a[144:145], v7 offset:4096
  ds_read_b64_tr_b16 a[146:147], v7 offset:4608
  ds_read_b64_tr_b16 a[148:149], v7 offset:5120
  ds_read_b64_tr_b16 a[150:151], v7 offset:5632
  ds_read_b64_tr_b16 a[152:153], v7 offset:6144
  ds_read_b64_tr_b16 a[154:155], v7 offset:6656
  ds_read_b64_tr_b16 a[156:157], v7 offset:7168
  ds_read_b64_tr_b16 a[158:159], v7 offset:7680
  s_waitcnt lgkmcnt(0)
  s_waitcnt vmcnt(16)
  ds_read_b64_tr_b16 a[160:161], v7 offset:8192
  ds_read_b64_tr_b16 a[162:163], v7 offset:8704
  ds_read_b64_tr_b16 a[164:165], v7 offset:9216
  ds_read_b64_tr_b16 a[166:167], v7 offset:9728
  ds_read_b64_tr_b16 a[168:169], v7 offset:10240
  ds_read_b64_tr_b16 a[170:171], v7 offset:10752
  ds_read_b64_tr_b16 a[172:173], v7 offset:11264
  ds_read_b64_tr_b16 a[174:175], v7 offset:11776
  s_waitcnt lgkmcnt(0)
  ds_read_b64_tr_b16 a[176:177], v7 offset:12288
  ds_read_b64_tr_b16 a[178:179], v7 offset:12800
  ds_read_b64_tr_b16 a[180:181], v7 offset:13312
  ds_read_b64_tr_b16 a[182:183], v7 offset:13824
  ds_read_b64_tr_b16 a[184:185], v7 offset:14336
  ds_read_b64_tr_b16 a[186:187], v7 offset:14848
  ds_read_b64_tr_b16 a[188:189], v7 offset:15360
  ds_read_b64_tr_b16 a[190:191], v7 offset:15872
  s_waitcnt lgkmcnt(0)
  s_waitcnt vmcnt(8)
  ds_read_b64_tr_b16 a[192:193], v7 offset:16384
  ds_read_b64_tr_b16 a[194:195], v7 offset:16896
  ds_read_b64_tr_b16 a[196:197], v7 offset:17408
  ds_read_b64_tr_b16 a[198:199], v7 offset:17920
  ds_read_b64_tr_b16 a[200:201], v7 offset:18432
  ds_read_b64_tr_b16 a[202:203], v7 offset:18944
  ds_read_b64_tr_b16 a[204:205], v7 offset:19456
  ds_read_b64_tr_b16 a[206:207], v7 offset:19968
  s_waitcnt lgkmcnt(0)
  ds_read_b64_tr_b16 a[208:209], v7 offset:20480
  ds_read_b64_tr_b16 a[210:211], v7 offset:20992
  ds_read_b64_tr_b16 a[212:213], v7 offset:21504
  ds_read_b64_tr_b16 a[214:215], v7 offset:22016
  ds_read_b64_tr_b16 a[216:217], v7 offset:22528
  ds_read_b64_tr_b16 a[218:219], v7 offset:23040
  ds_read_b64_tr_b16 a[220:221], v7 offset:23552
  ds_read_b64_tr_b16 a[222:223], v7 offset:24064
  s_waitcnt lgkmcnt(0)
  s_waitcnt vmcnt(0)
  ds_read_b64_tr_b16 a[224:225], v7 offset:24576
  ds_read_b64_tr_b16 a[226:227], v7 offset:25088
  ds_read_b64_tr_b16 a[228:229], v7 offset:25600
  ds_read_b64_tr_b16 a[230:231], v7 offset:26112
  ds_read_b64_tr_b16 a[232:233], v7 offset:26624
  ds_read_b64_tr_b16 a[234:235], v7 offset:27136
  ds_read_b64_tr_b16 a[236:237], v7 offset:27648
  ds_read_b64_tr_b16 a[238:239], v7 offset:28160
  s_waitcnt lgkmcnt(0)
  ds_read_b64_tr_b16 a[240:241], v7 offset:28672
  ds_read_b64_tr_b16 a[242:243], v7 offset:29184
  ds_read_b64_tr_b16 a[244:245], v7 offset:29696
  ds_read_b64_tr_b16 a[246:247], v7 offset:30208
  ds_read_b64_tr_b16 a[248:249], v7 offset:30720
  ds_read_b64_tr_b16 a[250:251], v7 offset:31232
  ds_read_b64_tr_b16 a[252:253], v7 offset:31744
  ds_read_b64_tr_b16 a[254:255], v7 offset:32256
  s_waitcnt lgkmcnt(0)
  s_barrier
  v_and_b32 v3, 3, v1
  v_bfe_u32 v4, v1, 3, 2
  v_lshl_add_u32 v3, v4, 2, v3
  v_bfe_u32 v4, v1, 2, 1
  v_lshl_add_u32 v3, v4, 4, v3
  v_mul_u32_u24 v8, 0x500, v3
  v_lshrrev_b32 v3, 5, v1
  v_lshl_add_u32 v8, v3, 5, v8
  s_lshl_b32 s25, s23, 6
  s_lshl_b32 s24, s17, 3
  s_add_u32 s25, s25, s24
  v_add_u32 v8, s25, v8
  v_add_u32 v9, s29, v2
  s_lshl_b32 s25, s17, 12
  v_add_u32 v10, s25, v2
  v_lshrrev_b32 v3, 5, v1
  v_lshlrev_b32 v11, 10, v3
  v_and_b32 v3, 31, v1
  v_lshl_add_u32 v11, v3, 4, v11
  s_lshl_b32 s25, s23, 11
  s_lshr_b32 s24, s17, 1
  s_lshl_b32 s24, s24, 9
  s_add_u32 s25, s25, s24
  s_and_b32 s24, s17, 1
  s_lshl_b32 s24, s24, 3
  s_add_u32 s25, s25, s24
  v_add_u32 v11, s25, v11
  s_add_u32 s21, s22, 8
  s_cmp_eq_u32 s22, 0
  s_cselect_b32 s21, 0, s21
  s_mov_b32 s31, 3
  s_mov_b32 s92, 0
Lwotop_60:
  s_mul_i32 s27, s21, 40960
  s_add_u32 s25, s27, 104857600
  buffer_load_dwordx2 v[12:13], v11, s[4:7], s25 offen sc1
  s_lshl_b32 s24, s21, 2
  s_add_u32 s24, s24, s17
  s_lshl_b32 s24, s24, 7
  s_add_u32 s24, s24, 3866624
  v_mov_b32 v3, 0
Lwf_61:
  buffer_load_dword v4, v3, s[4:7], s24 offen sc1
  s_waitcnt vmcnt(0)
  v_readfirstlane_b32 s25, v4
  s_add_u32 s0, s0, 1
  s_cmp_ge_u32 s25, 32
  s_cbranch_scc1 Lwf_61_ok
  s_sleep 4
  s_cmp_lt_u32 s0, 1572864
  s_cbranch_scc1 Lwf_61
Lwf_61_ok:
  s_lshl_b32 s24, s21, 18
  s_lshl_b32 s25, s17, 16
  s_add_u32 s24, s24, s25
  s_add_u32 s24, s24, 179306496
  buffer_load_dwordx4 v[64:67], v2, s[4:7], s24 offen offset:0 sc1
  buffer_load_dwordx4 v[68:71], v2, s[4:7], s24 offen offset:1024 sc1
  buffer_load_dwordx4 v[72:75], v2, s[4:7], s24 offen offset:2048 sc1
  buffer_load_dwordx4 v[76:79], v2, s[4:7], s24 offen offset:3072 sc1
  s_add_u32 s24, s24, 4096
  buffer_load_dwordx4 v[80:83], v2, s[4:7], s24 offen offset:0 sc1
  buffer_load_dwordx4 v[84:87], v2, s[4:7], s24 offen offset:1024 sc1
  buffer_load_dwordx4 v[88:91], v2, s[4:7], s24 offen offset:2048 sc1
  buffer_load_dwordx4 v[92:95], v2, s[4:7], s24 offen offset:3072 sc1
  s_add_u32 s24, s24, 4096
  buffer_load_dwordx4 v[96:99], v2, s[4:7], s24 offen offset:0 sc1
  buffer_load_dwordx4 v[100:103], v2, s[4:7], s24 offen offset:1024 sc1
  buffer_load_dwordx4 v[104:107], v2, s[4:7], s24 offen offset:2048 sc1
  buffer_load_dwordx4 v[108:111], v2, s[4:7], s24 offen offset:3072 sc1
  s_add_u32 s24, s24, 4096
  buffer_load_dwordx4 v[112:115], v2, s[4:7], s24 offen offset:0 sc1
  buffer_load_dwordx4 v[116:119], v2, s[4:7], s24 offen offset:1024 sc1
  buffer_load_dwordx4 v[120:123], v2, s[4:7], s24 offen offset:2048 sc1
  buffer_load_dwordx4 v[124:127], v2, s[4:7], s24 offen offset:3072 sc1
  s_add_u32 s24, s24, 4096
  buffer_load_dwordx4 v[128:131], v2, s[4:7], s24 offen offset:0 sc1
  buffer_load_dwordx4 v[132:135], v2, s[4:7], s24 offen offset:1024 sc1
  buffer_load_dwordx4 v[136:139], v2, s[4:7], s24 offen offset:2048 sc1
  buffer_load_dwordx4 v[140:143], v2, s[4:7], s24 offen offset:3072 sc1
  s_add_u32 s24, s24, 4096
  buffer_load_dwordx4 v[144:147], v2, s[4:7], s24 offen offset:0 sc1
  buffer_load_dwordx4 v[148:151], v2, s[4:7], s24 offen offset:1024 sc1
  buffer_load_dwordx4 v[152:155], v2, s[4:7], s24 offen offset:2048 sc1
  buffer_load_dwordx4 v[156:159], v2, s[4:7], s24 offen offset:3072 sc1
  s_add_u32 s24, s24, 4096
  buffer_load_dwordx4 v[160:163], v2, s[4:7], s24 offen offset:0 sc1
  buffer_load_dwordx4 v[164:167], v2, s[4:7], s24 offen offset:1024 sc1
  buffer_load_dwordx4 v[168:171], v2, s[4:7], s24 offen offset:2048 sc1
  buffer_load_dwordx4 v[172:175], v2, s[4:7], s24 offen offset:3072 sc1
  s_add_u32 s24, s24, 4096
  buffer_load_dwordx4 v[176:179], v2, s[4:7], s24 offen offset:0 sc1
  buffer_load_dwordx4 v[180:183], v2, s[4:7], s24 offen offset:1024 sc1
  buffer_load_dwordx4 v[184:187], v2, s[4:7], s24 offen offset:2048 sc1
  buffer_load_dwordx4 v[188:191], v2, s[4:7], s24 offen offset:3072 sc1
  s_add_u32 s24, s24, 4096
  buffer_load_dwordx4 v[192:195], v2, s[4:7], s24 offen offset:0 sc1
  buffer_load_dwordx4 v[196:199], v2, s[4:7], s24 offen offset:1024 sc1
  buffer_load_dwordx4 v[200:203], v2, s[4:7], s24 offen offset:2048 sc1
  buffer_load_dwordx4 v[204:207], v2, s[4:7], s24 offen offset:3072 sc1
  s_add_u32 s24, s24, 4096
  buffer_load_dwordx4 v[208:211], v2, s[4:7], s24 offen offset:0 sc1
  buffer_load_dwordx4 v[212:215], v2, s[4:7], s24 offen offset:1024 sc1
  buffer_load_dwordx4 v[216:219], v2, s[4:7], s24 offen offset:2048 sc1
  buffer_load_dwordx4 v[220:223], v2, s[4:7], s24 offen offset:3072 sc1
  s_waitcnt vmcnt(39)
  v_mfma_f32_32x32x16_bf16 v[16:31], a[0:3], v[64:67], 0
  s_add_u32 s24, s24, 4096
  buffer_load_dwordx4 v[64:67], v2, s[4:7], s24 offen offset:0 sc1
  s_waitcnt vmcnt(39)
  v_mfma_f32_32x32x16_bf16 v[32:47], a[4:7], v[68:71], 0
  buffer_load_dwordx4 v[68:71], v2, s[4:7], s24 offen offset:1024 sc1
  s_waitcnt vmcnt(39)
  v_mfma_f32_32x32x16_bf16 v[16:31], a[8:11], v[72:75], v[16:31]
  buffer_load_dwordx4 v[72:75], v2, s[4:7], s24 offen offset:2048 sc1
  s_waitcnt vmcnt(39)
  v_mfma_f32_32x32x16_bf16 v[32:47], a[12:15], v[76:79], v[32:47]
  buffer_load_dwordx4 v[76:79], v2, s[4:7], s24 offen offset:3072 sc1
  s_waitcnt vmcnt(39)
  v_mfma_f32_32x32x16_bf16 v[16:31], a[16:19], v[80:83], v[16:31]
  s_add_u32 s24, s24, 4096
  buffer_load_dwordx4 v[80:83], v2, s[4:7], s24 offen offset:0 sc1
  s_waitcnt vmcnt(39)
  v_mfma_f32_32x32x16_bf16 v[32:47], a[20:23], v[84:87], v[32:47]
  buffer_load_dwordx4 v[84:87], v2, s[4:7], s24 offen offset:1024 sc1
  s_waitcnt vmcnt(39)
  v_mfma_f32_32x32x16_bf16 v[16:31], a[24:27], v[88:91], v[16:31]
  buffer_load_dwordx4 v[88:91], v2, s[4:7], s24 offen offset:2048 sc1
  s_waitcnt vmcnt(39)
  v_mfma_f32_32x32x16_bf16 v[32:47], a[28:31], v[92:95], v[32:47]
  buffer_load_dwordx4 v[92:95], v2, s[4:7], s24 offen offset:3072 sc1
  s_waitcnt vmcnt(39)
  v_mfma_f32_32x32x16_bf16 v[16:31], a[32:35], v[96:99], v[16:31]
  s_add_u32 s24, s24, 4096
  buffer_load_dwordx4 v[96:99], v2, s[4:7], s24 offen offset:0 sc1
  s_waitcnt vmcnt(39)
  v_mfma_f32_32x32x16_bf16 v[32:47], a[36:39], v[100:103], v[32:47]
  buffer_load_dwordx4 v[100:103], v2, s[4:7], s24 offen offset:1024 sc1
  s_waitcnt vmcnt(39)
  v_mfma_f32_32x32x16_bf16 v[16:31], a[40:43], v[104:107], v[16:31]
  buffer_load_dwordx4 v[104:107], v2, s[4:7], s24 offen offset:2048 sc1
  s_waitcnt vmcnt(39)
  v_mfma_f32_32x32x16_bf16 v[32:47], a[44:47], v[108:111], v[32:47]
  buffer_load_dwordx4 v[108:111], v2, s[4:7], s24 offen offset:3072 sc1
  s_waitcnt vmcnt(39)
  v_mfma_f32_32x32x16_bf16 v[16:31], a[48:51], v[112:115], v[16:31]
  s_add_u32 s24, s24, 4096
  buffer_load_dwordx4 v[112:115], v2, s[4:7], s24 offen offset:0 sc1
  s_waitcnt vmcnt(39)
  v_mfma_f32_32x32x16_bf16 v[32:47], a[52:55], v[116:119], v[32:47]
  buffer_load_dwordx4 v[116:119], v2, s[4:7], s24 offen offset:1024 sc1
  s_waitcnt vmcnt(39)
  v_mfma_f32_32x32x16_bf16 v[16:31], a[56:59], v[120:123], v[16:31]
  buffer_load_dwordx4 v[120:123], v2, s[4:7], s24 offen offset:2048 sc1
  s_waitcnt vmcnt(39)
  v_mfma_f32_32x32x16_bf16 v[32:47], a[60:63], v[124:127], v[32:47]
  buffer_load_dwordx4 v[124:127], v2, s[4:7], s24 offen offset:3072 sc1
  s_waitcnt vmcnt(39)
  v_mfma_f32_32x32x16_bf16 v[16:31], a[64:67], v[128:131], v[16:31]
  s_add_u32 s24, s24, 4096
  buffer_load_dwordx4 v[128:131], v2, s[4:7], s24 offen offset:0 sc1
  s_waitcnt vmcnt(39)
  v_mfma_f32_32x32x16_bf16 v[32:47], a[68:71], v[132:135], v[32:47]
  buffer_load_dwordx4 v[132:135], v2, s[4:7], s24 offen offset:1024 sc1
  s_waitcnt vmcnt(39)
  v_mfma_f32_32x32x16_bf16 v[16:31], a[72:75], v[136:139], v[16:31]
  buffer_load_dwordx4 v[136:139], v2, s[4:7], s24 offen offset:2048 sc1
  s_waitcnt vmcnt(39)
  v_mfma_f32_32x32x16_bf16 v[32:47], a[76:79], v[140:143], v[32:47]
  buffer_load_dwordx4 v[140:143], v2, s[4:7], s24 offen offset:3072 sc1
  s_waitcnt vmcnt(39)
  v_mfma_f32_32x32x16_bf16 v[16:31], a[80:83], v[144:147], v[16:31]
  s_add_u32 s24, s24, 4096
  buffer_load_dwordx4 v[144:147], v2, s[4:7], s24 offen offset:0 sc1
  s_waitcnt vmcnt(39)
  v_mfma_f32_32x32x16_bf16 v[32:47], a[84:87], v[148:151], v[32:47]
  buffer_load_dwordx4 v[148:151], v2, s[4:7], s24 offen offset:1024 sc1
  s_waitcnt vmcnt(39)
  v_mfma_f32_32x32x16_bf16 v[16:31], a[88:91], v[152:155], v[16:31]
  buffer_load_dwordx4 v[152:155], v2, s[4:7], s24 offen offset:2048 sc1
  s_waitcnt vmcnt(39)
  v_mfma_f32_32x32x16_bf16 v[32:47], a[92:95], v[156:159], v[32:47]
  buffer_load_dwordx4 v[156:159], v2, s[4:7], s24 offen offset:3072 sc1
  s_waitcnt vmcnt(39)
  v_mfma_f32_32x32x16_bf16 v[16:31], a[96:99], v[160:163], v[16:31]
  s_waitcnt vmcnt(38)
  v_mfma_f32_32x32x16_bf16 v[32:47], a[100:103], v[164:167], v[32:47]
  s_waitcnt vmcnt(37)
  v_mfma_f32_32x32x16_bf16 v[16:31], a[104:107], v[168:171], v[16:31]
  s_waitcnt vmcnt(36)
  v_mfma_f32_32x32x16_bf16 v[32:47], a[108:111], v[172:175], v[32:47]
  s_waitcnt vmcnt(35)
  v_mfma_f32_32x32x16_bf16 v[16:31], a[112:115], v[176:179], v[16:31]
  s_waitcnt vmcnt(34)
  v_mfma_f32_32x32x16_bf16 v[32:47], a[116:119], v[180:183], v[32:47]
  s_waitcnt vmcnt(33)
  v_mfma_f32_32x32x16_bf16 v[16:31], a[120:123], v[184:187], v[16:31]
  s_waitcnt vmcnt(32)
  v_mfma_f32_32x32x16_bf16 v[32:47], a[124:127], v[188:191], v[32:47]
  s_waitcnt vmcnt(31)
  v_mfma_f32_32x32x16_bf16 v[16:31], a[128:131], v[192:195], v[16:31]
  s_waitcnt vmcnt(30)
  v_mfma_f32_32x32x16_bf16 v[32:47], a[132:135], v[196:199], v[32:47]
  s_waitcnt vmcnt(29)
  v_mfma_f32_32x32x16_bf16 v[16:31], a[136:139], v[200:203], v[16:31]
  s_waitcnt vmcnt(28)
  v_mfma_f32_32x32x16_bf16 v[32:47], a[140:143], v[204:207], v[32:47]
  s_waitcnt vmcnt(27)
  v_mfma_f32_32x32x16_bf16 v[16:31], a[144:147], v[208:211], v[16:31]
  s_waitcnt vmcnt(26)
  v_mfma_f32_32x32x16_bf16 v[32:47], a[148:151], v[212:215], v[32:47]
  s_waitcnt vmcnt(25)
  v_mfma_f32_32x32x16_bf16 v[16:31], a[152:155], v[216:219], v[16:31]
  s_waitcnt vmcnt(24)
  v_mfma_f32_32x32x16_bf16 v[32:47], a[156:159], v[220:223], v[32:47]
  s_waitcnt vmcnt(23)
  v_mfma_f32_32x32x16_bf16 v[16:31], a[160:163], v[64:67], v[16:31]
  s_waitcnt vmcnt(22)
  v_mfma_f32_32x32x16_bf16 v[32:47], a[164:167], v[68:71], v[32:47]
  s_waitcnt vmcnt(21)
  v_mfma_f32_32x32x16_bf16 v[16:31], a[168:171], v[72:75], v[16:31]
  s_waitcnt vmcnt(20)
  v_mfma_f32_32x32x16_bf16 v[32:47], a[172:175], v[76:79], v[32:47]
  s_waitcnt vmcnt(19)
  v_mfma_f32_32x32x16_bf16 v[16:31], a[176:179], v[80:83], v[16:31]
  s_waitcnt vmcnt(18)
  v_mfma_f32_32x32x16_bf16 v[32:47], a[180:183], v[84:87], v[32:47]
  s_waitcnt vmcnt(17)
  v_mfma_f32_32x32x16_bf16 v[16:31], a[184:187], v[88:91], v[16:31]
  s_waitcnt vmcnt(16)
  v_mfma_f32_32x32x16_bf16 v[32:47], a[188:191], v[92:95], v[32:47]
  s_waitcnt vmcnt(15)
  v_mfma_f32_32x32x16_bf16 v[16:31], a[192:195], v[96:99], v[16:31]
  s_waitcnt vmcnt(14)
  v_mfma_f32_32x32x16_bf16 v[32:47], a[196:199], v[100:103], v[32:47]
  s_waitcnt vmcnt(13)
  v_mfma_f32_32x32x16_bf16 v[16:31], a[200:203], v[104:107], v[16:31]
  s_waitcnt vmcnt(12)
  v_mfma_f32_32x32x16_bf16 v[32:47], a[204:207], v[108:111], v[32:47]
  s_waitcnt vmcnt(11)
  v_mfma_f32_32x32x16_bf16 v[16:31], a[208:211], v[112:115], v[16:31]
  s_waitcnt vmcnt(10)
  v_mfma_f32_32x32x16_bf16 v[32:47], a[212:215], v[116:119], v[32:47]
  s_waitcnt vmcnt(9)
  v_mfma_f32_32x32x16_bf16 v[16:31], a[216:219], v[120:123], v[16:31]
  s_waitcnt vmcnt(8)
  v_mfma_f32_32x32x16_bf16 v[32:47], a[220:223], v[124:127], v[32:47]
  s_waitcnt vmcnt(7)
  v_mfma_f32_32x32x16_bf16 v[16:31], a[224:227], v[128:131], v[16:31]
  s_waitcnt vmcnt(6)
  v_mfma_f32_32x32x16_bf16 v[32:47], a[228:231], v[132:135], v[32:47]
  s_waitcnt vmcnt(5)
  v_mfma_f32_32x32x16_bf16 v[16:31], a[232:235], v[136:139], v[16:31]
  s_waitcnt vmcnt(4)
  v_mfma_f32_32x32x16_bf16 v[32:47], a[236:239], v[140:143], v[32:47]
  s_waitcnt vmcnt(3)
  v_mfma_f32_32x32x16_bf16 v[16:31], a[240:243], v[144:147], v[16:31]
  s_waitcnt vmcnt(2)
  v_mfma_f32_32x32x16_bf16 v[32:47], a[244:247], v[148:151], v[32:47]
  s_waitcnt vmcnt(1)
  v_mfma_f32_32x32x16_bf16 v[16:31], a[248:251], v[152:155], v[16:31]
  s_waitcnt vmcnt(0)
  v_mfma_f32_32x32x16_bf16 v[32:47], a[252:255], v[156:159], v[32:47]
  s_nop 11
  v_pk_add_f32 v[16:17], v[16:17], v[32:33]
  v_pk_add_f32 v[18:19], v[18:19], v[34:35]
  v_pk_add_f32 v[20:21], v[20:21], v[36:37]
  v_pk_add_f32 v[22:23], v[22:23], v[38:39]
  v_pk_add_f32 v[24:25], v[24:25], v[40:41]
  v_pk_add_f32 v[26:27], v[26:27], v[42:43]
  v_pk_add_f32 v[28:29], v[28:29], v[44:45]
  v_pk_add_f32 v[30:31], v[30:31], v[46:47]
  ds_write_b128 v9, v[16:19] offset:0
  ds_write_b128 v9, v[20:23] offset:4096
  ds_write_b128 v9, v[24:27] offset:8192
  ds_write_b128 v9, v[28:31] offset:12288
  s_waitcnt lgkmcnt(0)
  s_barrier
  ds_read_b128 v[16:19], v10 offset:0
  ds_read_b128 v[20:23], v10 offset:1024
  ds_read_b128 v[24:27], v10 offset:2048
  ds_read_b128 v[28:31], v10 offset:3072
  s_waitcnt lgkmcnt(0)
  s_barrier
  v_pk_add_f32 v[16:17], v[16:17], v[20:21]
  v_pk_add_f32 v[24:25], v[24:25], v[28:29]
  v_pk_add_f32 v[18:19], v[18:19], v[22:23]
  v_pk_add_f32 v[26:27], v[26:27], v[30:31]
  v_pk_add_f32 v[16:17], v[16:17], v[24:25]
  v_pk_add_f32 v[18:19], v[18:19], v[26:27]
  v_cvt_pk_bf16_f32 v20, v16, v17
  v_cvt_pk_bf16_f32 v21, v18, v19
  v_lshlrev_b32 v16, 16, v20
  v_and_b32 v17, 0xffff0000, v20
  v_lshlrev_b32 v18, 16, v21
  v_and_b32 v19, 0xffff0000, v21
  v_lshlrev_b32 v24, 16, v12
  v_and_b32 v25, 0xffff0000, v12
  v_lshlrev_b32 v26, 16, v13
  v_and_b32 v27, 0xffff0000, v13
  v_add_f32 v16, v16, v24
  v_add_f32 v17, v17, v25
  v_add_f32 v18, v18, v26
  v_add_f32 v19, v19, v27
  v_cvt_pk_bf16_f32 v20, v16, v17
  v_cvt_pk_bf16_f32 v21, v18, v19
  s_add_u32 s25, s27, 196083712
  buffer_store_dwordx2 v[20:21], v8, s[4:7], s25 offen sc1
  s_lshl_b32 s24, s21, 7
  s_add_u32 s24, s24, 3817472
  s_waitcnt vmcnt(0)
  s_barrier
  v_cmp_eq_u32 vcc, 0, v0
  s_nop 0
  s_and_saveexec_b64 s[32:33], vcc
  s_cbranch_execz Lsig_62
  v_mov_b32 v3, 0
  v_mov_b32 v4, 1
  buffer_atomic_add v4, v3, s[4:7], s24 offen
Lsig_62:
  s_mov_b64 exec, s[32:33]
  s_cmp_lt_u32 s21, 8
  s_cselect_b32 s24, 1, 3
  s_add_u32 s21, s21, s24
  s_cmp_lt_u32 s21, 64
  s_cbranch_scc1 Lwotop_60
  s_branch mk_g2p1
mk_nwo1:
  s_cmp_lt_u32 s50, 68
  s_cbranch_scc0 mk_nln1
  s_sub_u32 s22, s50, 60
  s_lshr_b32 s21, s22, 2
  s_and_b32 s22, s22, 3
  v_lshrrev_b32 v7, 5, v0
  s_lshl_b32 s24, s22, 3
  v_add_u32 v7, s24, v7
  v_mul_u32_u24 v6, 0x500, v7
  v_and_b32 v7, 31, v0
  v_lshl_add_u32 v6, v7, 3, v6
Lln2_63:
  s_lshl_b32 s24, s21, 7
  s_add_u32 s24, s24, 3817472
  s_cmp_lg_u32 s17, 0
  s_cbranch_scc1 Lwf_64_ok
  v_mov_b32 v3, 0
Lwf_64:
  buffer_load_dword v4, v3, s[4:7], s24 offen sc1
  s_waitcnt vmcnt(0)
  v_readfirstlane_b32 s25, v4
  s_add_u32 s0, s0, 1
  s_cmp_ge_u32 s25, 20
  s_cbranch_scc1 Lwf_64_ok
  s_sleep 2
  s_cmp_lt_u32 s0, 1572864
  s_cbranch_scc1 Lwf_64
Lwf_64_ok:
  s_barrier
  s_mul_i32 s27, s21, 40960
  s_add_u32 s25, s27, 196083712
  buffer_load_dwordx2 v[10:11], v6, s[4:7], s25 offen offset:0 sc1
  buffer_load_dwordx2 v[12:13], v6, s[4:7], s25 offen offset:256 sc1
  buffer_load_dwordx2 v[14:15], v6, s[4:7], s25 offen offset:512 sc1
  buffer_load_dwordx2 v[16:17], v6, s[4:7], s25 offen offset:768 sc1
  buffer_load_dwordx2 v[18:19], v6, s[4:7], s25 offen offset:1024 sc1
  s_waitcnt vmcnt(0)
  v_lshlrev_b32 v20, 16, v10
  v_and_b32 v21, 0xffff0000, v10
  v_lshlrev_b32 v22, 16, v11
  v_and_b32 v23, 0xffff0000, v11
  v_lshlrev_b32 v24, 16, v12
  v_and_b32 v25, 0xffff0000, v12
  v_lshlrev_b32 v26, 16, v13
  v_and_b32 v27, 0xffff0000, v13
  v_lshlrev_b32 v28, 16, v14
  v_and_b32 v29, 0xffff0000, v14
  v_lshlrev_b32 v30, 16, v15
  v_and_b32 v31, 0xffff0000, v15
  v_lshlrev_b32 v32, 16, v16
  v_and_b32 v33, 0xffff0000, v16
  v_lshlrev_b32 v34, 16, v17
  v_and_b32 v35, 0xffff0000, v17
  v_lshlrev_b32 v36, 16, v18
  v_and_b32 v37, 0xffff0000, v18
  v_lshlrev_b32 v38, 16, v19
  v_and_b32 v39, 0xffff0000, v19
  v_add_f32 v7, v20, v21
  v_add_f32 v8, v22, v23
  v_add_f32 v7, v7, v24
  v_add_f32 v8, v8, v25
  v_add_f32 v7, v7, v26
  v_add_f32 v8, v8, v27
  v_add_f32 v7, v7, v28
  v_add_f32 v8, v8, v29
  v_add_f32 v7, v7, v30
  v_add_f32 v8, v8, v31
  v_add_f32 v7, v7, v32
  v_add_f32 v8, v8, v33
  v_add_f32 v7, v7, v34
  v_add_f32 v8, v8, v35
  v_add_f32 v7, v7, v36
  v_add_f32 v8, v8, v37
  v_add_f32 v7, v7, v38
  v_add_f32 v8, v8, v39
  v_add_f32 v7, v7, v8
  s_nop 1
  v_add_f32_dpp v7, v7, v7 row_ror:8 row_mask:0xf bank_mask:0xf
  s_nop 1
  v_add_f32_dpp v7, v7, v7 row_ror:4 row_mask:0xf bank_mask:0xf
  s_nop 1
  v_add_f32_dpp v7, v7, v7 row_ror:2 row_mask:0xf bank_mask:0xf
  s_nop 1
  v_add_f32_dpp v7, v7, v7 row_ror:1 row_mask:0xf bank_mask:0xf
  v_mov_b32 v8, v7
  s_nop 1
  v_permlane16_swap_b32 v7, v8
  v_add_f32 v7, v7, v8
  v_mul_f32 v7, 0x3acccccd, v7
  v_sub_f32 v8, v20, v7
  v_mul_f32 v9, v8, v8
  v_sub_f32 v8, v21, v7
  v_fmac_f32 v9, v8, v8
  v_sub_f32 v8, v22, v7
  v_fmac_f32 v9, v8, v8
  v_sub_f32 v8, v23, v7
  v_fmac_f32 v9, v8, v8
  v_sub_f32 v8, v24, v7
  v_fmac_f32 v9, v8, v8
  v_sub_f32 v8, v25, v7
  v_fmac_f32 v9, v8, v8
  v_sub_f32 v8, v26, v7
  v_fmac_f32 v9, v8, v8
  v_sub_f32 v8, v27, v7
  v_fmac_f32 v9, v8, v8
  v_sub_f32 v8, v28, v7
  v_fmac_f32 v9, v8, v8
  v_sub_f32 v8, v29, v7
  v_fmac_f32 v9, v8, v8
  v_sub_f32 v8, v30, v7
  v_fmac_f32 v9, v8, v8
  v_sub_f32 v8, v31, v7
  v_fmac_f32 v9, v8, v8
  v_sub_f32 v8, v32, v7
  v_fmac_f32 v9, v8, v8
  v_sub_f32 v8, v33, v7
  v_fmac_f32 v9, v8, v8
  v_sub_f32 v8, v34, v7
  v_fmac_f32 v9, v8, v8
  v_sub_f32 v8, v35, v7
  v_fmac_f32 v9, v8, v8
  v_sub_f32 v8, v36, v7
  v_fmac_f32 v9, v8, v8
  v_sub_f32 v8, v37, v7
  v_fmac_f32 v9, v8, v8
  v_sub_f32 v8, v38, v7
  v_fmac_f32 v9, v8, v8
  v_sub_f32 v8, v39, v7
  v_fmac_f32 v9, v8, v8
  s_nop 1
  v_add_f32_dpp v9, v9, v9 row_ror:8 row_mask:0xf bank_mask:0xf
  s_nop 1
  v_add_f32_dpp v9, v9, v9 row_ror:4 row_mask:0xf bank_mask:0xf
  s_nop 1
  v_add_f32_dpp v9, v9, v9 row_ror:2 row_mask:0xf bank_mask:0xf
  s_nop 1
  v_add_f32_dpp v9, v9, v9 row_ror:1 row_mask:0xf bank_mask:0xf
  v_mov_b32 v8, v9
  s_nop 1
  v_permlane16_swap_b32 v9, v8
  v_add_f32 v9, v9, v8
  v_mul_f32 v9, 0x3acccccd, v9
  v_cvt_pk_bf16_f32 v7, v7, v7
  v_and_b32 v7, 0xffff0000, v7
  v_cvt_pk_bf16_f32 v9, v9, v9
  v_and_b32 v9, 0xffff0000, v9
  v_add_f32 v9, 0x3727c5ac, v9
  v_cvt_pk_bf16_f32 v9, v9, v9
  v_and_b32 v9, 0xffff0000, v9
  v_sqrt_f32 v9, v9
  s_nop 0
  v_cvt_pk_bf16_f32 v9, v9, v9
  v_and_b32 v9, 0xffff0000, v9
  v_rcp_f32 v9, v9
  v_sub_f32 v20, v20, v7
  v_sub_f32 v21, v21, v7
  v_cvt_pk_bf16_f32 v10, v20, v21
  v_sub_f32 v22, v22, v7
  v_sub_f32 v23, v23, v7
  v_cvt_pk_bf16_f32 v11, v22, v23
  v_sub_f32 v24, v24, v7
  v_sub_f32 v25, v25, v7
  v_cvt_pk_bf16_f32 v12, v24, v25
  v_sub_f32 v26, v26, v7
  v_sub_f32 v27, v27, v7
  v_cvt_pk_bf16_f32 v13, v26, v27
  v_sub_f32 v28, v28, v7
  v_sub_f32 v29, v29, v7
  v_cvt_pk_bf16_f32 v14, v28, v29
  v_sub_f32 v30, v30, v7
  v_sub_f32 v31, v31, v7
  v_cvt_pk_bf16_f32 v15, v30, v31
  v_sub_f32 v32, v32, v7
  v_sub_f32 v33, v33, v7
  v_cvt_pk_bf16_f32 v16, v32, v33
  v_sub_f32 v34, v34, v7
  v_sub_f32 v35, v35, v7
  v_cvt_pk_bf16_f32 v17, v34, v35
  v_sub_f32 v36, v36, v7
  v_sub_f32 v37, v37, v7
  v_cvt_pk_bf16_f32 v18, v36, v37
  v_sub_f32 v38, v38, v7
  v_sub_f32 v39, v39, v7
  v_cvt_pk_bf16_f32 v19, v38, v39
  v_lshlrev_b32 v20, 16, v10
  v_and_b32 v21, 0xffff0000, v10
  v_mul_f32 v20, v20, v9
  v_mul_f32 v21, v21, v9
  v_cvt_pk_bf16_f32 v10, v20, v21
  v_lshlrev_b32 v22, 16, v11
  v_and_b32 v23, 0xffff0000, v11
  v_mul_f32 v22, v22, v9
  v_mul_f32 v23, v23, v9
  v_cvt_pk_bf16_f32 v11, v22, v23
  v_lshlrev_b32 v24, 16, v12
  v_and_b32 v25, 0xffff0000, v12
  v_mul_f32 v24, v24, v9
  v_mul_f32 v25, v25, v9
  v_cvt_pk_bf16_f32 v12, v24, v25
  v_lshlrev_b32 v26, 16, v13
  v_and_b32 v27, 0xffff0000, v13
  v_mul_f32 v26, v26, v9
  v_mul_f32 v27, v27, v9
  v_cvt_pk_bf16_f32 v13, v26, v27
  v_lshlrev_b32 v28, 16, v14
  v_and_b32 v29, 0xffff0000, v14
  v_mul_f32 v28, v28, v9
  v_mul_f32 v29, v29, v9
  v_cvt_pk_bf16_f32 v14, v28, v29
  v_lshlrev_b32 v30, 16, v15
  v_and_b32 v31, 0xffff0000, v15
  v_mul_f32 v30, v30, v9
  v_mul_f32 v31, v31, v9
  v_cvt_pk_bf16_f32 v15, v30, v31
  v_lshlrev_b32 v32, 16, v16
  v_and_b32 v33, 0xffff0000, v16
  v_mul_f32 v32, v32, v9
  v_mul_f32 v33, v33, v9
  v_cvt_pk_bf16_f32 v16, v32, v33
  v_lshlrev_b32 v34, 16, v17
  v_and_b32 v35, 0xffff0000, v17
  v_mul_f32 v34, v34, v9
  v_mul_f32 v35, v35, v9
  v_cvt_pk_bf16_f32 v17, v34, v35
  v_lshlrev_b32 v36, 16, v18
  v_and_b32 v37, 0xffff0000, v18
  v_mul_f32 v36, v36, v9
  v_mul_f32 v37, v37, v9
  v_cvt_pk_bf16_f32 v18, v36, v37
  v_lshlrev_b32 v38, 16, v19
  v_and_b32 v39, 0xffff0000, v19
  v_mul_f32 v38, v38, v9
  v_mul_f32 v39, v39, v9
  v_cvt_pk_bf16_f32 v19, v38, v39
  v_lshlrev_b32 v20, 16, v10
  v_and_b32 v21, 0xffff0000, v10
  v_lshlrev_b32 v22, 16, v11
  v_and_b32 v23, 0xffff0000, v11
  v_lshlrev_b32 v24, 16, v12
  v_and_b32 v25, 0xffff0000, v12
  v_lshlrev_b32 v26, 16, v13
  v_and_b32 v27, 0xffff0000, v13
  v_lshlrev_b32 v28, 16, v14
  v_and_b32 v29, 0xffff0000, v14
  v_lshlrev_b32 v30, 16, v15
  v_and_b32 v31, 0xffff0000, v15
  v_lshlrev_b32 v32, 16, v16
  v_and_b32 v33, 0xffff0000, v16
  v_lshlrev_b32 v34, 16, v17
  v_and_b32 v35, 0xffff0000, v17
  v_lshlrev_b32 v36, 16, v18
  v_and_b32 v37, 0xffff0000, v18
  v_lshlrev_b32 v38, 16, v19
  v_and_b32 v39, 0xffff0000, v19
  v_add_f32 v7, v20, v21
  v_add_f32 v8, v22, v23
  v_add_f32 v7, v7, v24
  v_add_f32 v8, v8, v25
  v_add_f32 v7, v7, v26
  v_add_f32 v8, v8, v27
  v_add_f32 v7, v7, v28
  v_add_f32 v8, v8, v29
  v_add_f32 v7, v7, v30
  v_add_f32 v8, v8, v31
  v_add_f32 v7, v7, v32
  v_add_f32 v8, v8, v33
  v_add_f32 v7, v7, v34
  v_add_f32 v8, v8, v35
  v_add_f32 v7, v7, v36
  v_add_f32 v8, v8, v37
  v_add_f32 v7, v7, v38
  v_add_f32 v8, v8, v39
  v_add_f32 v7, v7, v8
  s_nop 1
  v_add_f32_dpp v7, v7, v7 row_ror:8 row_mask:0xf bank_mask:0xf
  s_nop 1
  v_add_f32_dpp v7, v7, v7 row_ror:4 row_mask:0xf bank_mask:0xf
  s_nop 1
  v_add_f32_dpp v7, v7, v7 row_ror:2 row_mask:0xf bank_mask:0xf
  s_nop 1
  v_add_f32_dpp v7, v7, v7 row_ror:1 row_mask:0xf bank_mask:0xf
  v_mov_b32 v8, v7
  s_nop 1
  v_permlane16_swap_b32 v7, v8
  v_add_f32 v7, v7, v8
  v_mul_f32 v7, 0x3acccccd, v7
  v_sub_f32 v8, v20, v7
  v_mul_f32 v9, v8, v8
  v_sub_f32 v8, v21, v7
  v_fmac_f32 v9, v8, v8
  v_sub_f32 v8, v22, v7
  v_fmac_f32 v9, v8, v8
  v_sub_f32 v8, v23, v7
  v_fmac_f32 v9, v8, v8
  v_sub_f32 v8, v24, v7
  v_fmac_f32 v9, v8, v8
  v_sub_f32 v8, v25, v7
  v_fmac_f32 v9, v8, v8
  v_sub_f32 v8, v26, v7
  v_fmac_f32 v9, v8, v8
  v_sub_f32 v8, v27, v7
  v_fmac_f32 v9, v8, v8
  v_sub_f32 v8, v28, v7
  v_fmac_f32 v9, v8, v8
  v_sub_f32 v8, v29, v7
  v_fmac_f32 v9, v8, v8
  v_sub_f32 v8, v30, v7
  v_fmac_f32 v9, v8, v8
  v_sub_f32 v8, v31, v7
  v_fmac_f32 v9, v8, v8
  v_sub_f32 v8, v32, v7
  v_fmac_f32 v9, v8, v8
  v_sub_f32 v8, v33, v7
  v_fmac_f32 v9, v8, v8
  v_sub_f32 v8, v34, v7
  v_fmac_f32 v9, v8, v8
  v_sub_f32 v8, v35, v7
  v_fmac_f32 v9, v8, v8
  v_sub_f32 v8, v36, v7
  v_fmac_f32 v9, v8, v8
  v_sub_f32 v8, v37, v7
  v_fmac_f32 v9, v8, v8
  v_sub_f32 v8, v38, v7
  v_fmac_f32 v9, v8, v8
  v_sub_f32 v8, v39, v7
  v_fmac_f32 v9, v8, v8
  s_nop 1
  v_add_f32_dpp v9, v9, v9 row_ror:8 row_mask:0xf bank_mask:0xf
  s_nop 1
  v_add_f32_dpp v9, v9, v9 row_ror:4 row_mask:0xf bank_mask:0xf
  s_nop 1
  v_add_f32_dpp v9, v9, v9 row_ror:2 row_mask:0xf bank_mask:0xf
  s_nop 1
  v_add_f32_dpp v9, v9, v9 row_ror:1 row_mask:0xf bank_mask:0xf
  v_mov_b32 v8, v9
  s_nop 1
  v_permlane16_swap_b32 v9, v8
  v_add_f32 v9, v9, v8
  v_mul_f32 v9, 0x3acccccd, v9
  v_cvt_pk_bf16_f32 v7, v7, v7
  v_and_b32 v7, 0xffff0000, v7
  v_cvt_pk_bf16_f32 v9, v9, v9
  v_and_b32 v9, 0xffff0000, v9
  v_add_f32 v9, 0x3727c5ac, v9
  v_cvt_pk_bf16_f32 v9, v9, v9
  v_and_b32 v9, 0xffff0000, v9
  v_sqrt_f32 v9, v9
  s_nop 0
  v_cvt_pk_bf16_f32 v9, v9, v9
  v_and_b32 v9, 0xffff0000, v9
  v_rcp_f32 v9, v9
  v_sub_f32 v20, v20, v7
  v_sub_f32 v21, v21, v7
  v_cvt_pk_bf16_f32 v10, v20, v21
  v_sub_f32 v22, v22, v7
  v_sub_f32 v23, v23, v7
  v_cvt_pk_bf16_f32 v11, v22, v23
  v_sub_f32 v24, v24, v7
  v_sub_f32 v25, v25, v7
  v_cvt_pk_bf16_f32 v12, v24, v25
  v_sub_f32 v26, v26, v7
  v_sub_f32 v27, v27, v7
  v_cvt_pk_bf16_f32 v13, v26, v27
  v_sub_f32 v28, v28, v7
  v_sub_f32 v29, v29, v7
  v_cvt_pk_bf16_f32 v14, v28, v29
  v_sub_f32 v30, v30, v7
  v_sub_f32 v31, v31, v7
  v_cvt_pk_bf16_f32 v15, v30, v31
  v_sub_f32 v32, v32, v7
  v_sub_f32 v33, v33, v7
  v_cvt_pk_bf16_f32 v16, v32, v33
  v_sub_f32 v34, v34, v7
  v_sub_f32 v35, v35, v7
  v_cvt_pk_bf16_f32 v17, v34, v35
  v_sub_f32 v36, v36, v7
  v_sub_f32 v37, v37, v7
  v_cvt_pk_bf16_f32 v18, v36, v37
  v_sub_f32 v38, v38, v7
  v_sub_f32 v39, v39, v7
  v_cvt_pk_bf16_f32 v19, v38, v39
  v_lshlrev_b32 v20, 16, v10
  v_and_b32 v21, 0xffff0000, v10
  v_mul_f32 v20, v20, v9
  v_mul_f32 v21, v21, v9
  v_cvt_pk_bf16_f32 v10, v20, v21
  v_lshlrev_b32 v22, 16, v11
  v_and_b32 v23, 0xffff0000, v11
  v_mul_f32 v22, v22, v9
  v_mul_f32 v23, v23, v9
  v_cvt_pk_bf16_f32 v11, v22, v23
  v_lshlrev_b32 v24, 16, v12
  v_and_b32 v25, 0xffff0000, v12
  v_mul_f32 v24, v24, v9
  v_mul_f32 v25, v25, v9
  v_cvt_pk_bf16_f32 v12, v24, v25
  v_lshlrev_b32 v26, 16, v13
  v_and_b32 v27, 0xffff0000, v13
  v_mul_f32 v26, v26, v9
  v_mul_f32 v27, v27, v9
  v_cvt_pk_bf16_f32 v13, v26, v27
  v_lshlrev_b32 v28, 16, v14
  v_and_b32 v29, 0xffff0000, v14
  v_mul_f32 v28, v28, v9
  v_mul_f32 v29, v29, v9
  v_cvt_pk_bf16_f32 v14, v28, v29
  v_lshlrev_b32 v30, 16, v15
  v_and_b32 v31, 0xffff0000, v15
  v_mul_f32 v30, v30, v9
  v_mul_f32 v31, v31, v9
  v_cvt_pk_bf16_f32 v15, v30, v31
  v_lshlrev_b32 v32, 16, v16
  v_and_b32 v33, 0xffff0000, v16
  v_mul_f32 v32, v32, v9
  v_mul_f32 v33, v33, v9
  v_cvt_pk_bf16_f32 v16, v32, v33
  v_lshlrev_b32 v34, 16, v17
  v_and_b32 v35, 0xffff0000, v17
  v_mul_f32 v34, v34, v9
  v_mul_f32 v35, v35, v9
  v_cvt_pk_bf16_f32 v17, v34, v35
  v_lshlrev_b32 v36, 16, v18
  v_and_b32 v37, 0xffff0000, v18
  v_mul_f32 v36, v36, v9
  v_mul_f32 v37, v37, v9
  v_cvt_pk_bf16_f32 v18, v36, v37
  v_lshlrev_b32 v38, 16, v19
  v_and_b32 v39, 0xffff0000, v19
  v_mul_f32 v38, v38, v9
  v_mul_f32 v39, v39, v9
  v_cvt_pk_bf16_f32 v19, v38, v39
  s_add_u32 s25, s27, 199229440
  buffer_store_dwordx2 v[10:11], v6, s[4:7], s25 offen offset:0 sc1
  buffer_store_dwordx2 v[12:13], v6, s[4:7], s25 offen offset:256 sc1
  buffer_store_dwordx2 v[14:15], v6, s[4:7], s25 offen offset:512 sc1
  buffer_store_dwordx2 v[16:17], v6, s[4:7], s25 offen offset:768 sc1
  buffer_store_dwordx2 v[18:19], v6, s[4:7], s25 offen offset:1024 sc1
  s_lshl_b32 s24, s21, 7
  s_lshl_b32 s25, s22, 2
  s_add_u32 s24, s24, s25
  s_add_u32 s24, s24, 3809280
  s_waitcnt vmcnt(0)
  s_barrier
  s_cmp_eq_u32 s17, 0
  s_cbranch_scc0 Lsf_65
  v_mov_b32 v4, 1
  buffer_store_dword v4, off, s[4:7], s24 sc1
Lsf_65:
  s_add_u32 s21, s21, 2
  s_cmp_lt_u32 s21, 64
  s_cbranch_scc1 Lln2_63
  s_branch mk_g2p1
mk_nln1:
  s_cmp_lt_u32 s50, 158
  s_cbranch_scc0 mk_g2p1
  s_mul_i32 s22, s35, 6554
  s_lshr_b32 s22, s22, 16
  s_mul_i32 s24, s22, 10
  s_sub_u32 s23, s35, s24
  v_lshlrev_b32 v5, 2, v1
  s_mul_i32 s24, s22, 442368
  s_add_u32 s24, s24, s29
  s_add_u32 s72, s24, 8388608
  s_add_u32 s73, s24, 8499200
  s_add_u32 s74, s24, 8609792
  s_add_u32 s75, s24, 8720384
  s_mul_i32 s78, s22, 21846
  s_lshr_b32 s78, s78, 16
  s_mul_i32 s78, s78, 3
  s_sub_u32 s78, s22, s78
  s_mul_i32 s78, s78, 36864
  s_mov_b32 s79, s78
  s_lshl_b32 s25, s17, 15
  s_add_u32 s24, s72, s78
  buffer_load_dwordx4 v[96:99], v2, s[4:7], s24 offen sc1
  s_add_u32 s24, s73, s78
  buffer_load_dwordx4 v[100:103], v2, s[4:7], s24 offen sc1
  s_add_u32 s24, s74, s78
  buffer_load_dwordx4 v[104:107], v2, s[4:7], s24 offen sc1
  s_add_u32 s24, s75, s78
  buffer_load_dwordx4 v[108:111], v2, s[4:7], s24 offen sc1
  s_add_u32 s78, s78, 4096
  s_cmp_eq_u32 s78, 110592
  s_cselect_b32 s78, 0, s78
  s_add_u32 s24, s72, s78
  buffer_load_dwordx4 v[112:115], v2, s[4:7], s24 offen sc1
  s_add_u32 s24, s73, s78
  buffer_load_dwordx4 v[116:119], v2, s[4:7], s24 offen sc1
  s_add_u32 s24, s74, s78
  buffer_load_dwordx4 v[120:123], v2, s[4:7], s24 offen sc1
  s_add_u32 s24, s75, s78
  buffer_load_dwordx4 v[124:127], v2, s[4:7], s24 offen sc1
  s_add_u32 s78, s78, 4096
  s_cmp_eq_u32 s78, 110592
  s_cselect_b32 s78, 0, s78
  s_add_u32 s24, s72, s78
  buffer_load_dwordx4 v[128:131], v2, s[4:7], s24 offen sc1
  s_add_u32 s24, s73, s78
  buffer_load_dwordx4 v[132:135], v2, s[4:7], s24 offen sc1
  s_add_u32 s24, s74, s78
  buffer_load_dwordx4 v[136:139], v2, s[4:7], s24 offen sc1
  s_add_u32 s24, s75, s78
  buffer_load_dwordx4 v[140:143], v2, s[4:7], s24 offen sc1
  s_add_u32 s78, s78, 4096
  s_cmp_eq_u32 s78, 110592
  s_cselect_b32 s78, 0, s78
  s_add_u32 s24, s72, s78
  buffer_load_dwordx4 v[144:147], v2, s[4:7], s24 offen sc1
  s_add_u32 s24, s73, s78
  buffer_load_dwordx4 v[148:151], v2, s[4:7], s24 offen sc1
  s_add_u32 s24, s74, s78
  buffer_load_dwordx4 v[152:155], v2, s[4:7], s24 offen sc1
  s_add_u32 s24, s75, s78
  buffer_load_dwordx4 v[156:159], v2, s[4:7], s24 offen sc1
  s_add_u32 s78, s78, 4096
  s_cmp_eq_u32 s78, 110592
  s_cselect_b32 s78, 0, s78
  s_add_u32 s24, s72, s78
  buffer_load_dwordx4 v[160:163], v2, s[4:7], s24 offen sc1
  s_add_u32 s24, s73, s78
  buffer_load_dwordx4 v[164:167], v2, s[4:7], s24 offen sc1
  s_add_u32 s24, s74, s78
  buffer_load_dwordx4 v[168:171], v2, s[4:7], s24 offen sc1
  s_add_u32 s24, s75, s78
  buffer_load_dwordx4 v[172:175], v2, s[4:7], s24 offen sc1
  s_add_u32 s78, s78, 4096
  s_cmp_eq_u32 s78, 110592
  s_cselect_b32 s78, 0, s78
  s_add_u32 s24, s72, s78
  buffer_load_dwordx4 v[176:179], v2, s[4:7], s24 offen sc1
  s_add_u32 s24, s73, s78
  buffer_load_dwordx4 v[180:183], v2, s[4:7], s24 offen sc1
  s_add_u32 s24, s74, s78
  buffer_load_dwordx4 v[184:187], v2, s[4:7], s24 offen sc1
  s_add_u32 s24, s75, s78
  buffer_load_dwordx4 v[188:191], v2, s[4:7], s24 offen sc1
  s_add_u32 s78, s78, 4096
  s_cmp_eq_u32 s78, 110592
  s_cselect_b32 s78, 0, s78
  s_add_u32 s24, s72, s78
  buffer_load_dwordx4 v[192:195], v2, s[4:7], s24 offen sc1
  s_add_u32 s24, s73, s78
  buffer_load_dwordx4 v[196:199], v2, s[4:7], s24 offen sc1
  s_add_u32 s24, s74, s78
  buffer_load_dwordx4 v[200:203], v2, s[4:7], s24 offen sc1
  s_add_u32 s24, s75, s78
  buffer_load_dwordx4 v[204:207], v2, s[4:7], s24 offen sc1
  s_add_u32 s78, s78, 4096
  s_cmp_eq_u32 s78, 110592
  s_cselect_b32 s78, 0, s78
  s_add_u32 s24, s72, s78
  buffer_load_dwordx4 v[208:211], v2, s[4:7], s24 offen sc1
  s_add_u32 s24, s73, s78
  buffer_load_dwordx4 v[212:215], v2, s[4:7], s24 offen sc1
  s_add_u32 s24, s74, s78
  buffer_load_dwordx4 v[216:219], v2, s[4:7], s24 offen sc1
  s_add_u32 s24, s75, s78
  buffer_load_dwordx4 v[220:223], v2, s[4:7], s24 offen sc1
  s_add_u32 s78, s78, 4096
  s_cmp_eq_u32 s78, 110592
  s_cselect_b32 s78, 0, s78
  s_add_u32 s24, s72, s78
  buffer_load_dwordx4 v[224:227], v2, s[4:7], s24 offen sc1
  s_add_u32 s24, s73, s78
  buffer_load_dwordx4 v[228:231], v2, s[4:7], s24 offen sc1
  s_add_u32 s24, s74, s78
  buffer_load_dwordx4 v[232:235], v2, s[4:7], s24 offen sc1
  s_add_u32 s24, s75, s78
  buffer_load_dwordx4 v[236:239], v2, s[4:7], s24 offen sc1
  s_add_u32 s78, s78, 4096
  s_cmp_eq_u32 s78, 110592
  s_cselect_b32 s78, 0, s78
  s_add_u32 s24, s72, s78
  buffer_load_dwordx4 v[240:243], v2, s[4:7], s24 offen sc1
  s_add_u32 s24, s73, s78
  buffer_load_dwordx4 v[244:247], v2, s[4:7], s24 offen sc1
  s_add_u32 s24, s74, s78
  buffer_load_dwordx4 v[248:251], v2, s[4:7], s24 offen sc1
  s_add_u32 s24, s75, s78
  buffer_load_dwordx4 v[252:255], v2, s[4:7], s24 offen sc1
  s_add_u32 s78, s78, 4096
  s_cmp_eq_u32 s78, 110592
  s_cselect_b32 s78, 0, s78
  s_add_u32 s24, s72, s78
  buffer_load_dwordx4 a[128:131], v2, s[4:7], s24 offen sc1
  s_add_u32 s24, s73, s78
  buffer_load_dwordx4 a[132:135], v2, s[4:7], s24 offen sc1
  s_add_u32 s24, s74, s78
  buffer_load_dwordx4 a[136:139], v2, s[4:7], s24 offen sc1
  s_add_u32 s24, s75, s78
  buffer_load_dwordx4 a[140:143], v2, s[4:7], s24 offen sc1
  s_add_u32 s78, s78, 4096
  s_cmp_eq_u32 s78, 110592
  s_cselect_b32 s78, 0, s78
  s_add_u32 s24, s72, s78
  buffer_load_dwordx4 a[144:147], v2, s[4:7], s24 offen sc1
  s_add_u32 s24, s73, s78
  buffer_load_dwordx4 a[148:151], v2, s[4:7], s24 offen sc1
  s_add_u32 s24, s74, s78
  buffer_load_dwordx4 a[152:155], v2, s[4:7], s24 offen sc1
  s_add_u32 s24, s75, s78
  buffer_load_dwordx4 a[156:159], v2, s[4:7], s24 offen sc1
  s_add_u32 s78, s78, 4096
  s_cmp_eq_u32 s78, 110592
  s_cselect_b32 s78, 0, s78
  s_waitcnt vmcnt(24)
  s_add_u32 s24, s72, s78
  buffer_load_dwordx4 a[160:163], v2, s[4:7], s24 offen sc1
  s_add_u32 s24, s73, s78
  buffer_load_dwordx4 a[164:167], v2, s[4:7], s24 offen sc1
  s_add_u32 s24, s74, s78
  buffer_load_dwordx4 a[168:171], v2, s[4:7], s24 offen sc1
  s_add_u32 s24, s75, s78
  buffer_load_dwordx4 a[172:175], v2, s[4:7], s24 offen sc1
  s_add_u32 s78, s78, 4096
  s_cmp_eq_u32 s78, 110592
  s_cselect_b32 s78, 0, s78
  s_add_u32 s24, s72, s78
  buffer_load_dwordx4 a[176:179], v2, s[4:7], s24 offen sc1
  s_add_u32 s24, s73, s78
  buffer_load_dwordx4 a[180:183], v2, s[4:7], s24 offen sc1
  s_add_u32 s24, s74, s78
  buffer_load_dwordx4 a[184:187], v2, s[4:7], s24 offen sc1
  s_add_u32 s24, s75, s78
  buffer_load_dwordx4 a[188:191], v2, s[4:7], s24 offen sc1
  s_add_u32 s78, s78, 4096
  s_cmp_eq_u32 s78, 110592
  s_cselect_b32 s78, 0, s78
  s_add_u32 s24, s72, s78
  buffer_load_dwordx4 a[192:195], v2, s[4:7], s24 offen sc1
  s_add_u32 s24, s73, s78
  buffer_load_dwordx4 a[196:199], v2, s[4:7], s24 offen sc1
  s_add_u32 s24, s74, s78
  buffer_load_dwordx4 a[200:203], v2, s[4:7], s24 offen sc1
  s_add_u32 s24, s75, s78
  buffer_load_dwordx4 a[204:207], v2, s[4:7], s24 offen sc1
  s_add_u32 s78, s78, 4096
  s_cmp_eq_u32 s78, 110592
  s_cselect_b32 s78, 0, s78
  s_add_u32 s24, s72, s78
  buffer_load_dwordx4 a[208:211], v2, s[4:7], s24 offen sc1
  s_add_u32 s24, s73, s78
  buffer_load_dwordx4 a[212:215], v2, s[4:7], s24 offen sc1
  s_add_u32 s24, s74, s78
  buffer_load_dwordx4 a[216:219], v2, s[4:7], s24 offen sc1
  s_add_u32 s24, s75, s78
  buffer_load_dwordx4 a[220:223], v2, s[4:7], s24 offen sc1
  s_add_u32 s78, s78, 4096
  s_cmp_eq_u32 s78, 110592
  s_cselect_b32 s78, 0, s78
  s_add_u32 s24, s72, s78
  buffer_load_dwordx4 a[224:227], v2, s[4:7], s24 offen sc1
  s_add_u32 s24, s73, s78
  buffer_load_dwordx4 a[228:231], v2, s[4:7], s24 offen sc1
  s_add_u32 s24, s74, s78
  buffer_load_dwordx4 a[232:235], v2, s[4:7], s24 offen sc1
  s_add_u32 s24, s75, s78
  buffer_load_dwordx4 a[236:239], v2, s[4:7], s24 offen sc1
  s_add_u32 s78, s78, 4096
  s_cmp_eq_u32 s78, 110592
  s_cselect_b32 s78, 0, s78
  s_add_u32 s24, s72, s78
  buffer_load_dwordx4 a[240:243], v2, s[4:7], s24 offen sc1
  s_add_u32 s24, s73, s78
  buffer_load_dwordx4 a[244:247], v2, s[4:7], s24 offen sc1
  s_add_u32 s24, s74, s78
  buffer_load_dwordx4 a[248:251], v2, s[4:7], s24 offen sc1
  s_add_u32 s24, s75, s78
  buffer_load_dwordx4 a[252:255], v2, s[4:7], s24 offen sc1
  s_add_u32 s78, s78, 4096
  s_cmp_eq_u32 s78, 110592
  s_cselect_b32 s78, 0, s78
  s_add_u32 s24, s72, s78
  s_add_u32 m0, s25, 24576
  s_nop 0
  buffer_load_dwordx4 v2, s[4:7], s24 offen sc1 lds
  s_add_u32 s24, s73, s78
  s_add_u32 m0, s25, 25600
  s_nop 0
  buffer_load_dwordx4 v2, s[4:7], s24 offen sc1 lds
  s_add_u32 s24, s74, s78
  s_add_u32 m0, s25, 26624
  s_nop 0
  buffer_load_dwordx4 v2, s[4:7], s24 offen sc1 lds
  s_add_u32 s24, s75, s78
  s_add_u32 m0, s25, 27648
  s_nop 0
  buffer_load_dwordx4 v2, s[4:7], s24 offen sc1 lds
  s_add_u32 s78, s78, 4096
  s_cmp_eq_u32 s78, 110592
  s_cselect_b32 s78, 0, s78
  s_add_u32 s24, s72, s78
  s_add_u32 m0, s25, 28672
  s_nop 0
  buffer_load_dwordx4 v2, s[4:7], s24 offen sc1 lds
  s_add_u32 s24, s73, s78
  s_add_u32 m0, s25, 29696
  s_nop 0
  buffer_load_dwordx4 v2, s[4:7], s24 offen sc1 lds
  s_add_u32 s24, s74, s78
  s_add_u32 m0, s25, 30720
  s_nop 0
  buffer_load_dwordx4 v2, s[4:7], s24 offen sc1 lds
  s_add_u32 s24, s75, s78
  s_add_u32 m0, s25, 31744
  s_nop 0
  buffer_load_dwordx4 v2, s[4:7], s24 offen sc1 lds
  s_add_u32 s78, s78, 4096
  s_cmp_eq_u32 s78, 110592
  s_cselect_b32 s78, 0, s78
  s_waitcnt vmcnt(24)
  s_add_u32 s24, s72, s78
  s_add_u32 m0, s25, 32768
  s_nop 0
  buffer_load_dwordx4 v2, s[4:7], s24 offen sc1 lds
  s_add_u32 s24, s73, s78
  s_add_u32 m0, s25, 33792
  s_nop 0
  buffer_load_dwordx4 v2, s[4:7], s24 offen sc1 lds
  s_add_u32 s24, s74, s78
  s_add_u32 m0, s25, 34816
  s_nop 0
  buffer_load_dwordx4 v2, s[4:7], s24 offen sc1 lds
  s_add_u32 s24, s75, s78
  s_add_u32 m0, s25, 35840
  s_nop 0
  buffer_load_dwordx4 v2, s[4:7], s24 offen sc1 lds
  s_add_u32 s78, s78, 4096
  s_cmp_eq_u32 s78, 110592
  s_cselect_b32 s78, 0, s78
  s_add_u32 s24, s72, s78
  s_add_u32 m0, s25, 36864
  s_nop 0
  buffer_load_dwordx4 v2, s[4:7], s24 offen sc1 lds
  s_add_u32 s24, s73, s78
  s_add_u32 m0, s25, 37888
  s_nop 0
  buffer_load_dwordx4 v2, s[4:7], s24 offen sc1 lds
  s_add_u32 s24, s74, s78
  s_add_u32 m0, s25, 38912
  s_nop 0
  buffer_load_dwordx4 v2, s[4:7], s24 offen sc1 lds
  s_add_u32 s24, s75, s78
  s_add_u32 m0, s25, 39936
  s_nop 0
  buffer_load_dwordx4 v2, s[4:7], s24 offen sc1 lds
  s_add_u32 s78, s78, 4096
  s_cmp_eq_u32 s78, 110592
  s_cselect_b32 s78, 0, s78
  s_add_u32 s24, s72, s78
  s_add_u32 m0, s25, 40960
  s_nop 0
  buffer_load_dwordx4 v2, s[4:7], s24 offen sc1 lds
  s_add_u32 s24, s73, s78
  s_add_u32 m0, s25, 41984
  s_nop 0
  buffer_load_dwordx4 v2, s[4:7], s24 offen sc1 lds
  s_add_u32 s24, s74, s78
  s_add_u32 m0, s25, 43008
  s_nop 0
  buffer_load_dwordx4 v2, s[4:7], s24 offen sc1 lds
  s_add_u32 s24, s75, s78
  s_add_u32 m0, s25, 44032
  s_nop 0
  buffer_load_dwordx4 v2, s[4:7], s24 offen sc1 lds
  s_add_u32 s78, s78, 4096
  s_cmp_eq_u32 s78, 110592
  s_cselect_b32 s78, 0, s78
  s_add_u32 s24, s72, s78
  s_add_u32 m0, s25, 45056
  s_nop 0
  buffer_load_dwordx4 v2, s[4:7], s24 offen sc1 lds
  s_add_u32 s24, s73, s78
  s_add_u32 m0, s25, 46080
  s_nop 0
  buffer_load_dwordx4 v2, s[4:7], s24 offen sc1 lds
  s_add_u32 s24, s74, s78
  s_add_u32 m0, s25, 47104
  s_nop 0
  buffer_load_dwordx4 v2, s[4:7], s24 offen sc1 lds
  s_add_u32 s24, s75, s78
  s_add_u32 m0, s25, 48128
  s_nop 0
  buffer_load_dwordx4 v2, s[4:7], s24 offen sc1 lds
  s_add_u32 s78, s78, 4096
  s_cmp_eq_u32 s78, 110592
  s_cselect_b32 s78, 0, s78
  s_add_u32 s24, s72, s78
  s_add_u32 m0, s25, 49152
  s_nop 0
  buffer_load_dwordx4 v2, s[4:7], s24 offen sc1 lds
  s_add_u32 s24, s73, s78
  s_add_u32 m0, s25, 50176
  s_nop 0
  buffer_load_dwordx4 v2, s[4:7], s24 offen sc1 lds
  s_add_u32 s24, s74, s78
  s_add_u32 m0, s25, 51200
  s_nop 0
  buffer_load_dwordx4 v2, s[4:7], s24 offen sc1 lds
  s_add_u32 s24, s75, s78
  s_add_u32 m0, s25, 52224
  s_nop 0
  buffer_load_dwordx4 v2, s[4:7], s24 offen sc1 lds
  s_add_u32 s78, s78, 4096
  s_cmp_eq_u32 s78, 110592
  s_cselect_b32 s78, 0, s78
  s_add_u32 s24, s72, s78
  s_add_u32 m0, s25, 53248
  s_nop 0
  buffer_load_dwordx4 v2, s[4:7], s24 offen sc1 lds
  s_add_u32 s24, s73, s78
  s_add_u32 m0, s25, 54272
  s_nop 0
  buffer_load_dwordx4 v2, s[4:7], s24 offen sc1 lds
  s_add_u32 s24, s74, s78
  s_add_u32 m0, s25, 55296
  s_nop 0
  buffer_load_dwordx4 v2, s[4:7], s24 offen sc1 lds
  s_add_u32 s24, s75, s78
  s_add_u32 m0, s25, 56320
  s_nop 0
  buffer_load_dwordx4 v2, s[4:7], s24 offen sc1 lds
  s_add_u32 s78, s78, 4096
  s_cmp_eq_u32 s78, 110592
  s_cselect_b32 s78, 0, s78
  s_sub_u32 s24, s50, 68
  s_mul_i32 s22, s24, 13108
  s_lshr_b32 s22, s22, 16
  s_mul_i32 s25, s22, 5
  s_sub_u32 s23, s24, s25
  s_mov_b32 s8, s40
  s_and_b32 s9, s41, 0xffff
  s_mov_b32 s10, 7077888
  s_mov_b32 s11, 0x00020000
  s_mov_b32 s52, s42
  s_and_b32 s53, s43, 0xffff
  s_mov_b32 s54, 3456
  s_mov_b32 s55, 0x00020000
  s_mov_b32 s26, 5462
  s_movk_i32 s25, 3456
  s_mul_i32 s24, s22, 192
  v_add_u32 v3, 0, v0
  v_mul_lo_u32 v4, v3, s26
  v_lshrrev_b32 v4, 16, v4
  v_mul_u32_u24 v5, 12, v4
  v_sub_u32 v3, v3, v5
  v_mul_lo_u32 v4, v4, s25
  v_lshl_add_u32 v4, v3, 4, v4
  v_add_u32 v6, s24, v4
  v_add_u32 v3, 256, v0
  v_mul_lo_u32 v4, v3, s26
  v_lshrrev_b32 v4, 16, v4
  v_mul_u32_u24 v5, 12, v4
  v_sub_u32 v3, v3, v5
  v_mul_lo_u32 v4, v4, s25
  v_lshl_add_u32 v4, v3, 4, v4
  v_add_u32 v7, s24, v4
  s_lshl_b32 s24, s23, 8
  v_add_u32 v3, 0, v0
  v_lshrrev_b32 v4, 4, v3
  v_and_b32 v3, 15, v3
  v_and_b32 v5, 3, v4
  v_lshlrev_b32 v5, 2, v5
  v_xor_b32 v3, v3, v5
  v_mul_u32_u24 v4, 0x500, v4
  v_lshl_add_u32 v4, v3, 4, v4
  v_add_u32 v8, s24, v4
  v_add_u32 v3, 256, v0
  v_lshrrev_b32 v4, 4, v3
  v_and_b32 v3, 15, v3
  v_and_b32 v5, 3, v4
  v_lshlrev_b32 v5, 2, v5
  v_xor_b32 v3, v3, v5
  v_mul_u32_u24 v4, 0x500, v4
  v_lshl_add_u32 v4, v3, 4, v4
  v_add_u32 v9, s24, v4
  v_lshrrev_b32 v3, 5, v1
  v_mul_u32_u24 v3, 8, v3
  v_bfe_u32 v4, v1, 2, 2
  v_add_u32 v3, v3, v4
  v_mul_u32_u24 v10, 192, v3
  v_bfe_u32 v4, v1, 1, 1
  v_lshl_add_u32 v10, v4, 3, v10
  v_bfe_u32 v4, v1, 0, 1
  v_lshl_add_u32 v10, v4, 4, v10
  v_bfe_u32 v4, v1, 4, 1
  v_lshl_add_u32 v10, v4, 5, v10
  v_lshrrev_b32 v3, 5, v1
  v_mul_u32_u24 v3, 8, v3
  v_bfe_u32 v4, v1, 2, 2
  v_add_u32 v3, v3, v4
  v_mul_u32_u24 v11, 256, v3
  v_bfe_u32 v4, v1, 1, 1
  v_lshl_add_u32 v11, v4, 3, v11
  v_bfe_u32 v4, v1, 4, 1
  v_lshl_add_u32 v11, v4, 4, v11
  v_bfe_u32 v4, v1, 0, 1
  v_lshl_add_u32 v11, v4, 5, v11
  v_and_b32 v4, 3, v3
  v_lshlrev_b32 v4, 6, v4
  v_xor_b32 v11, v4, v11
  s_lshl_b32 s24, s17, 6
  v_xor_b32 v11, s24, v11
  v_lshlrev_b32 v5, 2, v1
  v_lshrrev_b32 v3, 5, v1
  v_lshlrev_b32 v3, 4, v3
  s_mul_i32 s24, s22, 192
  buffer_load_dwordx4 v[40:43], v3, s[52:55], s24 offen offset:0
  buffer_load_dwordx4 v[44:47], v3, s[52:55], s24 offen offset:32
  buffer_load_dwordx4 v[48:51], v3, s[52:55], s24 offen offset:64
  buffer_load_dwordx4 v[52:55], v3, s[52:55], s24 offen offset:96
  buffer_load_dwordx4 v[56:59], v3, s[52:55], s24 offen offset:128
  buffer_load_dwordx4 v[60:63], v3, s[52:55], s24 offen offset:160
  v_accvgpr_write_b32 a0, 0
  v_accvgpr_write_b32 a1, 0
  v_accvgpr_write_b32 a2, 0
  v_accvgpr_write_b32 a3, 0
  v_accvgpr_write_b32 a4, 0
  v_accvgpr_write_b32 a5, 0
  v_accvgpr_write_b32 a6, 0
  v_accvgpr_write_b32 a7, 0
  v_accvgpr_write_b32 a8, 0
  v_accvgpr_write_b32 a9, 0
  v_accvgpr_write_b32 a10, 0
  v_accvgpr_write_b32 a11, 0
  v_accvgpr_write_b32 a12, 0
  v_accvgpr_write_b32 a13, 0
  v_accvgpr_write_b32 a14, 0
  v_accvgpr_write_b32 a15, 0
  v_accvgpr_write_b32 a16, 0
  v_accvgpr_write_b32 a17, 0
  v_accvgpr_write_b32 a18, 0
  v_accvgpr_write_b32 a19, 0
  v_accvgpr_write_b32 a20, 0
  v_accvgpr_write_b32 a21, 0
  v_accvgpr_write_b32 a22, 0
  v_accvgpr_write_b32 a23, 0
  v_accvgpr_write_b32 a24, 0
  v_accvgpr_write_b32 a25, 0
  v_accvgpr_write_b32 a26, 0
  v_accvgpr_write_b32 a27, 0
  v_accvgpr_write_b32 a28, 0
  v_accvgpr_write_b32 a29, 0
  v_accvgpr_write_b32 a30, 0
  v_accvgpr_write_b32 a31, 0
  v_accvgpr_write_b32 a32, 0
  v_accvgpr_write_b32 a33, 0
  v_accvgpr_write_b32 a34, 0
  v_accvgpr_write_b32 a35, 0
  v_accvgpr_write_b32 a36, 0
  v_accvgpr_write_b32 a37, 0
  v_accvgpr_write_b32 a38, 0
  v_accvgpr_write_b32 a39, 0
  v_accvgpr_write_b32 a40, 0
  v_accvgpr_write_b32 a41, 0
  v_accvgpr_write_b32 a42, 0
  v_accvgpr_write_b32 a43, 0
  v_accvgpr_write_b32 a44, 0
  v_accvgpr_write_b32 a45, 0
  v_accvgpr_write_b32 a46, 0
  v_accvgpr_write_b32 a47, 0
  s_mov_b32 s27, 0
  s_mov_b32 s28, 199229440
  s_mov_b32 s31, 3809280
  s_mov_b32 s21, 0
  s_barrier
  s_add_u32 m0, s29, 0
  s_nop 0
  buffer_load_dwordx4 v6, s[8:11], s27 offen lds
  s_add_u32 m0, s29, 4096
  s_nop 0
  buffer_load_dwordx4 v7, s[8:11], s27 offen lds
  s_add_u32 s27, s27, 110592
Lg1p_66:
  s_cmp_lg_u32 s17, 0
  s_cbranch_scc1 Lww_67_ok
Lww_67:
  buffer_load_dword v12, v5, s[4:7], s31 offen sc1
  s_waitcnt vmcnt(0)
  v_cmp_eq_u32 vcc, 0, v12
  s_add_u32 s0, s0, 1
  s_and_b32 s25, vcc_lo, 15
  s_cbranch_scc0 Lww_67_ok
  s_sleep 2
  s_cmp_lt_u32 s0, 1572864
  s_cbranch_scc1 Lww_67
Lww_67_ok:
  s_barrier
  s_add_u32 m0, s29, 16384
  s_nop 0
  buffer_load_dwordx4 v8, s[4:7], s28 offen sc1 lds
  s_add_u32 m0, s29, 20480
  s_nop 0
  buffer_load_dwordx4 v9, s[4:7], s28 offen sc1 lds
  s_add_u32 m0, s29, 8192
  s_nop 0
  buffer_load_dwordx4 v6, s[8:11], s27 offen lds
  s_add_u32 m0, s29, 12288
  s_nop 0
  buffer_load_dwordx4 v7, s[8:11], s27 offen lds
  s_add_u32 s27, s27, 110592
  s_add_u32 s28, s28, 40960
  s_add_u32 s31, s31, 128
  s_waitcnt vmcnt(2)
  s_barrier
  ds_read_b64_tr_b16 v[28:29], v11 offset:16384
  ds_read_b64_tr_b16 v[30:31], v11 offset:17408
  ds_read_b64_tr_b16 v[16:17], v10 offset:0
  ds_read_b64_tr_b16 v[18:19], v10 offset:768
  ds_read_b64_tr_b16 v[20:21], v10 offset:64
  ds_read_b64_tr_b16 v[22:23], v10 offset:832
  ds_read_b64_tr_b16 v[24:25], v10 offset:128
  ds_read_b64_tr_b16 v[26:27], v10 offset:896
  ds_read_b64_tr_b16 v[76:77], v11 offset:20480
  ds_read_b64_tr_b16 v[78:79], v11 offset:21504
  ds_read_b64_tr_b16 v[64:65], v10 offset:3072
  ds_read_b64_tr_b16 v[66:67], v10 offset:3840
  ds_read_b64_tr_b16 v[68:69], v10 offset:3136
  ds_read_b64_tr_b16 v[70:71], v10 offset:3904
  ds_read_b64_tr_b16 v[72:73], v10 offset:3200
  ds_read_b64_tr_b16 v[74:75], v10 offset:3968
  s_waitcnt lgkmcnt(8)
  v_mfma_f32_32x32x16_bf16 a[0:15], v[16:19], v[28:31], a[0:15]
  v_mfma_f32_32x32x16_bf16 a[16:31], v[20:23], v[28:31], a[16:31]
  v_mfma_f32_32x32x16_bf16 a[32:47], v[24:27], v[28:31], a[32:47]
  s_waitcnt lgkmcnt(0)
  v_mfma_f32_32x32x16_bf16 a[0:15], v[64:67], v[76:79], a[0:15]
  v_mfma_f32_32x32x16_bf16 a[16:31], v[68:71], v[76:79], a[16:31]
  v_mfma_f32_32x32x16_bf16 a[32:47], v[72:75], v[76:79], a[32:47]
  s_barrier
  s_cmp_lg_u32 s17, 0
  s_cbranch_scc1 Lww_68_ok
Lww_68:
  buffer_load_dword v12, v5, s[4:7], s31 offen sc1
  s_waitcnt vmcnt(0)
  v_cmp_eq_u32 vcc, 0, v12
  s_add_u32 s0, s0, 1
  s_and_b32 s25, vcc_lo, 15
  s_cbranch_scc0 Lww_68_ok
  s_sleep 2
  s_cmp_lt_u32 s0, 1572864
  s_cbranch_scc1 Lww_68
Lww_68_ok:
  s_barrier
  s_add_u32 m0, s29, 16384
  s_nop 0
  buffer_load_dwordx4 v8, s[4:7], s28 offen sc1 lds
  s_add_u32 m0, s29, 20480
  s_nop 0
  buffer_load_dwordx4 v9, s[4:7], s28 offen sc1 lds
  s_add_u32 m0, s29, 0
  s_nop 0
  buffer_load_dwordx4 v6, s[8:11], s27 offen lds
  s_add_u32 m0, s29, 4096
  s_nop 0
  buffer_load_dwordx4 v7, s[8:11], s27 offen lds
  s_add_u32 s27, s27, 110592
  s_add_u32 s28, s28, 40960
  s_add_u32 s31, s31, 128
  s_waitcnt vmcnt(2)
  s_barrier
  ds_read_b64_tr_b16 v[28:29], v11 offset:16384
  ds_read_b64_tr_b16 v[30:31], v11 offset:17408
  ds_read_b64_tr_b16 v[16:17], v10 offset:8192
  ds_read_b64_tr_b16 v[18:19], v10 offset:8960
  ds_read_b64_tr_b16 v[20:21], v10 offset:8256
  ds_read_b64_tr_b16 v[22:23], v10 offset:9024
  ds_read_b64_tr_b16 v[24:25], v10 offset:8320
  ds_read_b64_tr_b16 v[26:27], v10 offset:9088
  ds_read_b64_tr_b16 v[76:77], v11 offset:20480
  ds_read_b64_tr_b16 v[78:79], v11 offset:21504
  ds_read_b64_tr_b16 v[64:65], v10 offset:11264
  ds_read_b64_tr_b16 v[66:67], v10 offset:12032
  ds_read_b64_tr_b16 v[68:69], v10 offset:11328
  ds_read_b64_tr_b16 v[70:71], v10 offset:12096
  ds_read_b64_tr_b16 v[72:73], v10 offset:11392
  ds_read_b64_tr_b16 v[74:75], v10 offset:12160
  s_waitcnt lgkmcnt(8)
  v_mfma_f32_32x32x16_bf16 a[0:15], v[16:19], v[28:31], a[0:15]
  v_mfma_f32_32x32x16_bf16 a[16:31], v[20:23], v[28:31], a[16:31]
  v_mfma_f32_32x32x16_bf16 a[32:47], v[24:27], v[28:31], a[32:47]
  s_waitcnt lgkmcnt(0)
  v_mfma_f32_32x32x16_bf16 a[0:15], v[64:67], v[76:79], a[0:15]
  v_mfma_f32_32x32x16_bf16 a[16:31], v[68:71], v[76:79], a[16:31]
  v_mfma_f32_32x32x16_bf16 a[32:47], v[72:75], v[76:79], a[32:47]
  s_barrier
  s_add_u32 s21, s21, 2
  s_cmp_lt_u32 s21, 64
  s_cbranch_scc1 Lg1p_66
  s_lshl_b32 s24, s23, 2
  s_add_u32 s24, s24, s17
  s_mul_i32 s26, s24, 110592
  s_mul_i32 s24, s22, 6144
  s_add_u32 s26, s26, s24
  s_add_u32 s26, s26, 202375168
  s_mov_b32 s24, 0xc0135761
  s_mov_b32 s27, 0xbdd2d3e8
  v_accvgpr_read_b32 v64, a0
  v_accvgpr_read_b32 v65, a1
  v_accvgpr_read_b32 v66, a2
  v_accvgpr_read_b32 v67, a3
  v_accvgpr_read_b32 v68, a4
  v_accvgpr_read_b32 v69, a5
  v_accvgpr_read_b32 v70, a6
  v_accvgpr_read_b32 v71, a7
  v_accvgpr_read_b32 v72, a8
  v_accvgpr_read_b32 v73, a9
  v_accvgpr_read_b32 v74, a10
  v_accvgpr_read_b32 v75, a11
  v_accvgpr_read_b32 v76, a12
  v_accvgpr_read_b32 v77, a13
  v_accvgpr_read_b32 v78, a14
  v_accvgpr_read_b32 v79, a15
  v_cvt_pk_bf16_f32 v16, v64, v65
  v_cvt_pk_bf16_f32 v17, v66, v67
  v_cvt_pk_bf16_f32 v18, v68, v69
  v_cvt_pk_bf16_f32 v19, v70, v71
  v_cvt_pk_bf16_f32 v20, v72, v73
  v_cvt_pk_bf16_f32 v21, v74, v75
  v_cvt_pk_bf16_f32 v22, v76, v77
  v_cvt_pk_bf16_f32 v23, v78, v79
  v_lshlrev_b32 v64, 16, v16
  v_and_b32 v65, 0xffff0000, v16
  v_lshlrev_b32 v66, 16, v17
  v_and_b32 v67, 0xffff0000, v17
  v_lshlrev_b32 v68, 16, v18
  v_and_b32 v69, 0xffff0000, v18
  v_lshlrev_b32 v70, 16, v19
  v_and_b32 v71, 0xffff0000, v19
  v_lshlrev_b32 v72, 16, v20
  v_and_b32 v73, 0xffff0000, v20
  v_lshlrev_b32 v74, 16, v21
  v_and_b32 v75, 0xffff0000, v21
  v_lshlrev_b32 v76, 16, v22
  v_and_b32 v77, 0xffff0000, v22
  v_lshlrev_b32 v78, 16, v23
  v_and_b32 v79, 0xffff0000, v23
  v_lshlrev_b32 v80, 16, v40
  v_and_b32 v81, 0xffff0000, v40
  v_lshlrev_b32 v82, 16, v41
  v_and_b32 v83, 0xffff0000, v41
  v_lshlrev_b32 v84, 16, v42
  v_and_b32 v85, 0xffff0000, v42
  v_lshlrev_b32 v86, 16, v43
  v_and_b32 v87, 0xffff0000, v43
  v_lshlrev_b32 v88, 16, v44
  v_and_b32 v89, 0xffff0000, v44
  v_lshlrev_b32 v90, 16, v45
  v_and_b32 v91, 0xffff0000, v45
  v_lshlrev_b32 v92, 16, v46
  v_and_b32 v93, 0xffff0000, v46
  v_lshlrev_b32 v94, 16, v47
  v_and_b32 v95, 0xffff0000, v47
  v_pk_add_f32 v[64:65], v[64:65], v[80:81]
  v_pk_add_f32 v[66:67], v[66:67], v[82:83]
  v_pk_add_f32 v[68:69], v[68:69], v[84:85]
  v_pk_add_f32 v[70:71], v[70:71], v[86:87]
  v_pk_add_f32 v[72:73], v[72:73], v[88:89]
  v_pk_add_f32 v[74:75], v[74:75], v[90:91]
  v_pk_add_f32 v[76:77], v[76:77], v[92:93]
  v_pk_add_f32 v[78:79], v[78:79], v[94:95]
  v_cvt_pk_bf16_f32 v16, v64, v65
  v_cvt_pk_bf16_f32 v17, v66, v67
  v_cvt_pk_bf16_f32 v18, v68, v69
  v_cvt_pk_bf16_f32 v19, v70, v71
  v_cvt_pk_bf16_f32 v20, v72, v73
  v_cvt_pk_bf16_f32 v21, v74, v75
  v_cvt_pk_bf16_f32 v22, v76, v77
  v_cvt_pk_bf16_f32 v23, v78, v79
  v_lshlrev_b32 v64, 16, v16
  v_and_b32 v65, 0xffff0000, v16
  v_lshlrev_b32 v66, 16, v17
  v_and_b32 v67, 0xffff0000, v17
  v_lshlrev_b32 v68, 16, v18
  v_and_b32 v69, 0xffff0000, v18
  v_lshlrev_b32 v70, 16, v19
  v_and_b32 v71, 0xffff0000, v19
  v_lshlrev_b32 v72, 16, v20
  v_and_b32 v73, 0xffff0000, v20
  v_lshlrev_b32 v74, 16, v21
  v_and_b32 v75, 0xffff0000, v21
  v_lshlrev_b32 v76, 16, v22
  v_and_b32 v77, 0xffff0000, v22
  v_lshlrev_b32 v78, 16, v23
  v_and_b32 v79, 0xffff0000, v23
  v_mul_f32 v80, v64, v64
  v_mul_f32 v81, v65, v65
  v_mul_f32 v82, v66, v66
  v_mul_f32 v83, v67, v67
  v_mul_f32 v84, v68, v68
  v_mul_f32 v85, v69, v69
  v_mul_f32 v86, v70, v70
  v_mul_f32 v87, v71, v71
  v_mov_b32 v40, s24
  v_fmac_f32 v40, s27, v80
  v_mov_b32 v41, s24
  v_fmac_f32 v41, s27, v81
  v_mov_b32 v42, s24
  v_fmac_f32 v42, s27, v82
  v_mov_b32 v43, s24
  v_fmac_f32 v43, s27, v83
  v_mov_b32 v44, s24
  v_fmac_f32 v44, s27, v84
  v_mov_b32 v45, s24
  v_fmac_f32 v45, s27, v85
  v_mov_b32 v46, s24
  v_fmac_f32 v46, s27, v86
  v_mov_b32 v47, s24
  v_fmac_f32 v47, s27, v87
  v_mul_f32 v80, v40, v64
  v_mul_f32 v81, v41, v65
  v_mul_f32 v82, v42, v66
  v_mul_f32 v83, v43, v67
  v_mul_f32 v84, v44, v68
  v_mul_f32 v85, v45, v69
  v_mul_f32 v86, v46, v70
  v_mul_f32 v87, v47, v71
  v_exp_f32 v80, v80
  v_exp_f32 v81, v81
  v_exp_f32 v82, v82
  v_exp_f32 v83, v83
  v_exp_f32 v84, v84
  v_exp_f32 v85, v85
  v_exp_f32 v86, v86
  v_exp_f32 v87, v87
  v_add_f32 v80, 1.0, v80
  v_add_f32 v81, 1.0, v81
  v_add_f32 v82, 1.0, v82
  v_add_f32 v83, 1.0, v83
  v_add_f32 v84, 1.0, v84
  v_add_f32 v85, 1.0, v85
  v_add_f32 v86, 1.0, v86
  v_add_f32 v87, 1.0, v87
  v_rcp_f32 v80, v80
  v_rcp_f32 v81, v81
  v_rcp_f32 v82, v82
  v_rcp_f32 v83, v83
  v_rcp_f32 v84, v84
  v_rcp_f32 v85, v85
  v_rcp_f32 v86, v86
  v_rcp_f32 v87, v87
  v_mul_f32 v64, v64, v80
  v_mul_f32 v65, v65, v81
  v_mul_f32 v66, v66, v82
  v_mul_f32 v67, v67, v83
  v_mul_f32 v68, v68, v84
  v_mul_f32 v69, v69, v85
  v_mul_f32 v70, v70, v86
  v_mul_f32 v71, v71, v87
  v_mul_f32 v88, v72, v72
  v_mul_f32 v89, v73, v73
  v_mul_f32 v90, v74, v74
  v_mul_f32 v91, v75, v75
  v_mul_f32 v92, v76, v76
  v_mul_f32 v93, v77, v77
  v_mul_f32 v94, v78, v78
  v_mul_f32 v95, v79, v79
  v_mov_b32 v40, s24
  v_fmac_f32 v40, s27, v88
  v_mov_b32 v41, s24
  v_fmac_f32 v41, s27, v89
  v_mov_b32 v42, s24
  v_fmac_f32 v42, s27, v90
  v_mov_b32 v43, s24
  v_fmac_f32 v43, s27, v91
  v_mov_b32 v44, s24
  v_fmac_f32 v44, s27, v92
  v_mov_b32 v45, s24
  v_fmac_f32 v45, s27, v93
  v_mov_b32 v46, s24
  v_fmac_f32 v46, s27, v94
  v_mov_b32 v47, s24
  v_fmac_f32 v47, s27, v95
  v_mul_f32 v88, v40, v72
  v_mul_f32 v89, v41, v73
  v_mul_f32 v90, v42, v74
  v_mul_f32 v91, v43, v75
  v_mul_f32 v92, v44, v76
  v_mul_f32 v93, v45, v77
  v_mul_f32 v94, v46, v78
  v_mul_f32 v95, v47, v79
  v_exp_f32 v88, v88
  v_exp_f32 v89, v89
  v_exp_f32 v90, v90
  v_exp_f32 v91, v91
  v_exp_f32 v92, v92
  v_exp_f32 v93, v93
  v_exp_f32 v94, v94
  v_exp_f32 v95, v95
  v_add_f32 v88, 1.0, v88
  v_add_f32 v89, 1.0, v89
  v_add_f32 v90, 1.0, v90
  v_add_f32 v91, 1.0, v91
  v_add_f32 v92, 1.0, v92
  v_add_f32 v93, 1.0, v93
  v_add_f32 v94, 1.0, v94
  v_add_f32 v95, 1.0, v95
  v_rcp_f32 v88, v88
  v_rcp_f32 v89, v89
  v_rcp_f32 v90, v90
  v_rcp_f32 v91, v91
  v_rcp_f32 v92, v92
  v_rcp_f32 v93, v93
  v_rcp_f32 v94, v94
  v_rcp_f32 v95, v95
  v_mul_f32 v72, v72, v88
  v_mul_f32 v73, v73, v89
  v_mul_f32 v74, v74, v90
  v_mul_f32 v75, v75, v91
  v_mul_f32 v76, v76, v92
  v_mul_f32 v77, v77, v93
  v_mul_f32 v78, v78, v94
  v_mul_f32 v79, v79, v95
  v_cvt_pk_bf16_f32 v16, v64, v65
  v_cvt_pk_bf16_f32 v17, v66, v67
  v_cvt_pk_bf16_f32 v18, v68, v69
  v_cvt_pk_bf16_f32 v19, v70, v71
  v_cvt_pk_bf16_f32 v20, v72, v73
  v_cvt_pk_bf16_f32 v21, v74, v75
  v_cvt_pk_bf16_f32 v22, v76, v77
  v_cvt_pk_bf16_f32 v23, v78, v79
  buffer_store_dwordx4 v[16:19], v2, s[4:7], s26 offen offset:0 sc1
  buffer_store_dwordx4 v[20:23], v2, s[4:7], s26 offen offset:1024 sc1
  v_accvgpr_read_b32 v64, a16
  v_accvgpr_read_b32 v65, a17
  v_accvgpr_read_b32 v66, a18
  v_accvgpr_read_b32 v67, a19
  v_accvgpr_read_b32 v68, a20
  v_accvgpr_read_b32 v69, a21
  v_accvgpr_read_b32 v70, a22
  v_accvgpr_read_b32 v71, a23
  v_accvgpr_read_b32 v72, a24
  v_accvgpr_read_b32 v73, a25
  v_accvgpr_read_b32 v74, a26
  v_accvgpr_read_b32 v75, a27
  v_accvgpr_read_b32 v76, a28
  v_accvgpr_read_b32 v77, a29
  v_accvgpr_read_b32 v78, a30
  v_accvgpr_read_b32 v79, a31
  v_cvt_pk_bf16_f32 v24, v64, v65
  v_cvt_pk_bf16_f32 v25, v66, v67
  v_cvt_pk_bf16_f32 v26, v68, v69
  v_cvt_pk_bf16_f32 v27, v70, v71
  v_cvt_pk_bf16_f32 v28, v72, v73
  v_cvt_pk_bf16_f32 v29, v74, v75
  v_cvt_pk_bf16_f32 v30, v76, v77
  v_cvt_pk_bf16_f32 v31, v78, v79
  v_lshlrev_b32 v64, 16, v24
  v_and_b32 v65, 0xffff0000, v24
  v_lshlrev_b32 v66, 16, v25
  v_and_b32 v67, 0xffff0000, v25
  v_lshlrev_b32 v68, 16, v26
  v_and_b32 v69, 0xffff0000, v26
  v_lshlrev_b32 v70, 16, v27
  v_and_b32 v71, 0xffff0000, v27
  v_lshlrev_b32 v72, 16, v28
  v_and_b32 v73, 0xffff0000, v28
  v_lshlrev_b32 v74, 16, v29
  v_and_b32 v75, 0xffff0000, v29
  v_lshlrev_b32 v76, 16, v30
  v_and_b32 v77, 0xffff0000, v30
  v_lshlrev_b32 v78, 16, v31
  v_and_b32 v79, 0xffff0000, v31
  v_lshlrev_b32 v80, 16, v48
  v_and_b32 v81, 0xffff0000, v48
  v_lshlrev_b32 v82, 16, v49
  v_and_b32 v83, 0xffff0000, v49
  v_lshlrev_b32 v84, 16, v50
  v_and_b32 v85, 0xffff0000, v50
  v_lshlrev_b32 v86, 16, v51
  v_and_b32 v87, 0xffff0000, v51
  v_lshlrev_b32 v88, 16, v52
  v_and_b32 v89, 0xffff0000, v52
  v_lshlrev_b32 v90, 16, v53
  v_and_b32 v91, 0xffff0000, v53
  v_lshlrev_b32 v92, 16, v54
  v_and_b32 v93, 0xffff0000, v54
  v_lshlrev_b32 v94, 16, v55
  v_and_b32 v95, 0xffff0000, v55
  v_pk_add_f32 v[64:65], v[64:65], v[80:81]
  v_pk_add_f32 v[66:67], v[66:67], v[82:83]
  v_pk_add_f32 v[68:69], v[68:69], v[84:85]
  v_pk_add_f32 v[70:71], v[70:71], v[86:87]
  v_pk_add_f32 v[72:73], v[72:73], v[88:89]
  v_pk_add_f32 v[74:75], v[74:75], v[90:91]
  v_pk_add_f32 v[76:77], v[76:77], v[92:93]
  v_pk_add_f32 v[78:79], v[78:79], v[94:95]
  v_cvt_pk_bf16_f32 v24, v64, v65
  v_cvt_pk_bf16_f32 v25, v66, v67
  v_cvt_pk_bf16_f32 v26, v68, v69
  v_cvt_pk_bf16_f32 v27, v70, v71
  v_cvt_pk_bf16_f32 v28, v72, v73
  v_cvt_pk_bf16_f32 v29, v74, v75
  v_cvt_pk_bf16_f32 v30, v76, v77
  v_cvt_pk_bf16_f32 v31, v78, v79
  v_lshlrev_b32 v64, 16, v24
  v_and_b32 v65, 0xffff0000, v24
  v_lshlrev_b32 v66, 16, v25
  v_and_b32 v67, 0xffff0000, v25
  v_lshlrev_b32 v68, 16, v26
  v_and_b32 v69, 0xffff0000, v26
  v_lshlrev_b32 v70, 16, v27
  v_and_b32 v71, 0xffff0000, v27
  v_lshlrev_b32 v72, 16, v28
  v_and_b32 v73, 0xffff0000, v28
  v_lshlrev_b32 v74, 16, v29
  v_and_b32 v75, 0xffff0000, v29
  v_lshlrev_b32 v76, 16, v30
  v_and_b32 v77, 0xffff0000, v30
  v_lshlrev_b32 v78, 16, v31
  v_and_b32 v79, 0xffff0000, v31
  v_mul_f32 v80, v64, v64
  v_mul_f32 v81, v65, v65
  v_mul_f32 v82, v66, v66
  v_mul_f32 v83, v67, v67
  v_mul_f32 v84, v68, v68
  v_mul_f32 v85, v69, v69
  v_mul_f32 v86, v70, v70
  v_mul_f32 v87, v71, v71
  v_mov_b32 v48, s24
  v_fmac_f32 v48, s27, v80
  v_mov_b32 v49, s24
  v_fmac_f32 v49, s27, v81
  v_mov_b32 v50, s24
  v_fmac_f32 v50, s27, v82
  v_mov_b32 v51, s24
  v_fmac_f32 v51, s27, v83
  v_mov_b32 v52, s24
  v_fmac_f32 v52, s27, v84
  v_mov_b32 v53, s24
  v_fmac_f32 v53, s27, v85
  v_mov_b32 v54, s24
  v_fmac_f32 v54, s27, v86
  v_mov_b32 v55, s24
  v_fmac_f32 v55, s27, v87
  v_mul_f32 v80, v48, v64
  v_mul_f32 v81, v49, v65
  v_mul_f32 v82, v50, v66
  v_mul_f32 v83, v51, v67
  v_mul_f32 v84, v52, v68
  v_mul_f32 v85, v53, v69
  v_mul_f32 v86, v54, v70
  v_mul_f32 v87, v55, v71
  v_exp_f32 v80, v80
  v_exp_f32 v81, v81
  v_exp_f32 v82, v82
  v_exp_f32 v83, v83
  v_exp_f32 v84, v84
  v_exp_f32 v85, v85
  v_exp_f32 v86, v86
  v_exp_f32 v87, v87
  v_add_f32 v80, 1.0, v80
  v_add_f32 v81, 1.0, v81
  v_add_f32 v82, 1.0, v82
  v_add_f32 v83, 1.0, v83
  v_add_f32 v84, 1.0, v84
  v_add_f32 v85, 1.0, v85
  v_add_f32 v86, 1.0, v86
  v_add_f32 v87, 1.0, v87
  v_rcp_f32 v80, v80
  v_rcp_f32 v81, v81
  v_rcp_f32 v82, v82
  v_rcp_f32 v83, v83
  v_rcp_f32 v84, v84
  v_rcp_f32 v85, v85
  v_rcp_f32 v86, v86
  v_rcp_f32 v87, v87
  v_mul_f32 v64, v64, v80
  v_mul_f32 v65, v65, v81
  v_mul_f32 v66, v66, v82
  v_mul_f32 v67, v67, v83
  v_mul_f32 v68, v68, v84
  v_mul_f32 v69, v69, v85
  v_mul_f32 v70, v70, v86
  v_mul_f32 v71, v71, v87
  v_mul_f32 v88, v72, v72
  v_mul_f32 v89, v73, v73
  v_mul_f32 v90, v74, v74
  v_mul_f32 v91, v75, v75
  v_mul_f32 v92, v76, v76
  v_mul_f32 v93, v77, v77
  v_mul_f32 v94, v78, v78
  v_mul_f32 v95, v79, v79
  v_mov_b32 v48, s24
  v_fmac_f32 v48, s27, v88
  v_mov_b32 v49, s24
  v_fmac_f32 v49, s27, v89
  v_mov_b32 v50, s24
  v_fmac_f32 v50, s27, v90
  v_mov_b32 v51, s24
  v_fmac_f32 v51, s27, v91
  v_mov_b32 v52, s24
  v_fmac_f32 v52, s27, v92
  v_mov_b32 v53, s24
  v_fmac_f32 v53, s27, v93
  v_mov_b32 v54, s24
  v_fmac_f32 v54, s27, v94
  v_mov_b32 v55, s24
  v_fmac_f32 v55, s27, v95
  v_mul_f32 v88, v48, v72
  v_mul_f32 v89, v49, v73
  v_mul_f32 v90, v50, v74
  v_mul_f32 v91, v51, v75
  v_mul_f32 v92, v52, v76
  v_mul_f32 v93, v53, v77
  v_mul_f32 v94, v54, v78
  v_mul_f32 v95, v55, v79
  v_exp_f32 v88, v88
  v_exp_f32 v89, v89
  v_exp_f32 v90, v90
  v_exp_f32 v91, v91
  v_exp_f32 v92, v92
  v_exp_f32 v93, v93
  v_exp_f32 v94, v94
  v_exp_f32 v95, v95
  v_add_f32 v88, 1.0, v88
  v_add_f32 v89, 1.0, v89
  v_add_f32 v90, 1.0, v90
  v_add_f32 v91, 1.0, v91
  v_add_f32 v92, 1.0, v92
  v_add_f32 v93, 1.0, v93
  v_add_f32 v94, 1.0, v94
  v_add_f32 v95, 1.0, v95
  v_rcp_f32 v88, v88
  v_rcp_f32 v89, v89
  v_rcp_f32 v90, v90
  v_rcp_f32 v91, v91
  v_rcp_f32 v92, v92
  v_rcp_f32 v93, v93
  v_rcp_f32 v94, v94
  v_rcp_f32 v95, v95
  v_mul_f32 v72, v72, v88
  v_mul_f32 v73, v73, v89
  v_mul_f32 v74, v74, v90
  v_mul_f32 v75, v75, v91
  v_mul_f32 v76, v76, v92
  v_mul_f32 v77, v77, v93
  v_mul_f32 v78, v78, v94
  v_mul_f32 v79, v79, v95
  v_cvt_pk_bf16_f32 v24, v64, v65
  v_cvt_pk_bf16_f32 v25, v66, v67
  v_cvt_pk_bf16_f32 v26, v68, v69
  v_cvt_pk_bf16_f32 v27, v70, v71
  v_cvt_pk_bf16_f32 v28, v72, v73
  v_cvt_pk_bf16_f32 v29, v74, v75
  v_cvt_pk_bf16_f32 v30, v76, v77
  v_cvt_pk_bf16_f32 v31, v78, v79
  buffer_store_dwordx4 v[24:27], v2, s[4:7], s26 offen offset:2048 sc1
  buffer_store_dwordx4 v[28:31], v2, s[4:7], s26 offen offset:3072 sc1
  v_accvgpr_read_b32 v64, a32
  v_accvgpr_read_b32 v65, a33
  v_accvgpr_read_b32 v66, a34
  v_accvgpr_read_b32 v67, a35
  v_accvgpr_read_b32 v68, a36
  v_accvgpr_read_b32 v69, a37
  v_accvgpr_read_b32 v70, a38
  v_accvgpr_read_b32 v71, a39
  v_accvgpr_read_b32 v72, a40
  v_accvgpr_read_b32 v73, a41
  v_accvgpr_read_b32 v74, a42
  v_accvgpr_read_b32 v75, a43
  v_accvgpr_read_b32 v76, a44
  v_accvgpr_read_b32 v77, a45
  v_accvgpr_read_b32 v78, a46
  v_accvgpr_read_b32 v79, a47
  v_cvt_pk_bf16_f32 v32, v64, v65
  v_cvt_pk_bf16_f32 v33, v66, v67
  v_cvt_pk_bf16_f32 v34, v68, v69
  v_cvt_pk_bf16_f32 v35, v70, v71
  v_cvt_pk_bf16_f32 v36, v72, v73
  v_cvt_pk_bf16_f32 v37, v74, v75
  v_cvt_pk_bf16_f32 v38, v76, v77
  v_cvt_pk_bf16_f32 v39, v78, v79
  v_lshlrev_b32 v64, 16, v32
  v_and_b32 v65, 0xffff0000, v32
  v_lshlrev_b32 v66, 16, v33
  v_and_b32 v67, 0xffff0000, v33
  v_lshlrev_b32 v68, 16, v34
  v_and_b32 v69, 0xffff0000, v34
  v_lshlrev_b32 v70, 16, v35
  v_and_b32 v71, 0xffff0000, v35
  v_lshlrev_b32 v72, 16, v36
  v_and_b32 v73, 0xffff0000, v36
  v_lshlrev_b32 v74, 16, v37
  v_and_b32 v75, 0xffff0000, v37
  v_lshlrev_b32 v76, 16, v38
  v_and_b32 v77, 0xffff0000, v38
  v_lshlrev_b32 v78, 16, v39
  v_and_b32 v79, 0xffff0000, v39
  v_lshlrev_b32 v80, 16, v56
  v_and_b32 v81, 0xffff0000, v56
  v_lshlrev_b32 v82, 16, v57
  v_and_b32 v83, 0xffff0000, v57
  v_lshlrev_b32 v84, 16, v58
  v_and_b32 v85, 0xffff0000, v58
  v_lshlrev_b32 v86, 16, v59
  v_and_b32 v87, 0xffff0000, v59
  v_lshlrev_b32 v88, 16, v60
  v_and_b32 v89, 0xffff0000, v60
  v_lshlrev_b32 v90, 16, v61
  v_and_b32 v91, 0xffff0000, v61
  v_lshlrev_b32 v92, 16, v62
  v_and_b32 v93, 0xffff0000, v62
  v_lshlrev_b32 v94, 16, v63
  v_and_b32 v95, 0xffff0000, v63
  v_pk_add_f32 v[64:65], v[64:65], v[80:81]
  v_pk_add_f32 v[66:67], v[66:67], v[82:83]
  v_pk_add_f32 v[68:69], v[68:69], v[84:85]
  v_pk_add_f32 v[70:71], v[70:71], v[86:87]
  v_pk_add_f32 v[72:73], v[72:73], v[88:89]
  v_pk_add_f32 v[74:75], v[74:75], v[90:91]
  v_pk_add_f32 v[76:77], v[76:77], v[92:93]
  v_pk_add_f32 v[78:79], v[78:79], v[94:95]
  v_cvt_pk_bf16_f32 v32, v64, v65
  v_cvt_pk_bf16_f32 v33, v66, v67
  v_cvt_pk_bf16_f32 v34, v68, v69
  v_cvt_pk_bf16_f32 v35, v70, v71
  v_cvt_pk_bf16_f32 v36, v72, v73
  v_cvt_pk_bf16_f32 v37, v74, v75
  v_cvt_pk_bf16_f32 v38, v76, v77
  v_cvt_pk_bf16_f32 v39, v78, v79
  v_lshlrev_b32 v64, 16, v32
  v_and_b32 v65, 0xffff0000, v32
  v_lshlrev_b32 v66, 16, v33
  v_and_b32 v67, 0xffff0000, v33
  v_lshlrev_b32 v68, 16, v34
  v_and_b32 v69, 0xffff0000, v34
  v_lshlrev_b32 v70, 16, v35
  v_and_b32 v71, 0xffff0000, v35
  v_lshlrev_b32 v72, 16, v36
  v_and_b32 v73, 0xffff0000, v36
  v_lshlrev_b32 v74, 16, v37
  v_and_b32 v75, 0xffff0000, v37
  v_lshlrev_b32 v76, 16, v38
  v_and_b32 v77, 0xffff0000, v38
  v_lshlrev_b32 v78, 16, v39
  v_and_b32 v79, 0xffff0000, v39
  v_mul_f32 v80, v64, v64
  v_mul_f32 v81, v65, v65
  v_mul_f32 v82, v66, v66
  v_mul_f32 v83, v67, v67
  v_mul_f32 v84, v68, v68
  v_mul_f32 v85, v69, v69
  v_mul_f32 v86, v70, v70
  v_mul_f32 v87, v71, v71
  v_mov_b32 v56, s24
  v_fmac_f32 v56, s27, v80
  v_mov_b32 v57, s24
  v_fmac_f32 v57, s27, v81
  v_mov_b32 v58, s24
  v_fmac_f32 v58, s27, v82
  v_mov_b32 v59, s24
  v_fmac_f32 v59, s27, v83
  v_mov_b32 v60, s24
  v_fmac_f32 v60, s27, v84
  v_mov_b32 v61, s24
  v_fmac_f32 v61, s27, v85
  v_mov_b32 v62, s24
  v_fmac_f32 v62, s27, v86
  v_mov_b32 v63, s24
  v_fmac_f32 v63, s27, v87
  v_mul_f32 v80, v56, v64
  v_mul_f32 v81, v57, v65
  v_mul_f32 v82, v58, v66
  v_mul_f32 v83, v59, v67
  v_mul_f32 v84, v60, v68
  v_mul_f32 v85, v61, v69
  v_mul_f32 v86, v62, v70
  v_mul_f32 v87, v63, v71
  v_exp_f32 v80, v80
  v_exp_f32 v81, v81
  v_exp_f32 v82, v82
  v_exp_f32 v83, v83
  v_exp_f32 v84, v84
  v_exp_f32 v85, v85
  v_exp_f32 v86, v86
  v_exp_f32 v87, v87
  v_add_f32 v80, 1.0, v80
  v_add_f32 v81, 1.0, v81
  v_add_f32 v82, 1.0, v82
  v_add_f32 v83, 1.0, v83
  v_add_f32 v84, 1.0, v84
  v_add_f32 v85, 1.0, v85
  v_add_f32 v86, 1.0, v86
  v_add_f32 v87, 1.0, v87
  v_rcp_f32 v80, v80
  v_rcp_f32 v81, v81
  v_rcp_f32 v82, v82
  v_rcp_f32 v83, v83
  v_rcp_f32 v84, v84
  v_rcp_f32 v85, v85
  v_rcp_f32 v86, v86
  v_rcp_f32 v87, v87
  v_mul_f32 v64, v64, v80
  v_mul_f32 v65, v65, v81
  v_mul_f32 v66, v66, v82
  v_mul_f32 v67, v67, v83
  v_mul_f32 v68, v68, v84
  v_mul_f32 v69, v69, v85
  v_mul_f32 v70, v70, v86
  v_mul_f32 v71, v71, v87
  v_mul_f32 v88, v72, v72
  v_mul_f32 v89, v73, v73
  v_mul_f32 v90, v74, v74
  v_mul_f32 v91, v75, v75
  v_mul_f32 v92, v76, v76
  v_mul_f32 v93, v77, v77
  v_mul_f32 v94, v78, v78
  v_mul_f32 v95, v79, v79
  v_mov_b32 v56, s24
  v_fmac_f32 v56, s27, v88
  v_mov_b32 v57, s24
  v_fmac_f32 v57, s27, v89
  v_mov_b32 v58, s24
  v_fmac_f32 v58, s27, v90
  v_mov_b32 v59, s24
  v_fmac_f32 v59, s27, v91
  v_mov_b32 v60, s24
  v_fmac_f32 v60, s27, v92
  v_mov_b32 v61, s24
  v_fmac_f32 v61, s27, v93
  v_mov_b32 v62, s24
  v_fmac_f32 v62, s27, v94
  v_mov_b32 v63, s24
  v_fmac_f32 v63, s27, v95
  v_mul_f32 v88, v56, v72
  v_mul_f32 v89, v57, v73
  v_mul_f32 v90, v58, v74
  v_mul_f32 v91, v59, v75
  v_mul_f32 v92, v60, v76
  v_mul_f32 v93, v61, v77
  v_mul_f32 v94, v62, v78
  v_mul_f32 v95, v63, v79
  v_exp_f32 v88, v88
  v_exp_f32 v89, v89
  v_exp_f32 v90, v90
  v_exp_f32 v91, v91
  v_exp_f32 v92, v92
  v_exp_f32 v93, v93
  v_exp_f32 v94, v94
  v_exp_f32 v95, v95
  v_add_f32 v88, 1.0, v88
  v_add_f32 v89, 1.0, v89
  v_add_f32 v90, 1.0, v90
  v_add_f32 v91, 1.0, v91
  v_add_f32 v92, 1.0, v92
  v_add_f32 v93, 1.0, v93
  v_add_f32 v94, 1.0, v94
  v_add_f32 v95, 1.0, v95
  v_rcp_f32 v88, v88
  v_rcp_f32 v89, v89
  v_rcp_f32 v90, v90
  v_rcp_f32 v91, v91
  v_rcp_f32 v92, v92
  v_rcp_f32 v93, v93
  v_rcp_f32 v94, v94
  v_rcp_f32 v95, v95
  v_mul_f32 v72, v72, v88
  v_mul_f32 v73, v73, v89
  v_mul_f32 v74, v74, v90
  v_mul_f32 v75, v75, v91
  v_mul_f32 v76, v76, v92
  v_mul_f32 v77, v77, v93
  v_mul_f32 v78, v78, v94
  v_mul_f32 v79, v79, v95
  v_cvt_pk_bf16_f32 v32, v64, v65
  v_cvt_pk_bf16_f32 v33, v66, v67
  v_cvt_pk_bf16_f32 v34, v68, v69
  v_cvt_pk_bf16_f32 v35, v70, v71
  v_cvt_pk_bf16_f32 v36, v72, v73
  v_cvt_pk_bf16_f32 v37, v74, v75
  v_cvt_pk_bf16_f32 v38, v76, v77
  v_cvt_pk_bf16_f32 v39, v78, v79
  s_add_u32 s26, s26, 4096
  buffer_store_dwordx4 v[32:35], v2, s[4:7], s26 offen offset:0 sc1
  buffer_store_dwordx4 v[36:39], v2, s[4:7], s26 offen offset:1024 sc1
  s_mul_i32 s24, s23, 18
  s_add_u32 s24, s24, s22
  s_lshl_b32 s24, s24, 7
  s_add_u32 s24, s24, 3825664
  s_waitcnt vmcnt(0)
  s_barrier
  s_cmp_eq_u32 s17, 0
  s_cbranch_scc0 Lsf_69
  v_mov_b32 v4, 1
  buffer_store_dword v4, off, s[4:7], s24 sc1
Lsf_69:
  s_branch mk_g21
mk_g2p1:
  s_mul_i32 s22, s35, 6554
  s_lshr_b32 s22, s22, 16
  s_mul_i32 s24, s22, 10
  s_sub_u32 s23, s35, s24
  v_lshlrev_b32 v5, 2, v1
  s_mul_i32 s24, s22, 442368
  s_add_u32 s24, s24, s29
  s_add_u32 s72, s24, 8388608
  s_add_u32 s73, s24, 8499200
  s_add_u32 s74, s24, 8609792
  s_add_u32 s75, s24, 8720384
  s_mul_i32 s78, s22, 21846
  s_lshr_b32 s78, s78, 16
  s_mul_i32 s78, s78, 3
  s_sub_u32 s78, s22, s78
  s_mul_i32 s78, s78, 36864
  s_mov_b32 s79, s78
  s_lshl_b32 s25, s17, 15
  s_add_u32 s24, s72, s78
  buffer_load_dwordx4 v[96:99], v2, s[4:7], s24 offen sc1
  s_add_u32 s24, s73, s78
  buffer_load_dwordx4 v[100:103], v2, s[4:7], s24 offen sc1
  s_add_u32 s24, s74, s78
  buffer_load_dwordx4 v[104:107], v2, s[4:7], s24 offen sc1
  s_add_u32 s24, s75, s78
  buffer_load_dwordx4 v[108:111], v2, s[4:7], s24 offen sc1
  s_add_u32 s78, s78, 4096
  s_cmp_eq_u32 s78, 110592
  s_cselect_b32 s78, 0, s78
  s_add_u32 s24, s72, s78
  buffer_load_dwordx4 v[112:115], v2, s[4:7], s24 offen sc1
  s_add_u32 s24, s73, s78
  buffer_load_dwordx4 v[116:119], v2, s[4:7], s24 offen sc1
  s_add_u32 s24, s74, s78
  buffer_load_dwordx4 v[120:123], v2, s[4:7], s24 offen sc1
  s_add_u32 s24, s75, s78
  buffer_load_dwordx4 v[124:127], v2, s[4:7], s24 offen sc1
  s_add_u32 s78, s78, 4096
  s_cmp_eq_u32 s78, 110592
  s_cselect_b32 s78, 0, s78
  s_add_u32 s24, s72, s78
  buffer_load_dwordx4 v[128:131], v2, s[4:7], s24 offen sc1
  s_add_u32 s24, s73, s78
  buffer_load_dwordx4 v[132:135], v2, s[4:7], s24 offen sc1
  s_add_u32 s24, s74, s78
  buffer_load_dwordx4 v[136:139], v2, s[4:7], s24 offen sc1
  s_add_u32 s24, s75, s78
  buffer_load_dwordx4 v[140:143], v2, s[4:7], s24 offen sc1
  s_add_u32 s78, s78, 4096
  s_cmp_eq_u32 s78, 110592
  s_cselect_b32 s78, 0, s78
  s_add_u32 s24, s72, s78
  buffer_load_dwordx4 v[144:147], v2, s[4:7], s24 offen sc1
  s_add_u32 s24, s73, s78
  buffer_load_dwordx4 v[148:151], v2, s[4:7], s24 offen sc1
  s_add_u32 s24, s74, s78
  buffer_load_dwordx4 v[152:155], v2, s[4:7], s24 offen sc1
  s_add_u32 s24, s75, s78
  buffer_load_dwordx4 v[156:159], v2, s[4:7], s24 offen sc1
  s_add_u32 s78, s78, 4096
  s_cmp_eq_u32 s78, 110592
  s_cselect_b32 s78, 0, s78
  s_add_u32 s24, s72, s78
  buffer_load_dwordx4 v[160:163], v2, s[4:7], s24 offen sc1
  s_add_u32 s24, s73, s78
  buffer_load_dwordx4 v[164:167], v2, s[4:7], s24 offen sc1
  s_add_u32 s24, s74, s78
  buffer_load_dwordx4 v[168:171], v2, s[4:7], s24 offen sc1
  s_add_u32 s24, s75, s78
  buffer_load_dwordx4 v[172:175], v2, s[4:7], s24 offen sc1
  s_add_u32 s78, s78, 4096
  s_cmp_eq_u32 s78, 110592
  s_cselect_b32 s78, 0, s78
  s_add_u32 s24, s72, s78
  buffer_load_dwordx4 v[176:179], v2, s[4:7], s24 offen sc1
  s_add_u32 s24, s73, s78
  buffer_load_dwordx4 v[180:183], v2, s[4:7], s24 offen sc1
  s_add_u32 s24, s74, s78
  buffer_load_dwordx4 v[184:187], v2, s[4:7], s24 offen sc1
  s_add_u32 s24, s75, s78
  buffer_load_dwordx4 v[188:191], v2, s[4:7], s24 offen sc1
  s_add_u32 s78, s78, 4096
  s_cmp_eq_u32 s78, 110592
  s_cselect_b32 s78, 0, s78
  s_add_u32 s24, s72, s78
  buffer_load_dwordx4 v[192:195], v2, s[4:7], s24 offen sc1
  s_add_u32 s24, s73, s78
  buffer_load_dwordx4 v[196:199], v2, s[4:7], s24 offen sc1
  s_add_u32 s24, s74, s78
  buffer_load_dwordx4 v[200:203], v2, s[4:7], s24 offen sc1
  s_add_u32 s24, s75, s78
  buffer_load_dwordx4 v[204:207], v2, s[4:7], s24 offen sc1
  s_add_u32 s78, s78, 4096
  s_cmp_eq_u32 s78, 110592
  s_cselect_b32 s78, 0, s78
  s_add_u32 s24, s72, s78
  buffer_load_dwordx4 v[208:211], v2, s[4:7], s24 offen sc1
  s_add_u32 s24, s73, s78
  buffer_load_dwordx4 v[212:215], v2, s[4:7], s24 offen sc1
  s_add_u32 s24, s74, s78
  buffer_load_dwordx4 v[216:219], v2, s[4:7], s24 offen sc1
  s_add_u32 s24, s75, s78
  buffer_load_dwordx4 v[220:223], v2, s[4:7], s24 offen sc1
  s_add_u32 s78, s78, 4096
  s_cmp_eq_u32 s78, 110592
  s_cselect_b32 s78, 0, s78
  s_add_u32 s24, s72, s78
  buffer_load_dwordx4 v[224:227], v2, s[4:7], s24 offen sc1
  s_add_u32 s24, s73, s78
  buffer_load_dwordx4 v[228:231], v2, s[4:7], s24 offen sc1
  s_add_u32 s24, s74, s78
  buffer_load_dwordx4 v[232:235], v2, s[4:7], s24 offen sc1
  s_add_u32 s24, s75, s78
  buffer_load_dwordx4 v[236:239], v2, s[4:7], s24 offen sc1
  s_add_u32 s78, s78, 4096
  s_cmp_eq_u32 s78, 110592
  s_cselect_b32 s78, 0, s78
  s_add_u32 s24, s72, s78
  buffer_load_dwordx4 v[240:243], v2, s[4:7], s24 offen sc1
  s_add_u32 s24, s73, s78
  buffer_load_dwordx4 v[244:247], v2, s[4:7], s24 offen sc1
  s_add_u32 s24, s74, s78
  buffer_load_dwordx4 v[248:251], v2, s[4:7], s24 offen sc1
  s_add_u32 s24, s75, s78
  buffer_load_dwordx4 v[252:255], v2, s[4:7], s24 offen sc1
  s_add_u32 s78, s78, 4096
  s_cmp_eq_u32 s78, 110592
  s_cselect_b32 s78, 0, s78
  s_add_u32 s24, s72, s78
  buffer_load_dwordx4 a[128:131], v2, s[4:7], s24 offen sc1
  s_add_u32 s24, s73, s78
  buffer_load_dwordx4 a[132:135], v2, s[4:7], s24 offen sc1
  s_add_u32 s24, s74, s78
  buffer_load_dwordx4 a[136:139], v2, s[4:7], s24 offen sc1
  s_add_u32 s24, s75, s78
  buffer_load_dwordx4 a[140:143], v2, s[4:7], s24 offen sc1
  s_add_u32 s78, s78, 4096
  s_cmp_eq_u32 s78, 110592
  s_cselect_b32 s78, 0, s78
  s_add_u32 s24, s72, s78
  buffer_load_dwordx4 a[144:147], v2, s[4:7], s24 offen sc1
  s_add_u32 s24, s73, s78
  buffer_load_dwordx4 a[148:151], v2, s[4:7], s24 offen sc1
  s_add_u32 s24, s74, s78
  buffer_load_dwordx4 a[152:155], v2, s[4:7], s24 offen sc1
  s_add_u32 s24, s75, s78
  buffer_load_dwordx4 a[156:159], v2, s[4:7], s24 offen sc1
  s_add_u32 s78, s78, 4096
  s_cmp_eq_u32 s78, 110592
  s_cselect_b32 s78, 0, s78
  s_waitcnt vmcnt(24)
  s_add_u32 s24, s72, s78
  buffer_load_dwordx4 a[160:163], v2, s[4:7], s24 offen sc1
  s_add_u32 s24, s73, s78
  buffer_load_dwordx4 a[164:167], v2, s[4:7], s24 offen sc1
  s_add_u32 s24, s74, s78
  buffer_load_dwordx4 a[168:171], v2, s[4:7], s24 offen sc1
  s_add_u32 s24, s75, s78
  buffer_load_dwordx4 a[172:175], v2, s[4:7], s24 offen sc1
  s_add_u32 s78, s78, 4096
  s_cmp_eq_u32 s78, 110592
  s_cselect_b32 s78, 0, s78
  s_add_u32 s24, s72, s78
  buffer_load_dwordx4 a[176:179], v2, s[4:7], s24 offen sc1
  s_add_u32 s24, s73, s78
  buffer_load_dwordx4 a[180:183], v2, s[4:7], s24 offen sc1
  s_add_u32 s24, s74, s78
  buffer_load_dwordx4 a[184:187], v2, s[4:7], s24 offen sc1
  s_add_u32 s24, s75, s78
  buffer_load_dwordx4 a[188:191], v2, s[4:7], s24 offen sc1
  s_add_u32 s78, s78, 4096
  s_cmp_eq_u32 s78, 110592
  s_cselect_b32 s78, 0, s78
  s_add_u32 s24, s72, s78
  buffer_load_dwordx4 a[192:195], v2, s[4:7], s24 offen sc1
  s_add_u32 s24, s73, s78
  buffer_load_dwordx4 a[196:199], v2, s[4:7], s24 offen sc1
  s_add_u32 s24, s74, s78
  buffer_load_dwordx4 a[200:203], v2, s[4:7], s24 offen sc1
  s_add_u32 s24, s75, s78
  buffer_load_dwordx4 a[204:207], v2, s[4:7], s24 offen sc1
  s_add_u32 s78, s78, 4096
  s_cmp_eq_u32 s78, 110592
  s_cselect_b32 s78, 0, s78
  s_add_u32 s24, s72, s78
  buffer_load_dwordx4 a[208:211], v2, s[4:7], s24 offen sc1
  s_add_u32 s24, s73, s78
  buffer_load_dwordx4 a[212:215], v2, s[4:7], s24 offen sc1
  s_add_u32 s24, s74, s78
  buffer_load_dwordx4 a[216:219], v2, s[4:7], s24 offen sc1
  s_add_u32 s24, s75, s78
  buffer_load_dwordx4 a[220:223], v2, s[4:7], s24 offen sc1
  s_add_u32 s78, s78, 4096
  s_cmp_eq_u32 s78, 110592
  s_cselect_b32 s78, 0, s78
  s_add_u32 s24, s72, s78
  buffer_load_dwordx4 a[224:227], v2, s[4:7], s24 offen sc1
  s_add_u32 s24, s73, s78
  buffer_load_dwordx4 a[228:231], v2, s[4:7], s24 offen sc1
  s_add_u32 s24, s74, s78
  buffer_load_dwordx4 a[232:235], v2, s[4:7], s24 offen sc1
  s_add_u32 s24, s75, s78
  buffer_load_dwordx4 a[236:239], v2, s[4:7], s24 offen sc1
  s_add_u32 s78, s78, 4096
  s_cmp_eq_u32 s78, 110592
  s_cselect_b32 s78, 0, s78
  s_add_u32 s24, s72, s78
  buffer_load_dwordx4 a[240:243], v2, s[4:7], s24 offen sc1
  s_add_u32 s24, s73, s78
  buffer_load_dwordx4 a[244:247], v2, s[4:7], s24 offen sc1
  s_add_u32 s24, s74, s78
  buffer_load_dwordx4 a[248:251], v2, s[4:7], s24 offen sc1
  s_add_u32 s24, s75, s78
  buffer_load_dwordx4 a[252:255], v2, s[4:7], s24 offen sc1
  s_add_u32 s78, s78, 4096
  s_cmp_eq_u32 s78, 110592
  s_cselect_b32 s78, 0, s78
  s_add_u32 s24, s72, s78
  s_add_u32 m0, s25, 24576
  s_nop 0
  buffer_load_dwordx4 v2, s[4:7], s24 offen sc1 lds
  s_add_u32 s24, s73, s78
  s_add_u32 m0, s25, 25600
  s_nop 0
  buffer_load_dwordx4 v2, s[4:7], s24 offen sc1 lds
  s_add_u32 s24, s74, s78
  s_add_u32 m0, s25, 26624
  s_nop 0
  buffer_load_dwordx4 v2, s[4:7], s24 offen sc1 lds
  s_add_u32 s24, s75, s78
  s_add_u32 m0, s25, 27648
  s_nop 0
  buffer_load_dwordx4 v2, s[4:7], s24 offen sc1 lds
  s_add_u32 s78, s78, 4096
  s_cmp_eq_u32 s78, 110592
  s_cselect_b32 s78, 0, s78
  s_add_u32 s24, s72, s78
  s_add_u32 m0, s25, 28672
  s_nop 0
  buffer_load_dwordx4 v2, s[4:7], s24 offen sc1 lds
  s_add_u32 s24, s73, s78
  s_add_u32 m0, s25, 29696
  s_nop 0
  buffer_load_dwordx4 v2, s[4:7], s24 offen sc1 lds
  s_add_u32 s24, s74, s78
  s_add_u32 m0, s25, 30720
  s_nop 0
  buffer_load_dwordx4 v2, s[4:7], s24 offen sc1 lds
  s_add_u32 s24, s75, s78
  s_add_u32 m0, s25, 31744
  s_nop 0
  buffer_load_dwordx4 v2, s[4:7], s24 offen sc1 lds
  s_add_u32 s78, s78, 4096
  s_cmp_eq_u32 s78, 110592
  s_cselect_b32 s78, 0, s78
  s_waitcnt vmcnt(24)
  s_add_u32 s24, s72, s78
  s_add_u32 m0, s25, 32768
  s_nop 0
  buffer_load_dwordx4 v2, s[4:7], s24 offen sc1 lds
  s_add_u32 s24, s73, s78
  s_add_u32 m0, s25, 33792
  s_nop 0
  buffer_load_dwordx4 v2, s[4:7], s24 offen sc1 lds
  s_add_u32 s24, s74, s78
  s_add_u32 m0, s25, 34816
  s_nop 0
  buffer_load_dwordx4 v2, s[4:7], s24 offen sc1 lds
  s_add_u32 s24, s75, s78
  s_add_u32 m0, s25, 35840
  s_nop 0
  buffer_load_dwordx4 v2, s[4:7], s24 offen sc1 lds
  s_add_u32 s78, s78, 4096
  s_cmp_eq_u32 s78, 110592
  s_cselect_b32 s78, 0, s78
  s_add_u32 s24, s72, s78
  s_add_u32 m0, s25, 36864
  s_nop 0
  buffer_load_dwordx4 v2, s[4:7], s24 offen sc1 lds
  s_add_u32 s24, s73, s78
  s_add_u32 m0, s25, 37888
  s_nop 0
  buffer_load_dwordx4 v2, s[4:7], s24 offen sc1 lds
  s_add_u32 s24, s74, s78
  s_add_u32 m0, s25, 38912
  s_nop 0
  buffer_load_dwordx4 v2, s[4:7], s24 offen sc1 lds
  s_add_u32 s24, s75, s78
  s_add_u32 m0, s25, 39936
  s_nop 0
  buffer_load_dwordx4 v2, s[4:7], s24 offen sc1 lds
  s_add_u32 s78, s78, 4096
  s_cmp_eq_u32 s78, 110592
  s_cselect_b32 s78, 0, s78
  s_add_u32 s24, s72, s78
  s_add_u32 m0, s25, 40960
  s_nop 0
  buffer_load_dwordx4 v2, s[4:7], s24 offen sc1 lds
  s_add_u32 s24, s73, s78
  s_add_u32 m0, s25, 41984
  s_nop 0
  buffer_load_dwordx4 v2, s[4:7], s24 offen sc1 lds
  s_add_u32 s24, s74, s78
  s_add_u32 m0, s25, 43008
  s_nop 0
  buffer_load_dwordx4 v2, s[4:7], s24 offen sc1 lds
  s_add_u32 s24, s75, s78
  s_add_u32 m0, s25, 44032
  s_nop 0
  buffer_load_dwordx4 v2, s[4:7], s24 offen sc1 lds
  s_add_u32 s78, s78, 4096
  s_cmp_eq_u32 s78, 110592
  s_cselect_b32 s78, 0, s78
  s_add_u32 s24, s72, s78
  s_add_u32 m0, s25, 45056
  s_nop 0
  buffer_load_dwordx4 v2, s[4:7], s24 offen sc1 lds
  s_add_u32 s24, s73, s78
  s_add_u32 m0, s25, 46080
  s_nop 0
  buffer_load_dwordx4 v2, s[4:7], s24 offen sc1 lds
  s_add_u32 s24, s74, s78
  s_add_u32 m0, s25, 47104
  s_nop 0
  buffer_load_dwordx4 v2, s[4:7], s24 offen sc1 lds
  s_add_u32 s24, s75, s78
  s_add_u32 m0, s25, 48128
  s_nop 0
  buffer_load_dwordx4 v2, s[4:7], s24 offen sc1 lds
  s_add_u32 s78, s78, 4096
  s_cmp_eq_u32 s78, 110592
  s_cselect_b32 s78, 0, s78
  s_add_u32 s24, s72, s78
  s_add_u32 m0, s25, 49152
  s_nop 0
  buffer_load_dwordx4 v2, s[4:7], s24 offen sc1 lds
  s_add_u32 s24, s73, s78
  s_add_u32 m0, s25, 50176
  s_nop 0
  buffer_load_dwordx4 v2, s[4:7], s24 offen sc1 lds
  s_add_u32 s24, s74, s78
  s_add_u32 m0, s25, 51200
  s_nop 0
  buffer_load_dwordx4 v2, s[4:7], s24 offen sc1 lds
  s_add_u32 s24, s75, s78
  s_add_u32 m0, s25, 52224
  s_nop 0
  buffer_load_dwordx4 v2, s[4:7], s24 offen sc1 lds
  s_add_u32 s78, s78, 4096
  s_cmp_eq_u32 s78, 110592
  s_cselect_b32 s78, 0, s78
  s_add_u32 s24, s72, s78
  s_add_u32 m0, s25, 53248
  s_nop 0
  buffer_load_dwordx4 v2, s[4:7], s24 offen sc1 lds
  s_add_u32 s24, s73, s78
  s_add_u32 m0, s25, 54272
  s_nop 0
  buffer_load_dwordx4 v2, s[4:7], s24 offen sc1 lds
  s_add_u32 s24, s74, s78
  s_add_u32 m0, s25, 55296
  s_nop 0
  buffer_load_dwordx4 v2, s[4:7], s24 offen sc1 lds
  s_add_u32 s24, s75, s78
  s_add_u32 m0, s25, 56320
  s_nop 0
  buffer_load_dwordx4 v2, s[4:7], s24 offen sc1 lds
  s_add_u32 s78, s78, 4096
  s_cmp_eq_u32 s78, 110592
  s_cselect_b32 s78, 0, s78
mk_g21:
  s_mul_i32 s22, s35, 6554
  s_lshr_b32 s22, s22, 16
  s_mul_i32 s24, s22, 10
  s_sub_u32 s23, s35, s24
  s_mov_b32 s52, s46
  s_and_b32 s53, s47, 0xffff
  s_mov_b32 s54, 4096
  s_mov_b32 s55, 0x00020000
  s_mul_i32 s24, s23, 221184
  s_add_u32 s24, s24, s29
  s_add_u32 s76, s24, 202375168
  s_add_u32 s77, s24, 202485760
  v_and_b32 v3, 31, v1
  v_lshrrev_b32 v4, 5, v1
  v_and_b32 v6, 3, v1
  v_bfe_u32 v10, v1, 3, 2
  v_lshl_add_u32 v6, v10, 2, v6
  v_bfe_u32 v10, v1, 2, 1
  v_lshl_add_u32 v6, v10, 4, v6
  s_lshl_b32 s24, s22, 2
  s_add_u32 s24, s24, s17
  s_lshl_b32 s25, s24, 5
  v_add_u32 v6, s25, v6
  s_movk_i32 s25, 1280
  v_mul_lo_u32 v7, v6, s25
  v_lshl_add_u32 v7, v4, 5, v7
  s_lshl_b32 s25, s23, 7
  v_add_u32 v7, s25, v7
  v_lshlrev_b32 v9, 10, v4
  v_lshl_add_u32 v9, v3, 4, v9
  s_mul_i32 s26, s24, 40960
  s_lshl_b32 s25, s23, 12
  s_add_u32 s26, s26, s25
  s_add_u32 s26, s26, 205520896
  v_lshlrev_b32 v3, 1, v6
  v_accvgpr_write_b32 a0, 0
  v_accvgpr_write_b32 a1, 0
  v_accvgpr_write_b32 a2, 0
  v_accvgpr_write_b32 a3, 0
  v_accvgpr_write_b32 a4, 0
  v_accvgpr_write_b32 a5, 0
  v_accvgpr_write_b32 a6, 0
  v_accvgpr_write_b32 a7, 0
  v_accvgpr_write_b32 a8, 0
  v_accvgpr_write_b32 a9, 0
  v_accvgpr_write_b32 a10, 0
  v_accvgpr_write_b32 a11, 0
  v_accvgpr_write_b32 a12, 0
  v_accvgpr_write_b32 a13, 0
  v_accvgpr_write_b32 a14, 0
  v_accvgpr_write_b32 a15, 0
  v_accvgpr_write_b32 a16, 0
  v_accvgpr_write_b32 a17, 0
  v_accvgpr_write_b32 a18, 0
  v_accvgpr_write_b32 a19, 0
  v_accvgpr_write_b32 a20, 0
  v_accvgpr_write_b32 a21, 0
  v_accvgpr_write_b32 a22, 0
  v_accvgpr_write_b32 a23, 0
  v_accvgpr_write_b32 a24, 0
  v_accvgpr_write_b32 a25, 0
  v_accvgpr_write_b32 a26, 0
  v_accvgpr_write_b32 a27, 0
  v_accvgpr_write_b32 a28, 0
  v_accvgpr_write_b32 a29, 0
  v_accvgpr_write_b32 a30, 0
  v_accvgpr_write_b32 a31, 0
  v_accvgpr_write_b32 a32, 0
  v_accvgpr_write_b32 a33, 0
  v_accvgpr_write_b32 a34, 0
  v_accvgpr_write_b32 a35, 0
  v_accvgpr_write_b32 a36, 0
  v_accvgpr_write_b32 a37, 0
  v_accvgpr_write_b32 a38, 0
  v_accvgpr_write_b32 a39, 0
  v_accvgpr_write_b32 a40, 0
  v_accvgpr_write_b32 a41, 0
  v_accvgpr_write_b32 a42, 0
  v_accvgpr_write_b32 a43, 0
  v_accvgpr_write_b32 a44, 0
  v_accvgpr_write_b32 a45, 0
  v_accvgpr_write_b32 a46, 0
  v_accvgpr_write_b32 a47, 0
  v_accvgpr_write_b32 a48, 0
  v_accvgpr_write_b32 a49, 0
  v_accvgpr_write_b32 a50, 0
  v_accvgpr_write_b32 a51, 0
  v_accvgpr_write_b32 a52, 0
  v_accvgpr_write_b32 a53, 0
  v_accvgpr_write_b32 a54, 0
  v_accvgpr_write_b32 a55, 0
  v_accvgpr_write_b32 a56, 0
  v_accvgpr_write_b32 a57, 0
  v_accvgpr_write_b32 a58, 0
  v_accvgpr_write_b32 a59, 0
  v_accvgpr_write_b32 a60, 0
  v_accvgpr_write_b32 a61, 0
  v_accvgpr_write_b32 a62, 0
  v_accvgpr_write_b32 a63, 0
  v_accvgpr_write_b32 a64, 0
  v_accvgpr_write_b32 a65, 0
  v_accvgpr_write_b32 a66, 0
  v_accvgpr_write_b32 a67, 0
  v_accvgpr_write_b32 a68, 0
  v_accvgpr_write_b32 a69, 0
  v_accvgpr_write_b32 a70, 0
  v_accvgpr_write_b32 a71, 0
  v_accvgpr_write_b32 a72, 0
  v_accvgpr_write_b32 a73, 0
  v_accvgpr_write_b32 a74, 0
  v_accvgpr_write_b32 a75, 0
  v_accvgpr_write_b32 a76, 0
  v_accvgpr_write_b32 a77, 0
  v_accvgpr_write_b32 a78, 0
  v_accvgpr_write_b32 a79, 0
  v_accvgpr_write_b32 a80, 0
  v_accvgpr_write_b32 a81, 0
  v_accvgpr_write_b32 a82, 0
  v_accvgpr_write_b32 a83, 0
  v_accvgpr_write_b32 a84, 0
  v_accvgpr_write_b32 a85, 0
  v_accvgpr_write_b32 a86, 0
  v_accvgpr_write_b32 a87, 0
  v_accvgpr_write_b32 a88, 0
  v_accvgpr_write_b32 a89, 0
  v_accvgpr_write_b32 a90, 0
  v_accvgpr_write_b32 a91, 0
  v_accvgpr_write_b32 a92, 0
  v_accvgpr_write_b32 a93, 0
  v_accvgpr_write_b32 a94, 0
  v_accvgpr_write_b32 a95, 0
  v_accvgpr_write_b32 a96, 0
  v_accvgpr_write_b32 a97, 0
  v_accvgpr_write_b32 a98, 0
  v_accvgpr_write_b32 a99, 0
  v_accvgpr_write_b32 a100, 0
  v_accvgpr_write_b32 a101, 0
  v_accvgpr_write_b32 a102, 0
  v_accvgpr_write_b32 a103, 0
  v_accvgpr_write_b32 a104, 0
  v_accvgpr_write_b32 a105, 0
  v_accvgpr_write_b32 a106, 0
  v_accvgpr_write_b32 a107, 0
  v_accvgpr_write_b32 a108, 0
  v_accvgpr_write_b32 a109, 0
  v_accvgpr_write_b32 a110, 0
  v_accvgpr_write_b32 a111, 0
  v_accvgpr_write_b32 a112, 0
  v_accvgpr_write_b32 a113, 0
  v_accvgpr_write_b32 a114, 0
  v_accvgpr_write_b32 a115, 0
  v_accvgpr_write_b32 a116, 0
  v_accvgpr_write_b32 a117, 0
  v_accvgpr_write_b32 a118, 0
  v_accvgpr_write_b32 a119, 0
  v_accvgpr_write_b32 a120, 0
  v_accvgpr_write_b32 a121, 0
  v_accvgpr_write_b32 a122, 0
  v_accvgpr_write_b32 a123, 0
  v_accvgpr_write_b32 a124, 0
  v_accvgpr_write_b32 a125, 0
  v_accvgpr_write_b32 a126, 0
  v_accvgpr_write_b32 a127, 0
  buffer_load_ushort v8, v3, s[52:55], 0 offen
  s_lshr_b32 s31, s23, 1
  s_mul_i32 s31, s31, 2304
  s_add_u32 s31, s31, 3825664
  v_lshlrev_b32 v5, 7, v1
  s_cmp_lg_u32 s17, 0
  s_cbranch_scc1 Lww_70_ok
Lww_70:
  buffer_load_dword v12, v5, s[4:7], s31 offen sc1
  s_waitcnt vmcnt(0)
  v_cmp_eq_u32 vcc, 0, v12
  s_add_u32 s0, s0, 1
  s_and_b32 s25, vcc_lo, 262143
  s_cbranch_scc0 Lww_70_ok
  s_sleep 2
  s_cmp_lt_u32 s0, 1572864
  s_cbranch_scc1 Lww_70
Lww_70_ok:
  s_barrier
  s_waitcnt vmcnt(0)
  s_add_u32 s24, s76, s79
  buffer_load_dwordx4 v[24:27], v2, s[4:7], s24 offen sc1
  s_add_u32 s24, s77, s79
  buffer_load_dwordx4 v[28:31], v2, s[4:7], s24 offen sc1
  s_add_u32 s79, s79, 4096
  s_cmp_eq_u32 s79, 110592
  s_cselect_b32 s79, 0, s79
  s_add_u32 s24, s76, s79
  buffer_load_dwordx4 v[32:35], v2, s[4:7], s24 offen sc1
  s_add_u32 s24, s77, s79
  buffer_load_dwordx4 v[36:39], v2, s[4:7], s24 offen sc1
  s_add_u32 s79, s79, 4096
  s_cmp_eq_u32 s79, 110592
  s_cselect_b32 s79, 0, s79
  s_add_u32 s24, s76, s79
  buffer_load_dwordx4 v[40:43], v2, s[4:7], s24 offen sc1
  s_add_u32 s24, s77, s79
  buffer_load_dwordx4 v[44:47], v2, s[4:7], s24 offen sc1
  s_add_u32 s79, s79, 4096
  s_cmp_eq_u32 s79, 110592
  s_cselect_b32 s79, 0, s79
  s_add_u32 s24, s76, s79
  buffer_load_dwordx4 v[48:51], v2, s[4:7], s24 offen sc1
  s_add_u32 s24, s77, s79
  buffer_load_dwordx4 v[52:55], v2, s[4:7], s24 offen sc1
  s_add_u32 s79, s79, 4096
  s_cmp_eq_u32 s79, 110592
  s_cselect_b32 s79, 0, s79
  s_add_u32 s24, s76, s79
  buffer_load_dwordx4 v[56:59], v2, s[4:7], s24 offen sc1
  s_add_u32 s24, s77, s79
  buffer_load_dwordx4 v[60:63], v2, s[4:7], s24 offen sc1
  s_add_u32 s79, s79, 4096
  s_cmp_eq_u32 s79, 110592
  s_cselect_b32 s79, 0, s79
  s_add_u32 s24, s76, s79
  buffer_load_dwordx4 v[64:67], v2, s[4:7], s24 offen sc1
  s_add_u32 s24, s77, s79
  buffer_load_dwordx4 v[68:71], v2, s[4:7], s24 offen sc1
  s_add_u32 s79, s79, 4096
  s_cmp_eq_u32 s79, 110592
  s_cselect_b32 s79, 0, s79
  s_add_u32 s24, s76, s79
  buffer_load_dwordx4 v[72:75], v2, s[4:7], s24 offen sc1
  s_add_u32 s24, s77, s79
  buffer_load_dwordx4 v[76:79], v2, s[4:7], s24 offen sc1
  s_add_u32 s79, s79, 4096
  s_cmp_eq_u32 s79, 110592
  s_cselect_b32 s79, 0, s79
  s_add_u32 s24, s76, s79
  buffer_load_dwordx4 v[80:83], v2, s[4:7], s24 offen sc1
  s_add_u32 s24, s77, s79
  buffer_load_dwordx4 v[84:87], v2, s[4:7], s24 offen sc1
  s_add_u32 s79, s79, 4096
  s_cmp_eq_u32 s79, 110592
  s_cselect_b32 s79, 0, s79
  s_add_u32 s24, s76, s79
  buffer_load_dwordx4 v[88:91], v2, s[4:7], s24 offen sc1
  s_add_u32 s24, s77, s79
  buffer_load_dwordx4 v[92:95], v2, s[4:7], s24 offen sc1
  s_add_u32 s79, s79, 4096
  s_cmp_eq_u32 s79, 110592
  s_cselect_b32 s79, 0, s79
  s_lshl_b32 s25, s17, 15
  s_add_u32 s25, s25, 24576
  v_add_u32 v10, s25, v2
  s_waitcnt vmcnt(16)
  v_mfma_f32_32x32x16_bf16 a[0:15], v[24:27], v[96:99], a[0:15]
  v_mfma_f32_32x32x16_bf16 a[16:31], v[28:31], v[96:99], a[16:31]
  v_mfma_f32_32x32x16_bf16 a[32:47], v[24:27], v[100:103], a[32:47]
  v_mfma_f32_32x32x16_bf16 a[48:63], v[28:31], v[100:103], a[48:63]
  v_mfma_f32_32x32x16_bf16 a[64:79], v[24:27], v[104:107], a[64:79]
  v_mfma_f32_32x32x16_bf16 a[80:95], v[28:31], v[104:107], a[80:95]
  v_mfma_f32_32x32x16_bf16 a[96:111], v[24:27], v[108:111], a[96:111]
  v_mfma_f32_32x32x16_bf16 a[112:127], v[28:31], v[108:111], a[112:127]
  s_add_u32 s24, s76, s79
  buffer_load_dwordx4 v[96:99], v2, s[4:7], s24 offen sc1
  s_add_u32 s24, s77, s79
  buffer_load_dwordx4 v[100:103], v2, s[4:7], s24 offen sc1
  s_add_u32 s79, s79, 4096
  s_cmp_eq_u32 s79, 110592
  s_cselect_b32 s79, 0, s79
  s_add_u32 s24, s76, s79
  buffer_load_dwordx4 v[104:107], v2, s[4:7], s24 offen sc1
  s_add_u32 s24, s77, s79
  buffer_load_dwordx4 v[108:111], v2, s[4:7], s24 offen sc1
  s_add_u32 s79, s79, 4096
  s_cmp_eq_u32 s79, 110592
  s_cselect_b32 s79, 0, s79
  s_add_u32 s24, s76, s79
  buffer_load_dwordx4 v[24:27], v2, s[4:7], s24 offen sc1
  s_add_u32 s24, s77, s79
  buffer_load_dwordx4 v[28:31], v2, s[4:7], s24 offen sc1
  s_add_u32 s79, s79, 4096
  s_cmp_eq_u32 s79, 110592
  s_cselect_b32 s79, 0, s79
  s_waitcnt vmcnt(20)
  v_mfma_f32_32x32x16_bf16 a[0:15], v[32:35], v[112:115], a[0:15]
  v_mfma_f32_32x32x16_bf16 a[16:31], v[36:39], v[112:115], a[16:31]
  v_mfma_f32_32x32x16_bf16 a[32:47], v[32:35], v[116:119], a[32:47]
  v_mfma_f32_32x32x16_bf16 a[48:63], v[36:39], v[116:119], a[48:63]
  v_mfma_f32_32x32x16_bf16 a[64:79], v[32:35], v[120:123], a[64:79]
  v_mfma_f32_32x32x16_bf16 a[80:95], v[36:39], v[120:123], a[80:95]
  v_mfma_f32_32x32x16_bf16 a[96:111], v[32:35], v[124:127], a[96:111]
  v_mfma_f32_32x32x16_bf16 a[112:127], v[36:39], v[124:127], a[112:127]
  s_add_u32 s24, s76, s79
  buffer_load_dwordx4 v[112:115], v2, s[4:7], s24 offen sc1
  s_add_u32 s24, s77, s79
  buffer_load_dwordx4 v[116:119], v2, s[4:7], s24 offen sc1
  s_add_u32 s79, s79, 4096
  s_cmp_eq_u32 s79, 110592
  s_cselect_b32 s79, 0, s79
  s_add_u32 s24, s76, s79
  buffer_load_dwordx4 v[120:123], v2, s[4:7], s24 offen sc1
  s_add_u32 s24, s77, s79
  buffer_load_dwordx4 v[124:127], v2, s[4:7], s24 offen sc1
  s_add_u32 s79, s79, 4096
  s_cmp_eq_u32 s79, 110592
  s_cselect_b32 s79, 0, s79
  s_add_u32 s24, s76, s79
  buffer_load_dwordx4 v[32:35], v2, s[4:7], s24 offen sc1
  s_add_u32 s24, s77, s79
  buffer_load_dwordx4 v[36:39], v2, s[4:7], s24 offen sc1
  s_add_u32 s79, s79, 4096
  s_cmp_eq_u32 s79, 110592
  s_cselect_b32 s79, 0, s79
  s_waitcnt vmcnt(24)
  v_mfma_f32_32x32x16_bf16 a[0:15], v[40:43], v[128:131], a[0:15]
  v_mfma_f32_32x32x16_bf16 a[16:31], v[44:47], v[128:131], a[16:31]
  v_mfma_f32_32x32x16_bf16 a[32:47], v[40:43], v[132:135], a[32:47]
  v_mfma_f32_32x32x16_bf16 a[48:63], v[44:47], v[132:135], a[48:63]
  v_mfma_f32_32x32x16_bf16 a[64:79], v[40:43], v[136:139], a[64:79]
  v_mfma_f32_32x32x16_bf16 a[80:95], v[44:47], v[136:139], a[80:95]
  v_mfma_f32_32x32x16_bf16 a[96:111], v[40:43], v[140:143], a[96:111]
  v_mfma_f32_32x32x16_bf16 a[112:127], v[44:47], v[140:143], a[112:127]
  s_add_u32 s24, s76, s79
  buffer_load_dwordx4 v[128:131], v2, s[4:7], s24 offen sc1
  s_add_u32 s24, s77, s79
  buffer_load_dwordx4 v[132:135], v2, s[4:7], s24 offen sc1
  s_add_u32 s79, s79, 4096
  s_cmp_eq_u32 s79, 110592
  s_cselect_b32 s79, 0, s79
  s_add_u32 s24, s76, s79
  buffer_load_dwordx4 v[136:139], v2, s[4:7], s24 offen sc1
  s_add_u32 s24, s77, s79
  buffer_load_dwordx4 v[140:143], v2, s[4:7], s24 offen sc1
  s_add_u32 s79, s79, 4096
  s_cmp_eq_u32 s79, 110592
  s_cselect_b32 s79, 0, s79
  s_add_u32 s24, s76, s79
  buffer_load_dwordx4 v[40:43], v2, s[4:7], s24 offen sc1
  s_add_u32 s24, s77, s79
  buffer_load_dwordx4 v[44:47], v2, s[4:7], s24 offen sc1
  s_add_u32 s79, s79, 4096
  s_cmp_eq_u32 s79, 110592
  s_cselect_b32 s79, 0, s79
  s_waitcnt vmcnt(28)
  v_mfma_f32_32x32x16_bf16 a[0:15], v[48:51], v[144:147], a[0:15]
  v_mfma_f32_32x32x16_bf16 a[16:31], v[52:55], v[144:147], a[16:31]
  v_mfma_f32_32x32x16_bf16 a[32:47], v[48:51], v[148:151], a[32:47]
  v_mfma_f32_32x32x16_bf16 a[48:63], v[52:55], v[148:151], a[48:63]
  v_mfma_f32_32x32x16_bf16 a[64:79], v[48:51], v[152:155], a[64:79]
  v_mfma_f32_32x32x16_bf16 a[80:95], v[52:55], v[152:155], a[80:95]
  v_mfma_f32_32x32x16_bf16 a[96:111], v[48:51], v[156:159], a[96:111]
  v_mfma_f32_32x32x16_bf16 a[112:127], v[52:55], v[156:159], a[112:127]
  s_add_u32 s24, s76, s79
  buffer_load_dwordx4 v[144:147], v2, s[4:7], s24 offen sc1
  s_add_u32 s24, s77, s79
  buffer_load_dwordx4 v[148:151], v2, s[4:7], s24 offen sc1
  s_add_u32 s79, s79, 4096
  s_cmp_eq_u32 s79, 110592
  s_cselect_b32 s79, 0, s79
  s_add_u32 s24, s76, s79
  buffer_load_dwordx4 v[152:155], v2, s[4:7], s24 offen sc1
  s_add_u32 s24, s77, s79
  buffer_load_dwordx4 v[156:159], v2, s[4:7], s24 offen sc1
  s_add_u32 s79, s79, 4096
  s_cmp_eq_u32 s79, 110592
  s_cselect_b32 s79, 0, s79
  s_add_u32 s24, s76, s79
  buffer_load_dwordx4 v[48:51], v2, s[4:7], s24 offen sc1
  s_add_u32 s24, s77, s79
  buffer_load_dwordx4 v[52:55], v2, s[4:7], s24 offen sc1
  s_add_u32 s79, s79, 4096
  s_cmp_eq_u32 s79, 110592
  s_cselect_b32 s79, 0, s79
  s_waitcnt vmcnt(32)
  v_mfma_f32_32x32x16_bf16 a[0:15], v[56:59], v[160:163], a[0:15]
  v_mfma_f32_32x32x16_bf16 a[16:31], v[60:63], v[160:163], a[16:31]
  v_mfma_f32_32x32x16_bf16 a[32:47], v[56:59], v[164:167], a[32:47]
  v_mfma_f32_32x32x16_bf16 a[48:63], v[60:63], v[164:167], a[48:63]
  v_mfma_f32_32x32x16_bf16 a[64:79], v[56:59], v[168:171], a[64:79]
  v_mfma_f32_32x32x16_bf16 a[80:95], v[60:63], v[168:171], a[80:95]
  v_mfma_f32_32x32x16_bf16 a[96:111], v[56:59], v[172:175], a[96:111]
  v_mfma_f32_32x32x16_bf16 a[112:127], v[60:63], v[172:175], a[112:127]
  s_add_u32 s24, s76, s79
  buffer_load_dwordx4 v[160:163], v2, s[4:7], s24 offen sc1
  s_add_u32 s24, s77, s79
  buffer_load_dwordx4 v[164:167], v2, s[4:7], s24 offen sc1
  s_add_u32 s79, s79, 4096
  s_cmp_eq_u32 s79, 110592
  s_cselect_b32 s79, 0, s79
  s_add_u32 s24, s76, s79
  buffer_load_dwordx4 v[168:171], v2, s[4:7], s24 offen sc1
  s_add_u32 s24, s77, s79
  buffer_load_dwordx4 v[172:175], v2, s[4:7], s24 offen sc1
  s_add_u32 s79, s79, 4096
  s_cmp_eq_u32 s79, 110592
  s_cselect_b32 s79, 0, s79
  s_add_u32 s24, s76, s79
  buffer_load_dwordx4 v[56:59], v2, s[4:7], s24 offen sc1
  s_add_u32 s24, s77, s79
  buffer_load_dwordx4 v[60:63], v2, s[4:7], s24 offen sc1
  s_add_u32 s79, s79, 4096
  s_cmp_eq_u32 s79, 110592
  s_cselect_b32 s79, 0, s79
  s_waitcnt vmcnt(36)
  v_mfma_f32_32x32x16_bf16 a[0:15], v[64:67], v[176:179], a[0:15]
  v_mfma_f32_32x32x16_bf16 a[16:31], v[68:71], v[176:179], a[16:31]
  v_mfma_f32_32x32x16_bf16 a[32:47], v[64:67], v[180:183], a[32:47]
  v_mfma_f32_32x32x16_bf16 a[48:63], v[68:71], v[180:183], a[48:63]
  v_mfma_f32_32x32x16_bf16 a[64:79], v[64:67], v[184:187], a[64:79]
  v_mfma_f32_32x32x16_bf16 a[80:95], v[68:71], v[184:187], a[80:95]
  v_mfma_f32_32x32x16_bf16 a[96:111], v[64:67], v[188:191], a[96:111]
  v_mfma_f32_32x32x16_bf16 a[112:127], v[68:71], v[188:191], a[112:127]
  s_add_u32 s24, s76, s79
  buffer_load_dwordx4 v[176:179], v2, s[4:7], s24 offen sc1
  s_add_u32 s24, s77, s79
  buffer_load_dwordx4 v[180:183], v2, s[4:7], s24 offen sc1
  s_add_u32 s79, s79, 4096
  s_cmp_eq_u32 s79, 110592
  s_cselect_b32 s79, 0, s79
  s_add_u32 s24, s76, s79
  buffer_load_dwordx4 v[184:187], v2, s[4:7], s24 offen sc1
  s_add_u32 s24, s77, s79
  buffer_load_dwordx4 v[188:191], v2, s[4:7], s24 offen sc1
  s_add_u32 s79, s79, 4096
  s_cmp_eq_u32 s79, 110592
  s_cselect_b32 s79, 0, s79
  s_add_u32 s24, s76, s79
  buffer_load_dwordx4 v[64:67], v2, s[4:7], s24 offen sc1
  s_add_u32 s24, s77, s79
  buffer_load_dwordx4 v[68:71], v2, s[4:7], s24 offen sc1
  s_add_u32 s79, s79, 4096
  s_cmp_eq_u32 s79, 110592
  s_cselect_b32 s79, 0, s79
  s_waitcnt vmcnt(40)
  v_mfma_f32_32x32x16_bf16 a[0:15], v[72:75], v[192:195], a[0:15]
  v_mfma_f32_32x32x16_bf16 a[16:31], v[76:79], v[192:195], a[16:31]
  v_mfma_f32_32x32x16_bf16 a[32:47], v[72:75], v[196:199], a[32:47]
  v_mfma_f32_32x32x16_bf16 a[48:63], v[76:79], v[196:199], a[48:63]
  v_mfma_f32_32x32x16_bf16 a[64:79], v[72:75], v[200:203], a[64:79]
  v_mfma_f32_32x32x16_bf16 a[80:95], v[76:79], v[200:203], a[80:95]
  v_mfma_f32_32x32x16_bf16 a[96:111], v[72:75], v[204:207], a[96:111]
  v_mfma_f32_32x32x16_bf16 a[112:127], v[76:79], v[204:207], a[112:127]
  s_waitcnt vmcnt(38)
  v_mfma_f32_32x32x16_bf16 a[0:15], v[80:83], v[208:211], a[0:15]
  v_mfma_f32_32x32x16_bf16 a[16:31], v[84:87], v[208:211], a[16:31]
  v_mfma_f32_32x32x16_bf16 a[32:47], v[80:83], v[212:215], a[32:47]
  v_mfma_f32_32x32x16_bf16 a[48:63], v[84:87], v[212:215], a[48:63]
  v_mfma_f32_32x32x16_bf16 a[64:79], v[80:83], v[216:219], a[64:79]
  v_mfma_f32_32x32x16_bf16 a[80:95], v[84:87], v[216:219], a[80:95]
  v_mfma_f32_32x32x16_bf16 a[96:111], v[80:83], v[220:223], a[96:111]
  v_mfma_f32_32x32x16_bf16 a[112:127], v[84:87], v[220:223], a[112:127]
  s_waitcnt vmcnt(36)
  v_mfma_f32_32x32x16_bf16 a[0:15], v[88:91], v[224:227], a[0:15]
  v_mfma_f32_32x32x16_bf16 a[16:31], v[92:95], v[224:227], a[16:31]
  v_mfma_f32_32x32x16_bf16 a[32:47], v[88:91], v[228:231], a[32:47]
  v_mfma_f32_32x32x16_bf16 a[48:63], v[92:95], v[228:231], a[48:63]
  v_mfma_f32_32x32x16_bf16 a[64:79], v[88:91], v[232:235], a[64:79]
  v_mfma_f32_32x32x16_bf16 a[80:95], v[92:95], v[232:235], a[80:95]
  v_mfma_f32_32x32x16_bf16 a[96:111], v[88:91], v[236:239], a[96:111]
  v_mfma_f32_32x32x16_bf16 a[112:127], v[92:95], v[236:239], a[112:127]
  s_add_u32 s24, s72, s78
  buffer_load_dwordx4 v[224:227], v2, s[4:7], s24 offen sc1
  s_add_u32 s24, s73, s78
  buffer_load_dwordx4 v[228:231], v2, s[4:7], s24 offen sc1
  s_add_u32 s24, s74, s78
  buffer_load_dwordx4 v[232:235], v2, s[4:7], s24 offen sc1
  s_add_u32 s24, s75, s78
  buffer_load_dwordx4 v[236:239], v2, s[4:7], s24 offen sc1
  s_add_u32 s78, s78, 4096
  s_cmp_eq_u32 s78, 110592
  s_cselect_b32 s78, 0, s78
  s_waitcnt vmcnt(38)
  v_mfma_f32_32x32x16_bf16 a[0:15], v[96:99], v[240:243], a[0:15]
  v_mfma_f32_32x32x16_bf16 a[16:31], v[100:103], v[240:243], a[16:31]
  v_mfma_f32_32x32x16_bf16 a[32:47], v[96:99], v[244:247], a[32:47]
  v_mfma_f32_32x32x16_bf16 a[48:63], v[100:103], v[244:247], a[48:63]
  v_mfma_f32_32x32x16_bf16 a[64:79], v[96:99], v[248:251], a[64:79]
  v_mfma_f32_32x32x16_bf16 a[80:95], v[100:103], v[248:251], a[80:95]
  v_mfma_f32_32x32x16_bf16 a[96:111], v[96:99], v[252:255], a[96:111]
  v_mfma_f32_32x32x16_bf16 a[112:127], v[100:103], v[252:255], a[112:127]
  s_mov_b32 s25, 196083712
  buffer_load_dwordx4 v[240:243], v7, s[4:7], s25 offen offset:0 sc1
  buffer_load_dwordx4 v[244:247], v7, s[4:7], s25 offen offset:16 sc1
  buffer_load_dwordx4 v[248:251], v7, s[4:7], s25 offen offset:64 sc1
  buffer_load_dwordx4 v[252:255], v7, s[4:7], s25 offen offset:80 sc1
  s_waitcnt vmcnt(40)
  v_mfma_f32_32x32x16_bf16 a[0:15], v[104:107], a[128:131], a[0:15]
  v_mfma_f32_32x32x16_bf16 a[16:31], v[108:111], a[128:131], a[16:31]
  v_mfma_f32_32x32x16_bf16 a[32:47], v[104:107], a[132:135], a[32:47]
  v_mfma_f32_32x32x16_bf16 a[48:63], v[108:111], a[132:135], a[48:63]
  v_mfma_f32_32x32x16_bf16 a[64:79], v[104:107], a[136:139], a[64:79]
  v_mfma_f32_32x32x16_bf16 a[80:95], v[108:111], a[136:139], a[80:95]
  v_mfma_f32_32x32x16_bf16 a[96:111], v[104:107], a[140:143], a[96:111]
  v_mfma_f32_32x32x16_bf16 a[112:127], v[108:111], a[140:143], a[112:127]
  s_waitcnt vmcnt(38)
  v_mfma_f32_32x32x16_bf16 a[0:15], v[24:27], a[144:147], a[0:15]
  v_mfma_f32_32x32x16_bf16 a[16:31], v[28:31], a[144:147], a[16:31]
  v_mfma_f32_32x32x16_bf16 a[32:47], v[24:27], a[148:151], a[32:47]
  v_mfma_f32_32x32x16_bf16 a[48:63], v[28:31], a[148:151], a[48:63]
  v_mfma_f32_32x32x16_bf16 a[64:79], v[24:27], a[152:155], a[64:79]
  v_mfma_f32_32x32x16_bf16 a[80:95], v[28:31], a[152:155], a[80:95]
  v_mfma_f32_32x32x16_bf16 a[96:111], v[24:27], a[156:159], a[96:111]
  v_mfma_f32_32x32x16_bf16 a[112:127], v[28:31], a[156:159], a[112:127]
  s_waitcnt vmcnt(36)
  v_mfma_f32_32x32x16_bf16 a[0:15], v[112:115], a[160:163], a[0:15]
  v_mfma_f32_32x32x16_bf16 a[16:31], v[116:119], a[160:163], a[16:31]
  v_mfma_f32_32x32x16_bf16 a[32:47], v[112:115], a[164:167], a[32:47]
  v_mfma_f32_32x32x16_bf16 a[48:63], v[116:119], a[164:167], a[48:63]
  v_mfma_f32_32x32x16_bf16 a[64:79], v[112:115], a[168:171], a[64:79]
  v_mfma_f32_32x32x16_bf16 a[80:95], v[116:119], a[168:171], a[80:95]
  v_mfma_f32_32x32x16_bf16 a[96:111], v[112:115], a[172:175], a[96:111]
  v_mfma_f32_32x32x16_bf16 a[112:127], v[116:119], a[172:175], a[112:127]
  s_waitcnt vmcnt(34)
  v_mfma_f32_32x32x16_bf16 a[0:15], v[120:123], a[176:179], a[0:15]
  v_mfma_f32_32x32x16_bf16 a[16:31], v[124:127], a[176:179], a[16:31]
  v_mfma_f32_32x32x16_bf16 a[32:47], v[120:123], a[180:183], a[32:47]
  v_mfma_f32_32x32x16_bf16 a[48:63], v[124:127], a[180:183], a[48:63]
  v_mfma_f32_32x32x16_bf16 a[64:79], v[120:123], a[184:187], a[64:79]
  v_mfma_f32_32x32x16_bf16 a[80:95], v[124:127], a[184:187], a[80:95]
  v_mfma_f32_32x32x16_bf16 a[96:111], v[120:123], a[188:191], a[96:111]
  v_mfma_f32_32x32x16_bf16 a[112:127], v[124:127], a[188:191], a[112:127]
  s_waitcnt vmcnt(32)
  v_mfma_f32_32x32x16_bf16 a[0:15], v[32:35], a[192:195], a[0:15]
  v_mfma_f32_32x32x16_bf16 a[16:31], v[36:39], a[192:195], a[16:31]
  v_mfma_f32_32x32x16_bf16 a[32:47], v[32:35], a[196:199], a[32:47]
  v_mfma_f32_32x32x16_bf16 a[48:63], v[36:39], a[196:199], a[48:63]
  v_mfma_f32_32x32x16_bf16 a[64:79], v[32:35], a[200:203], a[64:79]
  v_mfma_f32_32x32x16_bf16 a[80:95], v[36:39], a[200:203], a[80:95]
  v_mfma_f32_32x32x16_bf16 a[96:111], v[32:35], a[204:207], a[96:111]
  v_mfma_f32_32x32x16_bf16 a[112:127], v[36:39], a[204:207], a[112:127]
  s_waitcnt vmcnt(30)
  v_mfma_f32_32x32x16_bf16 a[0:15], v[128:131], a[208:211], a[0:15]
  v_mfma_f32_32x32x16_bf16 a[16:31], v[132:135], a[208:211], a[16:31]
  v_mfma_f32_32x32x16_bf16 a[32:47], v[128:131], a[212:215], a[32:47]
  v_mfma_f32_32x32x16_bf16 a[48:63], v[132:135], a[212:215], a[48:63]
  v_mfma_f32_32x32x16_bf16 a[64:79], v[128:131], a[216:219], a[64:79]
  v_mfma_f32_32x32x16_bf16 a[80:95], v[132:135], a[216:219], a[80:95]
  v_mfma_f32_32x32x16_bf16 a[96:111], v[128:131], a[220:223], a[96:111]
  v_mfma_f32_32x32x16_bf16 a[112:127], v[132:135], a[220:223], a[112:127]
  ds_read_b128 v[192:195], v10 offset:0
  ds_read_b128 v[196:199], v10 offset:1024
  ds_read_b128 v[200:203], v10 offset:2048
  ds_read_b128 v[204:207], v10 offset:3072
  ds_read_b128 v[208:211], v10 offset:4096
  ds_read_b128 v[212:215], v10 offset:5120
  ds_read_b128 v[216:219], v10 offset:6144
  ds_read_b128 v[220:223], v10 offset:7168
  s_waitcnt vmcnt(28)
  v_mfma_f32_32x32x16_bf16 a[0:15], v[136:139], a[224:227], a[0:15]
  v_mfma_f32_32x32x16_bf16 a[16:31], v[140:143], a[224:227], a[16:31]
  v_mfma_f32_32x32x16_bf16 a[32:47], v[136:139], a[228:231], a[32:47]
  v_mfma_f32_32x32x16_bf16 a[48:63], v[140:143], a[228:231], a[48:63]
  v_mfma_f32_32x32x16_bf16 a[64:79], v[136:139], a[232:235], a[64:79]
  v_mfma_f32_32x32x16_bf16 a[80:95], v[140:143], a[232:235], a[80:95]
  v_mfma_f32_32x32x16_bf16 a[96:111], v[136:139], a[236:239], a[96:111]
  v_mfma_f32_32x32x16_bf16 a[112:127], v[140:143], a[236:239], a[112:127]
  s_waitcnt vmcnt(26)
  v_mfma_f32_32x32x16_bf16 a[0:15], v[40:43], a[240:243], a[0:15]
  v_mfma_f32_32x32x16_bf16 a[16:31], v[44:47], a[240:243], a[16:31]
  v_mfma_f32_32x32x16_bf16 a[32:47], v[40:43], a[244:247], a[32:47]
  v_mfma_f32_32x32x16_bf16 a[48:63], v[44:47], a[244:247], a[48:63]
  v_mfma_f32_32x32x16_bf16 a[64:79], v[40:43], a[248:251], a[64:79]
  v_mfma_f32_32x32x16_bf16 a[80:95], v[44:47], a[248:251], a[80:95]
  v_mfma_f32_32x32x16_bf16 a[96:111], v[40:43], a[252:255], a[96:111]
  v_mfma_f32_32x32x16_bf16 a[112:127], v[44:47], a[252:255], a[112:127]
  s_waitcnt vmcnt(24)
  s_waitcnt lgkmcnt(4)
  v_mfma_f32_32x32x16_bf16 a[0:15], v[144:147], v[192:195], a[0:15]
  v_mfma_f32_32x32x16_bf16 a[16:31], v[148:151], v[192:195], a[16:31]
  v_mfma_f32_32x32x16_bf16 a[32:47], v[144:147], v[196:199], a[32:47]
  v_mfma_f32_32x32x16_bf16 a[48:63], v[148:151], v[196:199], a[48:63]
  v_mfma_f32_32x32x16_bf16 a[64:79], v[144:147], v[200:203], a[64:79]
  v_mfma_f32_32x32x16_bf16 a[80:95], v[148:151], v[200:203], a[80:95]
  v_mfma_f32_32x32x16_bf16 a[96:111], v[144:147], v[204:207], a[96:111]
  v_mfma_f32_32x32x16_bf16 a[112:127], v[148:151], v[204:207], a[112:127]
  ds_read_b128 v[192:195], v10 offset:8192
  ds_read_b128 v[196:199], v10 offset:9216
  ds_read_b128 v[200:203], v10 offset:10240
  ds_read_b128 v[204:207], v10 offset:11264
  s_waitcnt vmcnt(22)
  s_waitcnt lgkmcnt(4)
  v_mfma_f32_32x32x16_bf16 a[0:15], v[152:155], v[208:211], a[0:15]
  v_mfma_f32_32x32x16_bf16 a[16:31], v[156:159], v[208:211], a[16:31]
  v_mfma_f32_32x32x16_bf16 a[32:47], v[152:155], v[212:215], a[32:47]
  v_mfma_f32_32x32x16_bf16 a[48:63], v[156:159], v[212:215], a[48:63]
  v_mfma_f32_32x32x16_bf16 a[64:79], v[152:155], v[216:219], a[64:79]
  v_mfma_f32_32x32x16_bf16 a[80:95], v[156:159], v[216:219], a[80:95]
  v_mfma_f32_32x32x16_bf16 a[96:111], v[152:155], v[220:223], a[96:111]
  v_mfma_f32_32x32x16_bf16 a[112:127], v[156:159], v[220:223], a[112:127]
  ds_read_b128 v[208:211], v10 offset:12288
  ds_read_b128 v[212:215], v10 offset:13312
  ds_read_b128 v[216:219], v10 offset:14336
  ds_read_b128 v[220:223], v10 offset:15360
  s_waitcnt vmcnt(20)
  s_waitcnt lgkmcnt(4)
  v_mfma_f32_32x32x16_bf16 a[0:15], v[48:51], v[192:195], a[0:15]
  v_mfma_f32_32x32x16_bf16 a[16:31], v[52:55], v[192:195], a[16:31]
  v_mfma_f32_32x32x16_bf16 a[32:47], v[48:51], v[196:199], a[32:47]
  v_mfma_f32_32x32x16_bf16 a[48:63], v[52:55], v[196:199], a[48:63]
  v_mfma_f32_32x32x16_bf16 a[64:79], v[48:51], v[200:203], a[64:79]
  v_mfma_f32_32x32x16_bf16 a[80:95], v[52:55], v[200:203], a[80:95]
  v_mfma_f32_32x32x16_bf16 a[96:111], v[48:51], v[204:207], a[96:111]
  v_mfma_f32_32x32x16_bf16 a[112:127], v[52:55], v[204:207], a[112:127]
  ds_read_b128 v[192:195], v10 offset:16384
  ds_read_b128 v[196:199], v10 offset:17408
  ds_read_b128 v[200:203], v10 offset:18432
  ds_read_b128 v[204:207], v10 offset:19456
  s_waitcnt vmcnt(18)
  s_waitcnt lgkmcnt(4)
  v_mfma_f32_32x32x16_bf16 a[0:15], v[160:163], v[208:211], a[0:15]
  v_mfma_f32_32x32x16_bf16 a[16:31], v[164:167], v[208:211], a[16:31]
  v_mfma_f32_32x32x16_bf16 a[32:47], v[160:163], v[212:215], a[32:47]
  v_mfma_f32_32x32x16_bf16 a[48:63], v[164:167], v[212:215], a[48:63]
  v_mfma_f32_32x32x16_bf16 a[64:79], v[160:163], v[216:219], a[64:79]
  v_mfma_f32_32x32x16_bf16 a[80:95], v[164:167], v[216:219], a[80:95]
  v_mfma_f32_32x32x16_bf16 a[96:111], v[160:163], v[220:223], a[96:111]
  v_mfma_f32_32x32x16_bf16 a[112:127], v[164:167], v[220:223], a[112:127]
  ds_read_b128 v[208:211], v10 offset:20480
  ds_read_b128 v[212:215], v10 offset:21504
  ds_read_b128 v[216:219], v10 offset:22528
  ds_read_b128 v[220:223], v10 offset:23552
  s_waitcnt vmcnt(16)
  s_waitcnt lgkmcnt(4)
  v_mfma_f32_32x32x16_bf16 a[0:15], v[168:171], v[192:195], a[0:15]
  v_mfma_f32_32x32x16_bf16 a[16:31], v[172:175], v[192:195], a[16:31]
  v_mfma_f32_32x32x16_bf16 a[32:47], v[168:171], v[196:199], a[32:47]
  v_mfma_f32_32x32x16_bf16 a[48:63], v[172:175], v[196:199], a[48:63]
  v_mfma_f32_32x32x16_bf16 a[64:79], v[168:171], v[200:203], a[64:79]
  v_mfma_f32_32x32x16_bf16 a[80:95], v[172:175], v[200:203], a[80:95]
  v_mfma_f32_32x32x16_bf16 a[96:111], v[168:171], v[204:207], a[96:111]
  v_mfma_f32_32x32x16_bf16 a[112:127], v[172:175], v[204:207], a[112:127]
  ds_read_b128 v[192:195], v10 offset:24576
  ds_read_b128 v[196:199], v10 offset:25600
  ds_read_b128 v[200:203], v10 offset:26624
  ds_read_b128 v[204:207], v10 offset:27648
  s_waitcnt vmcnt(14)
  s_waitcnt lgkmcnt(4)
  v_mfma_f32_32x32x16_bf16 a[0:15], v[56:59], v[208:211], a[0:15]
  v_mfma_f32_32x32x16_bf16 a[16:31], v[60:63], v[208:211], a[16:31]
  v_mfma_f32_32x32x16_bf16 a[32:47], v[56:59], v[212:215], a[32:47]
  v_mfma_f32_32x32x16_bf16 a[48:63], v[60:63], v[212:215], a[48:63]
  v_mfma_f32_32x32x16_bf16 a[64:79], v[56:59], v[216:219], a[64:79]
  v_mfma_f32_32x32x16_bf16 a[80:95], v[60:63], v[216:219], a[80:95]
  v_mfma_f32_32x32x16_bf16 a[96:111], v[56:59], v[220:223], a[96:111]
  v_mfma_f32_32x32x16_bf16 a[112:127], v[60:63], v[220:223], a[112:127]
  ds_read_b128 v[208:211], v10 offset:28672
  ds_read_b128 v[212:215], v10 offset:29696
  ds_read_b128 v[216:219], v10 offset:30720
  ds_read_b128 v[220:223], v10 offset:31744
  s_waitcnt vmcnt(12)
  s_waitcnt lgkmcnt(4)
  v_mfma_f32_32x32x16_bf16 a[0:15], v[176:179], v[192:195], a[0:15]
  v_mfma_f32_32x32x16_bf16 a[16:31], v[180:183], v[192:195], a[16:31]
  v_mfma_f32_32x32x16_bf16 a[32:47], v[176:179], v[196:199], a[32:47]
  v_mfma_f32_32x32x16_bf16 a[48:63], v[180:183], v[196:199], a[48:63]
  v_mfma_f32_32x32x16_bf16 a[64:79], v[176:179], v[200:203], a[64:79]
  v_mfma_f32_32x32x16_bf16 a[80:95], v[180:183], v[200:203], a[80:95]
  v_mfma_f32_32x32x16_bf16 a[96:111], v[176:179], v[204:207], a[96:111]
  v_mfma_f32_32x32x16_bf16 a[112:127], v[180:183], v[204:207], a[112:127]
  s_waitcnt vmcnt(10)
  s_waitcnt lgkmcnt(0)
  v_mfma_f32_32x32x16_bf16 a[0:15], v[184:187], v[208:211], a[0:15]
  v_mfma_f32_32x32x16_bf16 a[16:31], v[188:191], v[208:211], a[16:31]
  v_mfma_f32_32x32x16_bf16 a[32:47], v[184:187], v[212:215], a[32:47]
  v_mfma_f32_32x32x16_bf16 a[48:63], v[188:191], v[212:215], a[48:63]
  v_mfma_f32_32x32x16_bf16 a[64:79], v[184:187], v[216:219], a[64:79]
  v_mfma_f32_32x32x16_bf16 a[80:95], v[188:191], v[216:219], a[80:95]
  v_mfma_f32_32x32x16_bf16 a[96:111], v[184:187], v[220:223], a[96:111]
  v_mfma_f32_32x32x16_bf16 a[112:127], v[188:191], v[220:223], a[112:127]
  s_waitcnt vmcnt(4)
  v_mfma_f32_32x32x16_bf16 a[0:15], v[64:67], v[224:227], a[0:15]
  v_mfma_f32_32x32x16_bf16 a[16:31], v[68:71], v[224:227], a[16:31]
  v_mfma_f32_32x32x16_bf16 a[32:47], v[64:67], v[228:231], a[32:47]
  v_mfma_f32_32x32x16_bf16 a[48:63], v[68:71], v[228:231], a[48:63]
  v_mfma_f32_32x32x16_bf16 a[64:79], v[64:67], v[232:235], a[64:79]
  v_mfma_f32_32x32x16_bf16 a[80:95], v[68:71], v[232:235], a[80:95]
  v_mfma_f32_32x32x16_bf16 a[96:111], v[64:67], v[236:239], a[96:111]
  v_mfma_f32_32x32x16_bf16 a[112:127], v[68:71], v[236:239], a[112:127]
  s_waitcnt vmcnt(0)
  s_barrier
  s_lshl_b32 s24, s17, 12
  v_add_u32 v12, s24, v2
  v_add_u32 v13, 0x10000, v12
  s_lshl_b32 s24, s17, 15
  v_add_u32 v14, s24, v2
  s_nop 7
  ds_write_b128 v12, a[0:3] offset:0
  ds_write_b128 v12, a[4:7] offset:1024
  ds_write_b128 v12, a[8:11] offset:2048
  ds_write_b128 v12, a[12:15] offset:3072
  ds_write_b128 v12, a[16:19] offset:16384
  ds_write_b128 v12, a[20:23] offset:17408
  ds_write_b128 v12, a[24:27] offset:18432
  ds_write_b128 v12, a[28:31] offset:19456
  ds_write_b128 v12, a[32:35] offset:32768
  ds_write_b128 v12, a[36:39] offset:33792
  ds_write_b128 v12, a[40:43] offset:34816
  ds_write_b128 v12, a[44:47] offset:35840
  ds_write_b128 v12, a[48:51] offset:49152
  ds_write_b128 v12, a[52:55] offset:50176
  ds_write_b128 v12, a[56:59] offset:51200
  ds_write_b128 v12, a[60:63] offset:52224
  ds_write_b128 v13, a[64:67] offset:0
  ds_write_b128 v13, a[68:71] offset:1024
  ds_write_b128 v13, a[72:75] offset:2048
  ds_write_b128 v13, a[76:79] offset:3072
  ds_write_b128 v13, a[80:83] offset:16384
  ds_write_b128 v13, a[84:87] offset:17408
  ds_write_b128 v13, a[88:91] offset:18432
  ds_write_b128 v13, a[92:95] offset:19456
  ds_write_b128 v13, a[96:99] offset:32768
  ds_write_b128 v13, a[100:103] offset:33792
  ds_write_b128 v13, a[104:107] offset:34816
  ds_write_b128 v13, a[108:111] offset:35840
  ds_write_b128 v13, a[112:115] offset:49152
  ds_write_b128 v13, a[116:119] offset:50176
  ds_write_b128 v13, a[120:123] offset:51200
  ds_write_b128 v13, a[124:127] offset:52224
  s_waitcnt lgkmcnt(0)
  s_barrier
  ds_read_b128 v[100:103], v14 offset:0
  ds_read_b128 v[104:107], v14 offset:1024
  ds_read_b128 v[108:111], v14 offset:2048
  ds_read_b128 v[112:115], v14 offset:3072
  ds_read_b128 v[116:119], v14 offset:4096
  ds_read_b128 v[120:123], v14 offset:5120
  ds_read_b128 v[124:127], v14 offset:6144
  ds_read_b128 v[128:131], v14 offset:7168
  ds_read_b128 v[132:135], v14 offset:8192
  ds_read_b128 v[136:139], v14 offset:9216
  ds_read_b128 v[140:143], v14 offset:10240
  ds_read_b128 v[144:147], v14 offset:11264
  ds_read_b128 v[148:151], v14 offset:12288
  ds_read_b128 v[152:155], v14 offset:13312
  ds_read_b128 v[156:159], v14 offset:14336
  ds_read_b128 v[160:163], v14 offset:15360
  ds_read_b128 v[164:167], v14 offset:16384
  ds_read_b128 v[168:171], v14 offset:17408
  ds_read_b128 v[172:175], v14 offset:18432
  ds_read_b128 v[176:179], v14 offset:19456
  ds_read_b128 v[180:183], v14 offset:20480
  ds_read_b128 v[184:187], v14 offset:21504
  ds_read_b128 v[188:191], v14 offset:22528
  ds_read_b128 v[192:195], v14 offset:23552
  ds_read_b128 v[196:199], v14 offset:24576
  ds_read_b128 v[200:203], v14 offset:25600
  ds_read_b128 v[204:207], v14 offset:26624
  ds_read_b128 v[208:211], v14 offset:27648
  ds_read_b128 v[212:215], v14 offset:28672
  ds_read_b128 v[216:219], v14 offset:29696
  ds_read_b128 v[220:223], v14 offset:30720
  ds_read_b128 v[224:227], v14 offset:31744
  v_lshlrev_b32 v8, 16, v8
  s_mov_b32 s8, s48
  s_and_b32 s9, s49, 0xffff
  s_mov_b32 s10, 2621440
  s_mov_b32 s11, 0x00020000
  s_waitcnt lgkmcnt(15)
  v_pk_add_f32 v[100:101], v[100:101], v[116:117]
  v_pk_add_f32 v[102:103], v[102:103], v[118:119]
  v_pk_add_f32 v[104:105], v[104:105], v[120:121]
  v_pk_add_f32 v[106:107], v[106:107], v[122:123]
  v_pk_add_f32 v[108:109], v[108:109], v[124:125]
  v_pk_add_f32 v[110:111], v[110:111], v[126:127]
  v_pk_add_f32 v[112:113], v[112:113], v[128:129]
  v_pk_add_f32 v[114:115], v[114:115], v[130:131]
  v_pk_add_f32 v[132:133], v[132:133], v[148:149]
  v_pk_add_f32 v[134:135], v[134:135], v[150:151]
  v_pk_add_f32 v[136:137], v[136:137], v[152:153]
  v_pk_add_f32 v[138:139], v[138:139], v[154:155]
  v_pk_add_f32 v[140:141], v[140:141], v[156:157]
  v_pk_add_f32 v[142:143], v[142:143], v[158:159]
  v_pk_add_f32 v[144:145], v[144:145], v[160:161]
  v_pk_add_f32 v[146:147], v[146:147], v[162:163]
  v_pk_add_f32 v[100:101], v[100:101], v[132:133]
  v_pk_add_f32 v[102:103], v[102:103], v[134:135]
  v_pk_add_f32 v[104:105], v[104:105], v[136:137]
  v_pk_add_f32 v[106:107], v[106:107], v[138:139]
  v_pk_add_f32 v[108:109], v[108:109], v[140:141]
  v_pk_add_f32 v[110:111], v[110:111], v[142:143]
  v_pk_add_f32 v[112:113], v[112:113], v[144:145]
  v_pk_add_f32 v[114:115], v[114:115], v[146:147]
  v_cvt_pk_bf16_f32 v116, v100, v101
  v_cvt_pk_bf16_f32 v117, v102, v103
  v_cvt_pk_bf16_f32 v118, v104, v105
  v_cvt_pk_bf16_f32 v119, v106, v107
  v_cvt_pk_bf16_f32 v120, v108, v109
  v_cvt_pk_bf16_f32 v121, v110, v111
  v_cvt_pk_bf16_f32 v122, v112, v113
  v_cvt_pk_bf16_f32 v123, v114, v115
  v_lshlrev_b32 v100, 16, v116
  v_and_b32 v101, 0xffff0000, v116
  v_lshlrev_b32 v102, 16, v117
  v_and_b32 v103, 0xffff0000, v117
  v_lshlrev_b32 v104, 16, v118
  v_and_b32 v105, 0xffff0000, v118
  v_lshlrev_b32 v106, 16, v119
  v_and_b32 v107, 0xffff0000, v119
  v_lshlrev_b32 v108, 16, v120
  v_and_b32 v109, 0xffff0000, v120
  v_lshlrev_b32 v110, 16, v121
  v_and_b32 v111, 0xffff0000, v121
  v_lshlrev_b32 v112, 16, v122
  v_and_b32 v113, 0xffff0000, v122
  v_lshlrev_b32 v114, 16, v123
  v_and_b32 v115, 0xffff0000, v123
  v_add_f32 v100, v100, v8
  v_add_f32 v101, v101, v8
  v_add_f32 v102, v102, v8
  v_add_f32 v103, v103, v8
  v_add_f32 v104, v104, v8
  v_add_f32 v105, v105, v8
  v_add_f32 v106, v106, v8
  v_add_f32 v107, v107, v8
  v_add_f32 v108, v108, v8
  v_add_f32 v109, v109, v8
  v_add_f32 v110, v110, v8
  v_add_f32 v111, v111, v8
  v_add_f32 v112, v112, v8
  v_add_f32 v113, v113, v8
  v_add_f32 v114, v114, v8
  v_add_f32 v115, v115, v8
  v_cvt_pk_bf16_f32 v116, v100, v101
  v_cvt_pk_bf16_f32 v117, v102, v103
  v_cvt_pk_bf16_f32 v118, v104, v105
  v_cvt_pk_bf16_f32 v119, v106, v107
  v_cvt_pk_bf16_f32 v120, v108, v109
  v_cvt_pk_bf16_f32 v121, v110, v111
  v_cvt_pk_bf16_f32 v122, v112, v113
  v_cvt_pk_bf16_f32 v123, v114, v115
  v_lshlrev_b32 v100, 16, v116
  v_and_b32 v101, 0xffff0000, v116
  v_lshlrev_b32 v102, 16, v117
  v_and_b32 v103, 0xffff0000, v117
  v_lshlrev_b32 v104, 16, v118
  v_and_b32 v105, 0xffff0000, v118
  v_lshlrev_b32 v106, 16, v119
  v_and_b32 v107, 0xffff0000, v119
  v_lshlrev_b32 v108, 16, v120
  v_and_b32 v109, 0xffff0000, v120
  v_lshlrev_b32 v110, 16, v121
  v_and_b32 v111, 0xffff0000, v121
  v_lshlrev_b32 v112, 16, v122
  v_and_b32 v113, 0xffff0000, v122
  v_lshlrev_b32 v114, 16, v123
  v_and_b32 v115, 0xffff0000, v123
  v_lshlrev_b32 v132, 16, v240
  v_and_b32 v133, 0xffff0000, v240
  v_lshlrev_b32 v134, 16, v241
  v_and_b32 v135, 0xffff0000, v241
  v_lshlrev_b32 v136, 16, v242
  v_and_b32 v137, 0xffff0000, v242
  v_lshlrev_b32 v138, 16, v243
  v_and_b32 v139, 0xffff0000, v243
  v_lshlrev_b32 v140, 16, v244
  v_and_b32 v141, 0xffff0000, v244
  v_lshlrev_b32 v142, 16, v245
  v_and_b32 v143, 0xffff0000, v245
  v_lshlrev_b32 v144, 16, v246
  v_and_b32 v145, 0xffff0000, v246
  v_lshlrev_b32 v146, 16, v247
  v_and_b32 v147, 0xffff0000, v247
  v_pk_add_f32 v[100:101], v[100:101], v[132:133]
  v_pk_add_f32 v[102:103], v[102:103], v[134:135]
  v_pk_add_f32 v[104:105], v[104:105], v[136:137]
  v_pk_add_f32 v[106:107], v[106:107], v[138:139]
  v_pk_add_f32 v[108:109], v[108:109], v[140:141]
  v_pk_add_f32 v[110:111], v[110:111], v[142:143]
  v_pk_add_f32 v[112:113], v[112:113], v[144:145]
  v_pk_add_f32 v[114:115], v[114:115], v[146:147]
  v_cvt_pk_bf16_f32 v116, v100, v101
  v_cvt_pk_bf16_f32 v117, v102, v103
  v_cvt_pk_bf16_f32 v118, v104, v105
  v_cvt_pk_bf16_f32 v119, v106, v107
  v_cvt_pk_bf16_f32 v120, v108, v109
  v_cvt_pk_bf16_f32 v121, v110, v111
  v_cvt_pk_bf16_f32 v122, v112, v113
  v_cvt_pk_bf16_f32 v123, v114, v115
  buffer_store_dwordx4 v[116:119], v7, s[8:11], 0 offen offset:0
  buffer_store_dwordx4 v[120:123], v7, s[8:11], 0 offen offset:16
  s_waitcnt lgkmcnt(8)
  v_pk_add_f32 v[164:165], v[164:165], v[180:181]
  v_pk_add_f32 v[166:167], v[166:167], v[182:183]
  v_pk_add_f32 v[168:169], v[168:169], v[184:185]
  v_pk_add_f32 v[170:171], v[170:171], v[186:187]
  v_pk_add_f32 v[172:173], v[172:173], v[188:189]
  v_pk_add_f32 v[174:175], v[174:175], v[190:191]
  v_pk_add_f32 v[176:177], v[176:177], v[192:193]
  v_pk_add_f32 v[178:179], v[178:179], v[194:195]
  s_waitcnt lgkmcnt(0)
  v_pk_add_f32 v[196:197], v[196:197], v[212:213]
  v_pk_add_f32 v[198:199], v[198:199], v[214:215]
  v_pk_add_f32 v[200:201], v[200:201], v[216:217]
  v_pk_add_f32 v[202:203], v[202:203], v[218:219]
  v_pk_add_f32 v[204:205], v[204:205], v[220:221]
  v_pk_add_f32 v[206:207], v[206:207], v[222:223]
  v_pk_add_f32 v[208:209], v[208:209], v[224:225]
  v_pk_add_f32 v[210:211], v[210:211], v[226:227]
  v_pk_add_f32 v[164:165], v[164:165], v[196:197]
  v_pk_add_f32 v[166:167], v[166:167], v[198:199]
  v_pk_add_f32 v[168:169], v[168:169], v[200:201]
  v_pk_add_f32 v[170:171], v[170:171], v[202:203]
  v_pk_add_f32 v[172:173], v[172:173], v[204:205]
  v_pk_add_f32 v[174:175], v[174:175], v[206:207]
  v_pk_add_f32 v[176:177], v[176:177], v[208:209]
  v_pk_add_f32 v[178:179], v[178:179], v[210:211]
  v_cvt_pk_bf16_f32 v180, v164, v165
  v_cvt_pk_bf16_f32 v181, v166, v167
  v_cvt_pk_bf16_f32 v182, v168, v169
  v_cvt_pk_bf16_f32 v183, v170, v171
  v_cvt_pk_bf16_f32 v184, v172, v173
  v_cvt_pk_bf16_f32 v185, v174, v175
  v_cvt_pk_bf16_f32 v186, v176, v177
  v_cvt_pk_bf16_f32 v187, v178, v179
  v_lshlrev_b32 v164, 16, v180
  v_and_b32 v165, 0xffff0000, v180
  v_lshlrev_b32 v166, 16, v181
  v_and_b32 v167, 0xffff0000, v181
  v_lshlrev_b32 v168, 16, v182
  v_and_b32 v169, 0xffff0000, v182
  v_lshlrev_b32 v170, 16, v183
  v_and_b32 v171, 0xffff0000, v183
  v_lshlrev_b32 v172, 16, v184
  v_and_b32 v173, 0xffff0000, v184
  v_lshlrev_b32 v174, 16, v185
  v_and_b32 v175, 0xffff0000, v185
  v_lshlrev_b32 v176, 16, v186
  v_and_b32 v177, 0xffff0000, v186
  v_lshlrev_b32 v178, 16, v187
  v_and_b32 v179, 0xffff0000, v187
  v_add_f32 v164, v164, v8
  v_add_f32 v165, v165, v8
  v_add_f32 v166, v166, v8
  v_add_f32 v167, v167, v8
  v_add_f32 v168, v168, v8
  v_add_f32 v169, v169, v8
  v_add_f32 v170, v170, v8
  v_add_f32 v171, v171, v8
  v_add_f32 v172, v172, v8
  v_add_f32 v173, v173, v8
  v_add_f32 v174, v174, v8
  v_add_f32 v175, v175, v8
  v_add_f32 v176, v176, v8
  v_add_f32 v177, v177, v8
  v_add_f32 v178, v178, v8
  v_add_f32 v179, v179, v8
  v_cvt_pk_bf16_f32 v180, v164, v165
  v_cvt_pk_bf16_f32 v181, v166, v167
  v_cvt_pk_bf16_f32 v182, v168, v169
  v_cvt_pk_bf16_f32 v183, v170, v171
  v_cvt_pk_bf16_f32 v184, v172, v173
  v_cvt_pk_bf16_f32 v185, v174, v175
  v_cvt_pk_bf16_f32 v186, v176, v177
  v_cvt_pk_bf16_f32 v187, v178, v179
  v_lshlrev_b32 v164, 16, v180
  v_and_b32 v165, 0xffff0000, v180
  v_lshlrev_b32 v166, 16, v181
  v_and_b32 v167, 0xffff0000, v181
  v_lshlrev_b32 v168, 16, v182
  v_and_b32 v169, 0xffff0000, v182
  v_lshlrev_b32 v170, 16, v183
  v_and_b32 v171, 0xffff0000, v183
  v_lshlrev_b32 v172, 16, v184
  v_and_b32 v173, 0xffff0000, v184
  v_lshlrev_b32 v174, 16, v185
  v_and_b32 v175, 0xffff0000, v185
  v_lshlrev_b32 v176, 16, v186
  v_and_b32 v177, 0xffff0000, v186
  v_lshlrev_b32 v178, 16, v187
  v_and_b32 v179, 0xffff0000, v187
  v_lshlrev_b32 v196, 16, v248
  v_and_b32 v197, 0xffff0000, v248
  v_lshlrev_b32 v198, 16, v249
  v_and_b32 v199, 0xffff0000, v249
  v_lshlrev_b32 v200, 16, v250
  v_and_b32 v201, 0xffff0000, v250
  v_lshlrev_b32 v202, 16, v251
  v_and_b32 v203, 0xffff0000, v251
  v_lshlrev_b32 v204, 16, v252
  v_and_b32 v205, 0xffff0000, v252
  v_lshlrev_b32 v206, 16, v253
  v_and_b32 v207, 0xffff0000, v253
  v_lshlrev_b32 v208, 16, v254
  v_and_b32 v209, 0xffff0000, v254
  v_lshlrev_b32 v210, 16, v255
  v_and_b32 v211, 0xffff0000, v255
  v_pk_add_f32 v[164:165], v[164:165], v[196:197]
  v_pk_add_f32 v[166:167], v[166:167], v[198:199]
  v_pk_add_f32 v[168:169], v[168:169], v[200:201]
  v_pk_add_f32 v[170:171], v[170:171], v[202:203]
  v_pk_add_f32 v[172:173], v[172:173], v[204:205]
  v_pk_add_f32 v[174:175], v[174:175], v[206:207]
  v_pk_add_f32 v[176:177], v[176:177], v[208:209]
  v_pk_add_f32 v[178:179], v[178:179], v[210:211]
  v_cvt_pk_bf16_f32 v180, v164, v165
  v_cvt_pk_bf16_f32 v181, v166, v167
  v_cvt_pk_bf16_f32 v182, v168, v169
  v_cvt_pk_bf16_f32 v183, v170, v171
  v_cvt_pk_bf16_f32 v184, v172, v173
  v_cvt_pk_bf16_f32 v185, v174, v175
  v_cvt_pk_bf16_f32 v186, v176, v177
  v_cvt_pk_bf16_f32 v187, v178, v179
  buffer_store_dwordx4 v[180:183], v7, s[8:11], 0 offen offset:64
  buffer_store_dwordx4 v[184:187], v7, s[8:11], 0 offen offset:80
  s_endpgm
mk_codeend:
.section .rodata,"a"

.p2align 6
.amdhsa_kernel interleave_layers__memory_aug_recurrent_mem_tr__mixer_token_mlp__prompt_kernel
  .amdhsa_next_free_vgpr 512
  .amdhsa_next_free_sgpr 102
  .amdhsa_accum_offset 256
  .amdhsa_group_segment_fixed_size 0
  .amdhsa_kernarg_size 120
  .amdhsa_user_sgpr_count 2
  .amdhsa_user_sgpr_kernarg_segment_ptr 1
  .amdhsa_system_sgpr_workgroup_id_x 1
.end_amdhsa_kernel
```
